```python
import torch

def _softmax(x, axis=-1):
    return torch.softmax(x, dim=axis)
def _gelu(x):
    return torch.nn.functional.gelu(x, approximate="tanh")
def _silu(x):
    return torch.nn.functional.silu(x)
def _sigmoid(x):
    return torch.sigmoid(x)
def _layernorm(x, axis=-1, eps=1e-5):
    m = x.mean(dim=axis, keepdim=True)
    v = x.var(dim=axis, keepdim=True, unbiased=False)
    return (x - m) / torch.sqrt(v + eps)
def _scatter_add(tgt, idx, src, axis=0):
    return tgt.clone().index_add_(axis, idx, src)
def _segment_sum(src, seg, n):
    out = torch.zeros((n,) + src.shape[1:], dtype=src.dtype)
    return out.index_add_(0, seg, src)
def _pad(x, pw):
    flat = tuple(v for pair in reversed(pw) for v in pair)
    return torch.nn.functional.pad(x, flat)

kernel_name = 'concat_heads__gqa_block_cached__gqa_block_cached__near_ridge'

def setup_inputs():

    _w = (lambda a: (lambda t: t.to(torch.bfloat16) if t.is_floating_point() else t)(torch.as_tensor(a)))
    def _A_setup():
        B, Sq, D = 8, 256, 640
        Hq, Hkv, Sk, Dh = 32, 32, 1024, 192
        assert Hq % Hkv == 0, (Hq, Hkv)
        return {
            "x": _w((lambda *s: torch.randn(*s, dtype=torch.bfloat16) * 0.8)(B, Sq, D)),
            "k_cache": _w((lambda *s: torch.randn(*s, dtype=torch.bfloat16) * 0.8)(B, Hkv, Sk, Dh)),
            "v_cache": _w((lambda *s: torch.randn(*s, dtype=torch.bfloat16) * 0.05)(B, Hkv, Sk, Dh)),
            "wq": _w((lambda *s: torch.randn(*s, dtype=torch.bfloat16) * 0.8)(D, Hq * Dh) * (D ** -0.5)),
            "wo": _w((lambda *s: torch.randn(*s, dtype=torch.bfloat16) * 0.05)(Hq * Dh, D) * ((Hq * Dh) ** -0.5)),
        }
    _A_in = _A_setup()

    def _B_setup():
        B, Sq, D = 8, 256, 640
        Hq, Hkv, Sk, Dh = 32, 32, 1024, 192
        assert Hq % Hkv == 0, (Hq, Hkv)
        return {
            "x": _w((lambda *s: torch.randn(*s, dtype=torch.bfloat16) * 0.8)(B, Sq, D)),
            "k_cache": _w((lambda *s: torch.randn(*s, dtype=torch.bfloat16) * 0.8)(B, Hkv, Sk, Dh)),
            "v_cache": _w((lambda *s: torch.randn(*s, dtype=torch.bfloat16) * 0.05)(B, Hkv, Sk, Dh)),
            "wq": _w((lambda *s: torch.randn(*s, dtype=torch.bfloat16) * 0.8)(D, Hq * Dh) * (D ** -0.5)),
            "wo": _w((lambda *s: torch.randn(*s, dtype=torch.bfloat16) * 0.05)(Hq * Dh, D) * ((Hq * Dh) ** -0.5)),
        }
    _B_in = _B_setup()

    return {
        "A_x": _A_in["x"],
        "A_k_cache": _A_in["k_cache"],
        "A_v_cache": _A_in["v_cache"],
        "A_wq": _A_in["wq"],
        "A_wo": _A_in["wo"],
        "B_x": _B_in["x"],
        "B_k_cache": _B_in["k_cache"],
        "B_v_cache": _B_in["v_cache"],
        "B_wq": _B_in["wq"],
        "B_wo": _B_in["wo"],
    }

def reference(A_x, A_k_cache, A_v_cache, A_wq, A_wo, B_x, B_k_cache, B_v_cache, B_wq, B_wo):
    def _A_ref(x, k_cache, v_cache, wq, wo):
        B, Sq, D = x.shape
        Hq, Dh = 32, 192
        Hkv = k_cache.shape[1]
        rep = Hq // Hkv
        q = (lambda x, *d: x.permute(*d))((x @ wq).reshape(B, Sq, Hq, Dh), 0, 2, 1, 3)
        k = (lambda x, n, axis: torch.repeat_interleave(x, n, dim=axis))(k_cache, rep, axis=1)
        v = (lambda x, n, axis: torch.repeat_interleave(x, n, dim=axis))(v_cache, rep, axis=1)
        scores = torch.einsum("bhqd,bhkd->bhqk", q, k) * (Dh ** -0.5)
        p = _softmax(scores, axis=-1)
        o = torch.einsum("bhqk,bhkd->bhqd", p, v)
        return (lambda x, *d: x.permute(*d))(o, 0, 2, 1, 3).reshape(B, Sq, Hq * Dh) @ wo

    def _B_ref(x, k_cache, v_cache, wq, wo):
        B, Sq, D = x.shape
        Hq, Dh = 32, 192
        Hkv = k_cache.shape[1]
        rep = Hq // Hkv
        q = (lambda x, *d: x.permute(*d))((x @ wq).reshape(B, Sq, Hq, Dh), 0, 2, 1, 3)
        k = (lambda x, n, axis: torch.repeat_interleave(x, n, dim=axis))(k_cache, rep, axis=1)
        v = (lambda x, n, axis: torch.repeat_interleave(x, n, dim=axis))(v_cache, rep, axis=1)
        scores = torch.einsum("bhqd,bhkd->bhqk", q, k) * (Dh ** -0.5)
        p = _softmax(scores, axis=-1)
        o = torch.einsum("bhqk,bhkd->bhqd", p, v)
        return (lambda x, *d: x.permute(*d))(o, 0, 2, 1, 3).reshape(B, Sq, Hq * Dh) @ wo

    a = _A_ref(A_x, A_k_cache, A_v_cache, A_wq, A_wo)
    b = _B_ref(B_x, B_k_cache, B_v_cache, B_wq, B_wo)
    return torch.concatenate([a, b], axis=-1)
```

```asm
; @launch grid=(256,1,1) block=(256,1,1) lds=147456
.amdgcn_target "amdgcn-amd-amdhsa--gfx950"
.text
.globl concat_heads__gqa_block_cached__gqa_block_cached__near_ridge_kernel
.p2align 8
.type concat_heads__gqa_block_cached__gqa_block_cached__near_ridge_kernel,@function
concat_heads__gqa_block_cached__gqa_block_cached__near_ridge_kernel:
    s_cmp_ge_u32 s2, 256
    s_cbranch_scc1 attn_done
    s_load_dwordx16 s[4:19], s[0:1], 0
    s_load_dwordx8 s[20:27], s[0:1], 64
    s_load_dwordx2 s[28:29], s[0:1], 96
    s_and_b32 s39, s2, 7
    s_lshr_b32 s62, s2, 3
    s_and_b32 s30, s39, 1
    s_lshl_b32 s30, s30, 2
    s_and_b32 s63, s62, 3
    s_add_u32 s30, s30, s63
    s_lshr_b32 s31, s39, 1
    s_lshl_b32 s31, s31, 3
    s_lshr_b32 s63, s62, 2
    s_add_u32 s31, s31, s63
    v_lshrrev_b32 v245, 6, v0
    v_and_b32 v246, 63, v0
    s_nop 0
    v_readfirstlane_b32 s32, v245
    s_nop 3
    s_lshr_b32 s33, s32, 1
    s_and_b32 s39, s32, 1
    s_mul_i32 s34, s32, 6144
    s_mul_i32 s3, s2, 0
    s_lshr_b32 s62, s2, 3
    s_mul_i32 s62, s62, 0
    s_add_u32 s3, s3, s62
    s_and_b32 s3, s3, 31
    s_mul_i32 s37, s33, 31
    s_add_u32 s37, s37, s3
    s_and_b32 s37, s37, 31
    s_mul_i32 s37, s37, 12288
    s_cmp_eq_u32 s33, 1
    s_cselect_b64 s[64:65], -1, 0
    s_mov_b32 s60, 0x3dd53b95
    s_mov_b32 s61, 0x3dd53b95
    v_and_b32 v247, 15, v246
    v_lshrrev_b32 v249, 4, v246
    v_bfe_u32 v248, v246, 1, 3
    v_xor_b32 v248, v248, v249
    v_mul_u32_u24 v247, 384, v247
    v_add_u32 v247, 0x18000, v247
    v_lshl_add_u32 v232, v248, 4, v247
    v_xor_b32 v248, 4, v248
    v_lshl_add_u32 v233, v248, 4, v247
    v_lshrrev_b32 v247, 2, v246
    v_bfe_u32 v248, v247, 1, 2
    v_mul_u32_u24 v247, 384, v247
    v_and_b32 v250, 3, v246
    v_lshl_add_u32 v247, v250, 3, v247
    v_xor_b32 v250, 0, v248
    v_lshl_add_u32 v234, v250, 5, v247
    v_xor_b32 v250, 1, v248
    v_lshl_add_u32 v235, v250, 5, v247
    v_xor_b32 v250, 2, v248
    v_lshl_add_u32 v236, v250, 5, v247
    v_xor_b32 v250, 3, v248
    v_lshl_add_u32 v237, v250, 5, v247
    s_mul_i32 s62, s39, 384
    v_add_u32 v247, s62, v246
    v_mul_u32_u24 v248, 2731, v247
    v_lshrrev_b32 v248, 16, v248
    v_mul_u32_u24 v250, 24, v248
    v_sub_u32 v247, v247, v250
    v_bfe_u32 v250, v248, 1, 3
    v_xor_b32 v250, v250, v247
    v_bfe_u32 v245, v248, 1, 2
    v_lshlrev_b32 v245, 1, v245
    v_xor_b32 v245, v245, v247
    v_lshlrev_b32 v250, 4, v250
    v_lshlrev_b32 v245, 4, v245
    v_add_u32 v250, 0x80, v250
    v_add_u32 v245, 0x80, v245
    v_mul_u32_u24 v247, 384, v248
    v_add_u32 v250, v250, v247
    v_add_u32 v247, v245, v247
    v_mul_u32_u24 v248, 12288, v248
    v_add_u32 v238, v248, v245
    v_accvgpr_write_b32 a212, v238
    v_cndmask_b32 v245, v247, v250, s[64:65]
    v_cndmask_b32 v248, v250, v247, s[64:65]
    v_accvgpr_write_b32 a218, v245
    v_accvgpr_write_b32 a224, v248
    v_add_u32 v247, s62, v246
    v_add_u32 v247, 64, v247
    v_mul_u32_u24 v248, 2731, v247
    v_lshrrev_b32 v248, 16, v248
    v_mul_u32_u24 v250, 24, v248
    v_sub_u32 v247, v247, v250
    v_bfe_u32 v250, v248, 1, 3
    v_xor_b32 v250, v250, v247
    v_bfe_u32 v245, v248, 1, 2
    v_lshlrev_b32 v245, 1, v245
    v_xor_b32 v245, v245, v247
    v_lshlrev_b32 v250, 4, v250
    v_lshlrev_b32 v245, 4, v245
    v_add_u32 v250, 0xfffffc80, v250
    v_add_u32 v245, 0xfffffc80, v245
    v_mul_u32_u24 v247, 384, v248
    v_add_u32 v250, v250, v247
    v_add_u32 v247, v245, v247
    v_mul_u32_u24 v248, 12288, v248
    v_add_u32 v239, v248, v245
    v_accvgpr_write_b32 a213, v239
    v_cndmask_b32 v245, v247, v250, s[64:65]
    v_cndmask_b32 v248, v250, v247, s[64:65]
    v_accvgpr_write_b32 a219, v245
    v_accvgpr_write_b32 a225, v248
    v_add_u32 v247, s62, v246
    v_add_u32 v247, 128, v247
    v_mul_u32_u24 v248, 2731, v247
    v_lshrrev_b32 v248, 16, v248
    v_mul_u32_u24 v250, 24, v248
    v_sub_u32 v247, v247, v250
    v_bfe_u32 v250, v248, 1, 3
    v_xor_b32 v250, v250, v247
    v_bfe_u32 v245, v248, 1, 2
    v_lshlrev_b32 v245, 1, v245
    v_xor_b32 v245, v245, v247
    v_lshlrev_b32 v250, 4, v250
    v_lshlrev_b32 v245, 4, v245
    v_add_u32 v250, 0xfffff880, v250
    v_add_u32 v245, 0xfffff880, v245
    v_mul_u32_u24 v247, 384, v248
    v_add_u32 v250, v250, v247
    v_add_u32 v247, v245, v247
    v_mul_u32_u24 v248, 12288, v248
    v_add_u32 v240, v248, v245
    v_accvgpr_write_b32 a214, v240
    v_cndmask_b32 v245, v247, v250, s[64:65]
    v_cndmask_b32 v248, v250, v247, s[64:65]
    v_accvgpr_write_b32 a220, v245
    v_accvgpr_write_b32 a226, v248
    v_add_u32 v247, s62, v246
    v_add_u32 v247, 192, v247
    v_mul_u32_u24 v248, 2731, v247
    v_lshrrev_b32 v248, 16, v248
    v_mul_u32_u24 v250, 24, v248
    v_sub_u32 v247, v247, v250
    v_bfe_u32 v250, v248, 1, 3
    v_xor_b32 v250, v250, v247
    v_bfe_u32 v245, v248, 1, 2
    v_lshlrev_b32 v245, 1, v245
    v_xor_b32 v245, v245, v247
    v_lshlrev_b32 v250, 4, v250
    v_lshlrev_b32 v245, 4, v245
    v_add_u32 v250, 0x80, v250
    v_add_u32 v245, 0x80, v245
    v_mul_u32_u24 v247, 384, v248
    v_add_u32 v250, v250, v247
    v_add_u32 v247, v245, v247
    v_mul_u32_u24 v248, 12288, v248
    v_add_u32 v241, v248, v245
    v_accvgpr_write_b32 a215, v241
    v_cndmask_b32 v245, v247, v250, s[64:65]
    v_cndmask_b32 v248, v250, v247, s[64:65]
    v_accvgpr_write_b32 a221, v245
    v_accvgpr_write_b32 a227, v248
    v_add_u32 v247, s62, v246
    v_add_u32 v247, 256, v247
    v_mul_u32_u24 v248, 2731, v247
    v_lshrrev_b32 v248, 16, v248
    v_mul_u32_u24 v250, 24, v248
    v_sub_u32 v247, v247, v250
    v_bfe_u32 v250, v248, 1, 3
    v_xor_b32 v250, v250, v247
    v_bfe_u32 v245, v248, 1, 2
    v_lshlrev_b32 v245, 1, v245
    v_xor_b32 v245, v245, v247
    v_lshlrev_b32 v250, 4, v250
    v_lshlrev_b32 v245, 4, v245
    v_add_u32 v250, 0xfffffc80, v250
    v_add_u32 v245, 0xfffffc80, v245
    v_mul_u32_u24 v247, 384, v248
    v_add_u32 v250, v250, v247
    v_add_u32 v247, v245, v247
    v_mul_u32_u24 v248, 12288, v248
    v_add_u32 v242, v248, v245
    v_accvgpr_write_b32 a216, v242
    v_cndmask_b32 v245, v247, v250, s[64:65]
    v_cndmask_b32 v248, v250, v247, s[64:65]
    v_accvgpr_write_b32 a222, v245
    v_accvgpr_write_b32 a228, v248
    v_add_u32 v247, s62, v246
    v_add_u32 v247, 320, v247
    v_mul_u32_u24 v248, 2731, v247
    v_lshrrev_b32 v248, 16, v248
    v_mul_u32_u24 v250, 24, v248
    v_sub_u32 v247, v247, v250
    v_bfe_u32 v250, v248, 1, 3
    v_xor_b32 v250, v250, v247
    v_bfe_u32 v245, v248, 1, 2
    v_lshlrev_b32 v245, 1, v245
    v_xor_b32 v245, v245, v247
    v_lshlrev_b32 v250, 4, v250
    v_lshlrev_b32 v245, 4, v245
    v_add_u32 v250, 0xfffff880, v250
    v_add_u32 v245, 0xfffff880, v245
    v_mul_u32_u24 v247, 384, v248
    v_add_u32 v250, v250, v247
    v_add_u32 v247, v245, v247
    v_mul_u32_u24 v248, 12288, v248
    v_add_u32 v243, v248, v245
    v_accvgpr_write_b32 a217, v243
    v_cndmask_b32 v245, v247, v250, s[64:65]
    v_cndmask_b32 v248, v250, v247, s[64:65]
    v_accvgpr_write_b32 a223, v245
    v_accvgpr_write_b32 a229, v248
    v_lshlrev_b32 v244, 4, v246
    v_mov_b32 v252, 0
    v_mov_b32 v245, 0x3f803f80
    v_accvgpr_write_b32 a208, v245
    v_accvgpr_write_b32 a209, v245
    v_accvgpr_write_b32 a210, v245
    v_accvgpr_write_b32 a211, v245
    s_waitcnt lgkmcnt(0)
    s_mov_b32 s69, 0
    s_mov_b64 s[94:95], s[6:7]
    s_mov_b64 s[96:97], s[8:9]
    s_mul_i32 s62, s31, 384
    s_add_u32 s48, s10, s62
    s_addc_u32 s49, s11, 0
    s_sub_u32 s48, s48, 128
    s_subb_u32 s49, s49, 0
    s_mov_b32 s50, 0x80
    s_mov_b32 s51, 0x00020000
    s_sub_u32 s50, 0x780080, s62
    s_add_u32 s62, s30, 0
    s_lshl_b32 s62, s62, 2
    s_add_u32 s62, s62, s32
    s_mul_i32 s62, s62, 81920
    s_add_u32 s62, s62, 0x5800000
    s_add_u32 s52, s28, s62
    s_addc_u32 s53, s29, 0
    s_mov_b32 s54, 0x14000
    s_mov_b32 s55, 0x00020000
    s_mul_i32 s36, s33, 393216
    s_mul_i32 s62, s2, 3277
    s_lshr_b32 s62, s62, 16
    s_mul_i32 s63, s62, 20
    s_sub_u32 s63, s2, s63
    s_add_u32 s63, s63, s32
    s_lshl_b32 s62, s62, 11
    s_add_u32 s62, s62, 0x5d00000
    s_add_u32 s56, s28, s62
    s_addc_u32 s57, s29, 0
    s_mov_b32 s59, 0x00020000
    s_cmp_eq_u32 s63, 0
    s_cselect_b32 s58, 2048, 0
    s_cmp_lt_u32 s2, 160
    s_cselect_b32 s58, s58, 0
    v_lshlrev_b32 v245, 3, v244
    buffer_store_dword v252, v245, s[56:59], 0 offen sc1
    v_lshrrev_b32 v245, 4, v244
    v_and_b32 v246, 15, v245
    v_mul_u32_u24 v246, 1280, v246
    v_lshrrev_b32 v245, 4, v245
    v_lshl_add_u32 v246, v245, 3, v246
    s_lshl_b32 s62, s2, 2
    s_add_u32 s62, s62, s32
    s_mul_i32 s63, s62, 13108
    s_lshr_b32 s63, s63, 16
    s_mul_i32 s39, s63, 5
    s_sub_u32 s39, s62, s39
    s_cmp_lt_u32 s62, 640
    s_cselect_b32 s42, 0x280000, 0
    s_cselect_b32 s86, 0x280000, 0
    s_mov_b32 s40, s4
    s_mov_b32 s41, s5
    s_mov_b32 s43, 0x00020000
    s_mul_i32 s62, s63, 20480
    s_lshl_b32 s98, s39, 8
    s_add_u32 s98, s98, s62
    s_lshl_b32 s92, s39, 12
    s_add_u32 s92, s92, s62
    s_add_u32 s84, s28, 0x5800000
    s_addc_u32 s85, s29, 0
    s_mov_b32 s87, 0x00020000
    buffer_load_dwordx2 v[160:161], v246, s[40:43], s98 offen offset:0
    buffer_load_dwordx2 v[162:163], v246, s[40:43], s98 offen offset:32
    buffer_load_dwordx2 v[164:165], v246, s[40:43], s98 offen offset:64
    buffer_load_dwordx2 v[166:167], v246, s[40:43], s98 offen offset:96
    buffer_load_dwordx2 v[168:169], v246, s[40:43], s98 offen offset:128
    buffer_load_dwordx2 v[170:171], v246, s[40:43], s98 offen offset:160
    buffer_load_dwordx2 v[172:173], v246, s[40:43], s98 offen offset:192
    buffer_load_dwordx2 v[174:175], v246, s[40:43], s98 offen offset:224
    s_mul_i32 s62, s30, 327680
    s_mul_i32 s63, s32, 81920
    s_add_u32 s62, s62, s63
    s_add_u32 s44, s4, s62
    s_addc_u32 s45, s5, 0
    s_mov_b32 s46, 0x14000
    s_mov_b32 s47, 0x00020000
    v_lshrrev_b32 v245, 4, v244
    v_lshrrev_b32 v247, 3, v245
    v_and_b32 v245, 7, v245
    v_xor_b32 v245, v245, v247
    v_mul_u32_u24 v247, 1280, v247
    v_lshl_add_u32 v245, v245, 4, v247
    s_lshl_b32 s39, s32, 13
    s_add_u32 m0, s39, 49152
    s_mov_b32 s63, 0
    buffer_load_dwordx4 v245, s[44:47], s63 offen lds
    s_add_u32 m0, s39, 50176
    s_mov_b32 s63, 10240
    buffer_load_dwordx4 v245, s[44:47], s63 offen lds
    s_add_u32 m0, s39, 51200
    s_mov_b32 s63, 20480
    buffer_load_dwordx4 v245, s[44:47], s63 offen lds
    s_add_u32 m0, s39, 52224
    s_mov_b32 s63, 30720
    buffer_load_dwordx4 v245, s[44:47], s63 offen lds
    s_add_u32 m0, s39, 53248
    s_mov_b32 s63, 40960
    buffer_load_dwordx4 v245, s[44:47], s63 offen lds
    s_add_u32 m0, s39, 54272
    s_mov_b32 s63, 51200
    buffer_load_dwordx4 v245, s[44:47], s63 offen lds
    s_add_u32 m0, s39, 55296
    s_mov_b32 s63, 61440
    buffer_load_dwordx4 v245, s[44:47], s63 offen lds
    s_add_u32 m0, s39, 56320
    s_mov_b32 s63, 71680
    buffer_load_dwordx4 v245, s[44:47], s63 offen lds
    s_add_u32 m0, s34, 0
    s_nop 0
    buffer_load_dwordx4 v238, s[48:51], s36 offen offset:0  lds
    buffer_load_dwordx4 v239, s[48:51], s36 offen offset:1024  lds
    buffer_load_dwordx4 v240, s[48:51], s36 offen offset:2048  lds
    s_add_u32 m0, s34, 3072
    s_nop 0
    buffer_load_dwordx4 v241, s[48:51], s36 offen offset:0  lds
    buffer_load_dwordx4 v242, s[48:51], s36 offen offset:1024  lds
    buffer_load_dwordx4 v243, s[48:51], s36 offen offset:2048  lds
    s_add_u32 s36, s36, 786432
    s_add_u32 m0, s39, 81920
    s_mov_b32 s63, 128
    buffer_load_dwordx4 v245, s[44:47], s63 offen lds
    s_add_u32 m0, s39, 82944
    s_mov_b32 s63, 10368
    buffer_load_dwordx4 v245, s[44:47], s63 offen lds
    s_add_u32 m0, s39, 83968
    s_mov_b32 s63, 20608
    buffer_load_dwordx4 v245, s[44:47], s63 offen lds
    s_add_u32 m0, s39, 84992
    s_mov_b32 s63, 30848
    buffer_load_dwordx4 v245, s[44:47], s63 offen lds
    s_add_u32 m0, s39, 86016
    s_mov_b32 s63, 41088
    buffer_load_dwordx4 v245, s[44:47], s63 offen lds
    s_add_u32 m0, s39, 87040
    s_mov_b32 s63, 51328
    buffer_load_dwordx4 v245, s[44:47], s63 offen lds
    s_add_u32 m0, s39, 88064
    s_mov_b32 s63, 61568
    buffer_load_dwordx4 v245, s[44:47], s63 offen lds
    s_add_u32 m0, s39, 89088
    s_mov_b32 s63, 71808
    buffer_load_dwordx4 v245, s[44:47], s63 offen lds
    s_add_u32 m0, s39, 114688
    s_mov_b32 s63, 256
    buffer_load_dwordx4 v245, s[44:47], s63 offen lds
    s_add_u32 m0, s39, 115712
    s_mov_b32 s63, 10496
    buffer_load_dwordx4 v245, s[44:47], s63 offen lds
    s_add_u32 m0, s39, 116736
    s_mov_b32 s63, 20736
    buffer_load_dwordx4 v245, s[44:47], s63 offen lds
    s_add_u32 m0, s39, 117760
    s_mov_b32 s63, 30976
    buffer_load_dwordx4 v245, s[44:47], s63 offen lds
    s_add_u32 m0, s39, 118784
    s_mov_b32 s63, 41216
    buffer_load_dwordx4 v245, s[44:47], s63 offen lds
    s_add_u32 m0, s39, 119808
    s_mov_b32 s63, 51456
    buffer_load_dwordx4 v245, s[44:47], s63 offen lds
    s_add_u32 m0, s39, 120832
    s_mov_b32 s63, 61696
    buffer_load_dwordx4 v245, s[44:47], s63 offen lds
    s_add_u32 m0, s39, 121856
    s_mov_b32 s63, 71936
    buffer_load_dwordx4 v245, s[44:47], s63 offen lds
    s_waitcnt vmcnt(30)
    buffer_store_dwordx4 v[160:163], v244, s[84:87], s92 offen offset:0 sc1
    buffer_store_dwordx4 v[164:167], v244, s[84:87], s92 offen offset:1024 sc1
    buffer_store_dwordx4 v[168:171], v244, s[84:87], s92 offen offset:2048 sc1
    buffer_store_dwordx4 v[172:175], v244, s[84:87], s92 offen offset:3072 sc1
    s_sub_u32 s62, 255, s2
    s_lshl_b32 s62, s62, 2
    s_add_u32 s62, s62, s32
    s_mul_i32 s63, s62, 13108
    s_lshr_b32 s63, s63, 16
    s_mul_i32 s39, s63, 5
    s_sub_u32 s39, s62, s39
    s_cmp_lt_u32 s62, 640
    s_cselect_b32 s42, 0x280000, 0
    s_cselect_b32 s90, 0x280000, 0
    s_mov_b32 s40, s14
    s_mov_b32 s41, s15
    s_mov_b32 s43, 0x00020000
    s_mul_i32 s62, s63, 20480
    s_lshl_b32 s98, s39, 8
    s_add_u32 s98, s98, s62
    s_lshl_b32 s93, s39, 12
    s_add_u32 s93, s93, s62
    s_add_u32 s88, s28, 0x5a80000
    s_addc_u32 s89, s29, 0
    s_mov_b32 s91, 0x00020000
    buffer_load_dwordx2 v[176:177], v246, s[40:43], s98 offen offset:0
    buffer_load_dwordx2 v[178:179], v246, s[40:43], s98 offen offset:32
    buffer_load_dwordx2 v[180:181], v246, s[40:43], s98 offen offset:64
    buffer_load_dwordx2 v[182:183], v246, s[40:43], s98 offen offset:96
    buffer_load_dwordx2 v[184:185], v246, s[40:43], s98 offen offset:128
    buffer_load_dwordx2 v[186:187], v246, s[40:43], s98 offen offset:160
    buffer_load_dwordx2 v[188:189], v246, s[40:43], s98 offen offset:192
    buffer_load_dwordx2 v[190:191], v246, s[40:43], s98 offen offset:224
    s_add_u32 m0, s34, 24576
    s_nop 0
    buffer_load_dwordx4 v238, s[48:51], s36 offen offset:0  lds
    buffer_load_dwordx4 v239, s[48:51], s36 offen offset:1024  lds
    buffer_load_dwordx4 v240, s[48:51], s36 offen offset:2048  lds
    s_add_u32 m0, s34, 27648
    s_nop 0
    buffer_load_dwordx4 v241, s[48:51], s36 offen offset:0  lds
    buffer_load_dwordx4 v242, s[48:51], s36 offen offset:1024  lds
    buffer_load_dwordx4 v243, s[48:51], s36 offen offset:2048  lds
    s_add_u32 s36, s36, 786432
    s_and_b32 s62, s30, 3
    s_lshl_b32 s62, s62, 2
    s_add_u32 s62, s62, s32
    s_add_u32 s62, s62, 4
    s_mul_i32 s62, s62, 393216
    s_add_u32 s62, s62, 128
    v_lshrrev_b32 v245, 4, v244
    v_mul_u32_u24 v247, 21846, v245
    v_lshrrev_b32 v247, 16, v247
    v_mul_u32_u24 v248, 11904, v247
    v_lshl_add_u32 v248, v245, 7, v248
    v_cmp_gt_u32 vcc, 48, v245
    v_mov_b32 v247, 0x7f000000
    s_nop 0
    v_cndmask_b32 v248, v247, v248, vcc
    buffer_load_dword v254, v248, s[48:51], s62 offen
    s_add_u32 s62, s62, 196608
    buffer_load_dword v254, v248, s[48:51], s62 offen
    s_mov_b32 s64, s26
    s_mov_b32 s65, s27
    s_mov_b32 s66, 256
    s_mov_b32 s67, 0x00020000
    v_mov_b32 v247, 0
    v_mov_b32 v248, 1
    s_waitcnt vmcnt(16)
    s_barrier
    s_cmp_lg_u32 s32, 0
    s_cbranch_scc1 Lx_wait
    s_mov_b64 exec, 1
    s_cmp_ge_u32 s2, 160
    s_cbranch_scc1 Lx_noa
    s_mul_i32 s62, s2, 3277
    s_lshr_b32 s62, s62, 16
    s_lshr_b32 s39, s62, 2
    s_lshl_b32 s39, s39, 7
    s_and_b32 s63, s62, 3
    s_lshl_b32 s63, s63, 4
    s_add_u32 s39, s39, s63
    buffer_atomic_add v248, v247, s[64:67], s39 offen
Lx_noa:
    s_mov_b64 exec, -1
Lx_wait:
    s_waitcnt vmcnt(8)
    buffer_store_dwordx4 v[176:179], v244, s[88:91], s93 offen offset:0 sc1
    buffer_store_dwordx4 v[180:183], v244, s[88:91], s93 offen offset:1024 sc1
    buffer_store_dwordx4 v[184:187], v244, s[88:91], s93 offen offset:2048 sc1
    buffer_store_dwordx4 v[188:191], v244, s[88:91], s93 offen offset:3072 sc1
    v_lshrrev_b32 v245, 4, v244
    v_and_b32 v246, 15, v245
    v_lshrrev_b32 v247, 5, v245
    v_and_b32 v248, 7, v245
    v_xor_b32 v247, v247, v248
    v_bfe_u32 v248, v245, 4, 1
    v_lshlrev_b32 v248, 3, v248
    v_lshl_add_u32 v248, v246, 7, v248
    s_lshl_b32 s39, s32, 13
    v_add_u32 v248, s39, v248
    v_xor_b32 v245, 0, v247
    v_lshl_add_u32 v249, v245, 4, v248
    v_xor_b32 v245, 2, v247
    v_lshl_add_u32 v250, v245, 4, v248
    v_xor_b32 v245, 4, v247
    v_lshl_add_u32 v251, v245, 4, v248
    v_xor_b32 v245, 6, v247
    v_lshl_add_u32 v246, v245, 4, v248
    ds_read_b64 v[0:1], v249 offset:49152
    ds_read_b64 v[2:3], v250 offset:49152
    ds_read_b64 v[4:5], v249 offset:51200
    ds_read_b64 v[6:7], v250 offset:51200
    ds_read_b64 v[8:9], v249 offset:53248
    ds_read_b64 v[10:11], v250 offset:53248
    ds_read_b64 v[12:13], v249 offset:55296
    ds_read_b64 v[14:15], v250 offset:55296
    s_waitcnt lgkmcnt(0)
    ds_read_b64 v[16:17], v251 offset:49152
    ds_read_b64 v[18:19], v246 offset:49152
    ds_read_b64 v[20:21], v251 offset:51200
    ds_read_b64 v[22:23], v246 offset:51200
    ds_read_b64 v[24:25], v251 offset:53248
    ds_read_b64 v[26:27], v246 offset:53248
    ds_read_b64 v[28:29], v251 offset:55296
    ds_read_b64 v[30:31], v246 offset:55296
    s_waitcnt lgkmcnt(0)
    v_add_u32 v245, 0x14000, v249
    ds_read_b64 v[32:33], v245 offset:0
    v_add_u32 v245, 0x14000, v250
    ds_read_b64 v[34:35], v245 offset:0
    v_add_u32 v245, 0x14800, v249
    ds_read_b64 v[36:37], v245 offset:0
    v_add_u32 v245, 0x14800, v250
    ds_read_b64 v[38:39], v245 offset:0
    v_add_u32 v245, 0x15000, v249
    ds_read_b64 v[40:41], v245 offset:0
    v_add_u32 v245, 0x15000, v250
    ds_read_b64 v[42:43], v245 offset:0
    v_add_u32 v245, 0x15800, v249
    ds_read_b64 v[44:45], v245 offset:0
    v_add_u32 v245, 0x15800, v250
    ds_read_b64 v[46:47], v245 offset:0
    s_waitcnt lgkmcnt(0)
    v_add_u32 v245, 0x14000, v251
    ds_read_b64 v[48:49], v245 offset:0
    v_add_u32 v245, 0x14000, v246
    ds_read_b64 v[50:51], v245 offset:0
    v_add_u32 v245, 0x14800, v251
    ds_read_b64 v[52:53], v245 offset:0
    v_add_u32 v245, 0x14800, v246
    ds_read_b64 v[54:55], v245 offset:0
    v_add_u32 v245, 0x15000, v251
    ds_read_b64 v[56:57], v245 offset:0
    v_add_u32 v245, 0x15000, v246
    ds_read_b64 v[58:59], v245 offset:0
    v_add_u32 v245, 0x15800, v251
    ds_read_b64 v[60:61], v245 offset:0
    v_add_u32 v245, 0x15800, v246
    ds_read_b64 v[62:63], v245 offset:0
    s_waitcnt lgkmcnt(0)
    v_add_u32 v245, 0x1c000, v249
    ds_read_b64 v[64:65], v245 offset:0
    v_add_u32 v245, 0x1c000, v250
    ds_read_b64 v[66:67], v245 offset:0
    v_add_u32 v245, 0x1c800, v249
    ds_read_b64 v[68:69], v245 offset:0
    v_add_u32 v245, 0x1c800, v250
    ds_read_b64 v[70:71], v245 offset:0
    v_add_u32 v245, 0x1d000, v249
    ds_read_b64 v[72:73], v245 offset:0
    v_add_u32 v245, 0x1d000, v250
    ds_read_b64 v[74:75], v245 offset:0
    v_add_u32 v245, 0x1d800, v249
    ds_read_b64 v[76:77], v245 offset:0
    v_add_u32 v245, 0x1d800, v250
    ds_read_b64 v[78:79], v245 offset:0
    s_waitcnt lgkmcnt(0)
    v_add_u32 v245, 0x1c000, v251
    ds_read_b64 v[80:81], v245 offset:0
    v_add_u32 v245, 0x1c000, v246
    ds_read_b64 v[82:83], v245 offset:0
    v_add_u32 v245, 0x1c800, v251
    ds_read_b64 v[84:85], v245 offset:0
    v_add_u32 v245, 0x1c800, v246
    ds_read_b64 v[86:87], v245 offset:0
    v_add_u32 v245, 0x1d000, v251
    ds_read_b64 v[88:89], v245 offset:0
    v_add_u32 v245, 0x1d000, v246
    ds_read_b64 v[90:91], v245 offset:0
    v_add_u32 v245, 0x1d800, v251
    ds_read_b64 v[92:93], v245 offset:0
    v_add_u32 v245, 0x1d800, v246
    ds_read_b64 v[94:95], v245 offset:0
    s_waitcnt lgkmcnt(0)
    s_barrier
    ds_read_b64_tr_b16 v[208:209], v234 offset:0
    ds_read_b64_tr_b16 v[210:211], v234 offset:6144
    ds_read_b64_tr_b16 v[212:213], v235 offset:0
    ds_read_b64_tr_b16 v[214:215], v235 offset:6144
    ds_read_b64_tr_b16 v[216:217], v236 offset:0
    ds_read_b64_tr_b16 v[218:219], v236 offset:6144
    ds_read_b64_tr_b16 v[220:221], v237 offset:0
    ds_read_b64_tr_b16 v[222:223], v237 offset:6144
    ds_read_b64_tr_b16 v[224:225], v234 offset:128
    ds_read_b64_tr_b16 v[226:227], v234 offset:6272
    s_waitcnt lgkmcnt(6)
    v_mfma_f32_16x16x32_bf16 a[0:3], v[208:211], v[0:3], 0
    ds_read_b64_tr_b16 v[228:229], v235 offset:128
    ds_read_b64_tr_b16 v[230:231], v235 offset:6272
    v_mfma_f32_16x16x32_bf16 a[8:11], v[208:211], v[4:7], 0
    s_add_u32 m0, s34, 49152
    s_nop 0
    buffer_load_dwordx4 v238, s[48:51], s36 offen offset:0  lds
    v_mfma_f32_16x16x32_bf16 a[16:19], v[208:211], v[8:11], 0
    buffer_load_dwordx4 v239, s[48:51], s36 offen offset:1024  lds
    v_mfma_f32_16x16x32_bf16 a[24:27], v[208:211], v[12:15], 0
    v_mfma_f32_16x16x32_bf16 a[4:7], v[212:215], v[0:3], 0
    ds_read_b64_tr_b16 v[208:209], v236 offset:128
    ds_read_b64_tr_b16 v[210:211], v236 offset:6272
    buffer_load_dwordx4 v240, s[48:51], s36 offen offset:2048  lds
    v_mfma_f32_16x16x32_bf16 a[12:15], v[212:215], v[4:7], 0
    s_add_u32 m0, s34, 52224
    s_nop 0
    buffer_load_dwordx4 v241, s[48:51], s36 offen offset:0  lds
    v_mfma_f32_16x16x32_bf16 a[20:23], v[212:215], v[8:11], 0
    v_mfma_f32_16x16x32_bf16 a[28:31], v[212:215], v[12:15], 0
    s_waitcnt lgkmcnt(6)
    v_mfma_f32_16x16x32_bf16 a[32:35], v[216:219], v[0:3], 0
    ds_read_b64_tr_b16 v[212:213], v237 offset:128
    ds_read_b64_tr_b16 v[214:215], v237 offset:6272
    buffer_load_dwordx4 v242, s[48:51], s36 offen offset:1024  lds
    v_mfma_f32_16x16x32_bf16 a[40:43], v[216:219], v[4:7], 0
    buffer_load_dwordx4 v243, s[48:51], s36 offen offset:2048  lds
    s_add_u32 s36, s36, 786432
    v_mfma_f32_16x16x32_bf16 a[48:51], v[216:219], v[8:11], 0
    v_mfma_f32_16x16x32_bf16 a[56:59], v[216:219], v[12:15], 0
    v_mfma_f32_16x16x32_bf16 a[36:39], v[220:223], v[0:3], 0
    ds_read_b64_tr_b16 v[216:217], v234 offset:256
    ds_read_b64_tr_b16 v[218:219], v234 offset:6400
    v_mfma_f32_16x16x32_bf16 a[44:47], v[220:223], v[4:7], 0
    s_add_u32 m0, s34, 73728
    s_nop 0
    buffer_load_dwordx4 v238, s[48:51], s36 offen offset:0  lds
    v_mfma_f32_16x16x32_bf16 a[52:55], v[220:223], v[8:11], 0
    buffer_load_dwordx4 v239, s[48:51], s36 offen offset:1024  lds
    v_mfma_f32_16x16x32_bf16 a[60:63], v[220:223], v[12:15], 0
    s_waitcnt lgkmcnt(6)
    v_mfma_f32_16x16x32_bf16 a[64:67], v[224:227], v[0:3], 0
    ds_read_b64_tr_b16 v[220:221], v235 offset:256
    ds_read_b64_tr_b16 v[222:223], v235 offset:6400
    buffer_load_dwordx4 v240, s[48:51], s36 offen offset:2048  lds
    v_mfma_f32_16x16x32_bf16 a[72:75], v[224:227], v[4:7], 0
    s_add_u32 m0, s34, 76800
    s_nop 0
    buffer_load_dwordx4 v241, s[48:51], s36 offen offset:0  lds
    v_mfma_f32_16x16x32_bf16 a[80:83], v[224:227], v[8:11], 0
    v_mfma_f32_16x16x32_bf16 a[88:91], v[224:227], v[12:15], 0
    v_mfma_f32_16x16x32_bf16 a[68:71], v[228:231], v[0:3], 0
    ds_read_b64_tr_b16 v[224:225], v236 offset:256
    ds_read_b64_tr_b16 v[226:227], v236 offset:6400
    buffer_load_dwordx4 v242, s[48:51], s36 offen offset:1024  lds
    v_mfma_f32_16x16x32_bf16 a[76:79], v[228:231], v[4:7], 0
    buffer_load_dwordx4 v243, s[48:51], s36 offen offset:2048  lds
    s_add_u32 s36, s36, 786432
    v_mfma_f32_16x16x32_bf16 a[84:87], v[228:231], v[8:11], 0
    v_mfma_f32_16x16x32_bf16 a[92:95], v[228:231], v[12:15], 0
    s_waitcnt lgkmcnt(6)
    v_mfma_f32_16x16x32_bf16 a[96:99], v[208:211], v[0:3], 0
    ds_read_b64_tr_b16 v[228:229], v237 offset:256
    ds_read_b64_tr_b16 v[230:231], v237 offset:6400
    v_mfma_f32_16x16x32_bf16 a[104:107], v[208:211], v[4:7], 0
    s_add_u32 m0, s34, 98304
    s_nop 0
    buffer_load_dwordx4 v238, s[48:51], s36 offen offset:0  lds
    v_mfma_f32_16x16x32_bf16 a[112:115], v[208:211], v[8:11], 0
    buffer_load_dwordx4 v239, s[48:51], s36 offen offset:1024  lds
    v_mfma_f32_16x16x32_bf16 a[120:123], v[208:211], v[12:15], 0
    v_mfma_f32_16x16x32_bf16 a[100:103], v[212:215], v[0:3], 0
    ds_read_b64_tr_b16 v[208:209], v234 offset:12288
    ds_read_b64_tr_b16 v[210:211], v234 offset:18432
    buffer_load_dwordx4 v240, s[48:51], s36 offen offset:2048  lds
    v_mfma_f32_16x16x32_bf16 a[108:111], v[212:215], v[4:7], 0
    s_add_u32 m0, s34, 101376
    s_nop 0
    buffer_load_dwordx4 v241, s[48:51], s36 offen offset:0  lds
    v_mfma_f32_16x16x32_bf16 a[116:119], v[212:215], v[8:11], 0
    v_mfma_f32_16x16x32_bf16 a[124:127], v[212:215], v[12:15], 0
    s_waitcnt lgkmcnt(6)
    v_mfma_f32_16x16x32_bf16 a[128:131], v[216:219], v[0:3], 0
    ds_read_b64_tr_b16 v[212:213], v235 offset:12288
    ds_read_b64_tr_b16 v[214:215], v235 offset:18432
    buffer_load_dwordx4 v242, s[48:51], s36 offen offset:1024  lds
    v_mfma_f32_16x16x32_bf16 a[136:139], v[216:219], v[4:7], 0
    buffer_load_dwordx4 v243, s[48:51], s36 offen offset:2048  lds
    s_add_u32 s36, s36, 786432
    v_mfma_f32_16x16x32_bf16 a[144:147], v[216:219], v[8:11], 0
    v_mfma_f32_16x16x32_bf16 a[152:155], v[216:219], v[12:15], 0
    s_waitcnt vmcnt(18)
    s_barrier
    s_cmp_lg_u32 s32, 0
    s_cbranch_scc1 Lx_nob
    s_cmp_lt_u32 s2, 96
    s_cbranch_scc1 Lx_nob
    s_sub_u32 s62, 255, s2
    s_mul_i32 s62, s62, 3277
    s_lshr_b32 s62, s62, 16
    s_lshr_b32 s39, s62, 2
    s_lshl_b32 s39, s39, 7
    s_and_b32 s63, s62, 3
    s_lshl_b32 s63, s63, 4
    s_add_u32 s39, s39, s63
    s_add_u32 s39, s39, 64
    v_mov_b32 v252, 0
    v_mov_b32 v253, 1
    s_mov_b64 exec, 1
    buffer_atomic_add v253, v252, s[64:67], s39 offen
    s_mov_b64 exec, -1
Lx_nob:
    v_mfma_f32_16x16x32_bf16 a[132:135], v[220:223], v[0:3], 0
    ds_read_b64_tr_b16 v[216:217], v236 offset:12288
    ds_read_b64_tr_b16 v[218:219], v236 offset:18432
    v_mfma_f32_16x16x32_bf16 a[140:143], v[220:223], v[4:7], 0
    s_add_u32 m0, s34, 122880
    s_nop 0
    buffer_load_dwordx4 v238, s[48:51], s36 offen offset:0  lds
    v_mfma_f32_16x16x32_bf16 a[148:151], v[220:223], v[8:11], 0
    buffer_load_dwordx4 v239, s[48:51], s36 offen offset:1024  lds
    v_mfma_f32_16x16x32_bf16 a[156:159], v[220:223], v[12:15], 0
    s_waitcnt lgkmcnt(6)
    v_mfma_f32_16x16x32_bf16 a[160:163], v[224:227], v[0:3], 0
    ds_read_b64_tr_b16 v[220:221], v237 offset:12288
    ds_read_b64_tr_b16 v[222:223], v237 offset:18432
    buffer_load_dwordx4 v240, s[48:51], s36 offen offset:2048  lds
    v_mfma_f32_16x16x32_bf16 a[168:171], v[224:227], v[4:7], 0
    s_add_u32 m0, s34, 125952
    s_nop 0
    buffer_load_dwordx4 v241, s[48:51], s36 offen offset:0  lds
    v_mfma_f32_16x16x32_bf16 a[176:179], v[224:227], v[8:11], 0
    v_mfma_f32_16x16x32_bf16 a[184:187], v[224:227], v[12:15], 0
    v_mfma_f32_16x16x32_bf16 a[164:167], v[228:231], v[0:3], 0
    ds_read_b64_tr_b16 v[224:225], v234 offset:12416
    ds_read_b64_tr_b16 v[226:227], v234 offset:18560
    buffer_load_dwordx4 v242, s[48:51], s36 offen offset:1024  lds
    v_mfma_f32_16x16x32_bf16 a[172:175], v[228:231], v[4:7], 0
    buffer_load_dwordx4 v243, s[48:51], s36 offen offset:2048  lds
    s_add_u32 s36, s36, 786432
    v_mfma_f32_16x16x32_bf16 a[180:183], v[228:231], v[8:11], 0
    v_mfma_f32_16x16x32_bf16 a[188:191], v[228:231], v[12:15], 0
    s_waitcnt lgkmcnt(6)
    v_mfma_f32_16x16x32_bf16 a[0:3], v[208:211], v[16:19], a[0:3]
    ds_read_b64_tr_b16 v[228:229], v235 offset:12416
    ds_read_b64_tr_b16 v[230:231], v235 offset:18560
    v_mfma_f32_16x16x32_bf16 a[8:11], v[208:211], v[20:23], a[8:11]
    v_mfma_f32_16x16x32_bf16 a[16:19], v[208:211], v[24:27], a[16:19]
    v_mfma_f32_16x16x32_bf16 a[24:27], v[208:211], v[28:31], a[24:27]
    v_mfma_f32_16x16x32_bf16 a[4:7], v[212:215], v[16:19], a[4:7]
    ds_read_b64_tr_b16 v[208:209], v236 offset:12416
    ds_read_b64_tr_b16 v[210:211], v236 offset:18560
    v_mfma_f32_16x16x32_bf16 a[12:15], v[212:215], v[20:23], a[12:15]
    v_mfma_f32_16x16x32_bf16 a[20:23], v[212:215], v[24:27], a[20:23]
    v_mfma_f32_16x16x32_bf16 a[28:31], v[212:215], v[28:31], a[28:31]
    s_waitcnt lgkmcnt(6)
    v_mfma_f32_16x16x32_bf16 a[32:35], v[216:219], v[16:19], a[32:35]
    ds_read_b64_tr_b16 v[212:213], v237 offset:12416
    ds_read_b64_tr_b16 v[214:215], v237 offset:18560
    v_mfma_f32_16x16x32_bf16 a[40:43], v[216:219], v[20:23], a[40:43]
    v_mfma_f32_16x16x32_bf16 a[48:51], v[216:219], v[24:27], a[48:51]
    v_mfma_f32_16x16x32_bf16 a[56:59], v[216:219], v[28:31], a[56:59]
    v_mfma_f32_16x16x32_bf16 a[36:39], v[220:223], v[16:19], a[36:39]
    ds_read_b64_tr_b16 v[216:217], v234 offset:12544
    ds_read_b64_tr_b16 v[218:219], v234 offset:18688
    v_mfma_f32_16x16x32_bf16 a[44:47], v[220:223], v[20:23], a[44:47]
    v_mfma_f32_16x16x32_bf16 a[52:55], v[220:223], v[24:27], a[52:55]
    v_mfma_f32_16x16x32_bf16 a[60:63], v[220:223], v[28:31], a[60:63]
    s_waitcnt lgkmcnt(6)
    v_mfma_f32_16x16x32_bf16 a[64:67], v[224:227], v[16:19], a[64:67]
    ds_read_b64_tr_b16 v[220:221], v235 offset:12544
    ds_read_b64_tr_b16 v[222:223], v235 offset:18688
    v_mfma_f32_16x16x32_bf16 a[72:75], v[224:227], v[20:23], a[72:75]
    v_mfma_f32_16x16x32_bf16 a[80:83], v[224:227], v[24:27], a[80:83]
    v_mfma_f32_16x16x32_bf16 a[88:91], v[224:227], v[28:31], a[88:91]
    v_mfma_f32_16x16x32_bf16 a[68:71], v[228:231], v[16:19], a[68:71]
    ds_read_b64_tr_b16 v[224:225], v236 offset:12544
    ds_read_b64_tr_b16 v[226:227], v236 offset:18688
    v_mfma_f32_16x16x32_bf16 a[76:79], v[228:231], v[20:23], a[76:79]
    v_mfma_f32_16x16x32_bf16 a[84:87], v[228:231], v[24:27], a[84:87]
    v_mfma_f32_16x16x32_bf16 a[92:95], v[228:231], v[28:31], a[92:95]
    s_waitcnt lgkmcnt(6)
    v_mfma_f32_16x16x32_bf16 a[96:99], v[208:211], v[16:19], a[96:99]
    ds_read_b64_tr_b16 v[228:229], v237 offset:12544
    ds_read_b64_tr_b16 v[230:231], v237 offset:18688
    v_mfma_f32_16x16x32_bf16 a[104:107], v[208:211], v[20:23], a[104:107]
    v_mfma_f32_16x16x32_bf16 a[112:115], v[208:211], v[24:27], a[112:115]
    v_mfma_f32_16x16x32_bf16 a[120:123], v[208:211], v[28:31], a[120:123]
    v_mfma_f32_16x16x32_bf16 a[100:103], v[212:215], v[16:19], a[100:103]
    ds_read_b64_tr_b16 v[208:209], v234 offset:24576
    ds_read_b64_tr_b16 v[210:211], v234 offset:30720
    v_mfma_f32_16x16x32_bf16 a[108:111], v[212:215], v[20:23], a[108:111]
    v_mfma_f32_16x16x32_bf16 a[116:119], v[212:215], v[24:27], a[116:119]
    v_mfma_f32_16x16x32_bf16 a[124:127], v[212:215], v[28:31], a[124:127]
    s_waitcnt lgkmcnt(6)
    v_mfma_f32_16x16x32_bf16 a[128:131], v[216:219], v[16:19], a[128:131]
    ds_read_b64_tr_b16 v[212:213], v235 offset:24576
    ds_read_b64_tr_b16 v[214:215], v235 offset:30720
    v_mfma_f32_16x16x32_bf16 a[136:139], v[216:219], v[20:23], a[136:139]
    v_mfma_f32_16x16x32_bf16 a[144:147], v[216:219], v[24:27], a[144:147]
    v_mfma_f32_16x16x32_bf16 a[152:155], v[216:219], v[28:31], a[152:155]
    v_mfma_f32_16x16x32_bf16 a[132:135], v[220:223], v[16:19], a[132:135]
    ds_read_b64_tr_b16 v[216:217], v236 offset:24576
    ds_read_b64_tr_b16 v[218:219], v236 offset:30720
    v_mfma_f32_16x16x32_bf16 a[140:143], v[220:223], v[20:23], a[140:143]
    v_mfma_f32_16x16x32_bf16 a[148:151], v[220:223], v[24:27], a[148:151]
    v_mfma_f32_16x16x32_bf16 a[156:159], v[220:223], v[28:31], a[156:159]
    s_waitcnt lgkmcnt(6)
    v_mfma_f32_16x16x32_bf16 a[160:163], v[224:227], v[16:19], a[160:163]
    ds_read_b64_tr_b16 v[220:221], v237 offset:24576
    ds_read_b64_tr_b16 v[222:223], v237 offset:30720
    v_mfma_f32_16x16x32_bf16 a[168:171], v[224:227], v[20:23], a[168:171]
    v_mfma_f32_16x16x32_bf16 a[176:179], v[224:227], v[24:27], a[176:179]
    v_mfma_f32_16x16x32_bf16 a[184:187], v[224:227], v[28:31], a[184:187]
    v_mfma_f32_16x16x32_bf16 a[164:167], v[228:231], v[16:19], a[164:167]
    ds_read_b64_tr_b16 v[224:225], v234 offset:24704
    ds_read_b64_tr_b16 v[226:227], v234 offset:30848
    v_mfma_f32_16x16x32_bf16 a[172:175], v[228:231], v[20:23], a[172:175]
    v_mfma_f32_16x16x32_bf16 a[180:183], v[228:231], v[24:27], a[180:183]
    v_mfma_f32_16x16x32_bf16 a[188:191], v[228:231], v[28:31], a[188:191]
    s_waitcnt lgkmcnt(6)
    v_mfma_f32_16x16x32_bf16 a[0:3], v[208:211], v[32:35], a[0:3]
    ds_read_b64_tr_b16 v[228:229], v235 offset:24704
    ds_read_b64_tr_b16 v[230:231], v235 offset:30848
    v_mfma_f32_16x16x32_bf16 a[8:11], v[208:211], v[36:39], a[8:11]
    v_mfma_f32_16x16x32_bf16 a[16:19], v[208:211], v[40:43], a[16:19]
    v_mfma_f32_16x16x32_bf16 a[24:27], v[208:211], v[44:47], a[24:27]
    v_mfma_f32_16x16x32_bf16 a[4:7], v[212:215], v[32:35], a[4:7]
    ds_read_b64_tr_b16 v[208:209], v236 offset:24704
    ds_read_b64_tr_b16 v[210:211], v236 offset:30848
    v_mfma_f32_16x16x32_bf16 a[12:15], v[212:215], v[36:39], a[12:15]
    v_mfma_f32_16x16x32_bf16 a[20:23], v[212:215], v[40:43], a[20:23]
    v_mfma_f32_16x16x32_bf16 a[28:31], v[212:215], v[44:47], a[28:31]
    s_waitcnt lgkmcnt(6)
    v_mfma_f32_16x16x32_bf16 a[32:35], v[216:219], v[32:35], a[32:35]
    ds_read_b64_tr_b16 v[212:213], v237 offset:24704
    ds_read_b64_tr_b16 v[214:215], v237 offset:30848
    v_mfma_f32_16x16x32_bf16 a[40:43], v[216:219], v[36:39], a[40:43]
    v_mfma_f32_16x16x32_bf16 a[48:51], v[216:219], v[40:43], a[48:51]
    v_mfma_f32_16x16x32_bf16 a[56:59], v[216:219], v[44:47], a[56:59]
    v_mfma_f32_16x16x32_bf16 a[36:39], v[220:223], v[32:35], a[36:39]
    ds_read_b64_tr_b16 v[216:217], v234 offset:24832
    ds_read_b64_tr_b16 v[218:219], v234 offset:30976
    v_mfma_f32_16x16x32_bf16 a[44:47], v[220:223], v[36:39], a[44:47]
    v_mfma_f32_16x16x32_bf16 a[52:55], v[220:223], v[40:43], a[52:55]
    v_mfma_f32_16x16x32_bf16 a[60:63], v[220:223], v[44:47], a[60:63]
    s_waitcnt lgkmcnt(6)
    v_mfma_f32_16x16x32_bf16 a[64:67], v[224:227], v[32:35], a[64:67]
    ds_read_b64_tr_b16 v[220:221], v235 offset:24832
    ds_read_b64_tr_b16 v[222:223], v235 offset:30976
    v_mfma_f32_16x16x32_bf16 a[72:75], v[224:227], v[36:39], a[72:75]
    v_mfma_f32_16x16x32_bf16 a[80:83], v[224:227], v[40:43], a[80:83]
    v_mfma_f32_16x16x32_bf16 a[88:91], v[224:227], v[44:47], a[88:91]
    v_mfma_f32_16x16x32_bf16 a[68:71], v[228:231], v[32:35], a[68:71]
    ds_read_b64_tr_b16 v[224:225], v236 offset:24832
    ds_read_b64_tr_b16 v[226:227], v236 offset:30976
    v_mfma_f32_16x16x32_bf16 a[76:79], v[228:231], v[36:39], a[76:79]
    v_mfma_f32_16x16x32_bf16 a[84:87], v[228:231], v[40:43], a[84:87]
    v_mfma_f32_16x16x32_bf16 a[92:95], v[228:231], v[44:47], a[92:95]
    s_waitcnt lgkmcnt(6)
    v_mfma_f32_16x16x32_bf16 a[96:99], v[208:211], v[32:35], a[96:99]
    ds_read_b64_tr_b16 v[228:229], v237 offset:24832
    ds_read_b64_tr_b16 v[230:231], v237 offset:30976
    v_mfma_f32_16x16x32_bf16 a[104:107], v[208:211], v[36:39], a[104:107]
    v_mfma_f32_16x16x32_bf16 a[112:115], v[208:211], v[40:43], a[112:115]
    v_mfma_f32_16x16x32_bf16 a[120:123], v[208:211], v[44:47], a[120:123]
    v_mfma_f32_16x16x32_bf16 a[100:103], v[212:215], v[32:35], a[100:103]
    ds_read_b64_tr_b16 v[208:209], v234 offset:36864
    ds_read_b64_tr_b16 v[210:211], v234 offset:43008
    v_mfma_f32_16x16x32_bf16 a[108:111], v[212:215], v[36:39], a[108:111]
    v_mfma_f32_16x16x32_bf16 a[116:119], v[212:215], v[40:43], a[116:119]
    v_mfma_f32_16x16x32_bf16 a[124:127], v[212:215], v[44:47], a[124:127]
    s_waitcnt lgkmcnt(6)
    v_mfma_f32_16x16x32_bf16 a[128:131], v[216:219], v[32:35], a[128:131]
    ds_read_b64_tr_b16 v[212:213], v235 offset:36864
    ds_read_b64_tr_b16 v[214:215], v235 offset:43008
    v_mfma_f32_16x16x32_bf16 a[136:139], v[216:219], v[36:39], a[136:139]
    v_mfma_f32_16x16x32_bf16 a[144:147], v[216:219], v[40:43], a[144:147]
    v_mfma_f32_16x16x32_bf16 a[152:155], v[216:219], v[44:47], a[152:155]
    s_waitcnt vmcnt(18)
    s_barrier
    v_mfma_f32_16x16x32_bf16 a[132:135], v[220:223], v[32:35], a[132:135]
    ds_read_b64_tr_b16 v[216:217], v236 offset:36864
    ds_read_b64_tr_b16 v[218:219], v236 offset:43008
    v_mfma_f32_16x16x32_bf16 a[140:143], v[220:223], v[36:39], a[140:143]
    s_add_u32 m0, s34, 0
    s_nop 0
    buffer_load_dwordx4 v238, s[48:51], s36 offen offset:0  lds
    v_mfma_f32_16x16x32_bf16 a[148:151], v[220:223], v[40:43], a[148:151]
    v_mfma_f32_16x16x32_bf16 a[156:159], v[220:223], v[44:47], a[156:159]
    s_waitcnt lgkmcnt(6)
    v_mfma_f32_16x16x32_bf16 a[160:163], v[224:227], v[32:35], a[160:163]
    ds_read_b64_tr_b16 v[220:221], v237 offset:36864
    ds_read_b64_tr_b16 v[222:223], v237 offset:43008
    v_mfma_f32_16x16x32_bf16 a[168:171], v[224:227], v[36:39], a[168:171]
    v_mfma_f32_16x16x32_bf16 a[176:179], v[224:227], v[40:43], a[176:179]
    v_mfma_f32_16x16x32_bf16 a[184:187], v[224:227], v[44:47], a[184:187]
    v_mfma_f32_16x16x32_bf16 a[164:167], v[228:231], v[32:35], a[164:167]
    ds_read_b64_tr_b16 v[224:225], v234 offset:36992
    ds_read_b64_tr_b16 v[226:227], v234 offset:43136
    buffer_load_dwordx4 v239, s[48:51], s36 offen offset:1024  lds
    v_mfma_f32_16x16x32_bf16 a[172:175], v[228:231], v[36:39], a[172:175]
    v_mfma_f32_16x16x32_bf16 a[180:183], v[228:231], v[40:43], a[180:183]
    v_mfma_f32_16x16x32_bf16 a[188:191], v[228:231], v[44:47], a[188:191]
    s_waitcnt lgkmcnt(6)
    v_mfma_f32_16x16x32_bf16 a[0:3], v[208:211], v[48:51], a[0:3]
    ds_read_b64_tr_b16 v[228:229], v235 offset:36992
    ds_read_b64_tr_b16 v[230:231], v235 offset:43136
    v_mfma_f32_16x16x32_bf16 a[8:11], v[208:211], v[52:55], a[8:11]
    v_mfma_f32_16x16x32_bf16 a[16:19], v[208:211], v[56:59], a[16:19]
    v_mfma_f32_16x16x32_bf16 a[24:27], v[208:211], v[60:63], a[24:27]
    v_mfma_f32_16x16x32_bf16 a[4:7], v[212:215], v[48:51], a[4:7]
    ds_read_b64_tr_b16 v[208:209], v236 offset:36992
    ds_read_b64_tr_b16 v[210:211], v236 offset:43136
    buffer_load_dwordx4 v240, s[48:51], s36 offen offset:2048  lds
    v_mfma_f32_16x16x32_bf16 a[12:15], v[212:215], v[52:55], a[12:15]
    v_mfma_f32_16x16x32_bf16 a[20:23], v[212:215], v[56:59], a[20:23]
    v_mfma_f32_16x16x32_bf16 a[28:31], v[212:215], v[60:63], a[28:31]
    s_waitcnt lgkmcnt(6)
    v_mfma_f32_16x16x32_bf16 a[32:35], v[216:219], v[48:51], a[32:35]
    ds_read_b64_tr_b16 v[212:213], v237 offset:36992
    ds_read_b64_tr_b16 v[214:215], v237 offset:43136
    v_mfma_f32_16x16x32_bf16 a[40:43], v[216:219], v[52:55], a[40:43]
    v_mfma_f32_16x16x32_bf16 a[48:51], v[216:219], v[56:59], a[48:51]
    v_mfma_f32_16x16x32_bf16 a[56:59], v[216:219], v[60:63], a[56:59]
    v_mfma_f32_16x16x32_bf16 a[36:39], v[220:223], v[48:51], a[36:39]
    ds_read_b64_tr_b16 v[216:217], v234 offset:37120
    ds_read_b64_tr_b16 v[218:219], v234 offset:43264
    v_mfma_f32_16x16x32_bf16 a[44:47], v[220:223], v[52:55], a[44:47]
    s_add_u32 m0, s34, 3072
    s_nop 0
    buffer_load_dwordx4 v241, s[48:51], s36 offen offset:0  lds
    v_mfma_f32_16x16x32_bf16 a[52:55], v[220:223], v[56:59], a[52:55]
    v_mfma_f32_16x16x32_bf16 a[60:63], v[220:223], v[60:63], a[60:63]
    s_waitcnt lgkmcnt(6)
    v_mfma_f32_16x16x32_bf16 a[64:67], v[224:227], v[48:51], a[64:67]
    ds_read_b64_tr_b16 v[220:221], v235 offset:37120
    ds_read_b64_tr_b16 v[222:223], v235 offset:43264
    v_mfma_f32_16x16x32_bf16 a[72:75], v[224:227], v[52:55], a[72:75]
    v_mfma_f32_16x16x32_bf16 a[80:83], v[224:227], v[56:59], a[80:83]
    v_mfma_f32_16x16x32_bf16 a[88:91], v[224:227], v[60:63], a[88:91]
    v_mfma_f32_16x16x32_bf16 a[68:71], v[228:231], v[48:51], a[68:71]
    ds_read_b64_tr_b16 v[224:225], v236 offset:37120
    ds_read_b64_tr_b16 v[226:227], v236 offset:43264
    buffer_load_dwordx4 v242, s[48:51], s36 offen offset:1024  lds
    v_mfma_f32_16x16x32_bf16 a[76:79], v[228:231], v[52:55], a[76:79]
    v_mfma_f32_16x16x32_bf16 a[84:87], v[228:231], v[56:59], a[84:87]
    v_mfma_f32_16x16x32_bf16 a[92:95], v[228:231], v[60:63], a[92:95]
    s_waitcnt lgkmcnt(6)
    v_mfma_f32_16x16x32_bf16 a[96:99], v[208:211], v[48:51], a[96:99]
    ds_read_b64_tr_b16 v[228:229], v237 offset:37120
    ds_read_b64_tr_b16 v[230:231], v237 offset:43264
    v_mfma_f32_16x16x32_bf16 a[104:107], v[208:211], v[52:55], a[104:107]
    v_mfma_f32_16x16x32_bf16 a[112:115], v[208:211], v[56:59], a[112:115]
    v_mfma_f32_16x16x32_bf16 a[120:123], v[208:211], v[60:63], a[120:123]
    v_mfma_f32_16x16x32_bf16 a[100:103], v[212:215], v[48:51], a[100:103]
    v_add_u32 v234, 0xc000, v234
    v_add_u32 v235, 0xc000, v235
    v_add_u32 v236, 0xc000, v236
    v_add_u32 v237, 0xc000, v237
    ds_read_b64_tr_b16 v[208:209], v234 offset:0
    ds_read_b64_tr_b16 v[210:211], v234 offset:6144
    v_mfma_f32_16x16x32_bf16 a[108:111], v[212:215], v[52:55], a[108:111]
    buffer_load_dwordx4 v243, s[48:51], s36 offen offset:2048  lds
    s_add_u32 s36, s36, 786432
    v_mfma_f32_16x16x32_bf16 a[116:119], v[212:215], v[56:59], a[116:119]
    v_mfma_f32_16x16x32_bf16 a[124:127], v[212:215], v[60:63], a[124:127]
    s_waitcnt lgkmcnt(6)
    v_mfma_f32_16x16x32_bf16 a[128:131], v[216:219], v[48:51], a[128:131]
    ds_read_b64_tr_b16 v[212:213], v235 offset:0
    ds_read_b64_tr_b16 v[214:215], v235 offset:6144
    v_mfma_f32_16x16x32_bf16 a[136:139], v[216:219], v[52:55], a[136:139]
    v_mfma_f32_16x16x32_bf16 a[144:147], v[216:219], v[56:59], a[144:147]
    v_mfma_f32_16x16x32_bf16 a[152:155], v[216:219], v[60:63], a[152:155]
    v_mfma_f32_16x16x32_bf16 a[132:135], v[220:223], v[48:51], a[132:135]
    ds_read_b64_tr_b16 v[216:217], v236 offset:0
    ds_read_b64_tr_b16 v[218:219], v236 offset:6144
    v_mfma_f32_16x16x32_bf16 a[140:143], v[220:223], v[52:55], a[140:143]
    v_mfma_f32_16x16x32_bf16 a[148:151], v[220:223], v[56:59], a[148:151]
    v_mfma_f32_16x16x32_bf16 a[156:159], v[220:223], v[60:63], a[156:159]
    s_waitcnt lgkmcnt(6)
    v_mfma_f32_16x16x32_bf16 a[160:163], v[224:227], v[48:51], a[160:163]
    ds_read_b64_tr_b16 v[220:221], v237 offset:0
    ds_read_b64_tr_b16 v[222:223], v237 offset:6144
    v_mfma_f32_16x16x32_bf16 a[168:171], v[224:227], v[52:55], a[168:171]
    v_mfma_f32_16x16x32_bf16 a[176:179], v[224:227], v[56:59], a[176:179]
    v_mfma_f32_16x16x32_bf16 a[184:187], v[224:227], v[60:63], a[184:187]
    v_mfma_f32_16x16x32_bf16 a[164:167], v[228:231], v[48:51], a[164:167]
    ds_read_b64_tr_b16 v[224:225], v234 offset:128
    ds_read_b64_tr_b16 v[226:227], v234 offset:6272
    v_mfma_f32_16x16x32_bf16 a[172:175], v[228:231], v[52:55], a[172:175]
    v_mfma_f32_16x16x32_bf16 a[180:183], v[228:231], v[56:59], a[180:183]
    v_mfma_f32_16x16x32_bf16 a[188:191], v[228:231], v[60:63], a[188:191]
    s_cmp_lg_u32 s32, 0
    s_cbranch_scc1 Lx_skip
    s_mov_b32 s64, s26
    s_mov_b32 s65, s27
    s_mov_b32 s66, 256
    s_mov_b32 s67, 0x00020000
    s_lshr_b32 s39, s30, 2
    s_lshl_b32 s39, s39, 7
    s_and_b32 s63, s30, 3
    s_lshl_b32 s63, s63, 4
    s_add_u32 s39, s39, s63
Lx_poll:
    buffer_load_dword v253, v252, s[64:67], s39 offen sc1
    s_waitcnt vmcnt(0)
    v_readfirstlane_b32 s62, v253
    s_nop 3
    s_cmp_ge_u32 s62, 20
    s_cbranch_scc1 Lx_poll_go
    s_sleep 4
    s_branch Lx_poll
Lx_poll_go:
Lx_skip:
    s_barrier
    s_mov_b32 s63, 6144
    buffer_load_dwordx4 v[96:99], v244, s[52:55], s63 offen offset:0 sc1
    s_mov_b32 s63, 6144
    buffer_load_dwordx4 v[112:115], v244, s[52:55], s63 offen offset:1024 sc1
    s_mov_b32 s63, 26624
    buffer_load_dwordx4 v[100:103], v244, s[52:55], s63 offen offset:0 sc1
    s_mov_b32 s63, 26624
    buffer_load_dwordx4 v[116:119], v244, s[52:55], s63 offen offset:1024 sc1
    s_mov_b32 s63, 47104
    buffer_load_dwordx4 v[104:107], v244, s[52:55], s63 offen offset:0 sc1
    s_mov_b32 s63, 47104
    buffer_load_dwordx4 v[120:123], v244, s[52:55], s63 offen offset:1024 sc1
    s_mov_b32 s63, 67584
    buffer_load_dwordx4 v[108:111], v244, s[52:55], s63 offen offset:0 sc1
    s_mov_b32 s63, 67584
    buffer_load_dwordx4 v[124:127], v244, s[52:55], s63 offen offset:1024 sc1
    s_mov_b32 s63, 8192
    buffer_load_dwordx4 v[128:131], v244, s[52:55], s63 offen offset:0 sc1
    s_mov_b32 s63, 8192
    buffer_load_dwordx4 v[144:147], v244, s[52:55], s63 offen offset:1024 sc1
    s_mov_b32 s63, 28672
    buffer_load_dwordx4 v[132:135], v244, s[52:55], s63 offen offset:0 sc1
    s_mov_b32 s63, 28672
    buffer_load_dwordx4 v[148:151], v244, s[52:55], s63 offen offset:1024 sc1
    s_mov_b32 s63, 49152
    buffer_load_dwordx4 v[136:139], v244, s[52:55], s63 offen offset:0 sc1
    s_mov_b32 s63, 49152
    buffer_load_dwordx4 v[152:155], v244, s[52:55], s63 offen offset:1024 sc1
    s_mov_b32 s63, 69632
    buffer_load_dwordx4 v[140:143], v244, s[52:55], s63 offen offset:0 sc1
    s_mov_b32 s63, 69632
    buffer_load_dwordx4 v[156:159], v244, s[52:55], s63 offen offset:1024 sc1
    s_mov_b32 s63, 10240
    buffer_load_dwordx4 v[0:3], v244, s[52:55], s63 offen offset:0 sc1
    s_mov_b32 s63, 10240
    buffer_load_dwordx4 v[16:19], v244, s[52:55], s63 offen offset:1024 sc1
    s_mov_b32 s63, 30720
    buffer_load_dwordx4 v[4:7], v244, s[52:55], s63 offen offset:0 sc1
    s_mov_b32 s63, 30720
    buffer_load_dwordx4 v[20:23], v244, s[52:55], s63 offen offset:1024 sc1
    s_mov_b32 s63, 51200
    buffer_load_dwordx4 v[8:11], v244, s[52:55], s63 offen offset:0 sc1
    s_mov_b32 s63, 51200
    buffer_load_dwordx4 v[24:27], v244, s[52:55], s63 offen offset:1024 sc1
    s_mov_b32 s63, 71680
    buffer_load_dwordx4 v[12:15], v244, s[52:55], s63 offen offset:0 sc1
    s_mov_b32 s63, 71680
    buffer_load_dwordx4 v[28:31], v244, s[52:55], s63 offen offset:1024 sc1
Lpass:
    s_waitcnt vmcnt(61)
    s_waitcnt lgkmcnt(6)
    v_mfma_f32_16x16x32_bf16 a[0:3], v[208:211], v[64:67], a[0:3]
    ds_read_b64_tr_b16 v[228:229], v235 offset:128
    ds_read_b64_tr_b16 v[230:231], v235 offset:6272
    v_mfma_f32_16x16x32_bf16 a[8:11], v[208:211], v[68:71], a[8:11]
    s_mov_b32 s63, 12288
    buffer_load_dwordx4 v[32:35], v244, s[52:55], s63 offen offset:0 sc1
    v_mfma_f32_16x16x32_bf16 a[16:19], v[208:211], v[72:75], a[16:19]
    v_mfma_f32_16x16x32_bf16 a[24:27], v[208:211], v[76:79], a[24:27]
    v_mfma_f32_16x16x32_bf16 a[4:7], v[212:215], v[64:67], a[4:7]
    ds_read_b64_tr_b16 v[208:209], v236 offset:128
    ds_read_b64_tr_b16 v[210:211], v236 offset:6272
    v_mfma_f32_16x16x32_bf16 a[12:15], v[212:215], v[68:71], a[12:15]
    s_mov_b32 s63, 12288
    buffer_load_dwordx4 v[48:51], v244, s[52:55], s63 offen offset:1024 sc1
    v_mfma_f32_16x16x32_bf16 a[20:23], v[212:215], v[72:75], a[20:23]
    v_mfma_f32_16x16x32_bf16 a[28:31], v[212:215], v[76:79], a[28:31]
    s_waitcnt lgkmcnt(6)
    v_mfma_f32_16x16x32_bf16 a[32:35], v[216:219], v[64:67], a[32:35]
    ds_read_b64_tr_b16 v[212:213], v237 offset:128
    ds_read_b64_tr_b16 v[214:215], v237 offset:6272
    v_mfma_f32_16x16x32_bf16 a[40:43], v[216:219], v[68:71], a[40:43]
    s_mov_b32 s63, 32768
    buffer_load_dwordx4 v[36:39], v244, s[52:55], s63 offen offset:0 sc1
    v_mfma_f32_16x16x32_bf16 a[48:51], v[216:219], v[72:75], a[48:51]
    v_mfma_f32_16x16x32_bf16 a[56:59], v[216:219], v[76:79], a[56:59]
    v_mfma_f32_16x16x32_bf16 a[36:39], v[220:223], v[64:67], a[36:39]
    ds_read_b64_tr_b16 v[216:217], v234 offset:256
    ds_read_b64_tr_b16 v[218:219], v234 offset:6400
    v_mfma_f32_16x16x32_bf16 a[44:47], v[220:223], v[68:71], a[44:47]
    s_mov_b32 s63, 32768
    buffer_load_dwordx4 v[52:55], v244, s[52:55], s63 offen offset:1024 sc1
    v_mfma_f32_16x16x32_bf16 a[52:55], v[220:223], v[72:75], a[52:55]
    v_mfma_f32_16x16x32_bf16 a[60:63], v[220:223], v[76:79], a[60:63]
    s_waitcnt lgkmcnt(6)
    v_mfma_f32_16x16x32_bf16 a[64:67], v[224:227], v[64:67], a[64:67]
    ds_read_b64_tr_b16 v[220:221], v235 offset:256
    ds_read_b64_tr_b16 v[222:223], v235 offset:6400
    v_mfma_f32_16x16x32_bf16 a[72:75], v[224:227], v[68:71], a[72:75]
    s_mov_b32 s63, 53248
    buffer_load_dwordx4 v[40:43], v244, s[52:55], s63 offen offset:0 sc1
    v_mfma_f32_16x16x32_bf16 a[80:83], v[224:227], v[72:75], a[80:83]
    v_mfma_f32_16x16x32_bf16 a[88:91], v[224:227], v[76:79], a[88:91]
    v_mfma_f32_16x16x32_bf16 a[68:71], v[228:231], v[64:67], a[68:71]
    ds_read_b64_tr_b16 v[224:225], v236 offset:256
    ds_read_b64_tr_b16 v[226:227], v236 offset:6400
    v_mfma_f32_16x16x32_bf16 a[76:79], v[228:231], v[68:71], a[76:79]
    s_mov_b32 s63, 53248
    buffer_load_dwordx4 v[56:59], v244, s[52:55], s63 offen offset:1024 sc1
    v_mfma_f32_16x16x32_bf16 a[84:87], v[228:231], v[72:75], a[84:87]
    v_mfma_f32_16x16x32_bf16 a[92:95], v[228:231], v[76:79], a[92:95]
    s_waitcnt lgkmcnt(6)
    v_mfma_f32_16x16x32_bf16 a[96:99], v[208:211], v[64:67], a[96:99]
    ds_read_b64_tr_b16 v[228:229], v237 offset:256
    ds_read_b64_tr_b16 v[230:231], v237 offset:6400
    v_mfma_f32_16x16x32_bf16 a[104:107], v[208:211], v[68:71], a[104:107]
    s_mov_b32 s63, 73728
    buffer_load_dwordx4 v[44:47], v244, s[52:55], s63 offen offset:0 sc1
    v_mfma_f32_16x16x32_bf16 a[112:115], v[208:211], v[72:75], a[112:115]
    v_mfma_f32_16x16x32_bf16 a[120:123], v[208:211], v[76:79], a[120:123]
    v_mfma_f32_16x16x32_bf16 a[100:103], v[212:215], v[64:67], a[100:103]
    ds_read_b64_tr_b16 v[208:209], v234 offset:12288
    ds_read_b64_tr_b16 v[210:211], v234 offset:18432
    v_mfma_f32_16x16x32_bf16 a[108:111], v[212:215], v[68:71], a[108:111]
    s_mov_b32 s63, 73728
    buffer_load_dwordx4 v[60:63], v244, s[52:55], s63 offen offset:1024 sc1
    v_mfma_f32_16x16x32_bf16 a[116:119], v[212:215], v[72:75], a[116:119]
    v_mfma_f32_16x16x32_bf16 a[124:127], v[212:215], v[76:79], a[124:127]
    s_waitcnt lgkmcnt(6)
    v_mfma_f32_16x16x32_bf16 a[128:131], v[216:219], v[64:67], a[128:131]
    ds_read_b64_tr_b16 v[212:213], v235 offset:12288
    ds_read_b64_tr_b16 v[214:215], v235 offset:18432
    v_mfma_f32_16x16x32_bf16 a[136:139], v[216:219], v[68:71], a[136:139]
    v_mfma_f32_16x16x32_bf16 a[144:147], v[216:219], v[72:75], a[144:147]
    v_mfma_f32_16x16x32_bf16 a[152:155], v[216:219], v[76:79], a[152:155]
    s_waitcnt vmcnt(28)
    s_waitcnt vmcnt(50)
    s_barrier
    s_cmp_eq_u32 s69, 0
    s_cbranch_scc1 Lrs0
    s_cmp_lg_u32 s32, 0
    s_cbranch_scc1 Lrs0
    s_lshl_b32 s62, s30, 11
    s_lshr_b32 s63, s31, 3
    s_add_u32 s63, s63, 0
    s_lshl_b32 s63, s63, 7
    s_add_u32 s62, s62, s63
    s_add_u32 s62, s62, 0x5d00000
    s_add_u32 s64, s28, s62
    s_addc_u32 s65, s29, 0
    s_mov_b32 s66, 4
    s_mov_b32 s67, 0x00020000
    v_mov_b32 v252, 0
    v_mov_b32 v253, 1
    s_mov_b64 exec, 1
    buffer_atomic_add v253, v252, s[64:67], 0 offen
    s_mov_b64 exec, -1
Lrs0:
    v_mfma_f32_16x16x32_bf16 a[132:135], v[220:223], v[64:67], a[132:135]
    ds_read_b64_tr_b16 v[216:217], v236 offset:12288
    ds_read_b64_tr_b16 v[218:219], v236 offset:18432
    v_mfma_f32_16x16x32_bf16 a[140:143], v[220:223], v[68:71], a[140:143]
    s_add_u32 m0, s34, 24576
    s_nop 0
    buffer_load_dwordx4 v238, s[48:51], s36 offen offset:0  lds
    v_mfma_f32_16x16x32_bf16 a[148:151], v[220:223], v[72:75], a[148:151]
    v_mfma_f32_16x16x32_bf16 a[156:159], v[220:223], v[76:79], a[156:159]
    s_waitcnt lgkmcnt(6)
    v_mfma_f32_16x16x32_bf16 a[160:163], v[224:227], v[64:67], a[160:163]
    ds_read_b64_tr_b16 v[220:221], v237 offset:12288
    ds_read_b64_tr_b16 v[222:223], v237 offset:18432
    v_mfma_f32_16x16x32_bf16 a[168:171], v[224:227], v[68:71], a[168:171]
    v_mfma_f32_16x16x32_bf16 a[176:179], v[224:227], v[72:75], a[176:179]
    v_mfma_f32_16x16x32_bf16 a[184:187], v[224:227], v[76:79], a[184:187]
    v_mfma_f32_16x16x32_bf16 a[164:167], v[228:231], v[64:67], a[164:167]
    ds_read_b64_tr_b16 v[224:225], v234 offset:12416
    ds_read_b64_tr_b16 v[226:227], v234 offset:18560
    buffer_load_dwordx4 v239, s[48:51], s36 offen offset:1024  lds
    v_mfma_f32_16x16x32_bf16 a[172:175], v[228:231], v[68:71], a[172:175]
    v_mfma_f32_16x16x32_bf16 a[180:183], v[228:231], v[72:75], a[180:183]
    v_mfma_f32_16x16x32_bf16 a[188:191], v[228:231], v[76:79], a[188:191]
    s_waitcnt lgkmcnt(6)
    v_mfma_f32_16x16x32_bf16 a[0:3], v[208:211], v[80:83], a[0:3]
    ds_read_b64_tr_b16 v[228:229], v235 offset:12416
    ds_read_b64_tr_b16 v[230:231], v235 offset:18560
    v_mfma_f32_16x16x32_bf16 a[8:11], v[208:211], v[84:87], a[8:11]
    v_mfma_f32_16x16x32_bf16 a[16:19], v[208:211], v[88:91], a[16:19]
    v_mfma_f32_16x16x32_bf16 a[24:27], v[208:211], v[92:95], a[24:27]
    v_mfma_f32_16x16x32_bf16 a[4:7], v[212:215], v[80:83], a[4:7]
    ds_read_b64_tr_b16 v[208:209], v236 offset:12416
    ds_read_b64_tr_b16 v[210:211], v236 offset:18560
    buffer_load_dwordx4 v240, s[48:51], s36 offen offset:2048  lds
    v_mfma_f32_16x16x32_bf16 a[12:15], v[212:215], v[84:87], a[12:15]
    v_mfma_f32_16x16x32_bf16 a[20:23], v[212:215], v[88:91], a[20:23]
    v_mfma_f32_16x16x32_bf16 a[28:31], v[212:215], v[92:95], a[28:31]
    s_waitcnt lgkmcnt(6)
    v_mfma_f32_16x16x32_bf16 a[32:35], v[216:219], v[80:83], a[32:35]
    ds_read_b64_tr_b16 v[212:213], v237 offset:12416
    ds_read_b64_tr_b16 v[214:215], v237 offset:18560
    v_mfma_f32_16x16x32_bf16 a[40:43], v[216:219], v[84:87], a[40:43]
    v_mfma_f32_16x16x32_bf16 a[48:51], v[216:219], v[88:91], a[48:51]
    v_mfma_f32_16x16x32_bf16 a[56:59], v[216:219], v[92:95], a[56:59]
    v_mfma_f32_16x16x32_bf16 a[36:39], v[220:223], v[80:83], a[36:39]
    ds_read_b64_tr_b16 v[216:217], v234 offset:12544
    ds_read_b64_tr_b16 v[218:219], v234 offset:18688
    v_mfma_f32_16x16x32_bf16 a[44:47], v[220:223], v[84:87], a[44:47]
    s_add_u32 m0, s34, 27648
    s_nop 0
    buffer_load_dwordx4 v241, s[48:51], s36 offen offset:0  lds
    v_mfma_f32_16x16x32_bf16 a[52:55], v[220:223], v[88:91], a[52:55]
    v_mfma_f32_16x16x32_bf16 a[60:63], v[220:223], v[92:95], a[60:63]
    s_waitcnt lgkmcnt(6)
    v_mfma_f32_16x16x32_bf16 a[64:67], v[224:227], v[80:83], a[64:67]
    ds_read_b64_tr_b16 v[220:221], v235 offset:12544
    ds_read_b64_tr_b16 v[222:223], v235 offset:18688
    v_mfma_f32_16x16x32_bf16 a[72:75], v[224:227], v[84:87], a[72:75]
    v_mfma_f32_16x16x32_bf16 a[80:83], v[224:227], v[88:91], a[80:83]
    v_mfma_f32_16x16x32_bf16 a[88:91], v[224:227], v[92:95], a[88:91]
    v_mfma_f32_16x16x32_bf16 a[68:71], v[228:231], v[80:83], a[68:71]
    ds_read_b64_tr_b16 v[224:225], v236 offset:12544
    ds_read_b64_tr_b16 v[226:227], v236 offset:18688
    buffer_load_dwordx4 v242, s[48:51], s36 offen offset:1024  lds
    v_mfma_f32_16x16x32_bf16 a[76:79], v[228:231], v[84:87], a[76:79]
    v_mfma_f32_16x16x32_bf16 a[84:87], v[228:231], v[88:91], a[84:87]
    v_mfma_f32_16x16x32_bf16 a[92:95], v[228:231], v[92:95], a[92:95]
    s_waitcnt lgkmcnt(6)
    v_mfma_f32_16x16x32_bf16 a[96:99], v[208:211], v[80:83], a[96:99]
    ds_read_b64_tr_b16 v[228:229], v237 offset:12544
    ds_read_b64_tr_b16 v[230:231], v237 offset:18688
    v_mfma_f32_16x16x32_bf16 a[104:107], v[208:211], v[84:87], a[104:107]
    v_mfma_f32_16x16x32_bf16 a[112:115], v[208:211], v[88:91], a[112:115]
    v_mfma_f32_16x16x32_bf16 a[120:123], v[208:211], v[92:95], a[120:123]
    v_mfma_f32_16x16x32_bf16 a[100:103], v[212:215], v[80:83], a[100:103]
    ds_read_b64_tr_b16 v[208:209], v234 offset:24576
    ds_read_b64_tr_b16 v[210:211], v234 offset:30720
    v_mfma_f32_16x16x32_bf16 a[108:111], v[212:215], v[84:87], a[108:111]
    buffer_load_dwordx4 v243, s[48:51], s36 offen offset:2048  lds
    s_add_u32 s36, s36, 786432
    v_mfma_f32_16x16x32_bf16 a[116:119], v[212:215], v[88:91], a[116:119]
    v_mfma_f32_16x16x32_bf16 a[124:127], v[212:215], v[92:95], a[124:127]
    s_waitcnt lgkmcnt(6)
    v_mfma_f32_16x16x32_bf16 a[128:131], v[216:219], v[80:83], a[128:131]
    ds_read_b64_tr_b16 v[212:213], v235 offset:24576
    ds_read_b64_tr_b16 v[214:215], v235 offset:30720
    v_mfma_f32_16x16x32_bf16 a[136:139], v[216:219], v[84:87], a[136:139]
    v_mfma_f32_16x16x32_bf16 a[144:147], v[216:219], v[88:91], a[144:147]
    v_mfma_f32_16x16x32_bf16 a[152:155], v[216:219], v[92:95], a[152:155]
    v_mfma_f32_16x16x32_bf16 a[132:135], v[220:223], v[80:83], a[132:135]
    ds_read_b64_tr_b16 v[216:217], v236 offset:24576
    ds_read_b64_tr_b16 v[218:219], v236 offset:30720
    v_mfma_f32_16x16x32_bf16 a[140:143], v[220:223], v[84:87], a[140:143]
    v_mfma_f32_16x16x32_bf16 a[148:151], v[220:223], v[88:91], a[148:151]
    v_mfma_f32_16x16x32_bf16 a[156:159], v[220:223], v[92:95], a[156:159]
    s_waitcnt lgkmcnt(6)
    v_mfma_f32_16x16x32_bf16 a[160:163], v[224:227], v[80:83], a[160:163]
    ds_read_b64_tr_b16 v[220:221], v237 offset:24576
    ds_read_b64_tr_b16 v[222:223], v237 offset:30720
    v_mfma_f32_16x16x32_bf16 a[168:171], v[224:227], v[84:87], a[168:171]
    v_mfma_f32_16x16x32_bf16 a[176:179], v[224:227], v[88:91], a[176:179]
    v_mfma_f32_16x16x32_bf16 a[184:187], v[224:227], v[92:95], a[184:187]
    v_mfma_f32_16x16x32_bf16 a[164:167], v[228:231], v[80:83], a[164:167]
    ds_read_b64_tr_b16 v[224:225], v234 offset:24704
    ds_read_b64_tr_b16 v[226:227], v234 offset:30848
    v_mfma_f32_16x16x32_bf16 a[172:175], v[228:231], v[84:87], a[172:175]
    v_mfma_f32_16x16x32_bf16 a[180:183], v[228:231], v[88:91], a[180:183]
    v_mfma_f32_16x16x32_bf16 a[188:191], v[228:231], v[92:95], a[188:191]
    s_waitcnt vmcnt(30)
    s_waitcnt lgkmcnt(6)
    v_mfma_f32_16x16x32_bf16 a[0:3], v[208:211], v[96:99], a[0:3]
    ds_read_b64_tr_b16 v[228:229], v235 offset:24704
    ds_read_b64_tr_b16 v[230:231], v235 offset:30848
    v_mfma_f32_16x16x32_bf16 a[8:11], v[208:211], v[100:103], a[8:11]
    s_mov_b32 s63, 14336
    buffer_load_dwordx4 v[64:67], v244, s[52:55], s63 offen offset:0 sc1
    v_mfma_f32_16x16x32_bf16 a[16:19], v[208:211], v[104:107], a[16:19]
    v_mfma_f32_16x16x32_bf16 a[24:27], v[208:211], v[108:111], a[24:27]
    v_mfma_f32_16x16x32_bf16 a[4:7], v[212:215], v[96:99], a[4:7]
    ds_read_b64_tr_b16 v[208:209], v236 offset:24704
    ds_read_b64_tr_b16 v[210:211], v236 offset:30848
    v_mfma_f32_16x16x32_bf16 a[12:15], v[212:215], v[100:103], a[12:15]
    s_mov_b32 s63, 14336
    buffer_load_dwordx4 v[80:83], v244, s[52:55], s63 offen offset:1024 sc1
    v_mfma_f32_16x16x32_bf16 a[20:23], v[212:215], v[104:107], a[20:23]
    v_mfma_f32_16x16x32_bf16 a[28:31], v[212:215], v[108:111], a[28:31]
    s_waitcnt lgkmcnt(6)
    v_mfma_f32_16x16x32_bf16 a[32:35], v[216:219], v[96:99], a[32:35]
    ds_read_b64_tr_b16 v[212:213], v237 offset:24704
    ds_read_b64_tr_b16 v[214:215], v237 offset:30848
    v_mfma_f32_16x16x32_bf16 a[40:43], v[216:219], v[100:103], a[40:43]
    s_mov_b32 s63, 34816
    buffer_load_dwordx4 v[68:71], v244, s[52:55], s63 offen offset:0 sc1
    v_mfma_f32_16x16x32_bf16 a[48:51], v[216:219], v[104:107], a[48:51]
    v_mfma_f32_16x16x32_bf16 a[56:59], v[216:219], v[108:111], a[56:59]
    v_mfma_f32_16x16x32_bf16 a[36:39], v[220:223], v[96:99], a[36:39]
    ds_read_b64_tr_b16 v[216:217], v234 offset:24832
    ds_read_b64_tr_b16 v[218:219], v234 offset:30976
    v_mfma_f32_16x16x32_bf16 a[44:47], v[220:223], v[100:103], a[44:47]
    s_mov_b32 s63, 34816
    buffer_load_dwordx4 v[84:87], v244, s[52:55], s63 offen offset:1024 sc1
    v_mfma_f32_16x16x32_bf16 a[52:55], v[220:223], v[104:107], a[52:55]
    v_mfma_f32_16x16x32_bf16 a[60:63], v[220:223], v[108:111], a[60:63]
    s_waitcnt lgkmcnt(6)
    v_mfma_f32_16x16x32_bf16 a[64:67], v[224:227], v[96:99], a[64:67]
    ds_read_b64_tr_b16 v[220:221], v235 offset:24832
    ds_read_b64_tr_b16 v[222:223], v235 offset:30976
    v_mfma_f32_16x16x32_bf16 a[72:75], v[224:227], v[100:103], a[72:75]
    s_mov_b32 s63, 55296
    buffer_load_dwordx4 v[72:75], v244, s[52:55], s63 offen offset:0 sc1
    v_mfma_f32_16x16x32_bf16 a[80:83], v[224:227], v[104:107], a[80:83]
    v_mfma_f32_16x16x32_bf16 a[88:91], v[224:227], v[108:111], a[88:91]
    v_mfma_f32_16x16x32_bf16 a[68:71], v[228:231], v[96:99], a[68:71]
    ds_read_b64_tr_b16 v[224:225], v236 offset:24832
    ds_read_b64_tr_b16 v[226:227], v236 offset:30976
    v_mfma_f32_16x16x32_bf16 a[76:79], v[228:231], v[100:103], a[76:79]
    s_mov_b32 s63, 55296
    buffer_load_dwordx4 v[88:91], v244, s[52:55], s63 offen offset:1024 sc1
    v_mfma_f32_16x16x32_bf16 a[84:87], v[228:231], v[104:107], a[84:87]
    v_mfma_f32_16x16x32_bf16 a[92:95], v[228:231], v[108:111], a[92:95]
    s_waitcnt lgkmcnt(6)
    v_mfma_f32_16x16x32_bf16 a[96:99], v[208:211], v[96:99], a[96:99]
    ds_read_b64_tr_b16 v[228:229], v237 offset:24832
    ds_read_b64_tr_b16 v[230:231], v237 offset:30976
    v_mfma_f32_16x16x32_bf16 a[104:107], v[208:211], v[100:103], a[104:107]
    s_mov_b32 s63, 75776
    buffer_load_dwordx4 v[76:79], v244, s[52:55], s63 offen offset:0 sc1
    v_mfma_f32_16x16x32_bf16 a[112:115], v[208:211], v[104:107], a[112:115]
    v_mfma_f32_16x16x32_bf16 a[120:123], v[208:211], v[108:111], a[120:123]
    v_mfma_f32_16x16x32_bf16 a[100:103], v[212:215], v[96:99], a[100:103]
    ds_read_b64_tr_b16 v[208:209], v234 offset:36864
    ds_read_b64_tr_b16 v[210:211], v234 offset:43008
    v_mfma_f32_16x16x32_bf16 a[108:111], v[212:215], v[100:103], a[108:111]
    s_mov_b32 s63, 75776
    buffer_load_dwordx4 v[92:95], v244, s[52:55], s63 offen offset:1024 sc1
    v_mfma_f32_16x16x32_bf16 a[116:119], v[212:215], v[104:107], a[116:119]
    v_mfma_f32_16x16x32_bf16 a[124:127], v[212:215], v[108:111], a[124:127]
    s_waitcnt lgkmcnt(6)
    v_mfma_f32_16x16x32_bf16 a[128:131], v[216:219], v[96:99], a[128:131]
    ds_read_b64_tr_b16 v[212:213], v235 offset:36864
    ds_read_b64_tr_b16 v[214:215], v235 offset:43008
    v_mfma_f32_16x16x32_bf16 a[136:139], v[216:219], v[100:103], a[136:139]
    v_mfma_f32_16x16x32_bf16 a[144:147], v[216:219], v[104:107], a[144:147]
    v_mfma_f32_16x16x32_bf16 a[152:155], v[216:219], v[108:111], a[152:155]
    s_barrier
    v_mfma_f32_16x16x32_bf16 a[132:135], v[220:223], v[96:99], a[132:135]
    ds_read_b64_tr_b16 v[216:217], v236 offset:36864
    ds_read_b64_tr_b16 v[218:219], v236 offset:43008
    v_mfma_f32_16x16x32_bf16 a[140:143], v[220:223], v[100:103], a[140:143]
    s_add_u32 m0, s34, 49152
    s_nop 0
    buffer_load_dwordx4 v238, s[48:51], s36 offen offset:0  lds
    v_mfma_f32_16x16x32_bf16 a[148:151], v[220:223], v[104:107], a[148:151]
    v_mfma_f32_16x16x32_bf16 a[156:159], v[220:223], v[108:111], a[156:159]
    s_waitcnt lgkmcnt(6)
    v_mfma_f32_16x16x32_bf16 a[160:163], v[224:227], v[96:99], a[160:163]
    ds_read_b64_tr_b16 v[220:221], v237 offset:36864
    ds_read_b64_tr_b16 v[222:223], v237 offset:43008
    v_mfma_f32_16x16x32_bf16 a[168:171], v[224:227], v[100:103], a[168:171]
    v_mfma_f32_16x16x32_bf16 a[176:179], v[224:227], v[104:107], a[176:179]
    v_mfma_f32_16x16x32_bf16 a[184:187], v[224:227], v[108:111], a[184:187]
    v_mfma_f32_16x16x32_bf16 a[164:167], v[228:231], v[96:99], a[164:167]
    ds_read_b64_tr_b16 v[224:225], v234 offset:36992
    ds_read_b64_tr_b16 v[226:227], v234 offset:43136
    buffer_load_dwordx4 v239, s[48:51], s36 offen offset:1024  lds
    v_mfma_f32_16x16x32_bf16 a[172:175], v[228:231], v[100:103], a[172:175]
    v_mfma_f32_16x16x32_bf16 a[180:183], v[228:231], v[104:107], a[180:183]
    v_mfma_f32_16x16x32_bf16 a[188:191], v[228:231], v[108:111], a[188:191]
    s_waitcnt lgkmcnt(6)
    v_mfma_f32_16x16x32_bf16 a[0:3], v[208:211], v[112:115], a[0:3]
    ds_read_b64_tr_b16 v[228:229], v235 offset:36992
    ds_read_b64_tr_b16 v[230:231], v235 offset:43136
    v_mfma_f32_16x16x32_bf16 a[8:11], v[208:211], v[116:119], a[8:11]
    v_mfma_f32_16x16x32_bf16 a[16:19], v[208:211], v[120:123], a[16:19]
    v_mfma_f32_16x16x32_bf16 a[24:27], v[208:211], v[124:127], a[24:27]
    v_mfma_f32_16x16x32_bf16 a[4:7], v[212:215], v[112:115], a[4:7]
    ds_read_b64_tr_b16 v[208:209], v236 offset:36992
    ds_read_b64_tr_b16 v[210:211], v236 offset:43136
    buffer_load_dwordx4 v240, s[48:51], s36 offen offset:2048  lds
    v_mfma_f32_16x16x32_bf16 a[12:15], v[212:215], v[116:119], a[12:15]
    v_mfma_f32_16x16x32_bf16 a[20:23], v[212:215], v[120:123], a[20:23]
    v_mfma_f32_16x16x32_bf16 a[28:31], v[212:215], v[124:127], a[28:31]
    s_waitcnt lgkmcnt(6)
    v_mfma_f32_16x16x32_bf16 a[32:35], v[216:219], v[112:115], a[32:35]
    ds_read_b64_tr_b16 v[212:213], v237 offset:36992
    ds_read_b64_tr_b16 v[214:215], v237 offset:43136
    v_mfma_f32_16x16x32_bf16 a[40:43], v[216:219], v[116:119], a[40:43]
    v_mfma_f32_16x16x32_bf16 a[48:51], v[216:219], v[120:123], a[48:51]
    v_mfma_f32_16x16x32_bf16 a[56:59], v[216:219], v[124:127], a[56:59]
    v_mfma_f32_16x16x32_bf16 a[36:39], v[220:223], v[112:115], a[36:39]
    ds_read_b64_tr_b16 v[216:217], v234 offset:37120
    ds_read_b64_tr_b16 v[218:219], v234 offset:43264
    v_mfma_f32_16x16x32_bf16 a[44:47], v[220:223], v[116:119], a[44:47]
    s_add_u32 m0, s34, 52224
    s_nop 0
    buffer_load_dwordx4 v241, s[48:51], s36 offen offset:0  lds
    v_mfma_f32_16x16x32_bf16 a[52:55], v[220:223], v[120:123], a[52:55]
    v_mfma_f32_16x16x32_bf16 a[60:63], v[220:223], v[124:127], a[60:63]
    s_waitcnt lgkmcnt(6)
    v_mfma_f32_16x16x32_bf16 a[64:67], v[224:227], v[112:115], a[64:67]
    ds_read_b64_tr_b16 v[220:221], v235 offset:37120
    ds_read_b64_tr_b16 v[222:223], v235 offset:43264
    v_mfma_f32_16x16x32_bf16 a[72:75], v[224:227], v[116:119], a[72:75]
    v_mfma_f32_16x16x32_bf16 a[80:83], v[224:227], v[120:123], a[80:83]
    v_mfma_f32_16x16x32_bf16 a[88:91], v[224:227], v[124:127], a[88:91]
    v_mfma_f32_16x16x32_bf16 a[68:71], v[228:231], v[112:115], a[68:71]
    ds_read_b64_tr_b16 v[224:225], v236 offset:37120
    ds_read_b64_tr_b16 v[226:227], v236 offset:43264
    buffer_load_dwordx4 v242, s[48:51], s36 offen offset:1024  lds
    v_mfma_f32_16x16x32_bf16 a[76:79], v[228:231], v[116:119], a[76:79]
    v_mfma_f32_16x16x32_bf16 a[84:87], v[228:231], v[120:123], a[84:87]
    v_mfma_f32_16x16x32_bf16 a[92:95], v[228:231], v[124:127], a[92:95]
    s_waitcnt lgkmcnt(6)
    v_mfma_f32_16x16x32_bf16 a[96:99], v[208:211], v[112:115], a[96:99]
    ds_read_b64_tr_b16 v[228:229], v237 offset:37120
    ds_read_b64_tr_b16 v[230:231], v237 offset:43264
    v_mfma_f32_16x16x32_bf16 a[104:107], v[208:211], v[116:119], a[104:107]
    v_mfma_f32_16x16x32_bf16 a[112:115], v[208:211], v[120:123], a[112:115]
    v_mfma_f32_16x16x32_bf16 a[120:123], v[208:211], v[124:127], a[120:123]
    v_mfma_f32_16x16x32_bf16 a[100:103], v[212:215], v[112:115], a[100:103]
    v_add_u32 v234, 0xc000, v234
    v_add_u32 v235, 0xc000, v235
    v_add_u32 v236, 0xc000, v236
    v_add_u32 v237, 0xc000, v237
    ds_read_b64_tr_b16 v[208:209], v234 offset:0
    ds_read_b64_tr_b16 v[210:211], v234 offset:6144
    v_mfma_f32_16x16x32_bf16 a[108:111], v[212:215], v[116:119], a[108:111]
    buffer_load_dwordx4 v243, s[48:51], s36 offen offset:2048  lds
    s_add_u32 s36, s36, 786432
    v_mfma_f32_16x16x32_bf16 a[116:119], v[212:215], v[120:123], a[116:119]
    v_mfma_f32_16x16x32_bf16 a[124:127], v[212:215], v[124:127], a[124:127]
    s_waitcnt lgkmcnt(6)
    v_mfma_f32_16x16x32_bf16 a[128:131], v[216:219], v[112:115], a[128:131]
    ds_read_b64_tr_b16 v[212:213], v235 offset:0
    ds_read_b64_tr_b16 v[214:215], v235 offset:6144
    v_mfma_f32_16x16x32_bf16 a[136:139], v[216:219], v[116:119], a[136:139]
    v_mfma_f32_16x16x32_bf16 a[144:147], v[216:219], v[120:123], a[144:147]
    v_mfma_f32_16x16x32_bf16 a[152:155], v[216:219], v[124:127], a[152:155]
    v_mfma_f32_16x16x32_bf16 a[132:135], v[220:223], v[112:115], a[132:135]
    ds_read_b64_tr_b16 v[216:217], v236 offset:0
    ds_read_b64_tr_b16 v[218:219], v236 offset:6144
    v_mfma_f32_16x16x32_bf16 a[140:143], v[220:223], v[116:119], a[140:143]
    v_mfma_f32_16x16x32_bf16 a[148:151], v[220:223], v[120:123], a[148:151]
    v_mfma_f32_16x16x32_bf16 a[156:159], v[220:223], v[124:127], a[156:159]
    s_waitcnt lgkmcnt(6)
    v_mfma_f32_16x16x32_bf16 a[160:163], v[224:227], v[112:115], a[160:163]
    ds_read_b64_tr_b16 v[220:221], v237 offset:0
    ds_read_b64_tr_b16 v[222:223], v237 offset:6144
    v_mfma_f32_16x16x32_bf16 a[168:171], v[224:227], v[116:119], a[168:171]
    v_mfma_f32_16x16x32_bf16 a[176:179], v[224:227], v[120:123], a[176:179]
    v_mfma_f32_16x16x32_bf16 a[184:187], v[224:227], v[124:127], a[184:187]
    v_mfma_f32_16x16x32_bf16 a[164:167], v[228:231], v[112:115], a[164:167]
    ds_read_b64_tr_b16 v[224:225], v234 offset:128
    ds_read_b64_tr_b16 v[226:227], v234 offset:6272
    v_mfma_f32_16x16x32_bf16 a[172:175], v[228:231], v[116:119], a[172:175]
    v_mfma_f32_16x16x32_bf16 a[180:183], v[228:231], v[120:123], a[180:183]
    v_mfma_f32_16x16x32_bf16 a[188:191], v[228:231], v[124:127], a[188:191]
    s_waitcnt vmcnt(36)
    s_waitcnt lgkmcnt(6)
    v_mfma_f32_16x16x32_bf16 a[0:3], v[208:211], v[128:131], a[0:3]
    ds_read_b64_tr_b16 v[228:229], v235 offset:128
    ds_read_b64_tr_b16 v[230:231], v235 offset:6272
    v_mfma_f32_16x16x32_bf16 a[8:11], v[208:211], v[132:135], a[8:11]
    s_mov_b32 s63, 16384
    buffer_load_dwordx4 v[96:99], v244, s[52:55], s63 offen offset:0 sc1
    v_mfma_f32_16x16x32_bf16 a[16:19], v[208:211], v[136:139], a[16:19]
    v_mfma_f32_16x16x32_bf16 a[24:27], v[208:211], v[140:143], a[24:27]
    v_mfma_f32_16x16x32_bf16 a[4:7], v[212:215], v[128:131], a[4:7]
    ds_read_b64_tr_b16 v[208:209], v236 offset:128
    ds_read_b64_tr_b16 v[210:211], v236 offset:6272
    v_mfma_f32_16x16x32_bf16 a[12:15], v[212:215], v[132:135], a[12:15]
    s_mov_b32 s63, 16384
    buffer_load_dwordx4 v[112:115], v244, s[52:55], s63 offen offset:1024 sc1
    v_mfma_f32_16x16x32_bf16 a[20:23], v[212:215], v[136:139], a[20:23]
    v_mfma_f32_16x16x32_bf16 a[28:31], v[212:215], v[140:143], a[28:31]
    s_waitcnt lgkmcnt(6)
    v_mfma_f32_16x16x32_bf16 a[32:35], v[216:219], v[128:131], a[32:35]
    ds_read_b64_tr_b16 v[212:213], v237 offset:128
    ds_read_b64_tr_b16 v[214:215], v237 offset:6272
    v_mfma_f32_16x16x32_bf16 a[40:43], v[216:219], v[132:135], a[40:43]
    s_mov_b32 s63, 36864
    buffer_load_dwordx4 v[100:103], v244, s[52:55], s63 offen offset:0 sc1
    v_mfma_f32_16x16x32_bf16 a[48:51], v[216:219], v[136:139], a[48:51]
    v_mfma_f32_16x16x32_bf16 a[56:59], v[216:219], v[140:143], a[56:59]
    v_mfma_f32_16x16x32_bf16 a[36:39], v[220:223], v[128:131], a[36:39]
    ds_read_b64_tr_b16 v[216:217], v234 offset:256
    ds_read_b64_tr_b16 v[218:219], v234 offset:6400
    v_mfma_f32_16x16x32_bf16 a[44:47], v[220:223], v[132:135], a[44:47]
    s_mov_b32 s63, 36864
    buffer_load_dwordx4 v[116:119], v244, s[52:55], s63 offen offset:1024 sc1
    v_mfma_f32_16x16x32_bf16 a[52:55], v[220:223], v[136:139], a[52:55]
    v_mfma_f32_16x16x32_bf16 a[60:63], v[220:223], v[140:143], a[60:63]
    s_waitcnt lgkmcnt(6)
    v_mfma_f32_16x16x32_bf16 a[64:67], v[224:227], v[128:131], a[64:67]
    ds_read_b64_tr_b16 v[220:221], v235 offset:256
    ds_read_b64_tr_b16 v[222:223], v235 offset:6400
    v_mfma_f32_16x16x32_bf16 a[72:75], v[224:227], v[132:135], a[72:75]
    s_mov_b32 s63, 57344
    buffer_load_dwordx4 v[104:107], v244, s[52:55], s63 offen offset:0 sc1
    v_mfma_f32_16x16x32_bf16 a[80:83], v[224:227], v[136:139], a[80:83]
    v_mfma_f32_16x16x32_bf16 a[88:91], v[224:227], v[140:143], a[88:91]
    v_mfma_f32_16x16x32_bf16 a[68:71], v[228:231], v[128:131], a[68:71]
    ds_read_b64_tr_b16 v[224:225], v236 offset:256
    ds_read_b64_tr_b16 v[226:227], v236 offset:6400
    v_mfma_f32_16x16x32_bf16 a[76:79], v[228:231], v[132:135], a[76:79]
    s_mov_b32 s63, 57344
    buffer_load_dwordx4 v[120:123], v244, s[52:55], s63 offen offset:1024 sc1
    v_mfma_f32_16x16x32_bf16 a[84:87], v[228:231], v[136:139], a[84:87]
    v_mfma_f32_16x16x32_bf16 a[92:95], v[228:231], v[140:143], a[92:95]
    s_waitcnt lgkmcnt(6)
    v_mfma_f32_16x16x32_bf16 a[96:99], v[208:211], v[128:131], a[96:99]
    ds_read_b64_tr_b16 v[228:229], v237 offset:256
    ds_read_b64_tr_b16 v[230:231], v237 offset:6400
    v_mfma_f32_16x16x32_bf16 a[104:107], v[208:211], v[132:135], a[104:107]
    s_mov_b32 s63, 77824
    buffer_load_dwordx4 v[108:111], v244, s[52:55], s63 offen offset:0 sc1
    v_mfma_f32_16x16x32_bf16 a[112:115], v[208:211], v[136:139], a[112:115]
    v_mfma_f32_16x16x32_bf16 a[120:123], v[208:211], v[140:143], a[120:123]
    v_mfma_f32_16x16x32_bf16 a[100:103], v[212:215], v[128:131], a[100:103]
    ds_read_b64_tr_b16 v[208:209], v234 offset:12288
    ds_read_b64_tr_b16 v[210:211], v234 offset:18432
    v_mfma_f32_16x16x32_bf16 a[108:111], v[212:215], v[132:135], a[108:111]
    s_mov_b32 s63, 77824
    buffer_load_dwordx4 v[124:127], v244, s[52:55], s63 offen offset:1024 sc1
    v_mfma_f32_16x16x32_bf16 a[116:119], v[212:215], v[136:139], a[116:119]
    v_mfma_f32_16x16x32_bf16 a[124:127], v[212:215], v[140:143], a[124:127]
    s_waitcnt lgkmcnt(6)
    v_mfma_f32_16x16x32_bf16 a[128:131], v[216:219], v[128:131], a[128:131]
    ds_read_b64_tr_b16 v[212:213], v235 offset:12288
    ds_read_b64_tr_b16 v[214:215], v235 offset:18432
    v_mfma_f32_16x16x32_bf16 a[136:139], v[216:219], v[132:135], a[136:139]
    v_mfma_f32_16x16x32_bf16 a[144:147], v[216:219], v[136:139], a[144:147]
    v_mfma_f32_16x16x32_bf16 a[152:155], v[216:219], v[140:143], a[152:155]
    s_waitcnt vmcnt(50)
    s_barrier
    v_mfma_f32_16x16x32_bf16 a[132:135], v[220:223], v[128:131], a[132:135]
    ds_read_b64_tr_b16 v[216:217], v236 offset:12288
    ds_read_b64_tr_b16 v[218:219], v236 offset:18432
    v_mfma_f32_16x16x32_bf16 a[140:143], v[220:223], v[132:135], a[140:143]
    s_add_u32 m0, s34, 73728
    s_nop 0
    buffer_load_dwordx4 v238, s[48:51], s36 offen offset:0  lds
    v_mfma_f32_16x16x32_bf16 a[148:151], v[220:223], v[136:139], a[148:151]
    v_mfma_f32_16x16x32_bf16 a[156:159], v[220:223], v[140:143], a[156:159]
    s_waitcnt lgkmcnt(6)
    v_mfma_f32_16x16x32_bf16 a[160:163], v[224:227], v[128:131], a[160:163]
    ds_read_b64_tr_b16 v[220:221], v237 offset:12288
    ds_read_b64_tr_b16 v[222:223], v237 offset:18432
    v_mfma_f32_16x16x32_bf16 a[168:171], v[224:227], v[132:135], a[168:171]
    v_mfma_f32_16x16x32_bf16 a[176:179], v[224:227], v[136:139], a[176:179]
    v_mfma_f32_16x16x32_bf16 a[184:187], v[224:227], v[140:143], a[184:187]
    v_mfma_f32_16x16x32_bf16 a[164:167], v[228:231], v[128:131], a[164:167]
    ds_read_b64_tr_b16 v[224:225], v234 offset:12416
    ds_read_b64_tr_b16 v[226:227], v234 offset:18560
    buffer_load_dwordx4 v239, s[48:51], s36 offen offset:1024  lds
    v_mfma_f32_16x16x32_bf16 a[172:175], v[228:231], v[132:135], a[172:175]
    v_mfma_f32_16x16x32_bf16 a[180:183], v[228:231], v[136:139], a[180:183]
    v_mfma_f32_16x16x32_bf16 a[188:191], v[228:231], v[140:143], a[188:191]
    s_waitcnt lgkmcnt(6)
    v_mfma_f32_16x16x32_bf16 a[0:3], v[208:211], v[144:147], a[0:3]
    ds_read_b64_tr_b16 v[228:229], v235 offset:12416
    ds_read_b64_tr_b16 v[230:231], v235 offset:18560
    v_mfma_f32_16x16x32_bf16 a[8:11], v[208:211], v[148:151], a[8:11]
    v_mfma_f32_16x16x32_bf16 a[16:19], v[208:211], v[152:155], a[16:19]
    v_mfma_f32_16x16x32_bf16 a[24:27], v[208:211], v[156:159], a[24:27]
    v_mfma_f32_16x16x32_bf16 a[4:7], v[212:215], v[144:147], a[4:7]
    ds_read_b64_tr_b16 v[208:209], v236 offset:12416
    ds_read_b64_tr_b16 v[210:211], v236 offset:18560
    buffer_load_dwordx4 v240, s[48:51], s36 offen offset:2048  lds
    v_mfma_f32_16x16x32_bf16 a[12:15], v[212:215], v[148:151], a[12:15]
    v_mfma_f32_16x16x32_bf16 a[20:23], v[212:215], v[152:155], a[20:23]
    v_mfma_f32_16x16x32_bf16 a[28:31], v[212:215], v[156:159], a[28:31]
    s_waitcnt lgkmcnt(6)
    v_mfma_f32_16x16x32_bf16 a[32:35], v[216:219], v[144:147], a[32:35]
    ds_read_b64_tr_b16 v[212:213], v237 offset:12416
    ds_read_b64_tr_b16 v[214:215], v237 offset:18560
    v_mfma_f32_16x16x32_bf16 a[40:43], v[216:219], v[148:151], a[40:43]
    v_mfma_f32_16x16x32_bf16 a[48:51], v[216:219], v[152:155], a[48:51]
    v_mfma_f32_16x16x32_bf16 a[56:59], v[216:219], v[156:159], a[56:59]
    v_mfma_f32_16x16x32_bf16 a[36:39], v[220:223], v[144:147], a[36:39]
    ds_read_b64_tr_b16 v[216:217], v234 offset:12544
    ds_read_b64_tr_b16 v[218:219], v234 offset:18688
    v_mfma_f32_16x16x32_bf16 a[44:47], v[220:223], v[148:151], a[44:47]
    s_add_u32 m0, s34, 76800
    s_nop 0
    buffer_load_dwordx4 v241, s[48:51], s36 offen offset:0  lds
    v_mfma_f32_16x16x32_bf16 a[52:55], v[220:223], v[152:155], a[52:55]
    v_mfma_f32_16x16x32_bf16 a[60:63], v[220:223], v[156:159], a[60:63]
    s_waitcnt lgkmcnt(6)
    v_mfma_f32_16x16x32_bf16 a[64:67], v[224:227], v[144:147], a[64:67]
    ds_read_b64_tr_b16 v[220:221], v235 offset:12544
    ds_read_b64_tr_b16 v[222:223], v235 offset:18688
    v_mfma_f32_16x16x32_bf16 a[72:75], v[224:227], v[148:151], a[72:75]
    v_mfma_f32_16x16x32_bf16 a[80:83], v[224:227], v[152:155], a[80:83]
    v_mfma_f32_16x16x32_bf16 a[88:91], v[224:227], v[156:159], a[88:91]
    v_mfma_f32_16x16x32_bf16 a[68:71], v[228:231], v[144:147], a[68:71]
    ds_read_b64_tr_b16 v[224:225], v236 offset:12544
    ds_read_b64_tr_b16 v[226:227], v236 offset:18688
    buffer_load_dwordx4 v242, s[48:51], s36 offen offset:1024  lds
    v_mfma_f32_16x16x32_bf16 a[76:79], v[228:231], v[148:151], a[76:79]
    v_mfma_f32_16x16x32_bf16 a[84:87], v[228:231], v[152:155], a[84:87]
    v_mfma_f32_16x16x32_bf16 a[92:95], v[228:231], v[156:159], a[92:95]
    s_waitcnt lgkmcnt(6)
    v_mfma_f32_16x16x32_bf16 a[96:99], v[208:211], v[144:147], a[96:99]
    ds_read_b64_tr_b16 v[228:229], v237 offset:12544
    ds_read_b64_tr_b16 v[230:231], v237 offset:18688
    v_mfma_f32_16x16x32_bf16 a[104:107], v[208:211], v[148:151], a[104:107]
    v_mfma_f32_16x16x32_bf16 a[112:115], v[208:211], v[152:155], a[112:115]
    v_mfma_f32_16x16x32_bf16 a[120:123], v[208:211], v[156:159], a[120:123]
    v_mfma_f32_16x16x32_bf16 a[100:103], v[212:215], v[144:147], a[100:103]
    ds_read_b64_tr_b16 v[208:209], v234 offset:24576
    ds_read_b64_tr_b16 v[210:211], v234 offset:30720
    v_mfma_f32_16x16x32_bf16 a[108:111], v[212:215], v[148:151], a[108:111]
    buffer_load_dwordx4 v243, s[48:51], s36 offen offset:2048  lds
    s_add_u32 s36, s36, 786432
    v_mfma_f32_16x16x32_bf16 a[116:119], v[212:215], v[152:155], a[116:119]
    v_mfma_f32_16x16x32_bf16 a[124:127], v[212:215], v[156:159], a[124:127]
    s_waitcnt lgkmcnt(6)
    v_mfma_f32_16x16x32_bf16 a[128:131], v[216:219], v[144:147], a[128:131]
    ds_read_b64_tr_b16 v[212:213], v235 offset:24576
    ds_read_b64_tr_b16 v[214:215], v235 offset:30720
    v_mfma_f32_16x16x32_bf16 a[136:139], v[216:219], v[148:151], a[136:139]
    v_mfma_f32_16x16x32_bf16 a[144:147], v[216:219], v[152:155], a[144:147]
    v_mfma_f32_16x16x32_bf16 a[152:155], v[216:219], v[156:159], a[152:155]
    v_mfma_f32_16x16x32_bf16 a[132:135], v[220:223], v[144:147], a[132:135]
    ds_read_b64_tr_b16 v[216:217], v236 offset:24576
    ds_read_b64_tr_b16 v[218:219], v236 offset:30720
    v_mfma_f32_16x16x32_bf16 a[140:143], v[220:223], v[148:151], a[140:143]
    v_mfma_f32_16x16x32_bf16 a[148:151], v[220:223], v[152:155], a[148:151]
    v_mfma_f32_16x16x32_bf16 a[156:159], v[220:223], v[156:159], a[156:159]
    s_waitcnt lgkmcnt(6)
    v_mfma_f32_16x16x32_bf16 a[160:163], v[224:227], v[144:147], a[160:163]
    ds_read_b64_tr_b16 v[220:221], v237 offset:24576
    ds_read_b64_tr_b16 v[222:223], v237 offset:30720
    v_mfma_f32_16x16x32_bf16 a[168:171], v[224:227], v[148:151], a[168:171]
    v_mfma_f32_16x16x32_bf16 a[176:179], v[224:227], v[152:155], a[176:179]
    v_mfma_f32_16x16x32_bf16 a[184:187], v[224:227], v[156:159], a[184:187]
    v_mfma_f32_16x16x32_bf16 a[164:167], v[228:231], v[144:147], a[164:167]
    ds_read_b64_tr_b16 v[224:225], v234 offset:24704
    ds_read_b64_tr_b16 v[226:227], v234 offset:30848
    v_mfma_f32_16x16x32_bf16 a[172:175], v[228:231], v[148:151], a[172:175]
    v_mfma_f32_16x16x32_bf16 a[180:183], v[228:231], v[152:155], a[180:183]
    v_mfma_f32_16x16x32_bf16 a[188:191], v[228:231], v[156:159], a[188:191]
    s_waitcnt vmcnt(42)
    s_waitcnt lgkmcnt(6)
    v_mfma_f32_16x16x32_bf16 a[0:3], v[208:211], v[0:3], a[0:3]
    ds_read_b64_tr_b16 v[228:229], v235 offset:24704
    ds_read_b64_tr_b16 v[230:231], v235 offset:30848
    v_mfma_f32_16x16x32_bf16 a[8:11], v[208:211], v[4:7], a[8:11]
    s_mov_b32 s63, 18432
    buffer_load_dwordx4 v[128:131], v244, s[52:55], s63 offen offset:0 sc1
    v_mfma_f32_16x16x32_bf16 a[16:19], v[208:211], v[8:11], a[16:19]
    v_mfma_f32_16x16x32_bf16 a[24:27], v[208:211], v[12:15], a[24:27]
    v_mfma_f32_16x16x32_bf16 a[4:7], v[212:215], v[0:3], a[4:7]
    ds_read_b64_tr_b16 v[208:209], v236 offset:24704
    ds_read_b64_tr_b16 v[210:211], v236 offset:30848
    v_mfma_f32_16x16x32_bf16 a[12:15], v[212:215], v[4:7], a[12:15]
    s_mov_b32 s63, 18432
    buffer_load_dwordx4 v[144:147], v244, s[52:55], s63 offen offset:1024 sc1
    v_mfma_f32_16x16x32_bf16 a[20:23], v[212:215], v[8:11], a[20:23]
    v_mfma_f32_16x16x32_bf16 a[28:31], v[212:215], v[12:15], a[28:31]
    s_waitcnt lgkmcnt(6)
    v_mfma_f32_16x16x32_bf16 a[32:35], v[216:219], v[0:3], a[32:35]
    ds_read_b64_tr_b16 v[212:213], v237 offset:24704
    ds_read_b64_tr_b16 v[214:215], v237 offset:30848
    v_mfma_f32_16x16x32_bf16 a[40:43], v[216:219], v[4:7], a[40:43]
    s_mov_b32 s63, 38912
    buffer_load_dwordx4 v[132:135], v244, s[52:55], s63 offen offset:0 sc1
    v_mfma_f32_16x16x32_bf16 a[48:51], v[216:219], v[8:11], a[48:51]
    v_mfma_f32_16x16x32_bf16 a[56:59], v[216:219], v[12:15], a[56:59]
    v_mfma_f32_16x16x32_bf16 a[36:39], v[220:223], v[0:3], a[36:39]
    ds_read_b64_tr_b16 v[216:217], v234 offset:24832
    ds_read_b64_tr_b16 v[218:219], v234 offset:30976
    v_mfma_f32_16x16x32_bf16 a[44:47], v[220:223], v[4:7], a[44:47]
    s_mov_b32 s63, 38912
    buffer_load_dwordx4 v[148:151], v244, s[52:55], s63 offen offset:1024 sc1
    v_mfma_f32_16x16x32_bf16 a[52:55], v[220:223], v[8:11], a[52:55]
    v_mfma_f32_16x16x32_bf16 a[60:63], v[220:223], v[12:15], a[60:63]
    s_waitcnt lgkmcnt(6)
    v_mfma_f32_16x16x32_bf16 a[64:67], v[224:227], v[0:3], a[64:67]
    ds_read_b64_tr_b16 v[220:221], v235 offset:24832
    ds_read_b64_tr_b16 v[222:223], v235 offset:30976
    v_mfma_f32_16x16x32_bf16 a[72:75], v[224:227], v[4:7], a[72:75]
    s_mov_b32 s63, 59392
    buffer_load_dwordx4 v[136:139], v244, s[52:55], s63 offen offset:0 sc1
    v_mfma_f32_16x16x32_bf16 a[80:83], v[224:227], v[8:11], a[80:83]
    v_mfma_f32_16x16x32_bf16 a[88:91], v[224:227], v[12:15], a[88:91]
    v_mfma_f32_16x16x32_bf16 a[68:71], v[228:231], v[0:3], a[68:71]
    ds_read_b64_tr_b16 v[224:225], v236 offset:24832
    ds_read_b64_tr_b16 v[226:227], v236 offset:30976
    v_mfma_f32_16x16x32_bf16 a[76:79], v[228:231], v[4:7], a[76:79]
    s_mov_b32 s63, 59392
    buffer_load_dwordx4 v[152:155], v244, s[52:55], s63 offen offset:1024 sc1
    v_mfma_f32_16x16x32_bf16 a[84:87], v[228:231], v[8:11], a[84:87]
    v_mfma_f32_16x16x32_bf16 a[92:95], v[228:231], v[12:15], a[92:95]
    s_waitcnt lgkmcnt(6)
    v_mfma_f32_16x16x32_bf16 a[96:99], v[208:211], v[0:3], a[96:99]
    ds_read_b64_tr_b16 v[228:229], v237 offset:24832
    ds_read_b64_tr_b16 v[230:231], v237 offset:30976
    v_mfma_f32_16x16x32_bf16 a[104:107], v[208:211], v[4:7], a[104:107]
    s_mov_b32 s63, 79872
    buffer_load_dwordx4 v[140:143], v244, s[52:55], s63 offen offset:0 sc1
    v_mfma_f32_16x16x32_bf16 a[112:115], v[208:211], v[8:11], a[112:115]
    v_mfma_f32_16x16x32_bf16 a[120:123], v[208:211], v[12:15], a[120:123]
    v_mfma_f32_16x16x32_bf16 a[100:103], v[212:215], v[0:3], a[100:103]
    ds_read_b64_tr_b16 v[208:209], v234 offset:36864
    ds_read_b64_tr_b16 v[210:211], v234 offset:43008
    v_mfma_f32_16x16x32_bf16 a[108:111], v[212:215], v[4:7], a[108:111]
    s_mov_b32 s63, 79872
    buffer_load_dwordx4 v[156:159], v244, s[52:55], s63 offen offset:1024 sc1
    v_mfma_f32_16x16x32_bf16 a[116:119], v[212:215], v[8:11], a[116:119]
    v_mfma_f32_16x16x32_bf16 a[124:127], v[212:215], v[12:15], a[124:127]
    s_waitcnt lgkmcnt(6)
    v_mfma_f32_16x16x32_bf16 a[128:131], v[216:219], v[0:3], a[128:131]
    ds_read_b64_tr_b16 v[212:213], v235 offset:36864
    ds_read_b64_tr_b16 v[214:215], v235 offset:43008
    v_mfma_f32_16x16x32_bf16 a[136:139], v[216:219], v[4:7], a[136:139]
    v_mfma_f32_16x16x32_bf16 a[144:147], v[216:219], v[8:11], a[144:147]
    v_mfma_f32_16x16x32_bf16 a[152:155], v[216:219], v[12:15], a[152:155]
    s_waitcnt vmcnt(50)
    s_barrier
    v_mfma_f32_16x16x32_bf16 a[132:135], v[220:223], v[0:3], a[132:135]
    ds_read_b64_tr_b16 v[216:217], v236 offset:36864
    ds_read_b64_tr_b16 v[218:219], v236 offset:43008
    v_mfma_f32_16x16x32_bf16 a[140:143], v[220:223], v[4:7], a[140:143]
    s_lshl_b32 s62, s30, 5
    s_add_u32 s62, s62, s31
    s_mul_i32 s62, s62, 393216
    s_cmp_eq_u32 s33, 1
    s_cselect_b64 s[98:99], s[94:95], s[96:97]
    s_cselect_b64 s[100:101], s[96:97], s[94:95]
    s_add_u32 s40, s98, s62
    s_addc_u32 s41, s99, 0
    s_sub_u32 s40, s40, 128
    s_subb_u32 s41, s41, 0
    s_mov_b32 s42, 0x60080
    s_mov_b32 s43, 0x00020000
    s_add_u32 s44, s100, s62
    s_addc_u32 s45, s101, 0
    s_sub_u32 s44, s44, 128
    s_subb_u32 s45, s45, 0
    s_mov_b32 s46, 0x60080
    s_mov_b32 s47, 0x00020000
    s_cmp_eq_u32 s33, 0
    s_cbranch_scc1 Lsa10
    v_accvgpr_read_b32 v238, a218
    v_accvgpr_read_b32 v239, a219
    v_accvgpr_read_b32 v240, a220
    v_accvgpr_read_b32 v241, a221
    v_accvgpr_read_b32 v242, a222
    v_accvgpr_read_b32 v243, a223
    s_branch Lsb10
Lsa10:
    v_accvgpr_read_b32 v238, a224
    v_accvgpr_read_b32 v239, a225
    v_accvgpr_read_b32 v240, a226
    v_accvgpr_read_b32 v241, a227
    v_accvgpr_read_b32 v242, a228
    v_accvgpr_read_b32 v243, a229
Lsb10:
    s_cmp_eq_u32 s33, 0
    s_cselect_b32 s64, s44, s40
    s_cselect_b32 s65, s45, s41
    s_mov_b32 s66, 0x60080
    s_mov_b32 s67, 0x00020000
    s_mul_i32 s35, s33, 1
    s_add_u32 s35, s35, s3
    s_and_b32 s35, s35, 31
    s_mul_i32 s35, s35, 12288
    s_add_u32 m0, s34, 98304
    s_nop 0
    buffer_load_dwordx4 v238, s[64:67], s35 offen offset:0 nt lds
    v_mfma_f32_16x16x32_bf16 a[148:151], v[220:223], v[8:11], a[148:151]
    v_mfma_f32_16x16x32_bf16 a[156:159], v[220:223], v[12:15], a[156:159]
    s_waitcnt lgkmcnt(6)
    v_mfma_f32_16x16x32_bf16 a[160:163], v[224:227], v[0:3], a[160:163]
    ds_read_b64_tr_b16 v[220:221], v237 offset:36864
    ds_read_b64_tr_b16 v[222:223], v237 offset:43008
    v_mfma_f32_16x16x32_bf16 a[168:171], v[224:227], v[4:7], a[168:171]
    v_mfma_f32_16x16x32_bf16 a[176:179], v[224:227], v[8:11], a[176:179]
    v_mfma_f32_16x16x32_bf16 a[184:187], v[224:227], v[12:15], a[184:187]
    v_mfma_f32_16x16x32_bf16 a[164:167], v[228:231], v[0:3], a[164:167]
    ds_read_b64_tr_b16 v[224:225], v234 offset:36992
    ds_read_b64_tr_b16 v[226:227], v234 offset:43136
    buffer_load_dwordx4 v239, s[64:67], s35 offen offset:1024 nt lds
    v_mfma_f32_16x16x32_bf16 a[172:175], v[228:231], v[4:7], a[172:175]
    v_mfma_f32_16x16x32_bf16 a[180:183], v[228:231], v[8:11], a[180:183]
    v_mfma_f32_16x16x32_bf16 a[188:191], v[228:231], v[12:15], a[188:191]
    s_waitcnt lgkmcnt(6)
    v_mfma_f32_16x16x32_bf16 a[0:3], v[208:211], v[16:19], a[0:3]
    ds_read_b64_tr_b16 v[228:229], v235 offset:36992
    ds_read_b64_tr_b16 v[230:231], v235 offset:43136
    v_mfma_f32_16x16x32_bf16 a[8:11], v[208:211], v[20:23], a[8:11]
    v_mfma_f32_16x16x32_bf16 a[16:19], v[208:211], v[24:27], a[16:19]
    v_mfma_f32_16x16x32_bf16 a[24:27], v[208:211], v[28:31], a[24:27]
    v_mfma_f32_16x16x32_bf16 a[4:7], v[212:215], v[16:19], a[4:7]
    ds_read_b64_tr_b16 v[208:209], v236 offset:36992
    ds_read_b64_tr_b16 v[210:211], v236 offset:43136
    buffer_load_dwordx4 v240, s[64:67], s35 offen offset:2048 nt lds
    v_mfma_f32_16x16x32_bf16 a[12:15], v[212:215], v[20:23], a[12:15]
    v_mfma_f32_16x16x32_bf16 a[20:23], v[212:215], v[24:27], a[20:23]
    v_mfma_f32_16x16x32_bf16 a[28:31], v[212:215], v[28:31], a[28:31]
    s_waitcnt lgkmcnt(6)
    v_mfma_f32_16x16x32_bf16 a[32:35], v[216:219], v[16:19], a[32:35]
    ds_read_b64_tr_b16 v[212:213], v237 offset:36992
    ds_read_b64_tr_b16 v[214:215], v237 offset:43136
    v_mfma_f32_16x16x32_bf16 a[40:43], v[216:219], v[20:23], a[40:43]
    v_mfma_f32_16x16x32_bf16 a[48:51], v[216:219], v[24:27], a[48:51]
    v_mfma_f32_16x16x32_bf16 a[56:59], v[216:219], v[28:31], a[56:59]
    v_mfma_f32_16x16x32_bf16 a[36:39], v[220:223], v[16:19], a[36:39]
    ds_read_b64_tr_b16 v[216:217], v234 offset:37120
    ds_read_b64_tr_b16 v[218:219], v234 offset:43264
    v_mfma_f32_16x16x32_bf16 a[44:47], v[220:223], v[20:23], a[44:47]
    s_add_u32 m0, s34, 101376
    s_nop 0
    buffer_load_dwordx4 v241, s[64:67], s35 offen offset:0 nt lds
    v_mfma_f32_16x16x32_bf16 a[52:55], v[220:223], v[24:27], a[52:55]
    v_mfma_f32_16x16x32_bf16 a[60:63], v[220:223], v[28:31], a[60:63]
    s_waitcnt lgkmcnt(6)
    v_mfma_f32_16x16x32_bf16 a[64:67], v[224:227], v[16:19], a[64:67]
    ds_read_b64_tr_b16 v[220:221], v235 offset:37120
    ds_read_b64_tr_b16 v[222:223], v235 offset:43264
    v_mfma_f32_16x16x32_bf16 a[72:75], v[224:227], v[20:23], a[72:75]
    v_mfma_f32_16x16x32_bf16 a[80:83], v[224:227], v[24:27], a[80:83]
    v_mfma_f32_16x16x32_bf16 a[88:91], v[224:227], v[28:31], a[88:91]
    v_mfma_f32_16x16x32_bf16 a[68:71], v[228:231], v[16:19], a[68:71]
    ds_read_b64_tr_b16 v[224:225], v236 offset:37120
    ds_read_b64_tr_b16 v[226:227], v236 offset:43264
    buffer_load_dwordx4 v242, s[64:67], s35 offen offset:1024 nt lds
    v_mfma_f32_16x16x32_bf16 a[76:79], v[228:231], v[20:23], a[76:79]
    v_mfma_f32_16x16x32_bf16 a[84:87], v[228:231], v[24:27], a[84:87]
    v_mfma_f32_16x16x32_bf16 a[92:95], v[228:231], v[28:31], a[92:95]
    s_waitcnt lgkmcnt(6)
    v_mfma_f32_16x16x32_bf16 a[96:99], v[208:211], v[16:19], a[96:99]
    ds_read_b64_tr_b16 v[228:229], v237 offset:37120
    ds_read_b64_tr_b16 v[230:231], v237 offset:43264
    v_mfma_f32_16x16x32_bf16 a[104:107], v[208:211], v[20:23], a[104:107]
    v_mfma_f32_16x16x32_bf16 a[112:115], v[208:211], v[24:27], a[112:115]
    v_mfma_f32_16x16x32_bf16 a[120:123], v[208:211], v[28:31], a[120:123]
    v_mfma_f32_16x16x32_bf16 a[100:103], v[212:215], v[16:19], a[100:103]
    v_add_u32 v234, 0xfffe8000, v234
    v_add_u32 v235, 0xfffe8000, v235
    v_add_u32 v236, 0xfffe8000, v236
    v_add_u32 v237, 0xfffe8000, v237
    ds_read_b64_tr_b16 v[208:209], v234 offset:0
    ds_read_b64_tr_b16 v[210:211], v234 offset:6144
    v_mfma_f32_16x16x32_bf16 a[108:111], v[212:215], v[20:23], a[108:111]
    buffer_load_dwordx4 v243, s[64:67], s35 offen offset:2048 nt lds
    v_mfma_f32_16x16x32_bf16 a[116:119], v[212:215], v[24:27], a[116:119]
    v_mfma_f32_16x16x32_bf16 a[124:127], v[212:215], v[28:31], a[124:127]
    s_waitcnt lgkmcnt(6)
    v_mfma_f32_16x16x32_bf16 a[128:131], v[216:219], v[16:19], a[128:131]
    ds_read_b64_tr_b16 v[212:213], v235 offset:0
    ds_read_b64_tr_b16 v[214:215], v235 offset:6144
    v_mfma_f32_16x16x32_bf16 a[136:139], v[216:219], v[20:23], a[136:139]
    v_mfma_f32_16x16x32_bf16 a[144:147], v[216:219], v[24:27], a[144:147]
    v_mfma_f32_16x16x32_bf16 a[152:155], v[216:219], v[28:31], a[152:155]
    v_mfma_f32_16x16x32_bf16 a[132:135], v[220:223], v[16:19], a[132:135]
    ds_read_b64_tr_b16 v[216:217], v236 offset:0
    ds_read_b64_tr_b16 v[218:219], v236 offset:6144
    v_mfma_f32_16x16x32_bf16 a[140:143], v[220:223], v[20:23], a[140:143]
    v_mfma_f32_16x16x32_bf16 a[148:151], v[220:223], v[24:27], a[148:151]
    v_mfma_f32_16x16x32_bf16 a[156:159], v[220:223], v[28:31], a[156:159]
    s_waitcnt lgkmcnt(6)
    v_mfma_f32_16x16x32_bf16 a[160:163], v[224:227], v[16:19], a[160:163]
    ds_read_b64_tr_b16 v[220:221], v237 offset:0
    ds_read_b64_tr_b16 v[222:223], v237 offset:6144
    v_mfma_f32_16x16x32_bf16 a[168:171], v[224:227], v[20:23], a[168:171]
    v_mfma_f32_16x16x32_bf16 a[176:179], v[224:227], v[24:27], a[176:179]
    v_mfma_f32_16x16x32_bf16 a[184:187], v[224:227], v[28:31], a[184:187]
    v_mfma_f32_16x16x32_bf16 a[164:167], v[228:231], v[16:19], a[164:167]
    ds_read_b64_tr_b16 v[224:225], v234 offset:128
    ds_read_b64_tr_b16 v[226:227], v234 offset:6272
    v_mfma_f32_16x16x32_bf16 a[172:175], v[228:231], v[20:23], a[172:175]
    v_mfma_f32_16x16x32_bf16 a[180:183], v[228:231], v[24:27], a[180:183]
    v_mfma_f32_16x16x32_bf16 a[188:191], v[228:231], v[28:31], a[188:191]
    s_waitcnt vmcnt(48)
    s_waitcnt lgkmcnt(6)
    v_mfma_f32_16x16x32_bf16 a[0:3], v[208:211], v[32:35], a[0:3]
    ds_read_b64_tr_b16 v[228:229], v235 offset:128
    ds_read_b64_tr_b16 v[230:231], v235 offset:6272
    v_mfma_f32_16x16x32_bf16 a[8:11], v[208:211], v[36:39], a[8:11]
    v_mfma_f32_16x16x32_bf16 a[16:19], v[208:211], v[40:43], a[16:19]
    v_mfma_f32_16x16x32_bf16 a[24:27], v[208:211], v[44:47], a[24:27]
    v_mfma_f32_16x16x32_bf16 a[4:7], v[212:215], v[32:35], a[4:7]
    ds_read_b64_tr_b16 v[208:209], v236 offset:128
    ds_read_b64_tr_b16 v[210:211], v236 offset:6272
    v_mfma_f32_16x16x32_bf16 a[12:15], v[212:215], v[36:39], a[12:15]
    v_mfma_f32_16x16x32_bf16 a[20:23], v[212:215], v[40:43], a[20:23]
    v_mfma_f32_16x16x32_bf16 a[28:31], v[212:215], v[44:47], a[28:31]
    s_waitcnt lgkmcnt(6)
    v_mfma_f32_16x16x32_bf16 a[32:35], v[216:219], v[32:35], a[32:35]
    ds_read_b64_tr_b16 v[212:213], v237 offset:128
    ds_read_b64_tr_b16 v[214:215], v237 offset:6272
    v_mfma_f32_16x16x32_bf16 a[40:43], v[216:219], v[36:39], a[40:43]
    v_mfma_f32_16x16x32_bf16 a[48:51], v[216:219], v[40:43], a[48:51]
    v_mfma_f32_16x16x32_bf16 a[56:59], v[216:219], v[44:47], a[56:59]
    v_mfma_f32_16x16x32_bf16 a[36:39], v[220:223], v[32:35], a[36:39]
    ds_read_b64_tr_b16 v[216:217], v234 offset:256
    ds_read_b64_tr_b16 v[218:219], v234 offset:6400
    v_mfma_f32_16x16x32_bf16 a[44:47], v[220:223], v[36:39], a[44:47]
    v_mfma_f32_16x16x32_bf16 a[52:55], v[220:223], v[40:43], a[52:55]
    v_mfma_f32_16x16x32_bf16 a[60:63], v[220:223], v[44:47], a[60:63]
    s_waitcnt lgkmcnt(6)
    v_mfma_f32_16x16x32_bf16 a[64:67], v[224:227], v[32:35], a[64:67]
    ds_read_b64_tr_b16 v[220:221], v235 offset:256
    ds_read_b64_tr_b16 v[222:223], v235 offset:6400
    v_mfma_f32_16x16x32_bf16 a[72:75], v[224:227], v[36:39], a[72:75]
    v_mfma_f32_16x16x32_bf16 a[80:83], v[224:227], v[40:43], a[80:83]
    v_mfma_f32_16x16x32_bf16 a[88:91], v[224:227], v[44:47], a[88:91]
    v_mfma_f32_16x16x32_bf16 a[68:71], v[228:231], v[32:35], a[68:71]
    ds_read_b64_tr_b16 v[224:225], v236 offset:256
    ds_read_b64_tr_b16 v[226:227], v236 offset:6400
    v_mfma_f32_16x16x32_bf16 a[76:79], v[228:231], v[36:39], a[76:79]
    v_mfma_f32_16x16x32_bf16 a[84:87], v[228:231], v[40:43], a[84:87]
    v_mfma_f32_16x16x32_bf16 a[92:95], v[228:231], v[44:47], a[92:95]
    s_waitcnt lgkmcnt(6)
    v_mfma_f32_16x16x32_bf16 a[96:99], v[208:211], v[32:35], a[96:99]
    ds_read_b64_tr_b16 v[228:229], v237 offset:256
    ds_read_b64_tr_b16 v[230:231], v237 offset:6400
    v_mfma_f32_16x16x32_bf16 a[104:107], v[208:211], v[36:39], a[104:107]
    v_mfma_f32_16x16x32_bf16 a[112:115], v[208:211], v[40:43], a[112:115]
    v_mfma_f32_16x16x32_bf16 a[120:123], v[208:211], v[44:47], a[120:123]
    v_mfma_f32_16x16x32_bf16 a[100:103], v[212:215], v[32:35], a[100:103]
    ds_read_b64_tr_b16 v[208:209], v234 offset:12288
    ds_read_b64_tr_b16 v[210:211], v234 offset:18432
    v_mfma_f32_16x16x32_bf16 a[108:111], v[212:215], v[36:39], a[108:111]
    v_mfma_f32_16x16x32_bf16 a[116:119], v[212:215], v[40:43], a[116:119]
    v_mfma_f32_16x16x32_bf16 a[124:127], v[212:215], v[44:47], a[124:127]
    s_waitcnt lgkmcnt(6)
    v_mfma_f32_16x16x32_bf16 a[128:131], v[216:219], v[32:35], a[128:131]
    ds_read_b64_tr_b16 v[212:213], v235 offset:12288
    ds_read_b64_tr_b16 v[214:215], v235 offset:18432
    v_mfma_f32_16x16x32_bf16 a[136:139], v[216:219], v[36:39], a[136:139]
    v_mfma_f32_16x16x32_bf16 a[144:147], v[216:219], v[40:43], a[144:147]
    v_mfma_f32_16x16x32_bf16 a[152:155], v[216:219], v[44:47], a[152:155]
    s_waitcnt vmcnt(42)
    s_barrier
    v_mfma_f32_16x16x32_bf16 a[132:135], v[220:223], v[32:35], a[132:135]
    ds_read_b64_tr_b16 v[216:217], v236 offset:12288
    ds_read_b64_tr_b16 v[218:219], v236 offset:18432
    v_mfma_f32_16x16x32_bf16 a[140:143], v[220:223], v[36:39], a[140:143]
    v_accvgpr_read_b32 v238, a218
    v_accvgpr_read_b32 v239, a219
    v_accvgpr_read_b32 v240, a220
    v_accvgpr_read_b32 v241, a221
    v_accvgpr_read_b32 v242, a222
    v_accvgpr_read_b32 v243, a223
    s_mul_i32 s35, s33, 2
    s_add_u32 s35, s35, s3
    s_and_b32 s35, s35, 31
    s_mul_i32 s35, s35, 12288
    s_add_u32 m0, s34, 122880
    s_nop 0
    buffer_load_dwordx4 v238, s[40:43], s35 offen offset:0 nt lds
    v_mfma_f32_16x16x32_bf16 a[148:151], v[220:223], v[40:43], a[148:151]
    v_mfma_f32_16x16x32_bf16 a[156:159], v[220:223], v[44:47], a[156:159]
    s_waitcnt lgkmcnt(6)
    v_mfma_f32_16x16x32_bf16 a[160:163], v[224:227], v[32:35], a[160:163]
    ds_read_b64_tr_b16 v[220:221], v237 offset:12288
    ds_read_b64_tr_b16 v[222:223], v237 offset:18432
    v_mfma_f32_16x16x32_bf16 a[168:171], v[224:227], v[36:39], a[168:171]
    v_mfma_f32_16x16x32_bf16 a[176:179], v[224:227], v[40:43], a[176:179]
    v_mfma_f32_16x16x32_bf16 a[184:187], v[224:227], v[44:47], a[184:187]
    v_mfma_f32_16x16x32_bf16 a[164:167], v[228:231], v[32:35], a[164:167]
    ds_read_b64_tr_b16 v[224:225], v234 offset:12416
    ds_read_b64_tr_b16 v[226:227], v234 offset:18560
    buffer_load_dwordx4 v239, s[40:43], s35 offen offset:1024 nt lds
    v_mfma_f32_16x16x32_bf16 a[172:175], v[228:231], v[36:39], a[172:175]
    v_mfma_f32_16x16x32_bf16 a[180:183], v[228:231], v[40:43], a[180:183]
    v_mfma_f32_16x16x32_bf16 a[188:191], v[228:231], v[44:47], a[188:191]
    s_waitcnt lgkmcnt(6)
    v_mfma_f32_16x16x32_bf16 a[0:3], v[208:211], v[48:51], a[0:3]
    ds_read_b64_tr_b16 v[228:229], v235 offset:12416
    ds_read_b64_tr_b16 v[230:231], v235 offset:18560
    v_mfma_f32_16x16x32_bf16 a[8:11], v[208:211], v[52:55], a[8:11]
    v_mfma_f32_16x16x32_bf16 a[16:19], v[208:211], v[56:59], a[16:19]
    v_mfma_f32_16x16x32_bf16 a[24:27], v[208:211], v[60:63], a[24:27]
    v_mfma_f32_16x16x32_bf16 a[4:7], v[212:215], v[48:51], a[4:7]
    ds_read_b64_tr_b16 v[208:209], v236 offset:12416
    ds_read_b64_tr_b16 v[210:211], v236 offset:18560
    buffer_load_dwordx4 v240, s[40:43], s35 offen offset:2048 nt lds
    v_mfma_f32_16x16x32_bf16 a[12:15], v[212:215], v[52:55], a[12:15]
    v_mfma_f32_16x16x32_bf16 a[20:23], v[212:215], v[56:59], a[20:23]
    v_mfma_f32_16x16x32_bf16 a[28:31], v[212:215], v[60:63], a[28:31]
    s_waitcnt lgkmcnt(6)
    v_mfma_f32_16x16x32_bf16 a[32:35], v[216:219], v[48:51], a[32:35]
    ds_read_b64_tr_b16 v[212:213], v237 offset:12416
    ds_read_b64_tr_b16 v[214:215], v237 offset:18560
    v_mfma_f32_16x16x32_bf16 a[40:43], v[216:219], v[52:55], a[40:43]
    v_mfma_f32_16x16x32_bf16 a[48:51], v[216:219], v[56:59], a[48:51]
    v_mfma_f32_16x16x32_bf16 a[56:59], v[216:219], v[60:63], a[56:59]
    v_mfma_f32_16x16x32_bf16 a[36:39], v[220:223], v[48:51], a[36:39]
    ds_read_b64_tr_b16 v[216:217], v234 offset:12544
    ds_read_b64_tr_b16 v[218:219], v234 offset:18688
    v_mfma_f32_16x16x32_bf16 a[44:47], v[220:223], v[52:55], a[44:47]
    s_add_u32 m0, s34, 125952
    s_nop 0
    buffer_load_dwordx4 v241, s[40:43], s35 offen offset:0 nt lds
    v_mfma_f32_16x16x32_bf16 a[52:55], v[220:223], v[56:59], a[52:55]
    v_mfma_f32_16x16x32_bf16 a[60:63], v[220:223], v[60:63], a[60:63]
    s_waitcnt lgkmcnt(6)
    v_mfma_f32_16x16x32_bf16 a[64:67], v[224:227], v[48:51], a[64:67]
    ds_read_b64_tr_b16 v[220:221], v235 offset:12544
    ds_read_b64_tr_b16 v[222:223], v235 offset:18688
    v_mfma_f32_16x16x32_bf16 a[72:75], v[224:227], v[52:55], a[72:75]
    v_mfma_f32_16x16x32_bf16 a[80:83], v[224:227], v[56:59], a[80:83]
    v_mfma_f32_16x16x32_bf16 a[88:91], v[224:227], v[60:63], a[88:91]
    v_mfma_f32_16x16x32_bf16 a[68:71], v[228:231], v[48:51], a[68:71]
    ds_read_b64_tr_b16 v[224:225], v236 offset:12544
    ds_read_b64_tr_b16 v[226:227], v236 offset:18688
    buffer_load_dwordx4 v242, s[40:43], s35 offen offset:1024 nt lds
    v_mfma_f32_16x16x32_bf16 a[76:79], v[228:231], v[52:55], a[76:79]
    v_mfma_f32_16x16x32_bf16 a[84:87], v[228:231], v[56:59], a[84:87]
    v_mfma_f32_16x16x32_bf16 a[92:95], v[228:231], v[60:63], a[92:95]
    s_waitcnt lgkmcnt(6)
    v_mfma_f32_16x16x32_bf16 a[96:99], v[208:211], v[48:51], a[96:99]
    ds_read_b64_tr_b16 v[228:229], v237 offset:12544
    ds_read_b64_tr_b16 v[230:231], v237 offset:18688
    v_mfma_f32_16x16x32_bf16 a[104:107], v[208:211], v[52:55], a[104:107]
    v_mfma_f32_16x16x32_bf16 a[112:115], v[208:211], v[56:59], a[112:115]
    v_mfma_f32_16x16x32_bf16 a[120:123], v[208:211], v[60:63], a[120:123]
    v_mfma_f32_16x16x32_bf16 a[100:103], v[212:215], v[48:51], a[100:103]
    ds_read_b64_tr_b16 v[208:209], v234 offset:24576
    ds_read_b64_tr_b16 v[210:211], v234 offset:30720
    v_mfma_f32_16x16x32_bf16 a[108:111], v[212:215], v[52:55], a[108:111]
    buffer_load_dwordx4 v243, s[40:43], s35 offen offset:2048 nt lds
    s_add_u32 s35, s35, 12288
    v_mfma_f32_16x16x32_bf16 a[116:119], v[212:215], v[56:59], a[116:119]
    v_mfma_f32_16x16x32_bf16 a[124:127], v[212:215], v[60:63], a[124:127]
    s_waitcnt lgkmcnt(6)
    v_mfma_f32_16x16x32_bf16 a[128:131], v[216:219], v[48:51], a[128:131]
    ds_read_b64_tr_b16 v[212:213], v235 offset:24576
    ds_read_b64_tr_b16 v[214:215], v235 offset:30720
    v_mfma_f32_16x16x32_bf16 a[136:139], v[216:219], v[52:55], a[136:139]
    v_mfma_f32_16x16x32_bf16 a[144:147], v[216:219], v[56:59], a[144:147]
    v_mfma_f32_16x16x32_bf16 a[152:155], v[216:219], v[60:63], a[152:155]
    v_mfma_f32_16x16x32_bf16 a[132:135], v[220:223], v[48:51], a[132:135]
    ds_read_b64_tr_b16 v[216:217], v236 offset:24576
    ds_read_b64_tr_b16 v[218:219], v236 offset:30720
    v_mfma_f32_16x16x32_bf16 a[140:143], v[220:223], v[52:55], a[140:143]
    v_mfma_f32_16x16x32_bf16 a[148:151], v[220:223], v[56:59], a[148:151]
    v_mfma_f32_16x16x32_bf16 a[156:159], v[220:223], v[60:63], a[156:159]
    s_waitcnt lgkmcnt(6)
    v_mfma_f32_16x16x32_bf16 a[160:163], v[224:227], v[48:51], a[160:163]
    ds_read_b64_tr_b16 v[220:221], v237 offset:24576
    ds_read_b64_tr_b16 v[222:223], v237 offset:30720
    v_mfma_f32_16x16x32_bf16 a[168:171], v[224:227], v[52:55], a[168:171]
    v_mfma_f32_16x16x32_bf16 a[176:179], v[224:227], v[56:59], a[176:179]
    v_mfma_f32_16x16x32_bf16 a[184:187], v[224:227], v[60:63], a[184:187]
    v_mfma_f32_16x16x32_bf16 a[164:167], v[228:231], v[48:51], a[164:167]
    ds_read_b64_tr_b16 v[224:225], v234 offset:24704
    ds_read_b64_tr_b16 v[226:227], v234 offset:30848
    v_mfma_f32_16x16x32_bf16 a[172:175], v[228:231], v[52:55], a[172:175]
    v_mfma_f32_16x16x32_bf16 a[180:183], v[228:231], v[56:59], a[180:183]
    v_mfma_f32_16x16x32_bf16 a[188:191], v[228:231], v[60:63], a[188:191]
    s_waitcnt vmcnt(40)
    s_waitcnt lgkmcnt(6)
    v_mfma_f32_16x16x32_bf16 a[0:3], v[208:211], v[64:67], a[0:3]
    ds_read_b64_tr_b16 v[228:229], v235 offset:24704
    ds_read_b64_tr_b16 v[230:231], v235 offset:30848
    v_mfma_f32_16x16x32_bf16 a[8:11], v[208:211], v[68:71], a[8:11]
    v_mfma_f32_16x16x32_bf16 a[16:19], v[208:211], v[72:75], a[16:19]
    v_mfma_f32_16x16x32_bf16 a[24:27], v[208:211], v[76:79], a[24:27]
    v_mfma_f32_16x16x32_bf16 a[4:7], v[212:215], v[64:67], a[4:7]
    ds_read_b64_tr_b16 v[208:209], v236 offset:24704
    ds_read_b64_tr_b16 v[210:211], v236 offset:30848
    v_mfma_f32_16x16x32_bf16 a[12:15], v[212:215], v[68:71], a[12:15]
    v_mfma_f32_16x16x32_bf16 a[20:23], v[212:215], v[72:75], a[20:23]
    v_mfma_f32_16x16x32_bf16 a[28:31], v[212:215], v[76:79], a[28:31]
    s_waitcnt lgkmcnt(6)
    v_mfma_f32_16x16x32_bf16 a[32:35], v[216:219], v[64:67], a[32:35]
    ds_read_b64_tr_b16 v[212:213], v237 offset:24704
    ds_read_b64_tr_b16 v[214:215], v237 offset:30848
    v_mfma_f32_16x16x32_bf16 a[40:43], v[216:219], v[68:71], a[40:43]
    v_mfma_f32_16x16x32_bf16 a[48:51], v[216:219], v[72:75], a[48:51]
    v_mfma_f32_16x16x32_bf16 a[56:59], v[216:219], v[76:79], a[56:59]
    v_mfma_f32_16x16x32_bf16 a[36:39], v[220:223], v[64:67], a[36:39]
    ds_read_b64_tr_b16 v[216:217], v234 offset:24832
    ds_read_b64_tr_b16 v[218:219], v234 offset:30976
    v_mfma_f32_16x16x32_bf16 a[44:47], v[220:223], v[68:71], a[44:47]
    v_mfma_f32_16x16x32_bf16 a[52:55], v[220:223], v[72:75], a[52:55]
    v_mfma_f32_16x16x32_bf16 a[60:63], v[220:223], v[76:79], a[60:63]
    s_waitcnt lgkmcnt(6)
    v_mfma_f32_16x16x32_bf16 a[64:67], v[224:227], v[64:67], a[64:67]
    ds_read_b64_tr_b16 v[220:221], v235 offset:24832
    ds_read_b64_tr_b16 v[222:223], v235 offset:30976
    v_mfma_f32_16x16x32_bf16 a[72:75], v[224:227], v[68:71], a[72:75]
    v_mfma_f32_16x16x32_bf16 a[80:83], v[224:227], v[72:75], a[80:83]
    v_mfma_f32_16x16x32_bf16 a[88:91], v[224:227], v[76:79], a[88:91]
    v_mfma_f32_16x16x32_bf16 a[68:71], v[228:231], v[64:67], a[68:71]
    ds_read_b64_tr_b16 v[224:225], v236 offset:24832
    ds_read_b64_tr_b16 v[226:227], v236 offset:30976
    v_mfma_f32_16x16x32_bf16 a[76:79], v[228:231], v[68:71], a[76:79]
    v_mfma_f32_16x16x32_bf16 a[84:87], v[228:231], v[72:75], a[84:87]
    v_mfma_f32_16x16x32_bf16 a[92:95], v[228:231], v[76:79], a[92:95]
    s_waitcnt lgkmcnt(6)
    v_mfma_f32_16x16x32_bf16 a[96:99], v[208:211], v[64:67], a[96:99]
    ds_read_b64_tr_b16 v[228:229], v237 offset:24832
    ds_read_b64_tr_b16 v[230:231], v237 offset:30976
    v_mfma_f32_16x16x32_bf16 a[104:107], v[208:211], v[68:71], a[104:107]
    v_mfma_f32_16x16x32_bf16 a[112:115], v[208:211], v[72:75], a[112:115]
    v_mfma_f32_16x16x32_bf16 a[120:123], v[208:211], v[76:79], a[120:123]
    v_mfma_f32_16x16x32_bf16 a[100:103], v[212:215], v[64:67], a[100:103]
    ds_read_b64_tr_b16 v[208:209], v234 offset:36864
    ds_read_b64_tr_b16 v[210:211], v234 offset:43008
    v_mfma_f32_16x16x32_bf16 a[108:111], v[212:215], v[68:71], a[108:111]
    v_mfma_f32_16x16x32_bf16 a[116:119], v[212:215], v[72:75], a[116:119]
    v_mfma_f32_16x16x32_bf16 a[124:127], v[212:215], v[76:79], a[124:127]
    s_waitcnt lgkmcnt(6)
    v_mfma_f32_16x16x32_bf16 a[128:131], v[216:219], v[64:67], a[128:131]
    ds_read_b64_tr_b16 v[212:213], v235 offset:36864
    ds_read_b64_tr_b16 v[214:215], v235 offset:43008
    v_mfma_f32_16x16x32_bf16 a[136:139], v[216:219], v[68:71], a[136:139]
    v_mfma_f32_16x16x32_bf16 a[144:147], v[216:219], v[72:75], a[144:147]
    v_mfma_f32_16x16x32_bf16 a[152:155], v[216:219], v[76:79], a[152:155]
    s_waitcnt vmcnt(34)
    s_barrier
    v_mfma_f32_16x16x32_bf16 a[132:135], v[220:223], v[64:67], a[132:135]
    ds_read_b64_tr_b16 v[216:217], v236 offset:36864
    ds_read_b64_tr_b16 v[218:219], v236 offset:43008
    v_mfma_f32_16x16x32_bf16 a[140:143], v[220:223], v[68:71], a[140:143]
    s_add_u32 m0, s34, 0
    s_nop 0
    buffer_load_dwordx4 v238, s[40:43], s35 offen offset:0 nt lds
    v_mfma_f32_16x16x32_bf16 a[148:151], v[220:223], v[72:75], a[148:151]
    v_mfma_f32_16x16x32_bf16 a[156:159], v[220:223], v[76:79], a[156:159]
    s_waitcnt lgkmcnt(6)
    v_mfma_f32_16x16x32_bf16 a[160:163], v[224:227], v[64:67], a[160:163]
    ds_read_b64_tr_b16 v[220:221], v237 offset:36864
    ds_read_b64_tr_b16 v[222:223], v237 offset:43008
    v_mfma_f32_16x16x32_bf16 a[168:171], v[224:227], v[68:71], a[168:171]
    v_mfma_f32_16x16x32_bf16 a[176:179], v[224:227], v[72:75], a[176:179]
    v_mfma_f32_16x16x32_bf16 a[184:187], v[224:227], v[76:79], a[184:187]
    v_mfma_f32_16x16x32_bf16 a[164:167], v[228:231], v[64:67], a[164:167]
    ds_read_b64_tr_b16 v[224:225], v234 offset:36992
    ds_read_b64_tr_b16 v[226:227], v234 offset:43136
    buffer_load_dwordx4 v239, s[40:43], s35 offen offset:1024 nt lds
    v_mfma_f32_16x16x32_bf16 a[172:175], v[228:231], v[68:71], a[172:175]
    v_mfma_f32_16x16x32_bf16 a[180:183], v[228:231], v[72:75], a[180:183]
    v_mfma_f32_16x16x32_bf16 a[188:191], v[228:231], v[76:79], a[188:191]
    s_waitcnt lgkmcnt(6)
    v_mfma_f32_16x16x32_bf16 a[0:3], v[208:211], v[80:83], a[0:3]
    ds_read_b64_tr_b16 v[228:229], v235 offset:36992
    ds_read_b64_tr_b16 v[230:231], v235 offset:43136
    v_mfma_f32_16x16x32_bf16 a[8:11], v[208:211], v[84:87], a[8:11]
    v_mfma_f32_16x16x32_bf16 a[16:19], v[208:211], v[88:91], a[16:19]
    v_mfma_f32_16x16x32_bf16 a[24:27], v[208:211], v[92:95], a[24:27]
    v_mfma_f32_16x16x32_bf16 a[4:7], v[212:215], v[80:83], a[4:7]
    ds_read_b64_tr_b16 v[208:209], v236 offset:36992
    ds_read_b64_tr_b16 v[210:211], v236 offset:43136
    buffer_load_dwordx4 v240, s[40:43], s35 offen offset:2048 nt lds
    v_mfma_f32_16x16x32_bf16 a[12:15], v[212:215], v[84:87], a[12:15]
    v_mfma_f32_16x16x32_bf16 a[20:23], v[212:215], v[88:91], a[20:23]
    v_mfma_f32_16x16x32_bf16 a[28:31], v[212:215], v[92:95], a[28:31]
    s_waitcnt lgkmcnt(6)
    v_mfma_f32_16x16x32_bf16 a[32:35], v[216:219], v[80:83], a[32:35]
    ds_read_b64_tr_b16 v[212:213], v237 offset:36992
    ds_read_b64_tr_b16 v[214:215], v237 offset:43136
    v_mfma_f32_16x16x32_bf16 a[40:43], v[216:219], v[84:87], a[40:43]
    v_mfma_f32_16x16x32_bf16 a[48:51], v[216:219], v[88:91], a[48:51]
    v_mfma_f32_16x16x32_bf16 a[56:59], v[216:219], v[92:95], a[56:59]
    v_mfma_f32_16x16x32_bf16 a[36:39], v[220:223], v[80:83], a[36:39]
    ds_read_b64_tr_b16 v[216:217], v234 offset:37120
    ds_read_b64_tr_b16 v[218:219], v234 offset:43264
    v_mfma_f32_16x16x32_bf16 a[44:47], v[220:223], v[84:87], a[44:47]
    s_add_u32 m0, s34, 3072
    s_nop 0
    buffer_load_dwordx4 v241, s[40:43], s35 offen offset:0 nt lds
    v_mfma_f32_16x16x32_bf16 a[52:55], v[220:223], v[88:91], a[52:55]
    v_mfma_f32_16x16x32_bf16 a[60:63], v[220:223], v[92:95], a[60:63]
    s_waitcnt lgkmcnt(6)
    v_mfma_f32_16x16x32_bf16 a[64:67], v[224:227], v[80:83], a[64:67]
    ds_read_b64_tr_b16 v[220:221], v235 offset:37120
    ds_read_b64_tr_b16 v[222:223], v235 offset:43264
    v_mfma_f32_16x16x32_bf16 a[72:75], v[224:227], v[84:87], a[72:75]
    v_mfma_f32_16x16x32_bf16 a[80:83], v[224:227], v[88:91], a[80:83]
    v_mfma_f32_16x16x32_bf16 a[88:91], v[224:227], v[92:95], a[88:91]
    v_mfma_f32_16x16x32_bf16 a[68:71], v[228:231], v[80:83], a[68:71]
    ds_read_b64_tr_b16 v[224:225], v236 offset:37120
    ds_read_b64_tr_b16 v[226:227], v236 offset:43264
    buffer_load_dwordx4 v242, s[40:43], s35 offen offset:1024 nt lds
    v_mfma_f32_16x16x32_bf16 a[76:79], v[228:231], v[84:87], a[76:79]
    v_mfma_f32_16x16x32_bf16 a[84:87], v[228:231], v[88:91], a[84:87]
    v_mfma_f32_16x16x32_bf16 a[92:95], v[228:231], v[92:95], a[92:95]
    s_waitcnt lgkmcnt(6)
    v_mfma_f32_16x16x32_bf16 a[96:99], v[208:211], v[80:83], a[96:99]
    ds_read_b64_tr_b16 v[228:229], v237 offset:37120
    ds_read_b64_tr_b16 v[230:231], v237 offset:43264
    v_mfma_f32_16x16x32_bf16 a[104:107], v[208:211], v[84:87], a[104:107]
    v_mfma_f32_16x16x32_bf16 a[112:115], v[208:211], v[88:91], a[112:115]
    v_mfma_f32_16x16x32_bf16 a[120:123], v[208:211], v[92:95], a[120:123]
    v_mfma_f32_16x16x32_bf16 a[100:103], v[212:215], v[80:83], a[100:103]
    v_add_u32 v234, 0xc000, v234
    v_add_u32 v235, 0xc000, v235
    v_add_u32 v236, 0xc000, v236
    v_add_u32 v237, 0xc000, v237
    ds_read_b64_tr_b16 v[208:209], v234 offset:0
    ds_read_b64_tr_b16 v[210:211], v234 offset:6144
    v_mfma_f32_16x16x32_bf16 a[108:111], v[212:215], v[84:87], a[108:111]
    buffer_load_dwordx4 v243, s[40:43], s35 offen offset:2048 nt lds
    s_add_u32 s35, s35, 12288
    v_mfma_f32_16x16x32_bf16 a[116:119], v[212:215], v[88:91], a[116:119]
    v_mfma_f32_16x16x32_bf16 a[124:127], v[212:215], v[92:95], a[124:127]
    s_waitcnt lgkmcnt(6)
    v_mfma_f32_16x16x32_bf16 a[128:131], v[216:219], v[80:83], a[128:131]
    ds_read_b64_tr_b16 v[212:213], v235 offset:0
    ds_read_b64_tr_b16 v[214:215], v235 offset:6144
    v_mfma_f32_16x16x32_bf16 a[136:139], v[216:219], v[84:87], a[136:139]
    v_mfma_f32_16x16x32_bf16 a[144:147], v[216:219], v[88:91], a[144:147]
    v_mfma_f32_16x16x32_bf16 a[152:155], v[216:219], v[92:95], a[152:155]
    v_mfma_f32_16x16x32_bf16 a[132:135], v[220:223], v[80:83], a[132:135]
    ds_read_b64_tr_b16 v[216:217], v236 offset:0
    ds_read_b64_tr_b16 v[218:219], v236 offset:6144
    v_mfma_f32_16x16x32_bf16 a[140:143], v[220:223], v[84:87], a[140:143]
    v_mfma_f32_16x16x32_bf16 a[148:151], v[220:223], v[88:91], a[148:151]
    v_mfma_f32_16x16x32_bf16 a[156:159], v[220:223], v[92:95], a[156:159]
    s_waitcnt lgkmcnt(6)
    v_mfma_f32_16x16x32_bf16 a[160:163], v[224:227], v[80:83], a[160:163]
    ds_read_b64_tr_b16 v[220:221], v237 offset:0
    ds_read_b64_tr_b16 v[222:223], v237 offset:6144
    v_mfma_f32_16x16x32_bf16 a[168:171], v[224:227], v[84:87], a[168:171]
    v_mfma_f32_16x16x32_bf16 a[176:179], v[224:227], v[88:91], a[176:179]
    v_mfma_f32_16x16x32_bf16 a[184:187], v[224:227], v[92:95], a[184:187]
    v_mfma_f32_16x16x32_bf16 a[164:167], v[228:231], v[80:83], a[164:167]
    ds_read_b64_tr_b16 v[224:225], v234 offset:128
    ds_read_b64_tr_b16 v[226:227], v234 offset:6272
    v_mfma_f32_16x16x32_bf16 a[172:175], v[228:231], v[84:87], a[172:175]
    v_mfma_f32_16x16x32_bf16 a[180:183], v[228:231], v[88:91], a[180:183]
    v_mfma_f32_16x16x32_bf16 a[188:191], v[228:231], v[92:95], a[188:191]
    s_waitcnt vmcnt(32)
    s_waitcnt lgkmcnt(6)
    v_mfma_f32_16x16x32_bf16 a[0:3], v[208:211], v[96:99], a[0:3]
    ds_read_b64_tr_b16 v[228:229], v235 offset:128
    ds_read_b64_tr_b16 v[230:231], v235 offset:6272
    v_mfma_f32_16x16x32_bf16 a[8:11], v[208:211], v[100:103], a[8:11]
    v_mfma_f32_16x16x32_bf16 a[16:19], v[208:211], v[104:107], a[16:19]
    v_mfma_f32_16x16x32_bf16 a[24:27], v[208:211], v[108:111], a[24:27]
    v_mfma_f32_16x16x32_bf16 a[4:7], v[212:215], v[96:99], a[4:7]
    ds_read_b64_tr_b16 v[208:209], v236 offset:128
    ds_read_b64_tr_b16 v[210:211], v236 offset:6272
    v_mfma_f32_16x16x32_bf16 a[12:15], v[212:215], v[100:103], a[12:15]
    v_mfma_f32_16x16x32_bf16 a[20:23], v[212:215], v[104:107], a[20:23]
    v_mfma_f32_16x16x32_bf16 a[28:31], v[212:215], v[108:111], a[28:31]
    s_waitcnt lgkmcnt(6)
    v_mfma_f32_16x16x32_bf16 a[32:35], v[216:219], v[96:99], a[32:35]
    ds_read_b64_tr_b16 v[212:213], v237 offset:128
    ds_read_b64_tr_b16 v[214:215], v237 offset:6272
    v_mfma_f32_16x16x32_bf16 a[40:43], v[216:219], v[100:103], a[40:43]
    v_mfma_f32_16x16x32_bf16 a[48:51], v[216:219], v[104:107], a[48:51]
    v_mfma_f32_16x16x32_bf16 a[56:59], v[216:219], v[108:111], a[56:59]
    v_mfma_f32_16x16x32_bf16 a[36:39], v[220:223], v[96:99], a[36:39]
    ds_read_b64_tr_b16 v[216:217], v234 offset:256
    ds_read_b64_tr_b16 v[218:219], v234 offset:6400
    v_mfma_f32_16x16x32_bf16 a[44:47], v[220:223], v[100:103], a[44:47]
    v_mfma_f32_16x16x32_bf16 a[52:55], v[220:223], v[104:107], a[52:55]
    v_mfma_f32_16x16x32_bf16 a[60:63], v[220:223], v[108:111], a[60:63]
    s_waitcnt lgkmcnt(6)
    v_mfma_f32_16x16x32_bf16 a[64:67], v[224:227], v[96:99], a[64:67]
    ds_read_b64_tr_b16 v[220:221], v235 offset:256
    ds_read_b64_tr_b16 v[222:223], v235 offset:6400
    v_mfma_f32_16x16x32_bf16 a[72:75], v[224:227], v[100:103], a[72:75]
    v_mfma_f32_16x16x32_bf16 a[80:83], v[224:227], v[104:107], a[80:83]
    v_mfma_f32_16x16x32_bf16 a[88:91], v[224:227], v[108:111], a[88:91]
    v_mfma_f32_16x16x32_bf16 a[68:71], v[228:231], v[96:99], a[68:71]
    ds_read_b64_tr_b16 v[224:225], v236 offset:256
    ds_read_b64_tr_b16 v[226:227], v236 offset:6400
    v_mfma_f32_16x16x32_bf16 a[76:79], v[228:231], v[100:103], a[76:79]
    v_mfma_f32_16x16x32_bf16 a[84:87], v[228:231], v[104:107], a[84:87]
    v_mfma_f32_16x16x32_bf16 a[92:95], v[228:231], v[108:111], a[92:95]
    s_waitcnt lgkmcnt(6)
    v_mfma_f32_16x16x32_bf16 a[96:99], v[208:211], v[96:99], a[96:99]
    ds_read_b64_tr_b16 v[228:229], v237 offset:256
    ds_read_b64_tr_b16 v[230:231], v237 offset:6400
    v_mfma_f32_16x16x32_bf16 a[104:107], v[208:211], v[100:103], a[104:107]
    v_mfma_f32_16x16x32_bf16 a[112:115], v[208:211], v[104:107], a[112:115]
    v_mfma_f32_16x16x32_bf16 a[120:123], v[208:211], v[108:111], a[120:123]
    v_mfma_f32_16x16x32_bf16 a[100:103], v[212:215], v[96:99], a[100:103]
    ds_read_b64_tr_b16 v[208:209], v234 offset:12288
    ds_read_b64_tr_b16 v[210:211], v234 offset:18432
    v_mfma_f32_16x16x32_bf16 a[108:111], v[212:215], v[100:103], a[108:111]
    v_mfma_f32_16x16x32_bf16 a[116:119], v[212:215], v[104:107], a[116:119]
    v_mfma_f32_16x16x32_bf16 a[124:127], v[212:215], v[108:111], a[124:127]
    s_waitcnt lgkmcnt(6)
    v_mfma_f32_16x16x32_bf16 a[128:131], v[216:219], v[96:99], a[128:131]
    ds_read_b64_tr_b16 v[212:213], v235 offset:12288
    ds_read_b64_tr_b16 v[214:215], v235 offset:18432
    v_mfma_f32_16x16x32_bf16 a[136:139], v[216:219], v[100:103], a[136:139]
    v_mfma_f32_16x16x32_bf16 a[144:147], v[216:219], v[104:107], a[144:147]
    v_mfma_f32_16x16x32_bf16 a[152:155], v[216:219], v[108:111], a[152:155]
    s_waitcnt vmcnt(26)
    s_barrier
    v_mfma_f32_16x16x32_bf16 a[132:135], v[220:223], v[96:99], a[132:135]
    ds_read_b64_tr_b16 v[216:217], v236 offset:12288
    ds_read_b64_tr_b16 v[218:219], v236 offset:18432
    v_mfma_f32_16x16x32_bf16 a[140:143], v[220:223], v[100:103], a[140:143]
    s_add_u32 m0, s34, 24576
    s_nop 0
    buffer_load_dwordx4 v238, s[40:43], s35 offen offset:0 nt lds
    v_mfma_f32_16x16x32_bf16 a[148:151], v[220:223], v[104:107], a[148:151]
    v_mfma_f32_16x16x32_bf16 a[156:159], v[220:223], v[108:111], a[156:159]
    s_waitcnt lgkmcnt(6)
    v_mfma_f32_16x16x32_bf16 a[160:163], v[224:227], v[96:99], a[160:163]
    ds_read_b64_tr_b16 v[220:221], v237 offset:12288
    ds_read_b64_tr_b16 v[222:223], v237 offset:18432
    v_mfma_f32_16x16x32_bf16 a[168:171], v[224:227], v[100:103], a[168:171]
    v_mfma_f32_16x16x32_bf16 a[176:179], v[224:227], v[104:107], a[176:179]
    v_mfma_f32_16x16x32_bf16 a[184:187], v[224:227], v[108:111], a[184:187]
    v_mfma_f32_16x16x32_bf16 a[164:167], v[228:231], v[96:99], a[164:167]
    ds_read_b64_tr_b16 v[224:225], v234 offset:12416
    ds_read_b64_tr_b16 v[226:227], v234 offset:18560
    buffer_load_dwordx4 v239, s[40:43], s35 offen offset:1024 nt lds
    v_mfma_f32_16x16x32_bf16 a[172:175], v[228:231], v[100:103], a[172:175]
    v_mfma_f32_16x16x32_bf16 a[180:183], v[228:231], v[104:107], a[180:183]
    v_mfma_f32_16x16x32_bf16 a[188:191], v[228:231], v[108:111], a[188:191]
    s_waitcnt lgkmcnt(6)
    v_mfma_f32_16x16x32_bf16 a[0:3], v[208:211], v[112:115], a[0:3]
    ds_read_b64_tr_b16 v[228:229], v235 offset:12416
    ds_read_b64_tr_b16 v[230:231], v235 offset:18560
    v_mfma_f32_16x16x32_bf16 a[8:11], v[208:211], v[116:119], a[8:11]
    v_mfma_f32_16x16x32_bf16 a[16:19], v[208:211], v[120:123], a[16:19]
    v_mfma_f32_16x16x32_bf16 a[24:27], v[208:211], v[124:127], a[24:27]
    v_mfma_f32_16x16x32_bf16 a[4:7], v[212:215], v[112:115], a[4:7]
    ds_read_b64_tr_b16 v[208:209], v236 offset:12416
    ds_read_b64_tr_b16 v[210:211], v236 offset:18560
    buffer_load_dwordx4 v240, s[40:43], s35 offen offset:2048 nt lds
    v_mfma_f32_16x16x32_bf16 a[12:15], v[212:215], v[116:119], a[12:15]
    v_mfma_f32_16x16x32_bf16 a[20:23], v[212:215], v[120:123], a[20:23]
    v_mfma_f32_16x16x32_bf16 a[28:31], v[212:215], v[124:127], a[28:31]
    s_waitcnt lgkmcnt(6)
    v_mfma_f32_16x16x32_bf16 a[32:35], v[216:219], v[112:115], a[32:35]
    ds_read_b64_tr_b16 v[212:213], v237 offset:12416
    ds_read_b64_tr_b16 v[214:215], v237 offset:18560
    v_mfma_f32_16x16x32_bf16 a[40:43], v[216:219], v[116:119], a[40:43]
    v_mfma_f32_16x16x32_bf16 a[48:51], v[216:219], v[120:123], a[48:51]
    v_mfma_f32_16x16x32_bf16 a[56:59], v[216:219], v[124:127], a[56:59]
    v_mfma_f32_16x16x32_bf16 a[36:39], v[220:223], v[112:115], a[36:39]
    ds_read_b64_tr_b16 v[216:217], v234 offset:12544
    ds_read_b64_tr_b16 v[218:219], v234 offset:18688
    v_mfma_f32_16x16x32_bf16 a[44:47], v[220:223], v[116:119], a[44:47]
    s_add_u32 m0, s34, 27648
    s_nop 0
    buffer_load_dwordx4 v241, s[40:43], s35 offen offset:0 nt lds
    v_mfma_f32_16x16x32_bf16 a[52:55], v[220:223], v[120:123], a[52:55]
    v_mfma_f32_16x16x32_bf16 a[60:63], v[220:223], v[124:127], a[60:63]
    s_waitcnt lgkmcnt(6)
    v_mfma_f32_16x16x32_bf16 a[64:67], v[224:227], v[112:115], a[64:67]
    ds_read_b64_tr_b16 v[220:221], v235 offset:12544
    ds_read_b64_tr_b16 v[222:223], v235 offset:18688
    v_mfma_f32_16x16x32_bf16 a[72:75], v[224:227], v[116:119], a[72:75]
    v_mfma_f32_16x16x32_bf16 a[80:83], v[224:227], v[120:123], a[80:83]
    v_mfma_f32_16x16x32_bf16 a[88:91], v[224:227], v[124:127], a[88:91]
    v_mfma_f32_16x16x32_bf16 a[68:71], v[228:231], v[112:115], a[68:71]
    ds_read_b64_tr_b16 v[224:225], v236 offset:12544
    ds_read_b64_tr_b16 v[226:227], v236 offset:18688
    buffer_load_dwordx4 v242, s[40:43], s35 offen offset:1024 nt lds
    v_mfma_f32_16x16x32_bf16 a[76:79], v[228:231], v[116:119], a[76:79]
    v_mfma_f32_16x16x32_bf16 a[84:87], v[228:231], v[120:123], a[84:87]
    v_mfma_f32_16x16x32_bf16 a[92:95], v[228:231], v[124:127], a[92:95]
    s_waitcnt lgkmcnt(6)
    v_mfma_f32_16x16x32_bf16 a[96:99], v[208:211], v[112:115], a[96:99]
    ds_read_b64_tr_b16 v[228:229], v237 offset:12544
    ds_read_b64_tr_b16 v[230:231], v237 offset:18688
    v_mfma_f32_16x16x32_bf16 a[104:107], v[208:211], v[116:119], a[104:107]
    v_mfma_f32_16x16x32_bf16 a[112:115], v[208:211], v[120:123], a[112:115]
    v_mfma_f32_16x16x32_bf16 a[120:123], v[208:211], v[124:127], a[120:123]
    v_mfma_f32_16x16x32_bf16 a[100:103], v[212:215], v[112:115], a[100:103]
    ds_read_b64_tr_b16 v[208:209], v234 offset:24576
    ds_read_b64_tr_b16 v[210:211], v234 offset:30720
    v_mfma_f32_16x16x32_bf16 a[108:111], v[212:215], v[116:119], a[108:111]
    buffer_load_dwordx4 v243, s[40:43], s35 offen offset:2048 nt lds
    s_add_u32 s35, s35, 12288
    v_mfma_f32_16x16x32_bf16 a[116:119], v[212:215], v[120:123], a[116:119]
    v_mfma_f32_16x16x32_bf16 a[124:127], v[212:215], v[124:127], a[124:127]
    s_waitcnt lgkmcnt(6)
    v_mfma_f32_16x16x32_bf16 a[128:131], v[216:219], v[112:115], a[128:131]
    ds_read_b64_tr_b16 v[212:213], v235 offset:24576
    ds_read_b64_tr_b16 v[214:215], v235 offset:30720
    v_mfma_f32_16x16x32_bf16 a[136:139], v[216:219], v[116:119], a[136:139]
    v_mfma_f32_16x16x32_bf16 a[144:147], v[216:219], v[120:123], a[144:147]
    v_mfma_f32_16x16x32_bf16 a[152:155], v[216:219], v[124:127], a[152:155]
    v_mfma_f32_16x16x32_bf16 a[132:135], v[220:223], v[112:115], a[132:135]
    ds_read_b64_tr_b16 v[216:217], v236 offset:24576
    ds_read_b64_tr_b16 v[218:219], v236 offset:30720
    v_mfma_f32_16x16x32_bf16 a[140:143], v[220:223], v[116:119], a[140:143]
    v_mfma_f32_16x16x32_bf16 a[148:151], v[220:223], v[120:123], a[148:151]
    v_mfma_f32_16x16x32_bf16 a[156:159], v[220:223], v[124:127], a[156:159]
    s_waitcnt lgkmcnt(6)
    v_mfma_f32_16x16x32_bf16 a[160:163], v[224:227], v[112:115], a[160:163]
    ds_read_b64_tr_b16 v[220:221], v237 offset:24576
    ds_read_b64_tr_b16 v[222:223], v237 offset:30720
    v_mfma_f32_16x16x32_bf16 a[168:171], v[224:227], v[116:119], a[168:171]
    v_mfma_f32_16x16x32_bf16 a[176:179], v[224:227], v[120:123], a[176:179]
    v_mfma_f32_16x16x32_bf16 a[184:187], v[224:227], v[124:127], a[184:187]
    v_mfma_f32_16x16x32_bf16 a[164:167], v[228:231], v[112:115], a[164:167]
    ds_read_b64_tr_b16 v[224:225], v234 offset:24704
    ds_read_b64_tr_b16 v[226:227], v234 offset:30848
    v_mfma_f32_16x16x32_bf16 a[172:175], v[228:231], v[116:119], a[172:175]
    v_mfma_f32_16x16x32_bf16 a[180:183], v[228:231], v[120:123], a[180:183]
    v_mfma_f32_16x16x32_bf16 a[188:191], v[228:231], v[124:127], a[188:191]
    s_waitcnt vmcnt(24)
    s_waitcnt lgkmcnt(6)
    v_mfma_f32_16x16x32_bf16 a[0:3], v[208:211], v[128:131], a[0:3]
    ds_read_b64_tr_b16 v[228:229], v235 offset:24704
    ds_read_b64_tr_b16 v[230:231], v235 offset:30848
    v_mfma_f32_16x16x32_bf16 a[8:11], v[208:211], v[132:135], a[8:11]
    v_mfma_f32_16x16x32_bf16 a[16:19], v[208:211], v[136:139], a[16:19]
    v_mfma_f32_16x16x32_bf16 a[24:27], v[208:211], v[140:143], a[24:27]
    v_mfma_f32_16x16x32_bf16 a[4:7], v[212:215], v[128:131], a[4:7]
    ds_read_b64_tr_b16 v[208:209], v236 offset:24704
    ds_read_b64_tr_b16 v[210:211], v236 offset:30848
    v_mfma_f32_16x16x32_bf16 a[12:15], v[212:215], v[132:135], a[12:15]
    v_mfma_f32_16x16x32_bf16 a[20:23], v[212:215], v[136:139], a[20:23]
    v_mfma_f32_16x16x32_bf16 a[28:31], v[212:215], v[140:143], a[28:31]
    s_waitcnt lgkmcnt(6)
    v_mfma_f32_16x16x32_bf16 a[32:35], v[216:219], v[128:131], a[32:35]
    ds_read_b64_tr_b16 v[212:213], v237 offset:24704
    ds_read_b64_tr_b16 v[214:215], v237 offset:30848
    v_mfma_f32_16x16x32_bf16 a[40:43], v[216:219], v[132:135], a[40:43]
    v_mfma_f32_16x16x32_bf16 a[48:51], v[216:219], v[136:139], a[48:51]
    v_mfma_f32_16x16x32_bf16 a[56:59], v[216:219], v[140:143], a[56:59]
    v_mfma_f32_16x16x32_bf16 a[36:39], v[220:223], v[128:131], a[36:39]
    ds_read_b64_tr_b16 v[216:217], v234 offset:24832
    ds_read_b64_tr_b16 v[218:219], v234 offset:30976
    v_mfma_f32_16x16x32_bf16 a[44:47], v[220:223], v[132:135], a[44:47]
    v_mfma_f32_16x16x32_bf16 a[52:55], v[220:223], v[136:139], a[52:55]
    v_mfma_f32_16x16x32_bf16 a[60:63], v[220:223], v[140:143], a[60:63]
    s_waitcnt lgkmcnt(6)
    v_mfma_f32_16x16x32_bf16 a[64:67], v[224:227], v[128:131], a[64:67]
    ds_read_b64_tr_b16 v[220:221], v235 offset:24832
    ds_read_b64_tr_b16 v[222:223], v235 offset:30976
    v_mfma_f32_16x16x32_bf16 a[72:75], v[224:227], v[132:135], a[72:75]
    v_mfma_f32_16x16x32_bf16 a[80:83], v[224:227], v[136:139], a[80:83]
    v_mfma_f32_16x16x32_bf16 a[88:91], v[224:227], v[140:143], a[88:91]
    v_mfma_f32_16x16x32_bf16 a[68:71], v[228:231], v[128:131], a[68:71]
    ds_read_b64_tr_b16 v[224:225], v236 offset:24832
    ds_read_b64_tr_b16 v[226:227], v236 offset:30976
    v_mfma_f32_16x16x32_bf16 a[76:79], v[228:231], v[132:135], a[76:79]
    v_mfma_f32_16x16x32_bf16 a[84:87], v[228:231], v[136:139], a[84:87]
    v_mfma_f32_16x16x32_bf16 a[92:95], v[228:231], v[140:143], a[92:95]
    s_waitcnt lgkmcnt(6)
    v_mfma_f32_16x16x32_bf16 a[96:99], v[208:211], v[128:131], a[96:99]
    ds_read_b64_tr_b16 v[228:229], v237 offset:24832
    ds_read_b64_tr_b16 v[230:231], v237 offset:30976
    v_mfma_f32_16x16x32_bf16 a[104:107], v[208:211], v[132:135], a[104:107]
    v_mfma_f32_16x16x32_bf16 a[112:115], v[208:211], v[136:139], a[112:115]
    v_mfma_f32_16x16x32_bf16 a[120:123], v[208:211], v[140:143], a[120:123]
    v_mfma_f32_16x16x32_bf16 a[100:103], v[212:215], v[128:131], a[100:103]
    ds_read_b64_tr_b16 v[208:209], v234 offset:36864
    ds_read_b64_tr_b16 v[210:211], v234 offset:43008
    v_mfma_f32_16x16x32_bf16 a[108:111], v[212:215], v[132:135], a[108:111]
    v_mfma_f32_16x16x32_bf16 a[116:119], v[212:215], v[136:139], a[116:119]
    v_mfma_f32_16x16x32_bf16 a[124:127], v[212:215], v[140:143], a[124:127]
    s_waitcnt lgkmcnt(6)
    v_mfma_f32_16x16x32_bf16 a[128:131], v[216:219], v[128:131], a[128:131]
    ds_read_b64_tr_b16 v[212:213], v235 offset:36864
    ds_read_b64_tr_b16 v[214:215], v235 offset:43008
    v_mfma_f32_16x16x32_bf16 a[136:139], v[216:219], v[132:135], a[136:139]
    v_mfma_f32_16x16x32_bf16 a[144:147], v[216:219], v[136:139], a[144:147]
    v_mfma_f32_16x16x32_bf16 a[152:155], v[216:219], v[140:143], a[152:155]
    s_waitcnt vmcnt(18)
    s_barrier
    v_mfma_f32_16x16x32_bf16 a[132:135], v[220:223], v[128:131], a[132:135]
    ds_read_b64_tr_b16 v[216:217], v236 offset:36864
    ds_read_b64_tr_b16 v[218:219], v236 offset:43008
    v_mfma_f32_16x16x32_bf16 a[140:143], v[220:223], v[132:135], a[140:143]
    s_add_u32 m0, s34, 49152
    s_nop 0
    buffer_load_dwordx4 v238, s[40:43], s35 offen offset:0 nt lds
    v_mfma_f32_16x16x32_bf16 a[148:151], v[220:223], v[136:139], a[148:151]
    v_mfma_f32_16x16x32_bf16 a[156:159], v[220:223], v[140:143], a[156:159]
    s_waitcnt lgkmcnt(6)
    v_mfma_f32_16x16x32_bf16 a[160:163], v[224:227], v[128:131], a[160:163]
    ds_read_b64_tr_b16 v[220:221], v237 offset:36864
    ds_read_b64_tr_b16 v[222:223], v237 offset:43008
    v_mfma_f32_16x16x32_bf16 a[168:171], v[224:227], v[132:135], a[168:171]
    v_mfma_f32_16x16x32_bf16 a[176:179], v[224:227], v[136:139], a[176:179]
    v_mfma_f32_16x16x32_bf16 a[184:187], v[224:227], v[140:143], a[184:187]
    v_mfma_f32_16x16x32_bf16 a[164:167], v[228:231], v[128:131], a[164:167]
    ds_read_b64_tr_b16 v[224:225], v234 offset:36992
    ds_read_b64_tr_b16 v[226:227], v234 offset:43136
    buffer_load_dwordx4 v239, s[40:43], s35 offen offset:1024 nt lds
    v_mfma_f32_16x16x32_bf16 a[172:175], v[228:231], v[132:135], a[172:175]
    v_mfma_f32_16x16x32_bf16 a[180:183], v[228:231], v[136:139], a[180:183]
    v_mfma_f32_16x16x32_bf16 a[188:191], v[228:231], v[140:143], a[188:191]
    s_waitcnt lgkmcnt(6)
    v_mfma_f32_16x16x32_bf16 a[0:3], v[208:211], v[144:147], a[0:3]
    ds_read_b64_tr_b16 v[228:229], v235 offset:36992
    ds_read_b64_tr_b16 v[230:231], v235 offset:43136
    v_mfma_f32_16x16x32_bf16 a[8:11], v[208:211], v[148:151], a[8:11]
    v_mfma_f32_16x16x32_bf16 a[16:19], v[208:211], v[152:155], a[16:19]
    v_mfma_f32_16x16x32_bf16 a[24:27], v[208:211], v[156:159], a[24:27]
    v_mfma_f32_16x16x32_bf16 a[4:7], v[212:215], v[144:147], a[4:7]
    ds_read_b64_tr_b16 v[208:209], v236 offset:36992
    ds_read_b64_tr_b16 v[210:211], v236 offset:43136
    buffer_load_dwordx4 v240, s[40:43], s35 offen offset:2048 nt lds
    v_mfma_f32_16x16x32_bf16 a[12:15], v[212:215], v[148:151], a[12:15]
    v_mfma_f32_16x16x32_bf16 a[20:23], v[212:215], v[152:155], a[20:23]
    v_mfma_f32_16x16x32_bf16 a[28:31], v[212:215], v[156:159], a[28:31]
    s_waitcnt lgkmcnt(6)
    v_mfma_f32_16x16x32_bf16 a[32:35], v[216:219], v[144:147], a[32:35]
    ds_read_b64_tr_b16 v[212:213], v237 offset:36992
    ds_read_b64_tr_b16 v[214:215], v237 offset:43136
    v_mfma_f32_16x16x32_bf16 a[40:43], v[216:219], v[148:151], a[40:43]
    v_mfma_f32_16x16x32_bf16 a[48:51], v[216:219], v[152:155], a[48:51]
    v_mfma_f32_16x16x32_bf16 a[56:59], v[216:219], v[156:159], a[56:59]
    v_mfma_f32_16x16x32_bf16 a[36:39], v[220:223], v[144:147], a[36:39]
    ds_read_b64_tr_b16 v[216:217], v234 offset:37120
    ds_read_b64_tr_b16 v[218:219], v234 offset:43264
    s_add_u32 m0, s34, 52224
    s_nop 0
    buffer_load_dwordx4 v241, s[40:43], s35 offen offset:0 nt lds
    v_accvgpr_read_b32 v160, a0
    v_accvgpr_read_b32 v161, a1
    v_accvgpr_read_b32 v162, a2
    v_accvgpr_read_b32 v163, a3
    v_accvgpr_read_b32 v164, a4
    v_mfma_f32_16x16x32_bf16 a[44:47], v[220:223], v[148:151], a[44:47]
    v_accvgpr_read_b32 v165, a5
    v_accvgpr_read_b32 v166, a6
    v_accvgpr_read_b32 v167, a7
    v_pk_mul_f32 v[160:161], v[160:161], s[60:61]
    v_pk_mul_f32 v[162:163], v[162:163], s[60:61]
    v_pk_mul_f32 v[164:165], v[164:165], s[60:61]
    v_pk_mul_f32 v[166:167], v[166:167], s[60:61]
    v_cvt_pk_bf16_f32 v0, v160, v161
    v_mfma_f32_16x16x32_bf16 a[52:55], v[220:223], v[152:155], a[52:55]
    v_cvt_pk_bf16_f32 v1, v162, v163
    v_cvt_pk_bf16_f32 v2, v164, v165
    v_cvt_pk_bf16_f32 v3, v166, v167
    v_accvgpr_read_b32 v168, a8
    v_accvgpr_read_b32 v169, a9
    v_accvgpr_read_b32 v170, a10
    v_accvgpr_read_b32 v171, a11
    v_mfma_f32_16x16x32_bf16 a[60:63], v[220:223], v[156:159], a[60:63]
    v_accvgpr_read_b32 v172, a12
    v_accvgpr_read_b32 v173, a13
    v_accvgpr_read_b32 v174, a14
    v_accvgpr_read_b32 v175, a15
    v_pk_mul_f32 v[168:169], v[168:169], s[60:61]
    v_pk_mul_f32 v[170:171], v[170:171], s[60:61]
    v_pk_mul_f32 v[172:173], v[172:173], s[60:61]
    s_waitcnt lgkmcnt(6)
    v_mfma_f32_16x16x32_bf16 a[64:67], v[224:227], v[144:147], a[64:67]
    ds_read_b64_tr_b16 v[220:221], v235 offset:37120
    ds_read_b64_tr_b16 v[222:223], v235 offset:43264
    v_pk_mul_f32 v[174:175], v[174:175], s[60:61]
    v_cvt_pk_bf16_f32 v4, v168, v169
    v_cvt_pk_bf16_f32 v5, v170, v171
    v_cvt_pk_bf16_f32 v6, v172, v173
    v_cvt_pk_bf16_f32 v7, v174, v175
    v_accvgpr_read_b32 v176, a16
    v_accvgpr_read_b32 v177, a17
    v_mfma_f32_16x16x32_bf16 a[72:75], v[224:227], v[148:151], a[72:75]
    v_accvgpr_read_b32 v178, a18
    v_accvgpr_read_b32 v179, a19
    v_accvgpr_read_b32 v180, a20
    v_accvgpr_read_b32 v181, a21
    v_accvgpr_read_b32 v182, a22
    v_accvgpr_read_b32 v183, a23
    v_pk_mul_f32 v[176:177], v[176:177], s[60:61]
    v_mfma_f32_16x16x32_bf16 a[80:83], v[224:227], v[152:155], a[80:83]
    v_pk_mul_f32 v[178:179], v[178:179], s[60:61]
    v_pk_mul_f32 v[180:181], v[180:181], s[60:61]
    v_pk_mul_f32 v[182:183], v[182:183], s[60:61]
    v_cvt_pk_bf16_f32 v8, v176, v177
    v_cvt_pk_bf16_f32 v9, v178, v179
    v_cvt_pk_bf16_f32 v10, v180, v181
    v_mfma_f32_16x16x32_bf16 a[88:91], v[224:227], v[156:159], a[88:91]
    v_cvt_pk_bf16_f32 v11, v182, v183
    v_accvgpr_read_b32 v184, a24
    v_accvgpr_read_b32 v185, a25
    v_accvgpr_read_b32 v186, a26
    v_accvgpr_read_b32 v187, a27
    v_accvgpr_read_b32 v188, a28
    v_mfma_f32_16x16x32_bf16 a[68:71], v[228:231], v[144:147], a[68:71]
    ds_read_b64_tr_b16 v[224:225], v236 offset:37120
    ds_read_b64_tr_b16 v[226:227], v236 offset:43264
    buffer_load_dwordx4 v242, s[40:43], s35 offen offset:1024 nt lds
    v_accvgpr_read_b32 v189, a29
    v_accvgpr_read_b32 v190, a30
    v_accvgpr_read_b32 v191, a31
    v_pk_mul_f32 v[184:185], v[184:185], s[60:61]
    v_pk_mul_f32 v[186:187], v[186:187], s[60:61]
    v_pk_mul_f32 v[188:189], v[188:189], s[60:61]
    v_pk_mul_f32 v[190:191], v[190:191], s[60:61]
    v_cvt_pk_bf16_f32 v12, v184, v185
    v_cvt_pk_bf16_f32 v13, v186, v187
    v_cvt_pk_bf16_f32 v14, v188, v189
    v_cvt_pk_bf16_f32 v15, v190, v191
    v_permlane32_swap_b32 v0, v2
    v_permlane32_swap_b32 v1, v3
    v_mfma_f32_16x16x32_bf16 a[76:79], v[228:231], v[148:151], a[76:79]
    v_permlane32_swap_b32 v4, v6
    v_permlane32_swap_b32 v5, v7
    v_permlane32_swap_b32 v8, v10
    v_permlane32_swap_b32 v9, v11
    v_permlane32_swap_b32 v12, v14
    v_permlane32_swap_b32 v13, v15
    v_permlane16_swap_b32 v0, v2
    v_permlane16_swap_b32 v1, v3
    v_permlane16_swap_b32 v4, v6
    v_permlane16_swap_b32 v5, v7
    v_permlane16_swap_b32 v8, v10
    v_permlane16_swap_b32 v9, v11
    v_permlane16_swap_b32 v12, v14
    v_permlane16_swap_b32 v13, v15
    v_mfma_f32_16x16x32_bf16 a[84:87], v[228:231], v[152:155], a[84:87]
    v_accvgpr_read_b32 v160, a32
    v_accvgpr_read_b32 v161, a33
    v_accvgpr_read_b32 v162, a34
    v_accvgpr_read_b32 v163, a35
    v_accvgpr_read_b32 v164, a36
    v_accvgpr_read_b32 v165, a37
    v_accvgpr_read_b32 v166, a38
    v_accvgpr_read_b32 v167, a39
    v_pk_mul_f32 v[160:161], v[160:161], s[60:61]
    v_pk_mul_f32 v[162:163], v[162:163], s[60:61]
    v_pk_mul_f32 v[164:165], v[164:165], s[60:61]
    v_pk_mul_f32 v[166:167], v[166:167], s[60:61]
    v_cvt_pk_bf16_f32 v16, v160, v161
    v_cvt_pk_bf16_f32 v17, v162, v163
    v_mfma_f32_16x16x32_bf16 a[92:95], v[228:231], v[156:159], a[92:95]
    v_cvt_pk_bf16_f32 v18, v164, v165
    v_cvt_pk_bf16_f32 v19, v166, v167
    v_accvgpr_read_b32 v168, a40
    v_accvgpr_read_b32 v169, a41
    v_accvgpr_read_b32 v170, a42
    v_accvgpr_read_b32 v171, a43
    v_accvgpr_read_b32 v172, a44
    v_accvgpr_read_b32 v173, a45
    v_accvgpr_read_b32 v174, a46
    v_accvgpr_read_b32 v175, a47
    v_pk_mul_f32 v[168:169], v[168:169], s[60:61]
    v_pk_mul_f32 v[170:171], v[170:171], s[60:61]
    v_pk_mul_f32 v[172:173], v[172:173], s[60:61]
    s_waitcnt lgkmcnt(6)
    v_mfma_f32_16x16x32_bf16 a[96:99], v[208:211], v[144:147], a[96:99]
    ds_read_b64_tr_b16 v[228:229], v237 offset:37120
    ds_read_b64_tr_b16 v[230:231], v237 offset:43264
    v_pk_mul_f32 v[174:175], v[174:175], s[60:61]
    v_cvt_pk_bf16_f32 v20, v168, v169
    v_cvt_pk_bf16_f32 v21, v170, v171
    v_cvt_pk_bf16_f32 v22, v172, v173
    v_cvt_pk_bf16_f32 v23, v174, v175
    v_accvgpr_read_b32 v176, a48
    v_accvgpr_read_b32 v177, a49
    v_mfma_f32_16x16x32_bf16 a[104:107], v[208:211], v[148:151], a[104:107]
    v_accvgpr_read_b32 v178, a50
    v_accvgpr_read_b32 v179, a51
    v_accvgpr_read_b32 v180, a52
    v_accvgpr_read_b32 v181, a53
    v_accvgpr_read_b32 v182, a54
    v_accvgpr_read_b32 v183, a55
    v_pk_mul_f32 v[176:177], v[176:177], s[60:61]
    v_mfma_f32_16x16x32_bf16 a[112:115], v[208:211], v[152:155], a[112:115]
    v_pk_mul_f32 v[178:179], v[178:179], s[60:61]
    v_pk_mul_f32 v[180:181], v[180:181], s[60:61]
    v_pk_mul_f32 v[182:183], v[182:183], s[60:61]
    v_cvt_pk_bf16_f32 v24, v176, v177
    v_cvt_pk_bf16_f32 v25, v178, v179
    v_cvt_pk_bf16_f32 v26, v180, v181
    v_mfma_f32_16x16x32_bf16 a[120:123], v[208:211], v[156:159], a[120:123]
    v_cvt_pk_bf16_f32 v27, v182, v183
    v_accvgpr_read_b32 v184, a56
    v_accvgpr_read_b32 v185, a57
    v_accvgpr_read_b32 v186, a58
    v_accvgpr_read_b32 v187, a59
    v_accvgpr_read_b32 v188, a60
    v_mfma_f32_16x16x32_bf16 a[100:103], v[212:215], v[144:147], a[100:103]
    ds_read_b128 v[208:211], v232 offset:0
    buffer_load_dwordx4 v243, s[40:43], s35 offen offset:2048 nt lds
    s_add_u32 s35, s35, 12288
    v_accvgpr_read_b32 v189, a61
    v_accvgpr_read_b32 v190, a62
    v_accvgpr_read_b32 v191, a63
    v_pk_mul_f32 v[184:185], v[184:185], s[60:61]
    v_pk_mul_f32 v[186:187], v[186:187], s[60:61]
    v_pk_mul_f32 v[188:189], v[188:189], s[60:61]
    v_pk_mul_f32 v[190:191], v[190:191], s[60:61]
    v_cvt_pk_bf16_f32 v28, v184, v185
    v_cvt_pk_bf16_f32 v29, v186, v187
    v_cvt_pk_bf16_f32 v30, v188, v189
    v_cvt_pk_bf16_f32 v31, v190, v191
    v_permlane32_swap_b32 v16, v18
    v_mfma_f32_16x16x32_bf16 a[108:111], v[212:215], v[148:151], a[108:111]
    v_permlane32_swap_b32 v17, v19
    v_permlane32_swap_b32 v20, v22
    v_permlane32_swap_b32 v21, v23
    v_permlane32_swap_b32 v24, v26
    v_permlane32_swap_b32 v25, v27
    v_permlane32_swap_b32 v28, v30
    v_permlane32_swap_b32 v29, v31
    v_permlane16_swap_b32 v16, v18
    v_permlane16_swap_b32 v17, v19
    v_permlane16_swap_b32 v20, v22
    v_permlane16_swap_b32 v21, v23
    v_permlane16_swap_b32 v24, v26
    v_permlane16_swap_b32 v25, v27
    v_permlane16_swap_b32 v28, v30
    v_mfma_f32_16x16x32_bf16 a[116:119], v[212:215], v[152:155], a[116:119]
    v_permlane16_swap_b32 v29, v31
    v_accvgpr_read_b32 v160, a64
    v_accvgpr_read_b32 v161, a65
    v_accvgpr_read_b32 v162, a66
    v_accvgpr_read_b32 v163, a67
    v_accvgpr_read_b32 v164, a68
    v_accvgpr_read_b32 v165, a69
    v_accvgpr_read_b32 v166, a70
    v_accvgpr_read_b32 v167, a71
    v_pk_mul_f32 v[160:161], v[160:161], s[60:61]
    v_pk_mul_f32 v[162:163], v[162:163], s[60:61]
    v_pk_mul_f32 v[164:165], v[164:165], s[60:61]
    v_pk_mul_f32 v[166:167], v[166:167], s[60:61]
    v_cvt_pk_bf16_f32 v32, v160, v161
    v_mfma_f32_16x16x32_bf16 a[124:127], v[212:215], v[156:159], a[124:127]
    v_cvt_pk_bf16_f32 v33, v162, v163
    v_cvt_pk_bf16_f32 v34, v164, v165
    v_cvt_pk_bf16_f32 v35, v166, v167
    v_accvgpr_read_b32 v168, a72
    v_accvgpr_read_b32 v169, a73
    v_accvgpr_read_b32 v170, a74
    v_accvgpr_read_b32 v171, a75
    v_accvgpr_read_b32 v172, a76
    v_accvgpr_read_b32 v173, a77
    v_accvgpr_read_b32 v174, a78
    v_accvgpr_read_b32 v175, a79
    v_pk_mul_f32 v[168:169], v[168:169], s[60:61]
    v_pk_mul_f32 v[170:171], v[170:171], s[60:61]
    v_pk_mul_f32 v[172:173], v[172:173], s[60:61]
    s_waitcnt lgkmcnt(5)
    v_mfma_f32_16x16x32_bf16 a[128:131], v[216:219], v[144:147], a[128:131]
    ds_read_b128 v[212:215], v232 offset:6144
    v_pk_mul_f32 v[174:175], v[174:175], s[60:61]
    v_cvt_pk_bf16_f32 v36, v168, v169
    v_cvt_pk_bf16_f32 v37, v170, v171
    v_cvt_pk_bf16_f32 v38, v172, v173
    v_cvt_pk_bf16_f32 v39, v174, v175
    v_accvgpr_read_b32 v176, a80
    v_accvgpr_read_b32 v177, a81
    v_mfma_f32_16x16x32_bf16 a[136:139], v[216:219], v[148:151], a[136:139]
    v_accvgpr_read_b32 v178, a82
    v_accvgpr_read_b32 v179, a83
    v_accvgpr_read_b32 v180, a84
    v_accvgpr_read_b32 v181, a85
    v_accvgpr_read_b32 v182, a86
    v_accvgpr_read_b32 v183, a87
    v_pk_mul_f32 v[176:177], v[176:177], s[60:61]
    v_mfma_f32_16x16x32_bf16 a[144:147], v[216:219], v[152:155], a[144:147]
    v_pk_mul_f32 v[178:179], v[178:179], s[60:61]
    v_pk_mul_f32 v[180:181], v[180:181], s[60:61]
    v_pk_mul_f32 v[182:183], v[182:183], s[60:61]
    v_cvt_pk_bf16_f32 v40, v176, v177
    v_cvt_pk_bf16_f32 v41, v178, v179
    v_cvt_pk_bf16_f32 v42, v180, v181
    v_mfma_f32_16x16x32_bf16 a[152:155], v[216:219], v[156:159], a[152:155]
    v_cvt_pk_bf16_f32 v43, v182, v183
    v_accvgpr_read_b32 v184, a88
    v_accvgpr_read_b32 v185, a89
    v_accvgpr_read_b32 v186, a90
    v_accvgpr_read_b32 v187, a91
    v_accvgpr_read_b32 v188, a92
    v_mfma_f32_16x16x32_bf16 a[132:135], v[220:223], v[144:147], a[132:135]
    ds_read_b128 v[216:219], v233 offset:0
    v_accvgpr_read_b32 v189, a93
    v_accvgpr_read_b32 v190, a94
    v_accvgpr_read_b32 v191, a95
    v_pk_mul_f32 v[184:185], v[184:185], s[60:61]
    v_pk_mul_f32 v[186:187], v[186:187], s[60:61]
    v_pk_mul_f32 v[188:189], v[188:189], s[60:61]
    v_pk_mul_f32 v[190:191], v[190:191], s[60:61]
    v_cvt_pk_bf16_f32 v44, v184, v185
    v_cvt_pk_bf16_f32 v45, v186, v187
    v_cvt_pk_bf16_f32 v46, v188, v189
    v_cvt_pk_bf16_f32 v47, v190, v191
    v_permlane32_swap_b32 v32, v34
    v_permlane32_swap_b32 v33, v35
    v_permlane32_swap_b32 v36, v38
    v_mfma_f32_16x16x32_bf16 a[140:143], v[220:223], v[148:151], a[140:143]
    v_permlane32_swap_b32 v37, v39
    v_permlane32_swap_b32 v40, v42
    v_permlane32_swap_b32 v41, v43
    v_permlane32_swap_b32 v44, v46
    v_permlane32_swap_b32 v45, v47
    v_permlane16_swap_b32 v32, v34
    v_permlane16_swap_b32 v33, v35
    v_permlane16_swap_b32 v36, v38
    v_permlane16_swap_b32 v37, v39
    v_permlane16_swap_b32 v40, v42
    v_permlane16_swap_b32 v41, v43
    v_permlane16_swap_b32 v44, v46
    v_permlane16_swap_b32 v45, v47
    v_accvgpr_read_b32 v160, a96
    v_mfma_f32_16x16x32_bf16 a[148:151], v[220:223], v[152:155], a[148:151]
    v_accvgpr_read_b32 v161, a97
    v_accvgpr_read_b32 v162, a98
    v_accvgpr_read_b32 v163, a99
    v_accvgpr_read_b32 v164, a100
    v_accvgpr_read_b32 v165, a101
    v_accvgpr_read_b32 v166, a102
    v_accvgpr_read_b32 v167, a103
    v_pk_mul_f32 v[160:161], v[160:161], s[60:61]
    v_pk_mul_f32 v[162:163], v[162:163], s[60:61]
    v_pk_mul_f32 v[164:165], v[164:165], s[60:61]
    v_pk_mul_f32 v[166:167], v[166:167], s[60:61]
    v_cvt_pk_bf16_f32 v48, v160, v161
    v_cvt_pk_bf16_f32 v49, v162, v163
    v_mfma_f32_16x16x32_bf16 a[156:159], v[220:223], v[156:159], a[156:159]
    v_cvt_pk_bf16_f32 v50, v164, v165
    v_cvt_pk_bf16_f32 v51, v166, v167
    v_accvgpr_read_b32 v168, a104
    v_accvgpr_read_b32 v169, a105
    v_accvgpr_read_b32 v170, a106
    v_accvgpr_read_b32 v171, a107
    v_accvgpr_read_b32 v172, a108
    v_accvgpr_read_b32 v173, a109
    v_accvgpr_read_b32 v174, a110
    v_accvgpr_read_b32 v175, a111
    v_pk_mul_f32 v[168:169], v[168:169], s[60:61]
    v_pk_mul_f32 v[170:171], v[170:171], s[60:61]
    v_pk_mul_f32 v[172:173], v[172:173], s[60:61]
    s_waitcnt lgkmcnt(3)
    v_mfma_f32_16x16x32_bf16 a[160:163], v[224:227], v[144:147], a[160:163]
    ds_read_b128 v[220:223], v233 offset:6144
    v_pk_mul_f32 v[174:175], v[174:175], s[60:61]
    v_cvt_pk_bf16_f32 v52, v168, v169
    v_cvt_pk_bf16_f32 v53, v170, v171
    v_cvt_pk_bf16_f32 v54, v172, v173
    v_cvt_pk_bf16_f32 v55, v174, v175
    v_accvgpr_read_b32 v176, a112
    v_accvgpr_read_b32 v177, a113
    v_mfma_f32_16x16x32_bf16 a[168:171], v[224:227], v[148:151], a[168:171]
    v_accvgpr_read_b32 v178, a114
    v_accvgpr_read_b32 v179, a115
    v_accvgpr_read_b32 v180, a116
    v_accvgpr_read_b32 v181, a117
    v_accvgpr_read_b32 v182, a118
    v_accvgpr_read_b32 v183, a119
    v_pk_mul_f32 v[176:177], v[176:177], s[60:61]
    v_mfma_f32_16x16x32_bf16 a[176:179], v[224:227], v[152:155], a[176:179]
    v_pk_mul_f32 v[178:179], v[178:179], s[60:61]
    v_pk_mul_f32 v[180:181], v[180:181], s[60:61]
    v_pk_mul_f32 v[182:183], v[182:183], s[60:61]
    v_cvt_pk_bf16_f32 v56, v176, v177
    v_cvt_pk_bf16_f32 v57, v178, v179
    v_cvt_pk_bf16_f32 v58, v180, v181
    v_mfma_f32_16x16x32_bf16 a[184:187], v[224:227], v[156:159], a[184:187]
    v_cvt_pk_bf16_f32 v59, v182, v183
    v_accvgpr_read_b32 v184, a120
    v_accvgpr_read_b32 v185, a121
    v_accvgpr_read_b32 v186, a122
    v_accvgpr_read_b32 v187, a123
    v_accvgpr_read_b32 v188, a124
    v_mfma_f32_16x16x32_bf16 a[164:167], v[228:231], v[144:147], a[164:167]
    ds_read_b128 v[224:227], v232 offset:128
    v_accvgpr_read_b32 v189, a125
    v_accvgpr_read_b32 v190, a126
    v_accvgpr_read_b32 v191, a127
    v_pk_mul_f32 v[184:185], v[184:185], s[60:61]
    v_pk_mul_f32 v[186:187], v[186:187], s[60:61]
    v_pk_mul_f32 v[188:189], v[188:189], s[60:61]
    v_pk_mul_f32 v[190:191], v[190:191], s[60:61]
    v_cvt_pk_bf16_f32 v60, v184, v185
    v_cvt_pk_bf16_f32 v61, v186, v187
    v_cvt_pk_bf16_f32 v62, v188, v189
    v_cvt_pk_bf16_f32 v63, v190, v191
    v_permlane32_swap_b32 v48, v50
    v_permlane32_swap_b32 v49, v51
    v_permlane32_swap_b32 v52, v54
    v_mfma_f32_16x16x32_bf16 a[172:175], v[228:231], v[148:151], a[172:175]
    v_permlane32_swap_b32 v53, v55
    v_permlane32_swap_b32 v56, v58
    v_permlane32_swap_b32 v57, v59
    v_permlane32_swap_b32 v60, v62
    v_permlane32_swap_b32 v61, v63
    v_permlane16_swap_b32 v48, v50
    v_permlane16_swap_b32 v49, v51
    v_permlane16_swap_b32 v52, v54
    v_permlane16_swap_b32 v53, v55
    v_permlane16_swap_b32 v56, v58
    v_permlane16_swap_b32 v57, v59
    v_permlane16_swap_b32 v60, v62
    v_permlane16_swap_b32 v61, v63
    v_accvgpr_read_b32 v160, a128
    v_mfma_f32_16x16x32_bf16 a[180:183], v[228:231], v[152:155], a[180:183]
    v_accvgpr_read_b32 v161, a129
    v_accvgpr_read_b32 v162, a130
    v_accvgpr_read_b32 v163, a131
    v_accvgpr_read_b32 v164, a132
    v_accvgpr_read_b32 v165, a133
    v_accvgpr_read_b32 v166, a134
    v_accvgpr_read_b32 v167, a135
    v_pk_mul_f32 v[160:161], v[160:161], s[60:61]
    v_pk_mul_f32 v[162:163], v[162:163], s[60:61]
    v_pk_mul_f32 v[164:165], v[164:165], s[60:61]
    v_pk_mul_f32 v[166:167], v[166:167], s[60:61]
    v_cvt_pk_bf16_f32 v64, v160, v161
    v_cvt_pk_bf16_f32 v65, v162, v163
    v_mfma_f32_16x16x32_bf16 a[188:191], v[228:231], v[156:159], a[188:191]
    v_cvt_pk_bf16_f32 v66, v164, v165
    v_cvt_pk_bf16_f32 v67, v166, v167
    v_accvgpr_read_b32 v168, a136
    v_accvgpr_read_b32 v169, a137
    v_accvgpr_read_b32 v170, a138
    v_accvgpr_read_b32 v171, a139
    v_accvgpr_read_b32 v172, a140
    v_accvgpr_read_b32 v173, a141
    v_accvgpr_read_b32 v174, a142
    v_accvgpr_read_b32 v175, a143
    v_pk_mul_f32 v[168:169], v[168:169], s[60:61]
    v_pk_mul_f32 v[170:171], v[170:171], s[60:61]
    v_pk_mul_f32 v[172:173], v[172:173], s[60:61]
    s_waitcnt lgkmcnt(3)
    v_mfma_f32_16x16x32_bf16 v[96:99], v[208:211], v[0:3], 0
    ds_read_b128 v[228:231], v232 offset:6272
    v_pk_mul_f32 v[174:175], v[174:175], s[60:61]
    v_cvt_pk_bf16_f32 v68, v168, v169
    v_cvt_pk_bf16_f32 v69, v170, v171
    v_cvt_pk_bf16_f32 v70, v172, v173
    v_cvt_pk_bf16_f32 v71, v174, v175
    v_accvgpr_read_b32 v176, a144
    v_accvgpr_read_b32 v177, a145
    v_mfma_f32_16x16x32_bf16 v[104:107], v[208:211], v[4:7], 0
    v_accvgpr_read_b32 v178, a146
    v_accvgpr_read_b32 v179, a147
    v_accvgpr_read_b32 v180, a148
    v_accvgpr_read_b32 v181, a149
    v_accvgpr_read_b32 v182, a150
    v_accvgpr_read_b32 v183, a151
    v_pk_mul_f32 v[176:177], v[176:177], s[60:61]
    v_mfma_f32_16x16x32_bf16 v[112:115], v[208:211], v[8:11], 0
    v_pk_mul_f32 v[178:179], v[178:179], s[60:61]
    v_pk_mul_f32 v[180:181], v[180:181], s[60:61]
    v_pk_mul_f32 v[182:183], v[182:183], s[60:61]
    v_cvt_pk_bf16_f32 v72, v176, v177
    v_cvt_pk_bf16_f32 v73, v178, v179
    v_cvt_pk_bf16_f32 v74, v180, v181
    v_mfma_f32_16x16x32_bf16 v[120:123], v[208:211], v[12:15], 0
    v_cvt_pk_bf16_f32 v75, v182, v183
    v_accvgpr_read_b32 v184, a152
    v_accvgpr_read_b32 v185, a153
    v_accvgpr_read_b32 v186, a154
    v_accvgpr_read_b32 v187, a155
    v_accvgpr_read_b32 v188, a156
    v_mfma_f32_16x16x32_bf16 v[100:103], v[212:215], v[0:3], 0
    ds_read_b128 v[208:211], v233 offset:128
    v_accvgpr_read_b32 v189, a157
    v_accvgpr_read_b32 v190, a158
    v_accvgpr_read_b32 v191, a159
    v_pk_mul_f32 v[184:185], v[184:185], s[60:61]
    v_pk_mul_f32 v[186:187], v[186:187], s[60:61]
    v_pk_mul_f32 v[188:189], v[188:189], s[60:61]
    v_pk_mul_f32 v[190:191], v[190:191], s[60:61]
    v_cvt_pk_bf16_f32 v76, v184, v185
    v_cvt_pk_bf16_f32 v77, v186, v187
    v_cvt_pk_bf16_f32 v78, v188, v189
    v_cvt_pk_bf16_f32 v79, v190, v191
    v_permlane32_swap_b32 v64, v66
    v_permlane32_swap_b32 v65, v67
    v_permlane32_swap_b32 v68, v70
    v_mfma_f32_16x16x32_bf16 v[108:111], v[212:215], v[4:7], 0
    v_permlane32_swap_b32 v69, v71
    v_permlane32_swap_b32 v72, v74
    v_permlane32_swap_b32 v73, v75
    v_permlane32_swap_b32 v76, v78
    v_permlane32_swap_b32 v77, v79
    v_permlane16_swap_b32 v64, v66
    v_permlane16_swap_b32 v65, v67
    v_permlane16_swap_b32 v68, v70
    v_permlane16_swap_b32 v69, v71
    v_permlane16_swap_b32 v72, v74
    v_permlane16_swap_b32 v73, v75
    v_permlane16_swap_b32 v76, v78
    v_permlane16_swap_b32 v77, v79
    v_accvgpr_read_b32 v160, a160
    v_mfma_f32_16x16x32_bf16 v[116:119], v[212:215], v[8:11], 0
    v_accvgpr_read_b32 v161, a161
    v_accvgpr_read_b32 v162, a162
    v_accvgpr_read_b32 v163, a163
    v_accvgpr_read_b32 v164, a164
    v_accvgpr_read_b32 v165, a165
    v_accvgpr_read_b32 v166, a166
    v_accvgpr_read_b32 v167, a167
    v_pk_mul_f32 v[160:161], v[160:161], s[60:61]
    v_pk_mul_f32 v[162:163], v[162:163], s[60:61]
    v_pk_mul_f32 v[164:165], v[164:165], s[60:61]
    v_pk_mul_f32 v[166:167], v[166:167], s[60:61]
    v_cvt_pk_bf16_f32 v80, v160, v161
    v_cvt_pk_bf16_f32 v81, v162, v163
    v_mfma_f32_16x16x32_bf16 v[124:127], v[212:215], v[12:15], 0
    v_cvt_pk_bf16_f32 v82, v164, v165
    v_cvt_pk_bf16_f32 v83, v166, v167
    v_accvgpr_read_b32 v168, a168
    v_accvgpr_read_b32 v169, a169
    v_accvgpr_read_b32 v170, a170
    v_accvgpr_read_b32 v171, a171
    v_accvgpr_read_b32 v172, a172
    v_accvgpr_read_b32 v173, a173
    v_accvgpr_read_b32 v174, a174
    v_accvgpr_read_b32 v175, a175
    v_pk_mul_f32 v[168:169], v[168:169], s[60:61]
    v_pk_mul_f32 v[170:171], v[170:171], s[60:61]
    v_pk_mul_f32 v[172:173], v[172:173], s[60:61]
    s_waitcnt lgkmcnt(3)
    v_mfma_f32_16x16x32_bf16 v[96:99], v[216:219], v[16:19], v[96:99]
    ds_read_b128 v[212:215], v233 offset:6272
    v_pk_mul_f32 v[174:175], v[174:175], s[60:61]
    v_cvt_pk_bf16_f32 v84, v168, v169
    v_cvt_pk_bf16_f32 v85, v170, v171
    v_cvt_pk_bf16_f32 v86, v172, v173
    v_cvt_pk_bf16_f32 v87, v174, v175
    v_accvgpr_read_b32 v176, a176
    v_accvgpr_read_b32 v177, a177
    v_mfma_f32_16x16x32_bf16 v[104:107], v[216:219], v[20:23], v[104:107]
    v_accvgpr_read_b32 v178, a178
    v_accvgpr_read_b32 v179, a179
    v_accvgpr_read_b32 v180, a180
    v_accvgpr_read_b32 v181, a181
    v_accvgpr_read_b32 v182, a182
    v_accvgpr_read_b32 v183, a183
    v_pk_mul_f32 v[176:177], v[176:177], s[60:61]
    v_mfma_f32_16x16x32_bf16 v[112:115], v[216:219], v[24:27], v[112:115]
    v_pk_mul_f32 v[178:179], v[178:179], s[60:61]
    v_pk_mul_f32 v[180:181], v[180:181], s[60:61]
    v_pk_mul_f32 v[182:183], v[182:183], s[60:61]
    v_cvt_pk_bf16_f32 v88, v176, v177
    v_cvt_pk_bf16_f32 v89, v178, v179
    v_cvt_pk_bf16_f32 v90, v180, v181
    v_mfma_f32_16x16x32_bf16 v[120:123], v[216:219], v[28:31], v[120:123]
    v_cvt_pk_bf16_f32 v91, v182, v183
    v_accvgpr_read_b32 v184, a184
    v_accvgpr_read_b32 v185, a185
    v_accvgpr_read_b32 v186, a186
    v_accvgpr_read_b32 v187, a187
    v_accvgpr_read_b32 v188, a188
    v_mfma_f32_16x16x32_bf16 v[100:103], v[220:223], v[16:19], v[100:103]
    ds_read_b128 v[216:219], v232 offset:256
    v_accvgpr_read_b32 v189, a189
    v_accvgpr_read_b32 v190, a190
    v_accvgpr_read_b32 v191, a191
    v_pk_mul_f32 v[184:185], v[184:185], s[60:61]
    v_pk_mul_f32 v[186:187], v[186:187], s[60:61]
    v_pk_mul_f32 v[188:189], v[188:189], s[60:61]
    v_pk_mul_f32 v[190:191], v[190:191], s[60:61]
    v_mfma_f32_16x16x32_bf16 v[108:111], v[220:223], v[20:23], v[108:111]
    v_cvt_pk_bf16_f32 v92, v184, v185
    v_cvt_pk_bf16_f32 v93, v186, v187
    v_cvt_pk_bf16_f32 v94, v188, v189
    v_cvt_pk_bf16_f32 v95, v190, v191
    v_permlane32_swap_b32 v80, v82
    v_permlane32_swap_b32 v81, v83
    v_permlane32_swap_b32 v84, v86
    v_mfma_f32_16x16x32_bf16 v[116:119], v[220:223], v[24:27], v[116:119]
    v_permlane32_swap_b32 v85, v87
    v_permlane32_swap_b32 v88, v90
    v_permlane32_swap_b32 v89, v91
    v_permlane32_swap_b32 v92, v94
    v_permlane32_swap_b32 v93, v95
    v_permlane16_swap_b32 v80, v82
    v_permlane16_swap_b32 v81, v83
    v_mfma_f32_16x16x32_bf16 v[124:127], v[220:223], v[28:31], v[124:127]
    v_permlane16_swap_b32 v84, v86
    v_permlane16_swap_b32 v85, v87
    v_permlane16_swap_b32 v88, v90
    v_permlane16_swap_b32 v89, v91
    v_permlane16_swap_b32 v92, v94
    v_permlane16_swap_b32 v93, v95
    s_waitcnt lgkmcnt(3)
    v_mfma_f32_16x16x32_bf16 v[96:99], v[224:227], v[32:35], v[96:99]
    ds_read_b128 v[220:223], v232 offset:6400
    v_mfma_f32_16x16x32_bf16 v[104:107], v[224:227], v[36:39], v[104:107]
    v_mfma_f32_16x16x32_bf16 v[112:115], v[224:227], v[40:43], v[112:115]
    v_mfma_f32_16x16x32_bf16 v[120:123], v[224:227], v[44:47], v[120:123]
    v_mfma_f32_16x16x32_bf16 v[100:103], v[228:231], v[32:35], v[100:103]
    ds_read_b128 v[224:227], v233 offset:256
    v_mfma_f32_16x16x32_bf16 v[108:111], v[228:231], v[36:39], v[108:111]
    v_mfma_f32_16x16x32_bf16 v[116:119], v[228:231], v[40:43], v[116:119]
    v_mfma_f32_16x16x32_bf16 v[124:127], v[228:231], v[44:47], v[124:127]
    s_waitcnt lgkmcnt(3)
    v_mfma_f32_16x16x32_bf16 v[96:99], v[208:211], v[48:51], v[96:99]
    ds_read_b128 v[228:231], v233 offset:6400
    v_mfma_f32_16x16x32_bf16 v[104:107], v[208:211], v[52:55], v[104:107]
    v_mfma_f32_16x16x32_bf16 v[112:115], v[208:211], v[56:59], v[112:115]
    v_mfma_f32_16x16x32_bf16 v[120:123], v[208:211], v[60:63], v[120:123]
    v_mfma_f32_16x16x32_bf16 v[100:103], v[212:215], v[48:51], v[100:103]
    ds_read_b128 v[208:211], v232 offset:12288
    v_mfma_f32_16x16x32_bf16 v[108:111], v[212:215], v[52:55], v[108:111]
    v_mfma_f32_16x16x32_bf16 v[116:119], v[212:215], v[56:59], v[116:119]
    v_mfma_f32_16x16x32_bf16 v[124:127], v[212:215], v[60:63], v[124:127]
    s_waitcnt lgkmcnt(3)
    v_mfma_f32_16x16x32_bf16 v[96:99], v[216:219], v[64:67], v[96:99]
    ds_read_b128 v[212:215], v233 offset:12288
    v_mfma_f32_16x16x32_bf16 v[104:107], v[216:219], v[68:71], v[104:107]
    v_mfma_f32_16x16x32_bf16 v[112:115], v[216:219], v[72:75], v[112:115]
    v_mfma_f32_16x16x32_bf16 v[120:123], v[216:219], v[76:79], v[120:123]
    s_waitcnt vmcnt(18)
    s_barrier
    v_mfma_f32_16x16x32_bf16 v[100:103], v[220:223], v[64:67], v[100:103]
    ds_read_b128 v[216:219], v232 offset:12416
    v_mfma_f32_16x16x32_bf16 v[108:111], v[220:223], v[68:71], v[108:111]
    s_add_u32 m0, s34, 73728
    s_nop 0
    buffer_load_dwordx4 v238, s[40:43], s35 offen offset:0 nt lds
    v_mfma_f32_16x16x32_bf16 v[116:119], v[220:223], v[72:75], v[116:119]
    v_mfma_f32_16x16x32_bf16 v[124:127], v[220:223], v[76:79], v[124:127]
    s_waitcnt lgkmcnt(3)
    v_mfma_f32_16x16x32_bf16 v[96:99], v[224:227], v[80:83], v[96:99]
    ds_read_b128 v[220:223], v233 offset:12416
    v_mfma_f32_16x16x32_bf16 v[104:107], v[224:227], v[84:87], v[104:107]
    v_mfma_f32_16x16x32_bf16 v[112:115], v[224:227], v[88:91], v[112:115]
    v_mfma_f32_16x16x32_bf16 v[120:123], v[224:227], v[92:95], v[120:123]
    v_mfma_f32_16x16x32_bf16 v[100:103], v[228:231], v[80:83], v[100:103]
    ds_read_b128 v[224:227], v232 offset:12544
    buffer_load_dwordx4 v239, s[40:43], s35 offen offset:1024 nt lds
    v_mfma_f32_16x16x32_bf16 v[108:111], v[228:231], v[84:87], v[108:111]
    v_mfma_f32_16x16x32_bf16 v[116:119], v[228:231], v[88:91], v[116:119]
    v_mfma_f32_16x16x32_bf16 v[124:127], v[228:231], v[92:95], v[124:127]
    s_waitcnt lgkmcnt(3)
    v_mfma_f32_16x16x32_bf16 v[128:131], v[208:211], v[0:3], 0
    ds_read_b128 v[228:231], v233 offset:12544
    v_mfma_f32_16x16x32_bf16 v[136:139], v[208:211], v[4:7], 0
    v_mfma_f32_16x16x32_bf16 v[144:147], v[208:211], v[8:11], 0
    v_mfma_f32_16x16x32_bf16 v[152:155], v[208:211], v[12:15], 0
    v_mfma_f32_16x16x32_bf16 v[128:131], v[212:215], v[16:19], v[128:131]
    ds_read_b128 v[208:211], v232 offset:18432
    buffer_load_dwordx4 v240, s[40:43], s35 offen offset:2048 nt lds
    v_mfma_f32_16x16x32_bf16 v[136:139], v[212:215], v[20:23], v[136:139]
    v_mfma_f32_16x16x32_bf16 v[144:147], v[212:215], v[24:27], v[144:147]
    v_mfma_f32_16x16x32_bf16 v[152:155], v[212:215], v[28:31], v[152:155]
    s_waitcnt lgkmcnt(3)
    v_mfma_f32_16x16x32_bf16 v[128:131], v[216:219], v[32:35], v[128:131]
    ds_read_b128 v[212:215], v233 offset:18432
    v_max3_f32 v249, v96, v97, v98
    v_max3_f32 v249, v249, v99, v100
    v_max3_f32 v249, v249, v101, v102
    v_max_f32 v249, v249, v103
    v_mov_b32 v245, v249
    v_mfma_f32_16x16x32_bf16 v[136:139], v[216:219], v[36:39], v[136:139]
    s_nop 1
    v_permlane32_swap_b32 v249, v245
    v_max_f32 v249, v249, v245
    v_mov_b32 v245, v249
    v_mfma_f32_16x16x32_bf16 v[144:147], v[216:219], v[40:43], v[144:147]
    s_nop 1
    v_permlane16_swap_b32 v249, v245
    v_max_f32 v249, v249, v245
    v_add_f32 v249, 0x40e00000, v249
    v_sub_f32 v192, 0, v249
    v_mfma_f32_16x16x32_bf16 v[152:155], v[216:219], v[44:47], v[152:155]
    v_sub_f32 v193, 0, v249
    v_sub_f32 v194, 0, v249
    v_sub_f32 v195, 0, v249
    v_sub_f32 v96, v96, v249
    v_sub_f32 v97, v97, v249
    v_sub_f32 v98, v98, v249
    v_mfma_f32_16x16x32_bf16 v[128:131], v[220:223], v[48:51], v[128:131]
    ds_read_b128 v[216:219], v232 offset:18560
    v_sub_f32 v99, v99, v249
    v_sub_f32 v100, v100, v249
    v_sub_f32 v101, v101, v249
    v_sub_f32 v102, v102, v249
    v_sub_f32 v103, v103, v249
    v_max3_f32 v249, v104, v105, v106
    v_mfma_f32_16x16x32_bf16 v[136:139], v[220:223], v[52:55], v[136:139]
    v_max3_f32 v249, v249, v107, v108
    v_max3_f32 v249, v249, v109, v110
    v_max_f32 v249, v249, v111
    v_mov_b32 v245, v249
    s_nop 1
    v_mfma_f32_16x16x32_bf16 v[144:147], v[220:223], v[56:59], v[144:147]
    v_permlane32_swap_b32 v249, v245
    v_max_f32 v249, v249, v245
    v_mov_b32 v245, v249
    s_nop 1
    v_permlane16_swap_b32 v249, v245
    v_mfma_f32_16x16x32_bf16 v[152:155], v[220:223], v[60:63], v[152:155]
    v_max_f32 v249, v249, v245
    v_add_f32 v249, 0x40e00000, v249
    v_sub_f32 v196, 0, v249
    s_add_u32 m0, s34, 76800
    s_nop 0
    buffer_load_dwordx4 v241, s[40:43], s35 offen offset:0 nt lds
    s_waitcnt lgkmcnt(3)
    v_mfma_f32_16x16x32_bf16 v[128:131], v[224:227], v[64:67], v[128:131]
    ds_read_b128 v[220:223], v233 offset:18560
    v_sub_f32 v197, 0, v249
    v_sub_f32 v198, 0, v249
    v_sub_f32 v199, 0, v249
    v_sub_f32 v104, v104, v249
    v_sub_f32 v105, v105, v249
    v_sub_f32 v106, v106, v249
    v_mfma_f32_16x16x32_bf16 v[136:139], v[224:227], v[68:71], v[136:139]
    v_sub_f32 v107, v107, v249
    v_sub_f32 v108, v108, v249
    v_sub_f32 v109, v109, v249
    v_sub_f32 v110, v110, v249
    v_sub_f32 v111, v111, v249
    v_mfma_f32_16x16x32_bf16 v[144:147], v[224:227], v[72:75], v[144:147]
    v_max3_f32 v249, v112, v113, v114
    v_max3_f32 v249, v249, v115, v116
    v_max3_f32 v249, v249, v117, v118
    v_max_f32 v249, v249, v119
    v_mov_b32 v245, v249
    v_mfma_f32_16x16x32_bf16 v[152:155], v[224:227], v[76:79], v[152:155]
    s_nop 1
    v_permlane32_swap_b32 v249, v245
    v_max_f32 v249, v249, v245
    v_mov_b32 v245, v249
    v_mfma_f32_16x16x32_bf16 v[128:131], v[228:231], v[80:83], v[128:131]
    ds_read_b128 v[224:227], v232 offset:18688
    s_nop 1
    v_permlane16_swap_b32 v249, v245
    v_max_f32 v249, v249, v245
    v_add_f32 v249, 0x40e00000, v249
    v_sub_f32 v200, 0, v249
    v_mfma_f32_16x16x32_bf16 v[136:139], v[228:231], v[84:87], v[136:139]
    v_sub_f32 v201, 0, v249
    v_sub_f32 v202, 0, v249
    v_sub_f32 v203, 0, v249
    v_sub_f32 v112, v112, v249
    v_sub_f32 v113, v113, v249
    v_sub_f32 v114, v114, v249
    v_mfma_f32_16x16x32_bf16 v[144:147], v[228:231], v[88:91], v[144:147]
    v_sub_f32 v115, v115, v249
    v_sub_f32 v116, v116, v249
    v_sub_f32 v117, v117, v249
    v_sub_f32 v118, v118, v249
    v_sub_f32 v119, v119, v249
    v_max3_f32 v249, v120, v121, v122
    v_mfma_f32_16x16x32_bf16 v[152:155], v[228:231], v[92:95], v[152:155]
    v_max3_f32 v249, v249, v123, v124
    v_max3_f32 v249, v249, v125, v126
    v_max_f32 v249, v249, v127
    v_mov_b32 v245, v249
    buffer_load_dwordx4 v242, s[40:43], s35 offen offset:1024 nt lds
    s_waitcnt lgkmcnt(3)
    v_mfma_f32_16x16x32_bf16 v[132:135], v[208:211], v[0:3], 0
    ds_read_b128 v[228:231], v233 offset:18688
    s_nop 1
    v_permlane32_swap_b32 v249, v245
    v_max_f32 v249, v249, v245
    v_mov_b32 v245, v249
    v_mfma_f32_16x16x32_bf16 v[140:143], v[208:211], v[4:7], 0
    s_nop 1
    v_permlane16_swap_b32 v249, v245
    v_max_f32 v249, v249, v245
    v_add_f32 v249, 0x40e00000, v249
    v_sub_f32 v204, 0, v249
    v_mfma_f32_16x16x32_bf16 v[148:151], v[208:211], v[8:11], 0
    v_sub_f32 v205, 0, v249
    v_sub_f32 v206, 0, v249
    v_sub_f32 v207, 0, v249
    v_sub_f32 v120, v120, v249
    v_sub_f32 v121, v121, v249
    v_sub_f32 v122, v122, v249
    v_mfma_f32_16x16x32_bf16 v[156:159], v[208:211], v[12:15], 0
    v_sub_f32 v123, v123, v249
    v_sub_f32 v124, v124, v249
    v_sub_f32 v125, v125, v249
    v_sub_f32 v126, v126, v249
    v_sub_f32 v127, v127, v249
    v_mfma_f32_16x16x32_bf16 v[132:135], v[212:215], v[16:19], v[132:135]
    v_add_u32 v234, 0xc000, v234
    v_add_u32 v235, 0xc000, v235
    v_add_u32 v236, 0xc000, v236
    v_add_u32 v237, 0xc000, v237
    ds_read_b64_tr_b16 v[208:209], v234 offset:24576
    ds_read_b64_tr_b16 v[210:211], v234 offset:30720
    v_exp_f32 v245, v96
    v_exp_f32 v246, v97
    v_mfma_f32_16x16x32_bf16 v[140:143], v[212:215], v[20:23], v[140:143]
    v_exp_f32 v247, v98
    v_cvt_pk_bf16_f32 v160, v245, v246
    v_exp_f32 v248, v99
    v_mfma_f32_16x16x32_bf16 v[148:151], v[212:215], v[24:27], v[148:151]
    v_exp_f32 v245, v104
    v_exp_f32 v246, v105
    v_cvt_pk_bf16_f32 v161, v247, v248
    v_mfma_f32_16x16x32_bf16 v[156:159], v[212:215], v[28:31], v[156:159]
    v_exp_f32 v247, v106
    buffer_load_dwordx4 v243, s[40:43], s35 offen offset:2048 nt lds
    s_add_u32 s35, s35, 12288
    s_waitcnt lgkmcnt(4)
    v_mfma_f32_16x16x32_bf16 v[132:135], v[216:219], v[32:35], v[132:135]
    ds_read_b64_tr_b16 v[212:213], v235 offset:24576
    ds_read_b64_tr_b16 v[214:215], v235 offset:30720
    v_cvt_pk_bf16_f32 v164, v245, v246
    v_exp_f32 v248, v107
    v_exp_f32 v245, v112
    v_mfma_f32_16x16x32_bf16 v[140:143], v[216:219], v[36:39], v[140:143]
    v_exp_f32 v246, v113
    v_cvt_pk_bf16_f32 v165, v247, v248
    v_mfma_f32_16x16x32_bf16 v[148:151], v[216:219], v[40:43], v[148:151]
    v_exp_f32 v247, v114
    v_cvt_pk_bf16_f32 v168, v245, v246
    v_exp_f32 v248, v115
    v_mfma_f32_16x16x32_bf16 v[156:159], v[216:219], v[44:47], v[156:159]
    v_exp_f32 v245, v120
    v_exp_f32 v246, v121
    v_mfma_f32_16x16x32_bf16 v[132:135], v[220:223], v[48:51], v[132:135]
    ds_read_b64_tr_b16 v[216:217], v236 offset:24576
    ds_read_b64_tr_b16 v[218:219], v236 offset:30720
    v_cvt_pk_bf16_f32 v169, v247, v248
    v_exp_f32 v247, v122
    v_cvt_pk_bf16_f32 v172, v245, v246
    v_mfma_f32_16x16x32_bf16 v[140:143], v[220:223], v[52:55], v[140:143]
    v_exp_f32 v248, v123
    v_exp_f32 v245, v100
    v_mfma_f32_16x16x32_bf16 v[148:151], v[220:223], v[56:59], v[148:151]
    v_exp_f32 v246, v101
    v_cvt_pk_bf16_f32 v173, v247, v248
    v_mfma_f32_16x16x32_bf16 v[156:159], v[220:223], v[60:63], v[156:159]
    v_exp_f32 v247, v102
    v_cvt_pk_bf16_f32 v162, v245, v246
    v_exp_f32 v248, v103
    s_waitcnt lgkmcnt(6)
    v_mfma_f32_16x16x32_bf16 v[132:135], v[224:227], v[64:67], v[132:135]
    ds_read_b64_tr_b16 v[220:221], v237 offset:24576
    ds_read_b64_tr_b16 v[222:223], v237 offset:30720
    v_exp_f32 v245, v108
    v_exp_f32 v246, v109
    v_mfma_f32_16x16x32_bf16 v[140:143], v[224:227], v[68:71], v[140:143]
    v_cvt_pk_bf16_f32 v163, v247, v248
    v_exp_f32 v247, v110
    v_cvt_pk_bf16_f32 v166, v245, v246
    v_mfma_f32_16x16x32_bf16 v[148:151], v[224:227], v[72:75], v[148:151]
    v_exp_f32 v248, v111
    v_exp_f32 v245, v116
    v_mfma_f32_16x16x32_bf16 v[156:159], v[224:227], v[76:79], v[156:159]
    v_exp_f32 v246, v117
    v_cvt_pk_bf16_f32 v167, v247, v248
    v_mfma_f32_16x16x32_bf16 v[132:135], v[228:231], v[80:83], v[132:135]
    ds_read_b64_tr_b16 v[224:225], v234 offset:24704
    ds_read_b64_tr_b16 v[226:227], v234 offset:30848
    v_exp_f32 v247, v118
    v_cvt_pk_bf16_f32 v170, v245, v246
    v_exp_f32 v248, v119
    v_mfma_f32_16x16x32_bf16 v[140:143], v[228:231], v[84:87], v[140:143]
    v_exp_f32 v245, v124
    v_exp_f32 v246, v125
    v_mfma_f32_16x16x32_bf16 v[148:151], v[228:231], v[88:91], v[148:151]
    v_cvt_pk_bf16_f32 v171, v247, v248
    v_exp_f32 v247, v126
    v_cvt_pk_bf16_f32 v174, v245, v246
    v_mfma_f32_16x16x32_bf16 v[156:159], v[228:231], v[92:95], v[156:159]
    v_exp_f32 v248, v127
    s_nop 0
    v_cvt_pk_bf16_f32 v175, v247, v248
    s_nop 4
    v_add_f32 v128, v128, v192
    v_add_f32 v129, v129, v192
    v_add_f32 v130, v130, v192
    v_add_f32 v131, v131, v192
    v_add_f32 v132, v132, v192
    v_add_f32 v133, v133, v192
    v_add_f32 v134, v134, v192
    v_add_f32 v135, v135, v192
    v_add_f32 v136, v136, v196
    v_add_f32 v137, v137, v196
    v_add_f32 v138, v138, v196
    v_add_f32 v139, v139, v196
    v_add_f32 v140, v140, v196
    v_add_f32 v141, v141, v196
    v_add_f32 v142, v142, v196
    v_add_f32 v143, v143, v196
    v_add_f32 v144, v144, v200
    v_add_f32 v145, v145, v200
    v_add_f32 v146, v146, v200
    v_add_f32 v147, v147, v200
    v_add_f32 v148, v148, v200
    v_add_f32 v149, v149, v200
    v_add_f32 v150, v150, v200
    v_add_f32 v151, v151, v200
    v_add_f32 v152, v152, v204
    v_add_f32 v153, v153, v204
    v_add_f32 v154, v154, v204
    v_add_f32 v155, v155, v204
    v_add_f32 v156, v156, v204
    v_add_f32 v157, v157, v204
    v_add_f32 v158, v158, v204
    v_add_f32 v159, v159, v204
    s_waitcnt lgkmcnt(6)
    v_mfma_f32_16x16x32_bf16 a[0:3], v[208:211], v[160:163], 0
    ds_read_b64_tr_b16 v[228:229], v235 offset:24704
    ds_read_b64_tr_b16 v[230:231], v235 offset:30848
    v_mfma_f32_16x16x32_bf16 a[8:11], v[208:211], v[164:167], 0
    v_exp_f32 v245, v128
    v_mfma_f32_16x16x32_bf16 a[16:19], v[208:211], v[168:171], 0
    v_exp_f32 v246, v129
    v_mfma_f32_16x16x32_bf16 a[24:27], v[208:211], v[172:175], 0
    v_mfma_f32_16x16x32_bf16 a[4:7], v[212:215], v[160:163], 0
    ds_read_b64_tr_b16 v[208:209], v236 offset:24704
    ds_read_b64_tr_b16 v[210:211], v236 offset:30848
    v_mfma_f32_16x16x32_bf16 a[12:15], v[212:215], v[164:167], 0
    v_exp_f32 v247, v130
    v_mfma_f32_16x16x32_bf16 a[20:23], v[212:215], v[168:171], 0
    v_cvt_pk_bf16_f32 v176, v245, v246
    v_mfma_f32_16x16x32_bf16 a[28:31], v[212:215], v[172:175], 0
    s_waitcnt lgkmcnt(6)
    v_mfma_f32_16x16x32_bf16 a[32:35], v[216:219], v[160:163], 0
    ds_read_b64_tr_b16 v[212:213], v237 offset:24704
    ds_read_b64_tr_b16 v[214:215], v237 offset:30848
    v_mfma_f32_16x16x32_bf16 a[40:43], v[216:219], v[164:167], 0
    v_exp_f32 v248, v131
    v_mfma_f32_16x16x32_bf16 a[48:51], v[216:219], v[168:171], 0
    v_exp_f32 v245, v136
    v_mfma_f32_16x16x32_bf16 a[56:59], v[216:219], v[172:175], 0
    v_mfma_f32_16x16x32_bf16 a[36:39], v[220:223], v[160:163], 0
    ds_read_b64_tr_b16 v[216:217], v234 offset:24832
    ds_read_b64_tr_b16 v[218:219], v234 offset:30976
    v_mfma_f32_16x16x32_bf16 a[44:47], v[220:223], v[164:167], 0
    v_exp_f32 v246, v137
    v_mfma_f32_16x16x32_bf16 a[52:55], v[220:223], v[168:171], 0
    v_cvt_pk_bf16_f32 v177, v247, v248
    v_mfma_f32_16x16x32_bf16 a[60:63], v[220:223], v[172:175], 0
    s_waitcnt lgkmcnt(6)
    v_mfma_f32_16x16x32_bf16 a[64:67], v[224:227], v[160:163], 0
    ds_read_b64_tr_b16 v[220:221], v235 offset:24832
    ds_read_b64_tr_b16 v[222:223], v235 offset:30976
    v_mfma_f32_16x16x32_bf16 a[72:75], v[224:227], v[164:167], 0
    v_exp_f32 v247, v138
    v_mfma_f32_16x16x32_bf16 a[80:83], v[224:227], v[168:171], 0
    v_cvt_pk_bf16_f32 v180, v245, v246
    v_mfma_f32_16x16x32_bf16 a[88:91], v[224:227], v[172:175], 0
    v_exp_f32 v248, v139
    v_mfma_f32_16x16x32_bf16 a[68:71], v[228:231], v[160:163], 0
    ds_read_b64_tr_b16 v[224:225], v236 offset:24832
    ds_read_b64_tr_b16 v[226:227], v236 offset:30976
    v_mfma_f32_16x16x32_bf16 a[76:79], v[228:231], v[164:167], 0
    v_exp_f32 v245, v144
    v_mfma_f32_16x16x32_bf16 a[84:87], v[228:231], v[168:171], 0
    v_exp_f32 v246, v145
    v_mfma_f32_16x16x32_bf16 a[92:95], v[228:231], v[172:175], 0
    s_waitcnt lgkmcnt(6)
    v_mfma_f32_16x16x32_bf16 a[96:99], v[208:211], v[160:163], 0
    ds_read_b64_tr_b16 v[228:229], v237 offset:24832
    ds_read_b64_tr_b16 v[230:231], v237 offset:30976
    v_mfma_f32_16x16x32_bf16 a[104:107], v[208:211], v[164:167], 0
    v_cvt_pk_bf16_f32 v181, v247, v248
    v_mfma_f32_16x16x32_bf16 a[112:115], v[208:211], v[168:171], 0
    v_exp_f32 v247, v146
    v_mfma_f32_16x16x32_bf16 a[120:123], v[208:211], v[172:175], 0
    v_mfma_f32_16x16x32_bf16 a[100:103], v[212:215], v[160:163], 0
    ds_read_b128 v[208:211], v232 offset:36864
    v_cvt_pk_bf16_f32 v184, v245, v246
    v_mfma_f32_16x16x32_bf16 a[108:111], v[212:215], v[164:167], 0
    v_exp_f32 v248, v147
    v_mfma_f32_16x16x32_bf16 a[116:119], v[212:215], v[168:171], 0
    v_mfma_f32_16x16x32_bf16 a[124:127], v[212:215], v[172:175], 0
    s_waitcnt lgkmcnt(5)
    v_mfma_f32_16x16x32_bf16 a[128:131], v[216:219], v[160:163], 0
    ds_read_b128 v[212:215], v233 offset:36864
    v_mfma_f32_16x16x32_bf16 a[136:139], v[216:219], v[164:167], 0
    v_exp_f32 v245, v152
    v_mfma_f32_16x16x32_bf16 a[144:147], v[216:219], v[168:171], 0
    v_exp_f32 v246, v153
    v_mfma_f32_16x16x32_bf16 a[152:155], v[216:219], v[172:175], 0
    s_waitcnt vmcnt(18)
    s_barrier
    v_mfma_f32_16x16x32_bf16 a[132:135], v[220:223], v[160:163], 0
    ds_read_b128 v[216:219], v232 offset:36992
    v_mfma_f32_16x16x32_bf16 a[140:143], v[220:223], v[164:167], 0
    s_add_u32 m0, s34, 98304
    s_nop 0
    buffer_load_dwordx4 v238, s[40:43], s35 offen offset:0 nt lds
    v_mfma_f32_16x16x32_bf16 a[148:151], v[220:223], v[168:171], 0
    v_cvt_pk_bf16_f32 v185, v247, v248
    v_mfma_f32_16x16x32_bf16 a[156:159], v[220:223], v[172:175], 0
    s_waitcnt lgkmcnt(3)
    v_mfma_f32_16x16x32_bf16 a[160:163], v[224:227], v[160:163], 0
    ds_read_b128 v[220:223], v233 offset:36992
    v_mfma_f32_16x16x32_bf16 a[168:171], v[224:227], v[164:167], 0
    v_exp_f32 v247, v154
    v_mfma_f32_16x16x32_bf16 a[176:179], v[224:227], v[168:171], 0
    v_cvt_pk_bf16_f32 v188, v245, v246
    v_mfma_f32_16x16x32_bf16 a[184:187], v[224:227], v[172:175], 0
    v_exp_f32 v248, v155
    v_mfma_f32_16x16x32_bf16 a[164:167], v[228:231], v[160:163], 0
    ds_read_b128 v[224:227], v232 offset:37120
    v_mfma_f32_16x16x32_bf16 a[172:175], v[228:231], v[164:167], 0
    v_exp_f32 v245, v132
    v_mfma_f32_16x16x32_bf16 a[180:183], v[228:231], v[168:171], 0
    buffer_load_dwordx4 v239, s[40:43], s35 offen offset:1024 nt lds
    v_mfma_f32_16x16x32_bf16 a[188:191], v[228:231], v[172:175], 0
    v_exp_f32 v246, v133
    v_mfma_f32_16x16x32_bf16 a[192:195], a[208:211], v[160:163], 0
    v_cvt_pk_bf16_f32 v189, v247, v248
    v_mfma_f32_16x16x32_bf16 a[196:199], a[208:211], v[164:167], 0
    v_exp_f32 v247, v134
    v_mfma_f32_16x16x32_bf16 a[200:203], a[208:211], v[168:171], 0
    v_cvt_pk_bf16_f32 v178, v245, v246
    v_mfma_f32_16x16x32_bf16 a[204:207], a[208:211], v[172:175], 0
    s_waitcnt lgkmcnt(3)
    v_mfma_f32_16x16x32_bf16 v[96:99], v[208:211], v[0:3], v[192:195]
    ds_read_b128 v[228:231], v233 offset:37120
    buffer_load_dwordx4 v240, s[40:43], s35 offen offset:2048 nt lds
    v_mfma_f32_16x16x32_bf16 v[104:107], v[208:211], v[4:7], v[196:199]
    v_exp_f32 v248, v135
    v_mfma_f32_16x16x32_bf16 v[112:115], v[208:211], v[8:11], v[200:203]
    v_exp_f32 v245, v140
    v_mfma_f32_16x16x32_bf16 v[120:123], v[208:211], v[12:15], v[204:207]
    v_mfma_f32_16x16x32_bf16 v[96:99], v[212:215], v[16:19], v[96:99]
    ds_read_b128 v[208:211], v232 offset:43008
    v_mfma_f32_16x16x32_bf16 v[104:107], v[212:215], v[20:23], v[104:107]
    v_exp_f32 v246, v141
    v_mfma_f32_16x16x32_bf16 v[112:115], v[212:215], v[24:27], v[112:115]
    v_cvt_pk_bf16_f32 v179, v247, v248
    v_mfma_f32_16x16x32_bf16 v[120:123], v[212:215], v[28:31], v[120:123]
    s_waitcnt lgkmcnt(3)
    v_mfma_f32_16x16x32_bf16 v[96:99], v[216:219], v[32:35], v[96:99]
    ds_read_b128 v[212:215], v233 offset:43008
    v_mfma_f32_16x16x32_bf16 v[104:107], v[216:219], v[36:39], v[104:107]
    v_exp_f32 v247, v142
    v_mfma_f32_16x16x32_bf16 v[112:115], v[216:219], v[40:43], v[112:115]
    s_add_u32 m0, s34, 101376
    s_nop 0
    buffer_load_dwordx4 v241, s[40:43], s35 offen offset:0 nt lds
    v_mfma_f32_16x16x32_bf16 v[120:123], v[216:219], v[44:47], v[120:123]
    v_cvt_pk_bf16_f32 v182, v245, v246
    v_mfma_f32_16x16x32_bf16 v[96:99], v[220:223], v[48:51], v[96:99]
    ds_read_b128 v[216:219], v232 offset:43136
    v_mfma_f32_16x16x32_bf16 v[104:107], v[220:223], v[52:55], v[104:107]
    v_exp_f32 v248, v143
    v_mfma_f32_16x16x32_bf16 v[112:115], v[220:223], v[56:59], v[112:115]
    v_exp_f32 v245, v148
    v_mfma_f32_16x16x32_bf16 v[120:123], v[220:223], v[60:63], v[120:123]
    s_waitcnt lgkmcnt(3)
    v_mfma_f32_16x16x32_bf16 v[96:99], v[224:227], v[64:67], v[96:99]
    ds_read_b128 v[220:223], v233 offset:43136
    v_mfma_f32_16x16x32_bf16 v[104:107], v[224:227], v[68:71], v[104:107]
    v_exp_f32 v246, v149
    v_mfma_f32_16x16x32_bf16 v[112:115], v[224:227], v[72:75], v[112:115]
    buffer_load_dwordx4 v242, s[40:43], s35 offen offset:1024 nt lds
    v_cvt_pk_bf16_f32 v183, v247, v248
    v_mfma_f32_16x16x32_bf16 v[120:123], v[224:227], v[76:79], v[120:123]
    v_exp_f32 v247, v150
    v_mfma_f32_16x16x32_bf16 v[96:99], v[228:231], v[80:83], v[96:99]
    ds_read_b128 v[224:227], v232 offset:43264
    v_cvt_pk_bf16_f32 v186, v245, v246
    v_mfma_f32_16x16x32_bf16 v[104:107], v[228:231], v[84:87], v[104:107]
    v_exp_f32 v248, v151
    v_mfma_f32_16x16x32_bf16 v[112:115], v[228:231], v[88:91], v[112:115]
    v_mfma_f32_16x16x32_bf16 v[120:123], v[228:231], v[92:95], v[120:123]
    s_waitcnt lgkmcnt(3)
    v_mfma_f32_16x16x32_bf16 v[100:103], v[208:211], v[0:3], v[192:195]
    ds_read_b128 v[228:231], v233 offset:43264
    v_mfma_f32_16x16x32_bf16 v[108:111], v[208:211], v[4:7], v[196:199]
    buffer_load_dwordx4 v243, s[40:43], s35 offen offset:2048 nt lds
    s_add_u32 s35, s35, 12288
    v_mfma_f32_16x16x32_bf16 v[116:119], v[208:211], v[8:11], v[200:203]
    v_exp_f32 v245, v156
    v_mfma_f32_16x16x32_bf16 v[124:127], v[208:211], v[12:15], v[204:207]
    v_exp_f32 v246, v157
    v_mfma_f32_16x16x32_bf16 v[100:103], v[212:215], v[16:19], v[100:103]
    v_add_u32 v234, 0xfffe8000, v234
    v_add_u32 v235, 0xfffe8000, v235
    v_add_u32 v236, 0xfffe8000, v236
    v_add_u32 v237, 0xfffe8000, v237
    ds_read_b64_tr_b16 v[208:209], v234 offset:0
    ds_read_b64_tr_b16 v[210:211], v234 offset:6144
    v_mfma_f32_16x16x32_bf16 v[108:111], v[212:215], v[20:23], v[108:111]
    v_cvt_pk_bf16_f32 v187, v247, v248
    v_mfma_f32_16x16x32_bf16 v[116:119], v[212:215], v[24:27], v[116:119]
    v_exp_f32 v247, v158
    v_mfma_f32_16x16x32_bf16 v[124:127], v[212:215], v[28:31], v[124:127]
    v_cvt_pk_bf16_f32 v190, v245, v246
    s_waitcnt lgkmcnt(4)
    v_mfma_f32_16x16x32_bf16 v[100:103], v[216:219], v[32:35], v[100:103]
    ds_read_b64_tr_b16 v[212:213], v235 offset:0
    ds_read_b64_tr_b16 v[214:215], v235 offset:6144
    v_mfma_f32_16x16x32_bf16 v[108:111], v[216:219], v[36:39], v[108:111]
    v_exp_f32 v248, v159
    v_mfma_f32_16x16x32_bf16 v[116:119], v[216:219], v[40:43], v[116:119]
    s_nop 0
    v_cvt_pk_bf16_f32 v191, v247, v248
    v_mfma_f32_16x16x32_bf16 v[124:127], v[216:219], v[44:47], v[124:127]
    v_mfma_f32_16x16x32_bf16 v[100:103], v[220:223], v[48:51], v[100:103]
    ds_read_b64_tr_b16 v[216:217], v236 offset:0
    ds_read_b64_tr_b16 v[218:219], v236 offset:6144
    v_mfma_f32_16x16x32_bf16 v[108:111], v[220:223], v[52:55], v[108:111]
    v_or3_b32 v245, v176, v177, v178
    v_or3_b32 v245, v245, v179, v180
    v_mfma_f32_16x16x32_bf16 v[116:119], v[220:223], v[56:59], v[116:119]
    v_or3_b32 v245, v245, v181, v182
    v_mfma_f32_16x16x32_bf16 v[124:127], v[220:223], v[60:63], v[124:127]
    s_waitcnt lgkmcnt(6)
    v_mfma_f32_16x16x32_bf16 v[100:103], v[224:227], v[64:67], v[100:103]
    ds_read_b64_tr_b16 v[220:221], v237 offset:0
    ds_read_b64_tr_b16 v[222:223], v237 offset:6144
    v_mfma_f32_16x16x32_bf16 v[108:111], v[224:227], v[68:71], v[108:111]
    v_or3_b32 v245, v245, v183, v184
    v_or3_b32 v245, v245, v185, v186
    v_mfma_f32_16x16x32_bf16 v[116:119], v[224:227], v[72:75], v[116:119]
    v_or3_b32 v245, v245, v187, v188
    v_mfma_f32_16x16x32_bf16 v[124:127], v[224:227], v[76:79], v[124:127]
    v_mfma_f32_16x16x32_bf16 v[100:103], v[228:231], v[80:83], v[100:103]
    ds_read_b64_tr_b16 v[224:225], v234 offset:128
    ds_read_b64_tr_b16 v[226:227], v234 offset:6272
    v_or3_b32 v245, v245, v189, v190
    v_mfma_f32_16x16x32_bf16 v[108:111], v[228:231], v[84:87], v[108:111]
    v_or_b32 v245, v245, v191
    v_and_b32 v245, 0x40004000, v245
    v_mfma_f32_16x16x32_bf16 v[116:119], v[228:231], v[88:91], v[116:119]
    v_mfma_f32_16x16x32_bf16 v[124:127], v[228:231], v[92:95], v[124:127]
    v_cmp_ne_u32 vcc, 0, v245
    s_cbranch_vccnz Lrare_0
Lrare_0_back:
    s_mov_b32 s38, 4
Lloop:
    s_waitcnt lgkmcnt(6)
    v_mfma_f32_16x16x32_bf16 a[0:3], v[208:211], v[176:179], a[0:3]
    ds_read_b64_tr_b16 v[228:229], v235 offset:128
    ds_read_b64_tr_b16 v[230:231], v235 offset:6272
    v_mfma_f32_16x16x32_bf16 a[8:11], v[208:211], v[180:183], a[8:11]
    v_exp_f32 v245, v96
    v_mfma_f32_16x16x32_bf16 a[16:19], v[208:211], v[184:187], a[16:19]
    v_exp_f32 v246, v97
    v_mfma_f32_16x16x32_bf16 a[24:27], v[208:211], v[188:191], a[24:27]
    v_mfma_f32_16x16x32_bf16 a[4:7], v[212:215], v[176:179], a[4:7]
    ds_read_b64_tr_b16 v[208:209], v236 offset:128
    ds_read_b64_tr_b16 v[210:211], v236 offset:6272
    v_mfma_f32_16x16x32_bf16 a[12:15], v[212:215], v[180:183], a[12:15]
    v_exp_f32 v247, v98
    v_mfma_f32_16x16x32_bf16 a[20:23], v[212:215], v[184:187], a[20:23]
    v_cvt_pk_bf16_f32 v160, v245, v246
    v_mfma_f32_16x16x32_bf16 a[28:31], v[212:215], v[188:191], a[28:31]
    s_waitcnt lgkmcnt(6)
    v_mfma_f32_16x16x32_bf16 a[32:35], v[216:219], v[176:179], a[32:35]
    ds_read_b64_tr_b16 v[212:213], v237 offset:128
    ds_read_b64_tr_b16 v[214:215], v237 offset:6272
    v_mfma_f32_16x16x32_bf16 a[40:43], v[216:219], v[180:183], a[40:43]
    v_exp_f32 v248, v99
    v_mfma_f32_16x16x32_bf16 a[48:51], v[216:219], v[184:187], a[48:51]
    v_exp_f32 v245, v104
    v_mfma_f32_16x16x32_bf16 a[56:59], v[216:219], v[188:191], a[56:59]
    v_mfma_f32_16x16x32_bf16 a[36:39], v[220:223], v[176:179], a[36:39]
    ds_read_b64_tr_b16 v[216:217], v234 offset:256
    ds_read_b64_tr_b16 v[218:219], v234 offset:6400
    v_mfma_f32_16x16x32_bf16 a[44:47], v[220:223], v[180:183], a[44:47]
    v_exp_f32 v246, v105
    v_mfma_f32_16x16x32_bf16 a[52:55], v[220:223], v[184:187], a[52:55]
    v_cvt_pk_bf16_f32 v161, v247, v248
    v_mfma_f32_16x16x32_bf16 a[60:63], v[220:223], v[188:191], a[60:63]
    s_waitcnt lgkmcnt(6)
    v_mfma_f32_16x16x32_bf16 a[64:67], v[224:227], v[176:179], a[64:67]
    ds_read_b64_tr_b16 v[220:221], v235 offset:256
    ds_read_b64_tr_b16 v[222:223], v235 offset:6400
    v_mfma_f32_16x16x32_bf16 a[72:75], v[224:227], v[180:183], a[72:75]
    v_exp_f32 v247, v106
    v_mfma_f32_16x16x32_bf16 a[80:83], v[224:227], v[184:187], a[80:83]
    v_cvt_pk_bf16_f32 v164, v245, v246
    v_mfma_f32_16x16x32_bf16 a[88:91], v[224:227], v[188:191], a[88:91]
    v_exp_f32 v248, v107
    v_mfma_f32_16x16x32_bf16 a[68:71], v[228:231], v[176:179], a[68:71]
    ds_read_b64_tr_b16 v[224:225], v236 offset:256
    ds_read_b64_tr_b16 v[226:227], v236 offset:6400
    v_mfma_f32_16x16x32_bf16 a[76:79], v[228:231], v[180:183], a[76:79]
    v_exp_f32 v245, v112
    v_mfma_f32_16x16x32_bf16 a[84:87], v[228:231], v[184:187], a[84:87]
    v_exp_f32 v246, v113
    v_mfma_f32_16x16x32_bf16 a[92:95], v[228:231], v[188:191], a[92:95]
    s_waitcnt lgkmcnt(6)
    v_mfma_f32_16x16x32_bf16 a[96:99], v[208:211], v[176:179], a[96:99]
    ds_read_b64_tr_b16 v[228:229], v237 offset:256
    ds_read_b64_tr_b16 v[230:231], v237 offset:6400
    v_mfma_f32_16x16x32_bf16 a[104:107], v[208:211], v[180:183], a[104:107]
    v_cvt_pk_bf16_f32 v165, v247, v248
    v_mfma_f32_16x16x32_bf16 a[112:115], v[208:211], v[184:187], a[112:115]
    v_exp_f32 v247, v114
    v_mfma_f32_16x16x32_bf16 a[120:123], v[208:211], v[188:191], a[120:123]
    v_mfma_f32_16x16x32_bf16 a[100:103], v[212:215], v[176:179], a[100:103]
    v_add_u32 v232, 0xfffe8000, v232
    v_add_u32 v233, 0xfffe8000, v233
    ds_read_b128 v[208:211], v232 offset:12288
    v_cvt_pk_bf16_f32 v168, v245, v246
    v_mfma_f32_16x16x32_bf16 a[108:111], v[212:215], v[180:183], a[108:111]
    v_exp_f32 v248, v115
    v_mfma_f32_16x16x32_bf16 a[116:119], v[212:215], v[184:187], a[116:119]
    v_mfma_f32_16x16x32_bf16 a[124:127], v[212:215], v[188:191], a[124:127]
    s_waitcnt lgkmcnt(5)
    v_mfma_f32_16x16x32_bf16 a[128:131], v[216:219], v[176:179], a[128:131]
    ds_read_b128 v[212:215], v233 offset:12288
    v_mfma_f32_16x16x32_bf16 a[136:139], v[216:219], v[180:183], a[136:139]
    v_exp_f32 v245, v120
    v_mfma_f32_16x16x32_bf16 a[144:147], v[216:219], v[184:187], a[144:147]
    v_exp_f32 v246, v121
    v_mfma_f32_16x16x32_bf16 a[152:155], v[216:219], v[188:191], a[152:155]
    s_waitcnt vmcnt(18)
    s_barrier
    v_mfma_f32_16x16x32_bf16 a[132:135], v[220:223], v[176:179], a[132:135]
    ds_read_b128 v[216:219], v232 offset:12416
    v_mfma_f32_16x16x32_bf16 a[140:143], v[220:223], v[180:183], a[140:143]
    s_add_u32 m0, s34, 122880
    s_nop 0
    buffer_load_dwordx4 v238, s[40:43], s35 offen offset:0 nt lds
    v_mfma_f32_16x16x32_bf16 a[148:151], v[220:223], v[184:187], a[148:151]
    v_cvt_pk_bf16_f32 v169, v247, v248
    v_mfma_f32_16x16x32_bf16 a[156:159], v[220:223], v[188:191], a[156:159]
    s_waitcnt lgkmcnt(3)
    v_mfma_f32_16x16x32_bf16 a[160:163], v[224:227], v[176:179], a[160:163]
    ds_read_b128 v[220:223], v233 offset:12416
    v_mfma_f32_16x16x32_bf16 a[168:171], v[224:227], v[180:183], a[168:171]
    v_exp_f32 v247, v122
    v_mfma_f32_16x16x32_bf16 a[176:179], v[224:227], v[184:187], a[176:179]
    v_cvt_pk_bf16_f32 v172, v245, v246
    v_mfma_f32_16x16x32_bf16 a[184:187], v[224:227], v[188:191], a[184:187]
    v_exp_f32 v248, v123
    v_mfma_f32_16x16x32_bf16 a[164:167], v[228:231], v[176:179], a[164:167]
    ds_read_b128 v[224:227], v232 offset:12544
    v_mfma_f32_16x16x32_bf16 a[172:175], v[228:231], v[180:183], a[172:175]
    v_exp_f32 v245, v100
    v_mfma_f32_16x16x32_bf16 a[180:183], v[228:231], v[184:187], a[180:183]
    buffer_load_dwordx4 v239, s[40:43], s35 offen offset:1024 nt lds
    v_mfma_f32_16x16x32_bf16 a[188:191], v[228:231], v[188:191], a[188:191]
    v_exp_f32 v246, v101
    v_mfma_f32_16x16x32_bf16 a[192:195], a[208:211], v[176:179], a[192:195]
    v_cvt_pk_bf16_f32 v173, v247, v248
    v_mfma_f32_16x16x32_bf16 a[196:199], a[208:211], v[180:183], a[196:199]
    v_exp_f32 v247, v102
    v_mfma_f32_16x16x32_bf16 a[200:203], a[208:211], v[184:187], a[200:203]
    v_cvt_pk_bf16_f32 v162, v245, v246
    v_mfma_f32_16x16x32_bf16 a[204:207], a[208:211], v[188:191], a[204:207]
    s_waitcnt lgkmcnt(3)
    v_mfma_f32_16x16x32_bf16 v[128:131], v[208:211], v[0:3], v[192:195]
    ds_read_b128 v[228:231], v233 offset:12544
    buffer_load_dwordx4 v240, s[40:43], s35 offen offset:2048 nt lds
    v_mfma_f32_16x16x32_bf16 v[136:139], v[208:211], v[4:7], v[196:199]
    v_exp_f32 v248, v103
    v_mfma_f32_16x16x32_bf16 v[144:147], v[208:211], v[8:11], v[200:203]
    v_exp_f32 v245, v108
    v_mfma_f32_16x16x32_bf16 v[152:155], v[208:211], v[12:15], v[204:207]
    v_mfma_f32_16x16x32_bf16 v[128:131], v[212:215], v[16:19], v[128:131]
    ds_read_b128 v[208:211], v232 offset:18432
    v_mfma_f32_16x16x32_bf16 v[136:139], v[212:215], v[20:23], v[136:139]
    v_exp_f32 v246, v109
    v_mfma_f32_16x16x32_bf16 v[144:147], v[212:215], v[24:27], v[144:147]
    v_cvt_pk_bf16_f32 v163, v247, v248
    v_mfma_f32_16x16x32_bf16 v[152:155], v[212:215], v[28:31], v[152:155]
    s_waitcnt lgkmcnt(3)
    v_mfma_f32_16x16x32_bf16 v[128:131], v[216:219], v[32:35], v[128:131]
    ds_read_b128 v[212:215], v233 offset:18432
    v_mfma_f32_16x16x32_bf16 v[136:139], v[216:219], v[36:39], v[136:139]
    v_exp_f32 v247, v110
    v_mfma_f32_16x16x32_bf16 v[144:147], v[216:219], v[40:43], v[144:147]
    s_add_u32 m0, s34, 125952
    s_nop 0
    buffer_load_dwordx4 v241, s[40:43], s35 offen offset:0 nt lds
    v_mfma_f32_16x16x32_bf16 v[152:155], v[216:219], v[44:47], v[152:155]
    v_cvt_pk_bf16_f32 v166, v245, v246
    v_mfma_f32_16x16x32_bf16 v[128:131], v[220:223], v[48:51], v[128:131]
    ds_read_b128 v[216:219], v232 offset:18560
    v_mfma_f32_16x16x32_bf16 v[136:139], v[220:223], v[52:55], v[136:139]
    v_exp_f32 v248, v111
    v_mfma_f32_16x16x32_bf16 v[144:147], v[220:223], v[56:59], v[144:147]
    v_exp_f32 v245, v116
    v_mfma_f32_16x16x32_bf16 v[152:155], v[220:223], v[60:63], v[152:155]
    s_waitcnt lgkmcnt(3)
    v_mfma_f32_16x16x32_bf16 v[128:131], v[224:227], v[64:67], v[128:131]
    ds_read_b128 v[220:223], v233 offset:18560
    v_mfma_f32_16x16x32_bf16 v[136:139], v[224:227], v[68:71], v[136:139]
    v_exp_f32 v246, v117
    v_mfma_f32_16x16x32_bf16 v[144:147], v[224:227], v[72:75], v[144:147]
    buffer_load_dwordx4 v242, s[40:43], s35 offen offset:1024 nt lds
    v_cvt_pk_bf16_f32 v167, v247, v248
    v_mfma_f32_16x16x32_bf16 v[152:155], v[224:227], v[76:79], v[152:155]
    v_exp_f32 v247, v118
    v_mfma_f32_16x16x32_bf16 v[128:131], v[228:231], v[80:83], v[128:131]
    ds_read_b128 v[224:227], v232 offset:18688
    v_cvt_pk_bf16_f32 v170, v245, v246
    v_mfma_f32_16x16x32_bf16 v[136:139], v[228:231], v[84:87], v[136:139]
    v_exp_f32 v248, v119
    v_mfma_f32_16x16x32_bf16 v[144:147], v[228:231], v[88:91], v[144:147]
    v_mfma_f32_16x16x32_bf16 v[152:155], v[228:231], v[92:95], v[152:155]
    s_waitcnt lgkmcnt(3)
    v_mfma_f32_16x16x32_bf16 v[132:135], v[208:211], v[0:3], v[192:195]
    ds_read_b128 v[228:231], v233 offset:18688
    v_mfma_f32_16x16x32_bf16 v[140:143], v[208:211], v[4:7], v[196:199]
    buffer_load_dwordx4 v243, s[40:43], s35 offen offset:2048 nt lds
    s_add_u32 s35, s35, 12288
    v_mfma_f32_16x16x32_bf16 v[148:151], v[208:211], v[8:11], v[200:203]
    v_exp_f32 v245, v124
    v_mfma_f32_16x16x32_bf16 v[156:159], v[208:211], v[12:15], v[204:207]
    v_exp_f32 v246, v125
    v_mfma_f32_16x16x32_bf16 v[132:135], v[212:215], v[16:19], v[132:135]
    ds_read_b64_tr_b16 v[208:209], v234 offset:24576
    ds_read_b64_tr_b16 v[210:211], v234 offset:30720
    v_mfma_f32_16x16x32_bf16 v[140:143], v[212:215], v[20:23], v[140:143]
    v_cvt_pk_bf16_f32 v171, v247, v248
    v_mfma_f32_16x16x32_bf16 v[148:151], v[212:215], v[24:27], v[148:151]
    v_exp_f32 v247, v126
    v_mfma_f32_16x16x32_bf16 v[156:159], v[212:215], v[28:31], v[156:159]
    v_cvt_pk_bf16_f32 v174, v245, v246
    s_waitcnt lgkmcnt(4)
    v_mfma_f32_16x16x32_bf16 v[132:135], v[216:219], v[32:35], v[132:135]
    ds_read_b64_tr_b16 v[212:213], v235 offset:24576
    ds_read_b64_tr_b16 v[214:215], v235 offset:30720
    v_mfma_f32_16x16x32_bf16 v[140:143], v[216:219], v[36:39], v[140:143]
    v_exp_f32 v248, v127
    v_mfma_f32_16x16x32_bf16 v[148:151], v[216:219], v[40:43], v[148:151]
    s_nop 0
    v_cvt_pk_bf16_f32 v175, v247, v248
    v_mfma_f32_16x16x32_bf16 v[156:159], v[216:219], v[44:47], v[156:159]
    v_mfma_f32_16x16x32_bf16 v[132:135], v[220:223], v[48:51], v[132:135]
    ds_read_b64_tr_b16 v[216:217], v236 offset:24576
    ds_read_b64_tr_b16 v[218:219], v236 offset:30720
    v_mfma_f32_16x16x32_bf16 v[140:143], v[220:223], v[52:55], v[140:143]
    v_or3_b32 v245, v160, v161, v162
    v_or3_b32 v245, v245, v163, v164
    v_mfma_f32_16x16x32_bf16 v[148:151], v[220:223], v[56:59], v[148:151]
    v_or3_b32 v245, v245, v165, v166
    v_mfma_f32_16x16x32_bf16 v[156:159], v[220:223], v[60:63], v[156:159]
    s_waitcnt lgkmcnt(6)
    v_mfma_f32_16x16x32_bf16 v[132:135], v[224:227], v[64:67], v[132:135]
    ds_read_b64_tr_b16 v[220:221], v237 offset:24576
    ds_read_b64_tr_b16 v[222:223], v237 offset:30720
    v_mfma_f32_16x16x32_bf16 v[140:143], v[224:227], v[68:71], v[140:143]
    v_or3_b32 v245, v245, v167, v168
    v_or3_b32 v245, v245, v169, v170
    v_mfma_f32_16x16x32_bf16 v[148:151], v[224:227], v[72:75], v[148:151]
    v_or3_b32 v245, v245, v171, v172
    v_mfma_f32_16x16x32_bf16 v[156:159], v[224:227], v[76:79], v[156:159]
    v_mfma_f32_16x16x32_bf16 v[132:135], v[228:231], v[80:83], v[132:135]
    ds_read_b64_tr_b16 v[224:225], v234 offset:24704
    ds_read_b64_tr_b16 v[226:227], v234 offset:30848
    v_or3_b32 v245, v245, v173, v174
    v_mfma_f32_16x16x32_bf16 v[140:143], v[228:231], v[84:87], v[140:143]
    v_or_b32 v245, v245, v175
    v_and_b32 v245, 0x40004000, v245
    v_mfma_f32_16x16x32_bf16 v[148:151], v[228:231], v[88:91], v[148:151]
    v_mfma_f32_16x16x32_bf16 v[156:159], v[228:231], v[92:95], v[156:159]
    v_cmp_ne_u32 vcc, 0, v245
    s_cbranch_vccnz Lrare_L0
Lrare_L0_back:
    s_waitcnt lgkmcnt(6)
    v_mfma_f32_16x16x32_bf16 a[0:3], v[208:211], v[160:163], a[0:3]
    ds_read_b64_tr_b16 v[228:229], v235 offset:24704
    ds_read_b64_tr_b16 v[230:231], v235 offset:30848
    v_mfma_f32_16x16x32_bf16 a[8:11], v[208:211], v[164:167], a[8:11]
    v_exp_f32 v245, v128
    v_mfma_f32_16x16x32_bf16 a[16:19], v[208:211], v[168:171], a[16:19]
    v_exp_f32 v246, v129
    v_mfma_f32_16x16x32_bf16 a[24:27], v[208:211], v[172:175], a[24:27]
    v_mfma_f32_16x16x32_bf16 a[4:7], v[212:215], v[160:163], a[4:7]
    ds_read_b64_tr_b16 v[208:209], v236 offset:24704
    ds_read_b64_tr_b16 v[210:211], v236 offset:30848
    v_mfma_f32_16x16x32_bf16 a[12:15], v[212:215], v[164:167], a[12:15]
    v_exp_f32 v247, v130
    v_mfma_f32_16x16x32_bf16 a[20:23], v[212:215], v[168:171], a[20:23]
    v_cvt_pk_bf16_f32 v176, v245, v246
    v_mfma_f32_16x16x32_bf16 a[28:31], v[212:215], v[172:175], a[28:31]
    s_waitcnt lgkmcnt(6)
    v_mfma_f32_16x16x32_bf16 a[32:35], v[216:219], v[160:163], a[32:35]
    ds_read_b64_tr_b16 v[212:213], v237 offset:24704
    ds_read_b64_tr_b16 v[214:215], v237 offset:30848
    v_mfma_f32_16x16x32_bf16 a[40:43], v[216:219], v[164:167], a[40:43]
    v_exp_f32 v248, v131
    v_mfma_f32_16x16x32_bf16 a[48:51], v[216:219], v[168:171], a[48:51]
    v_exp_f32 v245, v136
    v_mfma_f32_16x16x32_bf16 a[56:59], v[216:219], v[172:175], a[56:59]
    v_mfma_f32_16x16x32_bf16 a[36:39], v[220:223], v[160:163], a[36:39]
    ds_read_b64_tr_b16 v[216:217], v234 offset:24832
    ds_read_b64_tr_b16 v[218:219], v234 offset:30976
    v_mfma_f32_16x16x32_bf16 a[44:47], v[220:223], v[164:167], a[44:47]
    v_exp_f32 v246, v137
    v_mfma_f32_16x16x32_bf16 a[52:55], v[220:223], v[168:171], a[52:55]
    v_cvt_pk_bf16_f32 v177, v247, v248
    v_mfma_f32_16x16x32_bf16 a[60:63], v[220:223], v[172:175], a[60:63]
    s_waitcnt lgkmcnt(6)
    v_mfma_f32_16x16x32_bf16 a[64:67], v[224:227], v[160:163], a[64:67]
    ds_read_b64_tr_b16 v[220:221], v235 offset:24832
    ds_read_b64_tr_b16 v[222:223], v235 offset:30976
    v_mfma_f32_16x16x32_bf16 a[72:75], v[224:227], v[164:167], a[72:75]
    v_exp_f32 v247, v138
    v_mfma_f32_16x16x32_bf16 a[80:83], v[224:227], v[168:171], a[80:83]
    v_cvt_pk_bf16_f32 v180, v245, v246
    v_mfma_f32_16x16x32_bf16 a[88:91], v[224:227], v[172:175], a[88:91]
    v_exp_f32 v248, v139
    v_mfma_f32_16x16x32_bf16 a[68:71], v[228:231], v[160:163], a[68:71]
    ds_read_b64_tr_b16 v[224:225], v236 offset:24832
    ds_read_b64_tr_b16 v[226:227], v236 offset:30976
    v_mfma_f32_16x16x32_bf16 a[76:79], v[228:231], v[164:167], a[76:79]
    v_exp_f32 v245, v144
    v_mfma_f32_16x16x32_bf16 a[84:87], v[228:231], v[168:171], a[84:87]
    v_exp_f32 v246, v145
    v_mfma_f32_16x16x32_bf16 a[92:95], v[228:231], v[172:175], a[92:95]
    s_waitcnt lgkmcnt(6)
    v_mfma_f32_16x16x32_bf16 a[96:99], v[208:211], v[160:163], a[96:99]
    ds_read_b64_tr_b16 v[228:229], v237 offset:24832
    ds_read_b64_tr_b16 v[230:231], v237 offset:30976
    v_mfma_f32_16x16x32_bf16 a[104:107], v[208:211], v[164:167], a[104:107]
    v_cvt_pk_bf16_f32 v181, v247, v248
    v_mfma_f32_16x16x32_bf16 a[112:115], v[208:211], v[168:171], a[112:115]
    v_exp_f32 v247, v146
    v_mfma_f32_16x16x32_bf16 a[120:123], v[208:211], v[172:175], a[120:123]
    v_mfma_f32_16x16x32_bf16 a[100:103], v[212:215], v[160:163], a[100:103]
    ds_read_b128 v[208:211], v232 offset:36864
    v_cvt_pk_bf16_f32 v184, v245, v246
    v_mfma_f32_16x16x32_bf16 a[108:111], v[212:215], v[164:167], a[108:111]
    v_exp_f32 v248, v147
    v_mfma_f32_16x16x32_bf16 a[116:119], v[212:215], v[168:171], a[116:119]
    v_mfma_f32_16x16x32_bf16 a[124:127], v[212:215], v[172:175], a[124:127]
    s_waitcnt lgkmcnt(5)
    v_mfma_f32_16x16x32_bf16 a[128:131], v[216:219], v[160:163], a[128:131]
    ds_read_b128 v[212:215], v233 offset:36864
    v_mfma_f32_16x16x32_bf16 a[136:139], v[216:219], v[164:167], a[136:139]
    v_exp_f32 v245, v152
    v_mfma_f32_16x16x32_bf16 a[144:147], v[216:219], v[168:171], a[144:147]
    v_exp_f32 v246, v153
    v_mfma_f32_16x16x32_bf16 a[152:155], v[216:219], v[172:175], a[152:155]
    s_waitcnt vmcnt(18)
    s_barrier
    v_mfma_f32_16x16x32_bf16 a[132:135], v[220:223], v[160:163], a[132:135]
    ds_read_b128 v[216:219], v232 offset:36992
    v_mfma_f32_16x16x32_bf16 a[140:143], v[220:223], v[164:167], a[140:143]
    s_add_u32 m0, s34, 0
    s_nop 0
    buffer_load_dwordx4 v238, s[40:43], s35 offen offset:0 nt lds
    v_mfma_f32_16x16x32_bf16 a[148:151], v[220:223], v[168:171], a[148:151]
    v_cvt_pk_bf16_f32 v185, v247, v248
    v_mfma_f32_16x16x32_bf16 a[156:159], v[220:223], v[172:175], a[156:159]
    s_waitcnt lgkmcnt(3)
    v_mfma_f32_16x16x32_bf16 a[160:163], v[224:227], v[160:163], a[160:163]
    ds_read_b128 v[220:223], v233 offset:36992
    v_mfma_f32_16x16x32_bf16 a[168:171], v[224:227], v[164:167], a[168:171]
    v_exp_f32 v247, v154
    v_mfma_f32_16x16x32_bf16 a[176:179], v[224:227], v[168:171], a[176:179]
    v_cvt_pk_bf16_f32 v188, v245, v246
    v_mfma_f32_16x16x32_bf16 a[184:187], v[224:227], v[172:175], a[184:187]
    v_exp_f32 v248, v155
    v_mfma_f32_16x16x32_bf16 a[164:167], v[228:231], v[160:163], a[164:167]
    ds_read_b128 v[224:227], v232 offset:37120
    v_mfma_f32_16x16x32_bf16 a[172:175], v[228:231], v[164:167], a[172:175]
    v_exp_f32 v245, v132
    v_mfma_f32_16x16x32_bf16 a[180:183], v[228:231], v[168:171], a[180:183]
    buffer_load_dwordx4 v239, s[40:43], s35 offen offset:1024 nt lds
    v_mfma_f32_16x16x32_bf16 a[188:191], v[228:231], v[172:175], a[188:191]
    v_exp_f32 v246, v133
    v_mfma_f32_16x16x32_bf16 a[192:195], a[208:211], v[160:163], a[192:195]
    v_cvt_pk_bf16_f32 v189, v247, v248
    v_mfma_f32_16x16x32_bf16 a[196:199], a[208:211], v[164:167], a[196:199]
    v_exp_f32 v247, v134
    v_mfma_f32_16x16x32_bf16 a[200:203], a[208:211], v[168:171], a[200:203]
    v_cvt_pk_bf16_f32 v178, v245, v246
    v_mfma_f32_16x16x32_bf16 a[204:207], a[208:211], v[172:175], a[204:207]
    s_waitcnt lgkmcnt(3)
    v_mfma_f32_16x16x32_bf16 v[96:99], v[208:211], v[0:3], v[192:195]
    ds_read_b128 v[228:231], v233 offset:37120
    buffer_load_dwordx4 v240, s[40:43], s35 offen offset:2048 nt lds
    v_mfma_f32_16x16x32_bf16 v[104:107], v[208:211], v[4:7], v[196:199]
    v_exp_f32 v248, v135
    v_mfma_f32_16x16x32_bf16 v[112:115], v[208:211], v[8:11], v[200:203]
    v_exp_f32 v245, v140
    v_mfma_f32_16x16x32_bf16 v[120:123], v[208:211], v[12:15], v[204:207]
    v_mfma_f32_16x16x32_bf16 v[96:99], v[212:215], v[16:19], v[96:99]
    ds_read_b128 v[208:211], v232 offset:43008
    v_mfma_f32_16x16x32_bf16 v[104:107], v[212:215], v[20:23], v[104:107]
    v_exp_f32 v246, v141
    v_mfma_f32_16x16x32_bf16 v[112:115], v[212:215], v[24:27], v[112:115]
    v_cvt_pk_bf16_f32 v179, v247, v248
    v_mfma_f32_16x16x32_bf16 v[120:123], v[212:215], v[28:31], v[120:123]
    s_waitcnt lgkmcnt(3)
    v_mfma_f32_16x16x32_bf16 v[96:99], v[216:219], v[32:35], v[96:99]
    ds_read_b128 v[212:215], v233 offset:43008
    v_mfma_f32_16x16x32_bf16 v[104:107], v[216:219], v[36:39], v[104:107]
    v_exp_f32 v247, v142
    v_mfma_f32_16x16x32_bf16 v[112:115], v[216:219], v[40:43], v[112:115]
    s_add_u32 m0, s34, 3072
    s_nop 0
    buffer_load_dwordx4 v241, s[40:43], s35 offen offset:0 nt lds
    v_mfma_f32_16x16x32_bf16 v[120:123], v[216:219], v[44:47], v[120:123]
    v_cvt_pk_bf16_f32 v182, v245, v246
    v_mfma_f32_16x16x32_bf16 v[96:99], v[220:223], v[48:51], v[96:99]
    ds_read_b128 v[216:219], v232 offset:43136
    v_mfma_f32_16x16x32_bf16 v[104:107], v[220:223], v[52:55], v[104:107]
    v_exp_f32 v248, v143
    v_mfma_f32_16x16x32_bf16 v[112:115], v[220:223], v[56:59], v[112:115]
    v_exp_f32 v245, v148
    v_mfma_f32_16x16x32_bf16 v[120:123], v[220:223], v[60:63], v[120:123]
    s_waitcnt lgkmcnt(3)
    v_mfma_f32_16x16x32_bf16 v[96:99], v[224:227], v[64:67], v[96:99]
    ds_read_b128 v[220:223], v233 offset:43136
    v_mfma_f32_16x16x32_bf16 v[104:107], v[224:227], v[68:71], v[104:107]
    v_exp_f32 v246, v149
    v_mfma_f32_16x16x32_bf16 v[112:115], v[224:227], v[72:75], v[112:115]
    buffer_load_dwordx4 v242, s[40:43], s35 offen offset:1024 nt lds
    v_cvt_pk_bf16_f32 v183, v247, v248
    v_mfma_f32_16x16x32_bf16 v[120:123], v[224:227], v[76:79], v[120:123]
    v_exp_f32 v247, v150
    v_mfma_f32_16x16x32_bf16 v[96:99], v[228:231], v[80:83], v[96:99]
    ds_read_b128 v[224:227], v232 offset:43264
    v_cvt_pk_bf16_f32 v186, v245, v246
    v_mfma_f32_16x16x32_bf16 v[104:107], v[228:231], v[84:87], v[104:107]
    v_exp_f32 v248, v151
    v_mfma_f32_16x16x32_bf16 v[112:115], v[228:231], v[88:91], v[112:115]
    v_mfma_f32_16x16x32_bf16 v[120:123], v[228:231], v[92:95], v[120:123]
    s_waitcnt lgkmcnt(3)
    v_mfma_f32_16x16x32_bf16 v[100:103], v[208:211], v[0:3], v[192:195]
    ds_read_b128 v[228:231], v233 offset:43264
    v_mfma_f32_16x16x32_bf16 v[108:111], v[208:211], v[4:7], v[196:199]
    buffer_load_dwordx4 v243, s[40:43], s35 offen offset:2048 nt lds
    s_add_u32 s35, s35, 12288
    v_mfma_f32_16x16x32_bf16 v[116:119], v[208:211], v[8:11], v[200:203]
    v_exp_f32 v245, v156
    v_mfma_f32_16x16x32_bf16 v[124:127], v[208:211], v[12:15], v[204:207]
    v_exp_f32 v246, v157
    v_mfma_f32_16x16x32_bf16 v[100:103], v[212:215], v[16:19], v[100:103]
    v_add_u32 v234, 0xc000, v234
    v_add_u32 v235, 0xc000, v235
    v_add_u32 v236, 0xc000, v236
    v_add_u32 v237, 0xc000, v237
    ds_read_b64_tr_b16 v[208:209], v234 offset:0
    ds_read_b64_tr_b16 v[210:211], v234 offset:6144
    v_mfma_f32_16x16x32_bf16 v[108:111], v[212:215], v[20:23], v[108:111]
    v_cvt_pk_bf16_f32 v187, v247, v248
    v_mfma_f32_16x16x32_bf16 v[116:119], v[212:215], v[24:27], v[116:119]
    v_exp_f32 v247, v158
    v_mfma_f32_16x16x32_bf16 v[124:127], v[212:215], v[28:31], v[124:127]
    v_cvt_pk_bf16_f32 v190, v245, v246
    s_waitcnt lgkmcnt(4)
    v_mfma_f32_16x16x32_bf16 v[100:103], v[216:219], v[32:35], v[100:103]
    ds_read_b64_tr_b16 v[212:213], v235 offset:0
    ds_read_b64_tr_b16 v[214:215], v235 offset:6144
    v_mfma_f32_16x16x32_bf16 v[108:111], v[216:219], v[36:39], v[108:111]
    v_exp_f32 v248, v159
    v_mfma_f32_16x16x32_bf16 v[116:119], v[216:219], v[40:43], v[116:119]
    s_nop 0
    v_cvt_pk_bf16_f32 v191, v247, v248
    v_mfma_f32_16x16x32_bf16 v[124:127], v[216:219], v[44:47], v[124:127]
    v_mfma_f32_16x16x32_bf16 v[100:103], v[220:223], v[48:51], v[100:103]
    ds_read_b64_tr_b16 v[216:217], v236 offset:0
    ds_read_b64_tr_b16 v[218:219], v236 offset:6144
    v_mfma_f32_16x16x32_bf16 v[108:111], v[220:223], v[52:55], v[108:111]
    v_or3_b32 v245, v176, v177, v178
    v_or3_b32 v245, v245, v179, v180
    v_mfma_f32_16x16x32_bf16 v[116:119], v[220:223], v[56:59], v[116:119]
    v_or3_b32 v245, v245, v181, v182
    v_mfma_f32_16x16x32_bf16 v[124:127], v[220:223], v[60:63], v[124:127]
    s_waitcnt lgkmcnt(6)
    v_mfma_f32_16x16x32_bf16 v[100:103], v[224:227], v[64:67], v[100:103]
    ds_read_b64_tr_b16 v[220:221], v237 offset:0
    ds_read_b64_tr_b16 v[222:223], v237 offset:6144
    v_mfma_f32_16x16x32_bf16 v[108:111], v[224:227], v[68:71], v[108:111]
    v_or3_b32 v245, v245, v183, v184
    v_or3_b32 v245, v245, v185, v186
    v_mfma_f32_16x16x32_bf16 v[116:119], v[224:227], v[72:75], v[116:119]
    v_or3_b32 v245, v245, v187, v188
    v_mfma_f32_16x16x32_bf16 v[124:127], v[224:227], v[76:79], v[124:127]
    v_mfma_f32_16x16x32_bf16 v[100:103], v[228:231], v[80:83], v[100:103]
    ds_read_b64_tr_b16 v[224:225], v234 offset:128
    ds_read_b64_tr_b16 v[226:227], v234 offset:6272
    v_or3_b32 v245, v245, v189, v190
    v_mfma_f32_16x16x32_bf16 v[108:111], v[228:231], v[84:87], v[108:111]
    v_or_b32 v245, v245, v191
    v_and_b32 v245, 0x40004000, v245
    v_mfma_f32_16x16x32_bf16 v[116:119], v[228:231], v[88:91], v[116:119]
    v_mfma_f32_16x16x32_bf16 v[124:127], v[228:231], v[92:95], v[124:127]
    v_cmp_ne_u32 vcc, 0, v245
    s_cbranch_vccnz Lrare_L1
Lrare_L1_back:
    s_waitcnt lgkmcnt(6)
    v_mfma_f32_16x16x32_bf16 a[0:3], v[208:211], v[176:179], a[0:3]
    ds_read_b64_tr_b16 v[228:229], v235 offset:128
    ds_read_b64_tr_b16 v[230:231], v235 offset:6272
    v_mfma_f32_16x16x32_bf16 a[8:11], v[208:211], v[180:183], a[8:11]
    v_exp_f32 v245, v96
    v_mfma_f32_16x16x32_bf16 a[16:19], v[208:211], v[184:187], a[16:19]
    v_exp_f32 v246, v97
    v_mfma_f32_16x16x32_bf16 a[24:27], v[208:211], v[188:191], a[24:27]
    v_mfma_f32_16x16x32_bf16 a[4:7], v[212:215], v[176:179], a[4:7]
    ds_read_b64_tr_b16 v[208:209], v236 offset:128
    ds_read_b64_tr_b16 v[210:211], v236 offset:6272
    v_mfma_f32_16x16x32_bf16 a[12:15], v[212:215], v[180:183], a[12:15]
    v_exp_f32 v247, v98
    v_mfma_f32_16x16x32_bf16 a[20:23], v[212:215], v[184:187], a[20:23]
    v_cvt_pk_bf16_f32 v160, v245, v246
    v_mfma_f32_16x16x32_bf16 a[28:31], v[212:215], v[188:191], a[28:31]
    s_waitcnt lgkmcnt(6)
    v_mfma_f32_16x16x32_bf16 a[32:35], v[216:219], v[176:179], a[32:35]
    ds_read_b64_tr_b16 v[212:213], v237 offset:128
    ds_read_b64_tr_b16 v[214:215], v237 offset:6272
    v_mfma_f32_16x16x32_bf16 a[40:43], v[216:219], v[180:183], a[40:43]
    v_exp_f32 v248, v99
    v_mfma_f32_16x16x32_bf16 a[48:51], v[216:219], v[184:187], a[48:51]
    v_exp_f32 v245, v104
    v_mfma_f32_16x16x32_bf16 a[56:59], v[216:219], v[188:191], a[56:59]
    v_mfma_f32_16x16x32_bf16 a[36:39], v[220:223], v[176:179], a[36:39]
    ds_read_b64_tr_b16 v[216:217], v234 offset:256
    ds_read_b64_tr_b16 v[218:219], v234 offset:6400
    v_mfma_f32_16x16x32_bf16 a[44:47], v[220:223], v[180:183], a[44:47]
    v_exp_f32 v246, v105
    v_mfma_f32_16x16x32_bf16 a[52:55], v[220:223], v[184:187], a[52:55]
    v_cvt_pk_bf16_f32 v161, v247, v248
    v_mfma_f32_16x16x32_bf16 a[60:63], v[220:223], v[188:191], a[60:63]
    s_waitcnt lgkmcnt(6)
    v_mfma_f32_16x16x32_bf16 a[64:67], v[224:227], v[176:179], a[64:67]
    ds_read_b64_tr_b16 v[220:221], v235 offset:256
    ds_read_b64_tr_b16 v[222:223], v235 offset:6400
    v_mfma_f32_16x16x32_bf16 a[72:75], v[224:227], v[180:183], a[72:75]
    v_exp_f32 v247, v106
    v_mfma_f32_16x16x32_bf16 a[80:83], v[224:227], v[184:187], a[80:83]
    v_cvt_pk_bf16_f32 v164, v245, v246
    v_mfma_f32_16x16x32_bf16 a[88:91], v[224:227], v[188:191], a[88:91]
    v_exp_f32 v248, v107
    v_mfma_f32_16x16x32_bf16 a[68:71], v[228:231], v[176:179], a[68:71]
    ds_read_b64_tr_b16 v[224:225], v236 offset:256
    ds_read_b64_tr_b16 v[226:227], v236 offset:6400
    v_mfma_f32_16x16x32_bf16 a[76:79], v[228:231], v[180:183], a[76:79]
    v_exp_f32 v245, v112
    v_mfma_f32_16x16x32_bf16 a[84:87], v[228:231], v[184:187], a[84:87]
    v_exp_f32 v246, v113
    v_mfma_f32_16x16x32_bf16 a[92:95], v[228:231], v[188:191], a[92:95]
    s_waitcnt lgkmcnt(6)
    v_mfma_f32_16x16x32_bf16 a[96:99], v[208:211], v[176:179], a[96:99]
    ds_read_b64_tr_b16 v[228:229], v237 offset:256
    ds_read_b64_tr_b16 v[230:231], v237 offset:6400
    v_mfma_f32_16x16x32_bf16 a[104:107], v[208:211], v[180:183], a[104:107]
    v_cvt_pk_bf16_f32 v165, v247, v248
    v_mfma_f32_16x16x32_bf16 a[112:115], v[208:211], v[184:187], a[112:115]
    v_exp_f32 v247, v114
    v_mfma_f32_16x16x32_bf16 a[120:123], v[208:211], v[188:191], a[120:123]
    v_mfma_f32_16x16x32_bf16 a[100:103], v[212:215], v[176:179], a[100:103]
    v_add_u32 v232, 0xc000, v232
    v_add_u32 v233, 0xc000, v233
    ds_read_b128 v[208:211], v232 offset:12288
    v_cvt_pk_bf16_f32 v168, v245, v246
    v_mfma_f32_16x16x32_bf16 a[108:111], v[212:215], v[180:183], a[108:111]
    v_exp_f32 v248, v115
    v_mfma_f32_16x16x32_bf16 a[116:119], v[212:215], v[184:187], a[116:119]
    v_mfma_f32_16x16x32_bf16 a[124:127], v[212:215], v[188:191], a[124:127]
    s_waitcnt lgkmcnt(5)
    v_mfma_f32_16x16x32_bf16 a[128:131], v[216:219], v[176:179], a[128:131]
    ds_read_b128 v[212:215], v233 offset:12288
    v_mfma_f32_16x16x32_bf16 a[136:139], v[216:219], v[180:183], a[136:139]
    v_exp_f32 v245, v120
    v_mfma_f32_16x16x32_bf16 a[144:147], v[216:219], v[184:187], a[144:147]
    v_exp_f32 v246, v121
    v_mfma_f32_16x16x32_bf16 a[152:155], v[216:219], v[188:191], a[152:155]
    s_waitcnt vmcnt(18)
    s_barrier
    v_mfma_f32_16x16x32_bf16 a[132:135], v[220:223], v[176:179], a[132:135]
    ds_read_b128 v[216:219], v232 offset:12416
    v_mfma_f32_16x16x32_bf16 a[140:143], v[220:223], v[180:183], a[140:143]
    s_add_u32 m0, s34, 24576
    s_nop 0
    buffer_load_dwordx4 v238, s[40:43], s35 offen offset:0 nt lds
    v_mfma_f32_16x16x32_bf16 a[148:151], v[220:223], v[184:187], a[148:151]
    v_cvt_pk_bf16_f32 v169, v247, v248
    v_mfma_f32_16x16x32_bf16 a[156:159], v[220:223], v[188:191], a[156:159]
    s_waitcnt lgkmcnt(3)
    v_mfma_f32_16x16x32_bf16 a[160:163], v[224:227], v[176:179], a[160:163]
    ds_read_b128 v[220:223], v233 offset:12416
    v_mfma_f32_16x16x32_bf16 a[168:171], v[224:227], v[180:183], a[168:171]
    v_exp_f32 v247, v122
    v_mfma_f32_16x16x32_bf16 a[176:179], v[224:227], v[184:187], a[176:179]
    v_cvt_pk_bf16_f32 v172, v245, v246
    v_mfma_f32_16x16x32_bf16 a[184:187], v[224:227], v[188:191], a[184:187]
    v_exp_f32 v248, v123
    v_mfma_f32_16x16x32_bf16 a[164:167], v[228:231], v[176:179], a[164:167]
    ds_read_b128 v[224:227], v232 offset:12544
    v_mfma_f32_16x16x32_bf16 a[172:175], v[228:231], v[180:183], a[172:175]
    v_exp_f32 v245, v100
    v_mfma_f32_16x16x32_bf16 a[180:183], v[228:231], v[184:187], a[180:183]
    buffer_load_dwordx4 v239, s[40:43], s35 offen offset:1024 nt lds
    v_mfma_f32_16x16x32_bf16 a[188:191], v[228:231], v[188:191], a[188:191]
    v_exp_f32 v246, v101
    v_mfma_f32_16x16x32_bf16 a[192:195], a[208:211], v[176:179], a[192:195]
    v_cvt_pk_bf16_f32 v173, v247, v248
    v_mfma_f32_16x16x32_bf16 a[196:199], a[208:211], v[180:183], a[196:199]
    v_exp_f32 v247, v102
    v_mfma_f32_16x16x32_bf16 a[200:203], a[208:211], v[184:187], a[200:203]
    v_cvt_pk_bf16_f32 v162, v245, v246
    v_mfma_f32_16x16x32_bf16 a[204:207], a[208:211], v[188:191], a[204:207]
    s_waitcnt lgkmcnt(3)
    v_mfma_f32_16x16x32_bf16 v[128:131], v[208:211], v[0:3], v[192:195]
    ds_read_b128 v[228:231], v233 offset:12544
    buffer_load_dwordx4 v240, s[40:43], s35 offen offset:2048 nt lds
    v_mfma_f32_16x16x32_bf16 v[136:139], v[208:211], v[4:7], v[196:199]
    v_exp_f32 v248, v103
    v_mfma_f32_16x16x32_bf16 v[144:147], v[208:211], v[8:11], v[200:203]
    v_exp_f32 v245, v108
    v_mfma_f32_16x16x32_bf16 v[152:155], v[208:211], v[12:15], v[204:207]
    v_mfma_f32_16x16x32_bf16 v[128:131], v[212:215], v[16:19], v[128:131]
    ds_read_b128 v[208:211], v232 offset:18432
    v_mfma_f32_16x16x32_bf16 v[136:139], v[212:215], v[20:23], v[136:139]
    v_exp_f32 v246, v109
    v_mfma_f32_16x16x32_bf16 v[144:147], v[212:215], v[24:27], v[144:147]
    v_cvt_pk_bf16_f32 v163, v247, v248
    v_mfma_f32_16x16x32_bf16 v[152:155], v[212:215], v[28:31], v[152:155]
    s_waitcnt lgkmcnt(3)
    v_mfma_f32_16x16x32_bf16 v[128:131], v[216:219], v[32:35], v[128:131]
    ds_read_b128 v[212:215], v233 offset:18432
    v_mfma_f32_16x16x32_bf16 v[136:139], v[216:219], v[36:39], v[136:139]
    v_exp_f32 v247, v110
    v_mfma_f32_16x16x32_bf16 v[144:147], v[216:219], v[40:43], v[144:147]
    s_add_u32 m0, s34, 27648
    s_nop 0
    buffer_load_dwordx4 v241, s[40:43], s35 offen offset:0 nt lds
    v_mfma_f32_16x16x32_bf16 v[152:155], v[216:219], v[44:47], v[152:155]
    v_cvt_pk_bf16_f32 v166, v245, v246
    v_mfma_f32_16x16x32_bf16 v[128:131], v[220:223], v[48:51], v[128:131]
    ds_read_b128 v[216:219], v232 offset:18560
    v_mfma_f32_16x16x32_bf16 v[136:139], v[220:223], v[52:55], v[136:139]
    v_exp_f32 v248, v111
    v_mfma_f32_16x16x32_bf16 v[144:147], v[220:223], v[56:59], v[144:147]
    v_exp_f32 v245, v116
    v_mfma_f32_16x16x32_bf16 v[152:155], v[220:223], v[60:63], v[152:155]
    s_waitcnt lgkmcnt(3)
    v_mfma_f32_16x16x32_bf16 v[128:131], v[224:227], v[64:67], v[128:131]
    ds_read_b128 v[220:223], v233 offset:18560
    v_mfma_f32_16x16x32_bf16 v[136:139], v[224:227], v[68:71], v[136:139]
    v_exp_f32 v246, v117
    v_mfma_f32_16x16x32_bf16 v[144:147], v[224:227], v[72:75], v[144:147]
    buffer_load_dwordx4 v242, s[40:43], s35 offen offset:1024 nt lds
    v_cvt_pk_bf16_f32 v167, v247, v248
    v_mfma_f32_16x16x32_bf16 v[152:155], v[224:227], v[76:79], v[152:155]
    v_exp_f32 v247, v118
    v_mfma_f32_16x16x32_bf16 v[128:131], v[228:231], v[80:83], v[128:131]
    ds_read_b128 v[224:227], v232 offset:18688
    v_cvt_pk_bf16_f32 v170, v245, v246
    v_mfma_f32_16x16x32_bf16 v[136:139], v[228:231], v[84:87], v[136:139]
    v_exp_f32 v248, v119
    v_mfma_f32_16x16x32_bf16 v[144:147], v[228:231], v[88:91], v[144:147]
    v_mfma_f32_16x16x32_bf16 v[152:155], v[228:231], v[92:95], v[152:155]
    s_waitcnt lgkmcnt(3)
    v_mfma_f32_16x16x32_bf16 v[132:135], v[208:211], v[0:3], v[192:195]
    ds_read_b128 v[228:231], v233 offset:18688
    v_mfma_f32_16x16x32_bf16 v[140:143], v[208:211], v[4:7], v[196:199]
    buffer_load_dwordx4 v243, s[40:43], s35 offen offset:2048 nt lds
    s_add_u32 s35, s35, 12288
    v_mfma_f32_16x16x32_bf16 v[148:151], v[208:211], v[8:11], v[200:203]
    v_exp_f32 v245, v124
    v_mfma_f32_16x16x32_bf16 v[156:159], v[208:211], v[12:15], v[204:207]
    v_exp_f32 v246, v125
    v_mfma_f32_16x16x32_bf16 v[132:135], v[212:215], v[16:19], v[132:135]
    ds_read_b64_tr_b16 v[208:209], v234 offset:24576
    ds_read_b64_tr_b16 v[210:211], v234 offset:30720
    v_mfma_f32_16x16x32_bf16 v[140:143], v[212:215], v[20:23], v[140:143]
    v_cvt_pk_bf16_f32 v171, v247, v248
    v_mfma_f32_16x16x32_bf16 v[148:151], v[212:215], v[24:27], v[148:151]
    v_exp_f32 v247, v126
    v_mfma_f32_16x16x32_bf16 v[156:159], v[212:215], v[28:31], v[156:159]
    v_cvt_pk_bf16_f32 v174, v245, v246
    s_waitcnt lgkmcnt(4)
    v_mfma_f32_16x16x32_bf16 v[132:135], v[216:219], v[32:35], v[132:135]
    ds_read_b64_tr_b16 v[212:213], v235 offset:24576
    ds_read_b64_tr_b16 v[214:215], v235 offset:30720
    v_mfma_f32_16x16x32_bf16 v[140:143], v[216:219], v[36:39], v[140:143]
    v_exp_f32 v248, v127
    v_mfma_f32_16x16x32_bf16 v[148:151], v[216:219], v[40:43], v[148:151]
    s_nop 0
    v_cvt_pk_bf16_f32 v175, v247, v248
    v_mfma_f32_16x16x32_bf16 v[156:159], v[216:219], v[44:47], v[156:159]
    v_mfma_f32_16x16x32_bf16 v[132:135], v[220:223], v[48:51], v[132:135]
    ds_read_b64_tr_b16 v[216:217], v236 offset:24576
    ds_read_b64_tr_b16 v[218:219], v236 offset:30720
    v_mfma_f32_16x16x32_bf16 v[140:143], v[220:223], v[52:55], v[140:143]
    v_or3_b32 v245, v160, v161, v162
    v_or3_b32 v245, v245, v163, v164
    v_mfma_f32_16x16x32_bf16 v[148:151], v[220:223], v[56:59], v[148:151]
    v_or3_b32 v245, v245, v165, v166
    v_mfma_f32_16x16x32_bf16 v[156:159], v[220:223], v[60:63], v[156:159]
    s_waitcnt lgkmcnt(6)
    v_mfma_f32_16x16x32_bf16 v[132:135], v[224:227], v[64:67], v[132:135]
    ds_read_b64_tr_b16 v[220:221], v237 offset:24576
    ds_read_b64_tr_b16 v[222:223], v237 offset:30720
    v_mfma_f32_16x16x32_bf16 v[140:143], v[224:227], v[68:71], v[140:143]
    v_or3_b32 v245, v245, v167, v168
    v_or3_b32 v245, v245, v169, v170
    v_mfma_f32_16x16x32_bf16 v[148:151], v[224:227], v[72:75], v[148:151]
    v_or3_b32 v245, v245, v171, v172
    v_mfma_f32_16x16x32_bf16 v[156:159], v[224:227], v[76:79], v[156:159]
    v_mfma_f32_16x16x32_bf16 v[132:135], v[228:231], v[80:83], v[132:135]
    ds_read_b64_tr_b16 v[224:225], v234 offset:24704
    ds_read_b64_tr_b16 v[226:227], v234 offset:30848
    v_or3_b32 v245, v245, v173, v174
    v_mfma_f32_16x16x32_bf16 v[140:143], v[228:231], v[84:87], v[140:143]
    v_or_b32 v245, v245, v175
    v_and_b32 v245, 0x40004000, v245
    v_mfma_f32_16x16x32_bf16 v[148:151], v[228:231], v[88:91], v[148:151]
    v_mfma_f32_16x16x32_bf16 v[156:159], v[228:231], v[92:95], v[156:159]
    v_cmp_ne_u32 vcc, 0, v245
    s_cbranch_vccnz Lrare_L2
Lrare_L2_back:
    s_waitcnt lgkmcnt(6)
    v_mfma_f32_16x16x32_bf16 a[0:3], v[208:211], v[160:163], a[0:3]
    ds_read_b64_tr_b16 v[228:229], v235 offset:24704
    ds_read_b64_tr_b16 v[230:231], v235 offset:30848
    v_mfma_f32_16x16x32_bf16 a[8:11], v[208:211], v[164:167], a[8:11]
    v_exp_f32 v245, v128
    v_mfma_f32_16x16x32_bf16 a[16:19], v[208:211], v[168:171], a[16:19]
    v_exp_f32 v246, v129
    v_mfma_f32_16x16x32_bf16 a[24:27], v[208:211], v[172:175], a[24:27]
    v_mfma_f32_16x16x32_bf16 a[4:7], v[212:215], v[160:163], a[4:7]
    ds_read_b64_tr_b16 v[208:209], v236 offset:24704
    ds_read_b64_tr_b16 v[210:211], v236 offset:30848
    v_mfma_f32_16x16x32_bf16 a[12:15], v[212:215], v[164:167], a[12:15]
    v_exp_f32 v247, v130
    v_mfma_f32_16x16x32_bf16 a[20:23], v[212:215], v[168:171], a[20:23]
    v_cvt_pk_bf16_f32 v176, v245, v246
    v_mfma_f32_16x16x32_bf16 a[28:31], v[212:215], v[172:175], a[28:31]
    s_waitcnt lgkmcnt(6)
    v_mfma_f32_16x16x32_bf16 a[32:35], v[216:219], v[160:163], a[32:35]
    ds_read_b64_tr_b16 v[212:213], v237 offset:24704
    ds_read_b64_tr_b16 v[214:215], v237 offset:30848
    v_mfma_f32_16x16x32_bf16 a[40:43], v[216:219], v[164:167], a[40:43]
    v_exp_f32 v248, v131
    v_mfma_f32_16x16x32_bf16 a[48:51], v[216:219], v[168:171], a[48:51]
    v_exp_f32 v245, v136
    v_mfma_f32_16x16x32_bf16 a[56:59], v[216:219], v[172:175], a[56:59]
    v_mfma_f32_16x16x32_bf16 a[36:39], v[220:223], v[160:163], a[36:39]
    ds_read_b64_tr_b16 v[216:217], v234 offset:24832
    ds_read_b64_tr_b16 v[218:219], v234 offset:30976
    v_mfma_f32_16x16x32_bf16 a[44:47], v[220:223], v[164:167], a[44:47]
    v_exp_f32 v246, v137
    v_mfma_f32_16x16x32_bf16 a[52:55], v[220:223], v[168:171], a[52:55]
    v_cvt_pk_bf16_f32 v177, v247, v248
    v_mfma_f32_16x16x32_bf16 a[60:63], v[220:223], v[172:175], a[60:63]
    s_waitcnt lgkmcnt(6)
    v_mfma_f32_16x16x32_bf16 a[64:67], v[224:227], v[160:163], a[64:67]
    ds_read_b64_tr_b16 v[220:221], v235 offset:24832
    ds_read_b64_tr_b16 v[222:223], v235 offset:30976
    v_mfma_f32_16x16x32_bf16 a[72:75], v[224:227], v[164:167], a[72:75]
    v_exp_f32 v247, v138
    v_mfma_f32_16x16x32_bf16 a[80:83], v[224:227], v[168:171], a[80:83]
    v_cvt_pk_bf16_f32 v180, v245, v246
    v_mfma_f32_16x16x32_bf16 a[88:91], v[224:227], v[172:175], a[88:91]
    v_exp_f32 v248, v139
    v_mfma_f32_16x16x32_bf16 a[68:71], v[228:231], v[160:163], a[68:71]
    ds_read_b64_tr_b16 v[224:225], v236 offset:24832
    ds_read_b64_tr_b16 v[226:227], v236 offset:30976
    v_mfma_f32_16x16x32_bf16 a[76:79], v[228:231], v[164:167], a[76:79]
    v_exp_f32 v245, v144
    v_mfma_f32_16x16x32_bf16 a[84:87], v[228:231], v[168:171], a[84:87]
    v_exp_f32 v246, v145
    v_mfma_f32_16x16x32_bf16 a[92:95], v[228:231], v[172:175], a[92:95]
    s_waitcnt lgkmcnt(6)
    v_mfma_f32_16x16x32_bf16 a[96:99], v[208:211], v[160:163], a[96:99]
    ds_read_b64_tr_b16 v[228:229], v237 offset:24832
    ds_read_b64_tr_b16 v[230:231], v237 offset:30976
    v_mfma_f32_16x16x32_bf16 a[104:107], v[208:211], v[164:167], a[104:107]
    v_cvt_pk_bf16_f32 v181, v247, v248
    v_mfma_f32_16x16x32_bf16 a[112:115], v[208:211], v[168:171], a[112:115]
    v_exp_f32 v247, v146
    v_mfma_f32_16x16x32_bf16 a[120:123], v[208:211], v[172:175], a[120:123]
    v_mfma_f32_16x16x32_bf16 a[100:103], v[212:215], v[160:163], a[100:103]
    ds_read_b128 v[208:211], v232 offset:36864
    v_cvt_pk_bf16_f32 v184, v245, v246
    v_mfma_f32_16x16x32_bf16 a[108:111], v[212:215], v[164:167], a[108:111]
    v_exp_f32 v248, v147
    v_mfma_f32_16x16x32_bf16 a[116:119], v[212:215], v[168:171], a[116:119]
    v_mfma_f32_16x16x32_bf16 a[124:127], v[212:215], v[172:175], a[124:127]
    s_waitcnt lgkmcnt(5)
    v_mfma_f32_16x16x32_bf16 a[128:131], v[216:219], v[160:163], a[128:131]
    ds_read_b128 v[212:215], v233 offset:36864
    v_mfma_f32_16x16x32_bf16 a[136:139], v[216:219], v[164:167], a[136:139]
    v_exp_f32 v245, v152
    v_mfma_f32_16x16x32_bf16 a[144:147], v[216:219], v[168:171], a[144:147]
    v_exp_f32 v246, v153
    v_mfma_f32_16x16x32_bf16 a[152:155], v[216:219], v[172:175], a[152:155]
    s_waitcnt vmcnt(18)
    s_barrier
    v_mfma_f32_16x16x32_bf16 a[132:135], v[220:223], v[160:163], a[132:135]
    ds_read_b128 v[216:219], v232 offset:36992
    v_mfma_f32_16x16x32_bf16 a[140:143], v[220:223], v[164:167], a[140:143]
    s_add_u32 m0, s34, 49152
    s_nop 0
    buffer_load_dwordx4 v238, s[40:43], s35 offen offset:0 nt lds
    v_mfma_f32_16x16x32_bf16 a[148:151], v[220:223], v[168:171], a[148:151]
    v_cvt_pk_bf16_f32 v185, v247, v248
    v_mfma_f32_16x16x32_bf16 a[156:159], v[220:223], v[172:175], a[156:159]
    s_waitcnt lgkmcnt(3)
    v_mfma_f32_16x16x32_bf16 a[160:163], v[224:227], v[160:163], a[160:163]
    ds_read_b128 v[220:223], v233 offset:36992
    v_mfma_f32_16x16x32_bf16 a[168:171], v[224:227], v[164:167], a[168:171]
    v_exp_f32 v247, v154
    v_mfma_f32_16x16x32_bf16 a[176:179], v[224:227], v[168:171], a[176:179]
    v_cvt_pk_bf16_f32 v188, v245, v246
    v_mfma_f32_16x16x32_bf16 a[184:187], v[224:227], v[172:175], a[184:187]
    v_exp_f32 v248, v155
    v_mfma_f32_16x16x32_bf16 a[164:167], v[228:231], v[160:163], a[164:167]
    ds_read_b128 v[224:227], v232 offset:37120
    v_mfma_f32_16x16x32_bf16 a[172:175], v[228:231], v[164:167], a[172:175]
    v_exp_f32 v245, v132
    v_mfma_f32_16x16x32_bf16 a[180:183], v[228:231], v[168:171], a[180:183]
    buffer_load_dwordx4 v239, s[40:43], s35 offen offset:1024 nt lds
    v_mfma_f32_16x16x32_bf16 a[188:191], v[228:231], v[172:175], a[188:191]
    v_exp_f32 v246, v133
    v_mfma_f32_16x16x32_bf16 a[192:195], a[208:211], v[160:163], a[192:195]
    v_cvt_pk_bf16_f32 v189, v247, v248
    v_mfma_f32_16x16x32_bf16 a[196:199], a[208:211], v[164:167], a[196:199]
    v_exp_f32 v247, v134
    v_mfma_f32_16x16x32_bf16 a[200:203], a[208:211], v[168:171], a[200:203]
    v_cvt_pk_bf16_f32 v178, v245, v246
    v_mfma_f32_16x16x32_bf16 a[204:207], a[208:211], v[172:175], a[204:207]
    s_waitcnt lgkmcnt(3)
    v_mfma_f32_16x16x32_bf16 v[96:99], v[208:211], v[0:3], v[192:195]
    ds_read_b128 v[228:231], v233 offset:37120
    buffer_load_dwordx4 v240, s[40:43], s35 offen offset:2048 nt lds
    v_mfma_f32_16x16x32_bf16 v[104:107], v[208:211], v[4:7], v[196:199]
    v_exp_f32 v248, v135
    v_mfma_f32_16x16x32_bf16 v[112:115], v[208:211], v[8:11], v[200:203]
    v_exp_f32 v245, v140
    v_mfma_f32_16x16x32_bf16 v[120:123], v[208:211], v[12:15], v[204:207]
    v_mfma_f32_16x16x32_bf16 v[96:99], v[212:215], v[16:19], v[96:99]
    ds_read_b128 v[208:211], v232 offset:43008
    v_mfma_f32_16x16x32_bf16 v[104:107], v[212:215], v[20:23], v[104:107]
    v_exp_f32 v246, v141
    v_mfma_f32_16x16x32_bf16 v[112:115], v[212:215], v[24:27], v[112:115]
    v_cvt_pk_bf16_f32 v179, v247, v248
    v_mfma_f32_16x16x32_bf16 v[120:123], v[212:215], v[28:31], v[120:123]
    s_waitcnt lgkmcnt(3)
    v_mfma_f32_16x16x32_bf16 v[96:99], v[216:219], v[32:35], v[96:99]
    ds_read_b128 v[212:215], v233 offset:43008
    v_mfma_f32_16x16x32_bf16 v[104:107], v[216:219], v[36:39], v[104:107]
    v_exp_f32 v247, v142
    v_mfma_f32_16x16x32_bf16 v[112:115], v[216:219], v[40:43], v[112:115]
    s_add_u32 m0, s34, 52224
    s_nop 0
    buffer_load_dwordx4 v241, s[40:43], s35 offen offset:0 nt lds
    v_mfma_f32_16x16x32_bf16 v[120:123], v[216:219], v[44:47], v[120:123]
    v_cvt_pk_bf16_f32 v182, v245, v246
    v_mfma_f32_16x16x32_bf16 v[96:99], v[220:223], v[48:51], v[96:99]
    ds_read_b128 v[216:219], v232 offset:43136
    v_mfma_f32_16x16x32_bf16 v[104:107], v[220:223], v[52:55], v[104:107]
    v_exp_f32 v248, v143
    v_mfma_f32_16x16x32_bf16 v[112:115], v[220:223], v[56:59], v[112:115]
    v_exp_f32 v245, v148
    v_mfma_f32_16x16x32_bf16 v[120:123], v[220:223], v[60:63], v[120:123]
    s_waitcnt lgkmcnt(3)
    v_mfma_f32_16x16x32_bf16 v[96:99], v[224:227], v[64:67], v[96:99]
    ds_read_b128 v[220:223], v233 offset:43136
    v_mfma_f32_16x16x32_bf16 v[104:107], v[224:227], v[68:71], v[104:107]
    v_exp_f32 v246, v149
    v_mfma_f32_16x16x32_bf16 v[112:115], v[224:227], v[72:75], v[112:115]
    buffer_load_dwordx4 v242, s[40:43], s35 offen offset:1024 nt lds
    v_cvt_pk_bf16_f32 v183, v247, v248
    v_mfma_f32_16x16x32_bf16 v[120:123], v[224:227], v[76:79], v[120:123]
    v_exp_f32 v247, v150
    v_mfma_f32_16x16x32_bf16 v[96:99], v[228:231], v[80:83], v[96:99]
    ds_read_b128 v[224:227], v232 offset:43264
    v_cvt_pk_bf16_f32 v186, v245, v246
    v_mfma_f32_16x16x32_bf16 v[104:107], v[228:231], v[84:87], v[104:107]
    v_exp_f32 v248, v151
    v_mfma_f32_16x16x32_bf16 v[112:115], v[228:231], v[88:91], v[112:115]
    v_mfma_f32_16x16x32_bf16 v[120:123], v[228:231], v[92:95], v[120:123]
    s_waitcnt lgkmcnt(3)
    v_mfma_f32_16x16x32_bf16 v[100:103], v[208:211], v[0:3], v[192:195]
    ds_read_b128 v[228:231], v233 offset:43264
    v_mfma_f32_16x16x32_bf16 v[108:111], v[208:211], v[4:7], v[196:199]
    buffer_load_dwordx4 v243, s[40:43], s35 offen offset:2048 nt lds
    s_add_u32 s35, s35, 12288
    v_mfma_f32_16x16x32_bf16 v[116:119], v[208:211], v[8:11], v[200:203]
    v_exp_f32 v245, v156
    v_mfma_f32_16x16x32_bf16 v[124:127], v[208:211], v[12:15], v[204:207]
    v_exp_f32 v246, v157
    v_mfma_f32_16x16x32_bf16 v[100:103], v[212:215], v[16:19], v[100:103]
    v_add_u32 v234, 0xc000, v234
    v_add_u32 v235, 0xc000, v235
    v_add_u32 v236, 0xc000, v236
    v_add_u32 v237, 0xc000, v237
    ds_read_b64_tr_b16 v[208:209], v234 offset:0
    ds_read_b64_tr_b16 v[210:211], v234 offset:6144
    v_mfma_f32_16x16x32_bf16 v[108:111], v[212:215], v[20:23], v[108:111]
    v_cvt_pk_bf16_f32 v187, v247, v248
    v_mfma_f32_16x16x32_bf16 v[116:119], v[212:215], v[24:27], v[116:119]
    v_exp_f32 v247, v158
    v_mfma_f32_16x16x32_bf16 v[124:127], v[212:215], v[28:31], v[124:127]
    v_cvt_pk_bf16_f32 v190, v245, v246
    s_waitcnt lgkmcnt(4)
    v_mfma_f32_16x16x32_bf16 v[100:103], v[216:219], v[32:35], v[100:103]
    ds_read_b64_tr_b16 v[212:213], v235 offset:0
    ds_read_b64_tr_b16 v[214:215], v235 offset:6144
    v_mfma_f32_16x16x32_bf16 v[108:111], v[216:219], v[36:39], v[108:111]
    v_exp_f32 v248, v159
    v_mfma_f32_16x16x32_bf16 v[116:119], v[216:219], v[40:43], v[116:119]
    s_nop 0
    v_cvt_pk_bf16_f32 v191, v247, v248
    v_mfma_f32_16x16x32_bf16 v[124:127], v[216:219], v[44:47], v[124:127]
    v_mfma_f32_16x16x32_bf16 v[100:103], v[220:223], v[48:51], v[100:103]
    ds_read_b64_tr_b16 v[216:217], v236 offset:0
    ds_read_b64_tr_b16 v[218:219], v236 offset:6144
    v_mfma_f32_16x16x32_bf16 v[108:111], v[220:223], v[52:55], v[108:111]
    v_or3_b32 v245, v176, v177, v178
    v_or3_b32 v245, v245, v179, v180
    v_mfma_f32_16x16x32_bf16 v[116:119], v[220:223], v[56:59], v[116:119]
    v_or3_b32 v245, v245, v181, v182
    v_mfma_f32_16x16x32_bf16 v[124:127], v[220:223], v[60:63], v[124:127]
    s_waitcnt lgkmcnt(6)
    v_mfma_f32_16x16x32_bf16 v[100:103], v[224:227], v[64:67], v[100:103]
    ds_read_b64_tr_b16 v[220:221], v237 offset:0
    ds_read_b64_tr_b16 v[222:223], v237 offset:6144
    v_mfma_f32_16x16x32_bf16 v[108:111], v[224:227], v[68:71], v[108:111]
    v_or3_b32 v245, v245, v183, v184
    v_or3_b32 v245, v245, v185, v186
    v_mfma_f32_16x16x32_bf16 v[116:119], v[224:227], v[72:75], v[116:119]
    v_or3_b32 v245, v245, v187, v188
    v_mfma_f32_16x16x32_bf16 v[124:127], v[224:227], v[76:79], v[124:127]
    v_mfma_f32_16x16x32_bf16 v[100:103], v[228:231], v[80:83], v[100:103]
    ds_read_b64_tr_b16 v[224:225], v234 offset:128
    ds_read_b64_tr_b16 v[226:227], v234 offset:6272
    v_or3_b32 v245, v245, v189, v190
    v_mfma_f32_16x16x32_bf16 v[108:111], v[228:231], v[84:87], v[108:111]
    v_or_b32 v245, v245, v191
    v_and_b32 v245, 0x40004000, v245
    v_mfma_f32_16x16x32_bf16 v[116:119], v[228:231], v[88:91], v[116:119]
    v_mfma_f32_16x16x32_bf16 v[124:127], v[228:231], v[92:95], v[124:127]
    v_cmp_ne_u32 vcc, 0, v245
    s_cbranch_vccnz Lrare_L3
Lrare_L3_back:
    s_waitcnt lgkmcnt(6)
    v_mfma_f32_16x16x32_bf16 a[0:3], v[208:211], v[176:179], a[0:3]
    ds_read_b64_tr_b16 v[228:229], v235 offset:128
    ds_read_b64_tr_b16 v[230:231], v235 offset:6272
    v_mfma_f32_16x16x32_bf16 a[8:11], v[208:211], v[180:183], a[8:11]
    v_exp_f32 v245, v96
    v_mfma_f32_16x16x32_bf16 a[16:19], v[208:211], v[184:187], a[16:19]
    v_exp_f32 v246, v97
    v_mfma_f32_16x16x32_bf16 a[24:27], v[208:211], v[188:191], a[24:27]
    v_mfma_f32_16x16x32_bf16 a[4:7], v[212:215], v[176:179], a[4:7]
    ds_read_b64_tr_b16 v[208:209], v236 offset:128
    ds_read_b64_tr_b16 v[210:211], v236 offset:6272
    v_mfma_f32_16x16x32_bf16 a[12:15], v[212:215], v[180:183], a[12:15]
    v_exp_f32 v247, v98
    v_mfma_f32_16x16x32_bf16 a[20:23], v[212:215], v[184:187], a[20:23]
    v_cvt_pk_bf16_f32 v160, v245, v246
    v_mfma_f32_16x16x32_bf16 a[28:31], v[212:215], v[188:191], a[28:31]
    s_waitcnt lgkmcnt(6)
    v_mfma_f32_16x16x32_bf16 a[32:35], v[216:219], v[176:179], a[32:35]
    ds_read_b64_tr_b16 v[212:213], v237 offset:128
    ds_read_b64_tr_b16 v[214:215], v237 offset:6272
    v_mfma_f32_16x16x32_bf16 a[40:43], v[216:219], v[180:183], a[40:43]
    v_exp_f32 v248, v99
    v_mfma_f32_16x16x32_bf16 a[48:51], v[216:219], v[184:187], a[48:51]
    v_exp_f32 v245, v104
    v_mfma_f32_16x16x32_bf16 a[56:59], v[216:219], v[188:191], a[56:59]
    v_mfma_f32_16x16x32_bf16 a[36:39], v[220:223], v[176:179], a[36:39]
    ds_read_b64_tr_b16 v[216:217], v234 offset:256
    ds_read_b64_tr_b16 v[218:219], v234 offset:6400
    v_mfma_f32_16x16x32_bf16 a[44:47], v[220:223], v[180:183], a[44:47]
    v_exp_f32 v246, v105
    v_mfma_f32_16x16x32_bf16 a[52:55], v[220:223], v[184:187], a[52:55]
    v_cvt_pk_bf16_f32 v161, v247, v248
    v_mfma_f32_16x16x32_bf16 a[60:63], v[220:223], v[188:191], a[60:63]
    s_waitcnt lgkmcnt(6)
    v_mfma_f32_16x16x32_bf16 a[64:67], v[224:227], v[176:179], a[64:67]
    ds_read_b64_tr_b16 v[220:221], v235 offset:256
    ds_read_b64_tr_b16 v[222:223], v235 offset:6400
    v_mfma_f32_16x16x32_bf16 a[72:75], v[224:227], v[180:183], a[72:75]
    v_exp_f32 v247, v106
    v_mfma_f32_16x16x32_bf16 a[80:83], v[224:227], v[184:187], a[80:83]
    v_cvt_pk_bf16_f32 v164, v245, v246
    v_mfma_f32_16x16x32_bf16 a[88:91], v[224:227], v[188:191], a[88:91]
    v_exp_f32 v248, v107
    v_mfma_f32_16x16x32_bf16 a[68:71], v[228:231], v[176:179], a[68:71]
    ds_read_b64_tr_b16 v[224:225], v236 offset:256
    ds_read_b64_tr_b16 v[226:227], v236 offset:6400
    v_mfma_f32_16x16x32_bf16 a[76:79], v[228:231], v[180:183], a[76:79]
    v_exp_f32 v245, v112
    v_mfma_f32_16x16x32_bf16 a[84:87], v[228:231], v[184:187], a[84:87]
    v_exp_f32 v246, v113
    v_mfma_f32_16x16x32_bf16 a[92:95], v[228:231], v[188:191], a[92:95]
    s_waitcnt lgkmcnt(6)
    v_mfma_f32_16x16x32_bf16 a[96:99], v[208:211], v[176:179], a[96:99]
    ds_read_b64_tr_b16 v[228:229], v237 offset:256
    ds_read_b64_tr_b16 v[230:231], v237 offset:6400
    v_mfma_f32_16x16x32_bf16 a[104:107], v[208:211], v[180:183], a[104:107]
    v_cvt_pk_bf16_f32 v165, v247, v248
    v_mfma_f32_16x16x32_bf16 a[112:115], v[208:211], v[184:187], a[112:115]
    v_exp_f32 v247, v114
    v_mfma_f32_16x16x32_bf16 a[120:123], v[208:211], v[188:191], a[120:123]
    v_mfma_f32_16x16x32_bf16 a[100:103], v[212:215], v[176:179], a[100:103]
    v_add_u32 v232, 0xc000, v232
    v_add_u32 v233, 0xc000, v233
    ds_read_b128 v[208:211], v232 offset:12288
    v_cvt_pk_bf16_f32 v168, v245, v246
    v_mfma_f32_16x16x32_bf16 a[108:111], v[212:215], v[180:183], a[108:111]
    v_exp_f32 v248, v115
    v_mfma_f32_16x16x32_bf16 a[116:119], v[212:215], v[184:187], a[116:119]
    v_mfma_f32_16x16x32_bf16 a[124:127], v[212:215], v[188:191], a[124:127]
    s_waitcnt lgkmcnt(5)
    v_mfma_f32_16x16x32_bf16 a[128:131], v[216:219], v[176:179], a[128:131]
    ds_read_b128 v[212:215], v233 offset:12288
    v_mfma_f32_16x16x32_bf16 a[136:139], v[216:219], v[180:183], a[136:139]
    v_exp_f32 v245, v120
    v_mfma_f32_16x16x32_bf16 a[144:147], v[216:219], v[184:187], a[144:147]
    v_exp_f32 v246, v121
    v_mfma_f32_16x16x32_bf16 a[152:155], v[216:219], v[188:191], a[152:155]
    s_waitcnt vmcnt(18)
    s_barrier
    v_mfma_f32_16x16x32_bf16 a[132:135], v[220:223], v[176:179], a[132:135]
    ds_read_b128 v[216:219], v232 offset:12416
    v_mfma_f32_16x16x32_bf16 a[140:143], v[220:223], v[180:183], a[140:143]
    s_add_u32 m0, s34, 73728
    s_nop 0
    buffer_load_dwordx4 v238, s[40:43], s35 offen offset:0 nt lds
    v_mfma_f32_16x16x32_bf16 a[148:151], v[220:223], v[184:187], a[148:151]
    v_cvt_pk_bf16_f32 v169, v247, v248
    v_mfma_f32_16x16x32_bf16 a[156:159], v[220:223], v[188:191], a[156:159]
    s_waitcnt lgkmcnt(3)
    v_mfma_f32_16x16x32_bf16 a[160:163], v[224:227], v[176:179], a[160:163]
    ds_read_b128 v[220:223], v233 offset:12416
    v_mfma_f32_16x16x32_bf16 a[168:171], v[224:227], v[180:183], a[168:171]
    v_exp_f32 v247, v122
    v_mfma_f32_16x16x32_bf16 a[176:179], v[224:227], v[184:187], a[176:179]
    v_cvt_pk_bf16_f32 v172, v245, v246
    v_mfma_f32_16x16x32_bf16 a[184:187], v[224:227], v[188:191], a[184:187]
    v_exp_f32 v248, v123
    v_mfma_f32_16x16x32_bf16 a[164:167], v[228:231], v[176:179], a[164:167]
    ds_read_b128 v[224:227], v232 offset:12544
    v_mfma_f32_16x16x32_bf16 a[172:175], v[228:231], v[180:183], a[172:175]
    v_exp_f32 v245, v100
    v_mfma_f32_16x16x32_bf16 a[180:183], v[228:231], v[184:187], a[180:183]
    buffer_load_dwordx4 v239, s[40:43], s35 offen offset:1024 nt lds
    v_mfma_f32_16x16x32_bf16 a[188:191], v[228:231], v[188:191], a[188:191]
    v_exp_f32 v246, v101
    v_mfma_f32_16x16x32_bf16 a[192:195], a[208:211], v[176:179], a[192:195]
    v_cvt_pk_bf16_f32 v173, v247, v248
    v_mfma_f32_16x16x32_bf16 a[196:199], a[208:211], v[180:183], a[196:199]
    v_exp_f32 v247, v102
    v_mfma_f32_16x16x32_bf16 a[200:203], a[208:211], v[184:187], a[200:203]
    v_cvt_pk_bf16_f32 v162, v245, v246
    v_mfma_f32_16x16x32_bf16 a[204:207], a[208:211], v[188:191], a[204:207]
    s_waitcnt lgkmcnt(3)
    v_mfma_f32_16x16x32_bf16 v[128:131], v[208:211], v[0:3], v[192:195]
    ds_read_b128 v[228:231], v233 offset:12544
    buffer_load_dwordx4 v240, s[40:43], s35 offen offset:2048 nt lds
    v_mfma_f32_16x16x32_bf16 v[136:139], v[208:211], v[4:7], v[196:199]
    v_exp_f32 v248, v103
    v_mfma_f32_16x16x32_bf16 v[144:147], v[208:211], v[8:11], v[200:203]
    v_exp_f32 v245, v108
    v_mfma_f32_16x16x32_bf16 v[152:155], v[208:211], v[12:15], v[204:207]
    v_mfma_f32_16x16x32_bf16 v[128:131], v[212:215], v[16:19], v[128:131]
    ds_read_b128 v[208:211], v232 offset:18432
    v_mfma_f32_16x16x32_bf16 v[136:139], v[212:215], v[20:23], v[136:139]
    v_exp_f32 v246, v109
    v_mfma_f32_16x16x32_bf16 v[144:147], v[212:215], v[24:27], v[144:147]
    v_cvt_pk_bf16_f32 v163, v247, v248
    v_mfma_f32_16x16x32_bf16 v[152:155], v[212:215], v[28:31], v[152:155]
    s_waitcnt lgkmcnt(3)
    v_mfma_f32_16x16x32_bf16 v[128:131], v[216:219], v[32:35], v[128:131]
    ds_read_b128 v[212:215], v233 offset:18432
    v_mfma_f32_16x16x32_bf16 v[136:139], v[216:219], v[36:39], v[136:139]
    v_exp_f32 v247, v110
    v_mfma_f32_16x16x32_bf16 v[144:147], v[216:219], v[40:43], v[144:147]
    s_add_u32 m0, s34, 76800
    s_nop 0
    buffer_load_dwordx4 v241, s[40:43], s35 offen offset:0 nt lds
    v_mfma_f32_16x16x32_bf16 v[152:155], v[216:219], v[44:47], v[152:155]
    v_cvt_pk_bf16_f32 v166, v245, v246
    v_mfma_f32_16x16x32_bf16 v[128:131], v[220:223], v[48:51], v[128:131]
    ds_read_b128 v[216:219], v232 offset:18560
    v_mfma_f32_16x16x32_bf16 v[136:139], v[220:223], v[52:55], v[136:139]
    v_exp_f32 v248, v111
    v_mfma_f32_16x16x32_bf16 v[144:147], v[220:223], v[56:59], v[144:147]
    v_exp_f32 v245, v116
    v_mfma_f32_16x16x32_bf16 v[152:155], v[220:223], v[60:63], v[152:155]
    s_waitcnt lgkmcnt(3)
    v_mfma_f32_16x16x32_bf16 v[128:131], v[224:227], v[64:67], v[128:131]
    ds_read_b128 v[220:223], v233 offset:18560
    v_mfma_f32_16x16x32_bf16 v[136:139], v[224:227], v[68:71], v[136:139]
    v_exp_f32 v246, v117
    v_mfma_f32_16x16x32_bf16 v[144:147], v[224:227], v[72:75], v[144:147]
    buffer_load_dwordx4 v242, s[40:43], s35 offen offset:1024 nt lds
    v_cvt_pk_bf16_f32 v167, v247, v248
    v_mfma_f32_16x16x32_bf16 v[152:155], v[224:227], v[76:79], v[152:155]
    v_exp_f32 v247, v118
    v_mfma_f32_16x16x32_bf16 v[128:131], v[228:231], v[80:83], v[128:131]
    ds_read_b128 v[224:227], v232 offset:18688
    v_cvt_pk_bf16_f32 v170, v245, v246
    v_mfma_f32_16x16x32_bf16 v[136:139], v[228:231], v[84:87], v[136:139]
    v_exp_f32 v248, v119
    v_mfma_f32_16x16x32_bf16 v[144:147], v[228:231], v[88:91], v[144:147]
    v_mfma_f32_16x16x32_bf16 v[152:155], v[228:231], v[92:95], v[152:155]
    s_waitcnt lgkmcnt(3)
    v_mfma_f32_16x16x32_bf16 v[132:135], v[208:211], v[0:3], v[192:195]
    ds_read_b128 v[228:231], v233 offset:18688
    v_mfma_f32_16x16x32_bf16 v[140:143], v[208:211], v[4:7], v[196:199]
    buffer_load_dwordx4 v243, s[40:43], s35 offen offset:2048 nt lds
    s_add_u32 s35, s35, 12288
    v_mfma_f32_16x16x32_bf16 v[148:151], v[208:211], v[8:11], v[200:203]
    v_exp_f32 v245, v124
    v_mfma_f32_16x16x32_bf16 v[156:159], v[208:211], v[12:15], v[204:207]
    v_exp_f32 v246, v125
    v_mfma_f32_16x16x32_bf16 v[132:135], v[212:215], v[16:19], v[132:135]
    ds_read_b64_tr_b16 v[208:209], v234 offset:24576
    ds_read_b64_tr_b16 v[210:211], v234 offset:30720
    v_mfma_f32_16x16x32_bf16 v[140:143], v[212:215], v[20:23], v[140:143]
    v_cvt_pk_bf16_f32 v171, v247, v248
    v_mfma_f32_16x16x32_bf16 v[148:151], v[212:215], v[24:27], v[148:151]
    v_exp_f32 v247, v126
    v_mfma_f32_16x16x32_bf16 v[156:159], v[212:215], v[28:31], v[156:159]
    v_cvt_pk_bf16_f32 v174, v245, v246
    s_waitcnt lgkmcnt(4)
    v_mfma_f32_16x16x32_bf16 v[132:135], v[216:219], v[32:35], v[132:135]
    ds_read_b64_tr_b16 v[212:213], v235 offset:24576
    ds_read_b64_tr_b16 v[214:215], v235 offset:30720
    v_mfma_f32_16x16x32_bf16 v[140:143], v[216:219], v[36:39], v[140:143]
    v_exp_f32 v248, v127
    v_mfma_f32_16x16x32_bf16 v[148:151], v[216:219], v[40:43], v[148:151]
    s_nop 0
    v_cvt_pk_bf16_f32 v175, v247, v248
    v_mfma_f32_16x16x32_bf16 v[156:159], v[216:219], v[44:47], v[156:159]
    v_mfma_f32_16x16x32_bf16 v[132:135], v[220:223], v[48:51], v[132:135]
    ds_read_b64_tr_b16 v[216:217], v236 offset:24576
    ds_read_b64_tr_b16 v[218:219], v236 offset:30720
    v_mfma_f32_16x16x32_bf16 v[140:143], v[220:223], v[52:55], v[140:143]
    v_or3_b32 v245, v160, v161, v162
    v_or3_b32 v245, v245, v163, v164
    v_mfma_f32_16x16x32_bf16 v[148:151], v[220:223], v[56:59], v[148:151]
    v_or3_b32 v245, v245, v165, v166
    v_mfma_f32_16x16x32_bf16 v[156:159], v[220:223], v[60:63], v[156:159]
    s_waitcnt lgkmcnt(6)
    v_mfma_f32_16x16x32_bf16 v[132:135], v[224:227], v[64:67], v[132:135]
    ds_read_b64_tr_b16 v[220:221], v237 offset:24576
    ds_read_b64_tr_b16 v[222:223], v237 offset:30720
    v_mfma_f32_16x16x32_bf16 v[140:143], v[224:227], v[68:71], v[140:143]
    v_or3_b32 v245, v245, v167, v168
    v_or3_b32 v245, v245, v169, v170
    v_mfma_f32_16x16x32_bf16 v[148:151], v[224:227], v[72:75], v[148:151]
    v_or3_b32 v245, v245, v171, v172
    v_mfma_f32_16x16x32_bf16 v[156:159], v[224:227], v[76:79], v[156:159]
    v_mfma_f32_16x16x32_bf16 v[132:135], v[228:231], v[80:83], v[132:135]
    ds_read_b64_tr_b16 v[224:225], v234 offset:24704
    ds_read_b64_tr_b16 v[226:227], v234 offset:30848
    v_or3_b32 v245, v245, v173, v174
    v_mfma_f32_16x16x32_bf16 v[140:143], v[228:231], v[84:87], v[140:143]
    v_or_b32 v245, v245, v175
    v_and_b32 v245, 0x40004000, v245
    v_mfma_f32_16x16x32_bf16 v[148:151], v[228:231], v[88:91], v[148:151]
    v_mfma_f32_16x16x32_bf16 v[156:159], v[228:231], v[92:95], v[156:159]
    v_cmp_ne_u32 vcc, 0, v245
    s_cbranch_vccnz Lrare_L4
Lrare_L4_back:
    s_waitcnt lgkmcnt(6)
    v_mfma_f32_16x16x32_bf16 a[0:3], v[208:211], v[160:163], a[0:3]
    ds_read_b64_tr_b16 v[228:229], v235 offset:24704
    ds_read_b64_tr_b16 v[230:231], v235 offset:30848
    v_mfma_f32_16x16x32_bf16 a[8:11], v[208:211], v[164:167], a[8:11]
    v_exp_f32 v245, v128
    v_mfma_f32_16x16x32_bf16 a[16:19], v[208:211], v[168:171], a[16:19]
    v_exp_f32 v246, v129
    v_mfma_f32_16x16x32_bf16 a[24:27], v[208:211], v[172:175], a[24:27]
    v_mfma_f32_16x16x32_bf16 a[4:7], v[212:215], v[160:163], a[4:7]
    ds_read_b64_tr_b16 v[208:209], v236 offset:24704
    ds_read_b64_tr_b16 v[210:211], v236 offset:30848
    v_mfma_f32_16x16x32_bf16 a[12:15], v[212:215], v[164:167], a[12:15]
    v_exp_f32 v247, v130
    v_mfma_f32_16x16x32_bf16 a[20:23], v[212:215], v[168:171], a[20:23]
    v_cvt_pk_bf16_f32 v176, v245, v246
    v_mfma_f32_16x16x32_bf16 a[28:31], v[212:215], v[172:175], a[28:31]
    s_waitcnt lgkmcnt(6)
    v_mfma_f32_16x16x32_bf16 a[32:35], v[216:219], v[160:163], a[32:35]
    ds_read_b64_tr_b16 v[212:213], v237 offset:24704
    ds_read_b64_tr_b16 v[214:215], v237 offset:30848
    v_mfma_f32_16x16x32_bf16 a[40:43], v[216:219], v[164:167], a[40:43]
    v_exp_f32 v248, v131
    v_mfma_f32_16x16x32_bf16 a[48:51], v[216:219], v[168:171], a[48:51]
    v_exp_f32 v245, v136
    v_mfma_f32_16x16x32_bf16 a[56:59], v[216:219], v[172:175], a[56:59]
    v_mfma_f32_16x16x32_bf16 a[36:39], v[220:223], v[160:163], a[36:39]
    ds_read_b64_tr_b16 v[216:217], v234 offset:24832
    ds_read_b64_tr_b16 v[218:219], v234 offset:30976
    v_mfma_f32_16x16x32_bf16 a[44:47], v[220:223], v[164:167], a[44:47]
    v_exp_f32 v246, v137
    v_mfma_f32_16x16x32_bf16 a[52:55], v[220:223], v[168:171], a[52:55]
    v_cvt_pk_bf16_f32 v177, v247, v248
    v_mfma_f32_16x16x32_bf16 a[60:63], v[220:223], v[172:175], a[60:63]
    s_waitcnt lgkmcnt(6)
    v_mfma_f32_16x16x32_bf16 a[64:67], v[224:227], v[160:163], a[64:67]
    ds_read_b64_tr_b16 v[220:221], v235 offset:24832
    ds_read_b64_tr_b16 v[222:223], v235 offset:30976
    v_mfma_f32_16x16x32_bf16 a[72:75], v[224:227], v[164:167], a[72:75]
    v_exp_f32 v247, v138
    v_mfma_f32_16x16x32_bf16 a[80:83], v[224:227], v[168:171], a[80:83]
    v_cvt_pk_bf16_f32 v180, v245, v246
    v_mfma_f32_16x16x32_bf16 a[88:91], v[224:227], v[172:175], a[88:91]
    v_exp_f32 v248, v139
    v_mfma_f32_16x16x32_bf16 a[68:71], v[228:231], v[160:163], a[68:71]
    ds_read_b64_tr_b16 v[224:225], v236 offset:24832
    ds_read_b64_tr_b16 v[226:227], v236 offset:30976
    v_mfma_f32_16x16x32_bf16 a[76:79], v[228:231], v[164:167], a[76:79]
    v_exp_f32 v245, v144
    v_mfma_f32_16x16x32_bf16 a[84:87], v[228:231], v[168:171], a[84:87]
    v_exp_f32 v246, v145
    v_mfma_f32_16x16x32_bf16 a[92:95], v[228:231], v[172:175], a[92:95]
    s_waitcnt lgkmcnt(6)
    v_mfma_f32_16x16x32_bf16 a[96:99], v[208:211], v[160:163], a[96:99]
    ds_read_b64_tr_b16 v[228:229], v237 offset:24832
    ds_read_b64_tr_b16 v[230:231], v237 offset:30976
    v_mfma_f32_16x16x32_bf16 a[104:107], v[208:211], v[164:167], a[104:107]
    v_cvt_pk_bf16_f32 v181, v247, v248
    v_mfma_f32_16x16x32_bf16 a[112:115], v[208:211], v[168:171], a[112:115]
    v_exp_f32 v247, v146
    v_mfma_f32_16x16x32_bf16 a[120:123], v[208:211], v[172:175], a[120:123]
    v_mfma_f32_16x16x32_bf16 a[100:103], v[212:215], v[160:163], a[100:103]
    ds_read_b128 v[208:211], v232 offset:36864
    v_cvt_pk_bf16_f32 v184, v245, v246
    v_mfma_f32_16x16x32_bf16 a[108:111], v[212:215], v[164:167], a[108:111]
    v_exp_f32 v248, v147
    v_mfma_f32_16x16x32_bf16 a[116:119], v[212:215], v[168:171], a[116:119]
    v_mfma_f32_16x16x32_bf16 a[124:127], v[212:215], v[172:175], a[124:127]
    s_waitcnt lgkmcnt(5)
    v_mfma_f32_16x16x32_bf16 a[128:131], v[216:219], v[160:163], a[128:131]
    ds_read_b128 v[212:215], v233 offset:36864
    v_mfma_f32_16x16x32_bf16 a[136:139], v[216:219], v[164:167], a[136:139]
    v_exp_f32 v245, v152
    v_mfma_f32_16x16x32_bf16 a[144:147], v[216:219], v[168:171], a[144:147]
    v_exp_f32 v246, v153
    v_mfma_f32_16x16x32_bf16 a[152:155], v[216:219], v[172:175], a[152:155]
    s_waitcnt vmcnt(18)
    s_barrier
    v_mfma_f32_16x16x32_bf16 a[132:135], v[220:223], v[160:163], a[132:135]
    ds_read_b128 v[216:219], v232 offset:36992
    v_mfma_f32_16x16x32_bf16 a[140:143], v[220:223], v[164:167], a[140:143]
    s_add_u32 m0, s34, 98304
    s_nop 0
    buffer_load_dwordx4 v238, s[40:43], s35 offen offset:0 nt lds
    v_mfma_f32_16x16x32_bf16 a[148:151], v[220:223], v[168:171], a[148:151]
    v_cvt_pk_bf16_f32 v185, v247, v248
    v_mfma_f32_16x16x32_bf16 a[156:159], v[220:223], v[172:175], a[156:159]
    s_waitcnt lgkmcnt(3)
    v_mfma_f32_16x16x32_bf16 a[160:163], v[224:227], v[160:163], a[160:163]
    ds_read_b128 v[220:223], v233 offset:36992
    v_mfma_f32_16x16x32_bf16 a[168:171], v[224:227], v[164:167], a[168:171]
    v_exp_f32 v247, v154
    v_mfma_f32_16x16x32_bf16 a[176:179], v[224:227], v[168:171], a[176:179]
    v_cvt_pk_bf16_f32 v188, v245, v246
    v_mfma_f32_16x16x32_bf16 a[184:187], v[224:227], v[172:175], a[184:187]
    v_exp_f32 v248, v155
    v_mfma_f32_16x16x32_bf16 a[164:167], v[228:231], v[160:163], a[164:167]
    ds_read_b128 v[224:227], v232 offset:37120
    v_mfma_f32_16x16x32_bf16 a[172:175], v[228:231], v[164:167], a[172:175]
    v_exp_f32 v245, v132
    v_mfma_f32_16x16x32_bf16 a[180:183], v[228:231], v[168:171], a[180:183]
    buffer_load_dwordx4 v239, s[40:43], s35 offen offset:1024 nt lds
    v_mfma_f32_16x16x32_bf16 a[188:191], v[228:231], v[172:175], a[188:191]
    v_exp_f32 v246, v133
    v_mfma_f32_16x16x32_bf16 a[192:195], a[208:211], v[160:163], a[192:195]
    v_cvt_pk_bf16_f32 v189, v247, v248
    v_mfma_f32_16x16x32_bf16 a[196:199], a[208:211], v[164:167], a[196:199]
    v_exp_f32 v247, v134
    v_mfma_f32_16x16x32_bf16 a[200:203], a[208:211], v[168:171], a[200:203]
    v_cvt_pk_bf16_f32 v178, v245, v246
    v_mfma_f32_16x16x32_bf16 a[204:207], a[208:211], v[172:175], a[204:207]
    s_waitcnt lgkmcnt(3)
    v_mfma_f32_16x16x32_bf16 v[96:99], v[208:211], v[0:3], v[192:195]
    ds_read_b128 v[228:231], v233 offset:37120
    buffer_load_dwordx4 v240, s[40:43], s35 offen offset:2048 nt lds
    v_mfma_f32_16x16x32_bf16 v[104:107], v[208:211], v[4:7], v[196:199]
    v_exp_f32 v248, v135
    v_mfma_f32_16x16x32_bf16 v[112:115], v[208:211], v[8:11], v[200:203]
    v_exp_f32 v245, v140
    v_mfma_f32_16x16x32_bf16 v[120:123], v[208:211], v[12:15], v[204:207]
    v_mfma_f32_16x16x32_bf16 v[96:99], v[212:215], v[16:19], v[96:99]
    ds_read_b128 v[208:211], v232 offset:43008
    v_mfma_f32_16x16x32_bf16 v[104:107], v[212:215], v[20:23], v[104:107]
    v_exp_f32 v246, v141
    v_mfma_f32_16x16x32_bf16 v[112:115], v[212:215], v[24:27], v[112:115]
    v_cvt_pk_bf16_f32 v179, v247, v248
    v_mfma_f32_16x16x32_bf16 v[120:123], v[212:215], v[28:31], v[120:123]
    s_waitcnt lgkmcnt(3)
    v_mfma_f32_16x16x32_bf16 v[96:99], v[216:219], v[32:35], v[96:99]
    ds_read_b128 v[212:215], v233 offset:43008
    v_mfma_f32_16x16x32_bf16 v[104:107], v[216:219], v[36:39], v[104:107]
    v_exp_f32 v247, v142
    v_mfma_f32_16x16x32_bf16 v[112:115], v[216:219], v[40:43], v[112:115]
    s_add_u32 m0, s34, 101376
    s_nop 0
    buffer_load_dwordx4 v241, s[40:43], s35 offen offset:0 nt lds
    v_mfma_f32_16x16x32_bf16 v[120:123], v[216:219], v[44:47], v[120:123]
    v_cvt_pk_bf16_f32 v182, v245, v246
    v_mfma_f32_16x16x32_bf16 v[96:99], v[220:223], v[48:51], v[96:99]
    ds_read_b128 v[216:219], v232 offset:43136
    v_mfma_f32_16x16x32_bf16 v[104:107], v[220:223], v[52:55], v[104:107]
    v_exp_f32 v248, v143
    v_mfma_f32_16x16x32_bf16 v[112:115], v[220:223], v[56:59], v[112:115]
    v_exp_f32 v245, v148
    v_mfma_f32_16x16x32_bf16 v[120:123], v[220:223], v[60:63], v[120:123]
    s_waitcnt lgkmcnt(3)
    v_mfma_f32_16x16x32_bf16 v[96:99], v[224:227], v[64:67], v[96:99]
    ds_read_b128 v[220:223], v233 offset:43136
    v_mfma_f32_16x16x32_bf16 v[104:107], v[224:227], v[68:71], v[104:107]
    v_exp_f32 v246, v149
    v_mfma_f32_16x16x32_bf16 v[112:115], v[224:227], v[72:75], v[112:115]
    buffer_load_dwordx4 v242, s[40:43], s35 offen offset:1024 nt lds
    v_cvt_pk_bf16_f32 v183, v247, v248
    v_mfma_f32_16x16x32_bf16 v[120:123], v[224:227], v[76:79], v[120:123]
    v_exp_f32 v247, v150
    v_mfma_f32_16x16x32_bf16 v[96:99], v[228:231], v[80:83], v[96:99]
    ds_read_b128 v[224:227], v232 offset:43264
    v_cvt_pk_bf16_f32 v186, v245, v246
    v_mfma_f32_16x16x32_bf16 v[104:107], v[228:231], v[84:87], v[104:107]
    v_exp_f32 v248, v151
    v_mfma_f32_16x16x32_bf16 v[112:115], v[228:231], v[88:91], v[112:115]
    v_mfma_f32_16x16x32_bf16 v[120:123], v[228:231], v[92:95], v[120:123]
    s_waitcnt lgkmcnt(3)
    v_mfma_f32_16x16x32_bf16 v[100:103], v[208:211], v[0:3], v[192:195]
    ds_read_b128 v[228:231], v233 offset:43264
    v_mfma_f32_16x16x32_bf16 v[108:111], v[208:211], v[4:7], v[196:199]
    buffer_load_dwordx4 v243, s[40:43], s35 offen offset:2048 nt lds
    s_add_u32 s35, s35, 12288
    v_mfma_f32_16x16x32_bf16 v[116:119], v[208:211], v[8:11], v[200:203]
    v_exp_f32 v245, v156
    v_mfma_f32_16x16x32_bf16 v[124:127], v[208:211], v[12:15], v[204:207]
    v_exp_f32 v246, v157
    v_mfma_f32_16x16x32_bf16 v[100:103], v[212:215], v[16:19], v[100:103]
    v_add_u32 v234, 0xfffe8000, v234
    v_add_u32 v235, 0xfffe8000, v235
    v_add_u32 v236, 0xfffe8000, v236
    v_add_u32 v237, 0xfffe8000, v237
    ds_read_b64_tr_b16 v[208:209], v234 offset:0
    ds_read_b64_tr_b16 v[210:211], v234 offset:6144
    v_mfma_f32_16x16x32_bf16 v[108:111], v[212:215], v[20:23], v[108:111]
    v_cvt_pk_bf16_f32 v187, v247, v248
    v_mfma_f32_16x16x32_bf16 v[116:119], v[212:215], v[24:27], v[116:119]
    v_exp_f32 v247, v158
    v_mfma_f32_16x16x32_bf16 v[124:127], v[212:215], v[28:31], v[124:127]
    v_cvt_pk_bf16_f32 v190, v245, v246
    s_waitcnt lgkmcnt(4)
    v_mfma_f32_16x16x32_bf16 v[100:103], v[216:219], v[32:35], v[100:103]
    ds_read_b64_tr_b16 v[212:213], v235 offset:0
    ds_read_b64_tr_b16 v[214:215], v235 offset:6144
    v_mfma_f32_16x16x32_bf16 v[108:111], v[216:219], v[36:39], v[108:111]
    v_exp_f32 v248, v159
    v_mfma_f32_16x16x32_bf16 v[116:119], v[216:219], v[40:43], v[116:119]
    s_nop 0
    v_cvt_pk_bf16_f32 v191, v247, v248
    v_mfma_f32_16x16x32_bf16 v[124:127], v[216:219], v[44:47], v[124:127]
    v_mfma_f32_16x16x32_bf16 v[100:103], v[220:223], v[48:51], v[100:103]
    ds_read_b64_tr_b16 v[216:217], v236 offset:0
    ds_read_b64_tr_b16 v[218:219], v236 offset:6144
    v_mfma_f32_16x16x32_bf16 v[108:111], v[220:223], v[52:55], v[108:111]
    v_or3_b32 v245, v176, v177, v178
    v_or3_b32 v245, v245, v179, v180
    v_mfma_f32_16x16x32_bf16 v[116:119], v[220:223], v[56:59], v[116:119]
    v_or3_b32 v245, v245, v181, v182
    v_mfma_f32_16x16x32_bf16 v[124:127], v[220:223], v[60:63], v[124:127]
    s_waitcnt lgkmcnt(6)
    v_mfma_f32_16x16x32_bf16 v[100:103], v[224:227], v[64:67], v[100:103]
    ds_read_b64_tr_b16 v[220:221], v237 offset:0
    ds_read_b64_tr_b16 v[222:223], v237 offset:6144
    v_mfma_f32_16x16x32_bf16 v[108:111], v[224:227], v[68:71], v[108:111]
    v_or3_b32 v245, v245, v183, v184
    v_or3_b32 v245, v245, v185, v186
    v_mfma_f32_16x16x32_bf16 v[116:119], v[224:227], v[72:75], v[116:119]
    v_or3_b32 v245, v245, v187, v188
    v_mfma_f32_16x16x32_bf16 v[124:127], v[224:227], v[76:79], v[124:127]
    v_mfma_f32_16x16x32_bf16 v[100:103], v[228:231], v[80:83], v[100:103]
    ds_read_b64_tr_b16 v[224:225], v234 offset:128
    ds_read_b64_tr_b16 v[226:227], v234 offset:6272
    v_or3_b32 v245, v245, v189, v190
    v_mfma_f32_16x16x32_bf16 v[108:111], v[228:231], v[84:87], v[108:111]
    v_or_b32 v245, v245, v191
    v_and_b32 v245, 0x40004000, v245
    v_mfma_f32_16x16x32_bf16 v[116:119], v[228:231], v[88:91], v[116:119]
    v_mfma_f32_16x16x32_bf16 v[124:127], v[228:231], v[92:95], v[124:127]
    v_cmp_ne_u32 vcc, 0, v245
    s_cbranch_vccnz Lrare_L5
Lrare_L5_back:
    s_sub_u32 s38, s38, 1
    s_cmp_lg_u32 s38, 0
    s_cbranch_scc1 Lloop
    s_waitcnt lgkmcnt(6)
    v_mfma_f32_16x16x32_bf16 a[0:3], v[208:211], v[176:179], a[0:3]
    ds_read_b64_tr_b16 v[228:229], v235 offset:128
    ds_read_b64_tr_b16 v[230:231], v235 offset:6272
    v_mfma_f32_16x16x32_bf16 a[8:11], v[208:211], v[180:183], a[8:11]
    v_exp_f32 v245, v96
    v_mfma_f32_16x16x32_bf16 a[16:19], v[208:211], v[184:187], a[16:19]
    v_exp_f32 v246, v97
    v_mfma_f32_16x16x32_bf16 a[24:27], v[208:211], v[188:191], a[24:27]
    v_mfma_f32_16x16x32_bf16 a[4:7], v[212:215], v[176:179], a[4:7]
    ds_read_b64_tr_b16 v[208:209], v236 offset:128
    ds_read_b64_tr_b16 v[210:211], v236 offset:6272
    v_mfma_f32_16x16x32_bf16 a[12:15], v[212:215], v[180:183], a[12:15]
    v_exp_f32 v247, v98
    v_mfma_f32_16x16x32_bf16 a[20:23], v[212:215], v[184:187], a[20:23]
    v_cvt_pk_bf16_f32 v160, v245, v246
    v_mfma_f32_16x16x32_bf16 a[28:31], v[212:215], v[188:191], a[28:31]
    s_waitcnt lgkmcnt(6)
    v_mfma_f32_16x16x32_bf16 a[32:35], v[216:219], v[176:179], a[32:35]
    ds_read_b64_tr_b16 v[212:213], v237 offset:128
    ds_read_b64_tr_b16 v[214:215], v237 offset:6272
    v_mfma_f32_16x16x32_bf16 a[40:43], v[216:219], v[180:183], a[40:43]
    v_exp_f32 v248, v99
    v_mfma_f32_16x16x32_bf16 a[48:51], v[216:219], v[184:187], a[48:51]
    v_exp_f32 v245, v104
    v_mfma_f32_16x16x32_bf16 a[56:59], v[216:219], v[188:191], a[56:59]
    v_mfma_f32_16x16x32_bf16 a[36:39], v[220:223], v[176:179], a[36:39]
    ds_read_b64_tr_b16 v[216:217], v234 offset:256
    ds_read_b64_tr_b16 v[218:219], v234 offset:6400
    v_mfma_f32_16x16x32_bf16 a[44:47], v[220:223], v[180:183], a[44:47]
    v_exp_f32 v246, v105
    v_mfma_f32_16x16x32_bf16 a[52:55], v[220:223], v[184:187], a[52:55]
    v_cvt_pk_bf16_f32 v161, v247, v248
    v_mfma_f32_16x16x32_bf16 a[60:63], v[220:223], v[188:191], a[60:63]
    s_waitcnt lgkmcnt(6)
    v_mfma_f32_16x16x32_bf16 a[64:67], v[224:227], v[176:179], a[64:67]
    ds_read_b64_tr_b16 v[220:221], v235 offset:256
    ds_read_b64_tr_b16 v[222:223], v235 offset:6400
    v_mfma_f32_16x16x32_bf16 a[72:75], v[224:227], v[180:183], a[72:75]
    v_exp_f32 v247, v106
    v_mfma_f32_16x16x32_bf16 a[80:83], v[224:227], v[184:187], a[80:83]
    v_cvt_pk_bf16_f32 v164, v245, v246
    v_mfma_f32_16x16x32_bf16 a[88:91], v[224:227], v[188:191], a[88:91]
    v_exp_f32 v248, v107
    v_mfma_f32_16x16x32_bf16 a[68:71], v[228:231], v[176:179], a[68:71]
    ds_read_b64_tr_b16 v[224:225], v236 offset:256
    ds_read_b64_tr_b16 v[226:227], v236 offset:6400
    v_mfma_f32_16x16x32_bf16 a[76:79], v[228:231], v[180:183], a[76:79]
    v_exp_f32 v245, v112
    v_mfma_f32_16x16x32_bf16 a[84:87], v[228:231], v[184:187], a[84:87]
    v_exp_f32 v246, v113
    v_mfma_f32_16x16x32_bf16 a[92:95], v[228:231], v[188:191], a[92:95]
    s_waitcnt lgkmcnt(6)
    v_mfma_f32_16x16x32_bf16 a[96:99], v[208:211], v[176:179], a[96:99]
    ds_read_b64_tr_b16 v[228:229], v237 offset:256
    ds_read_b64_tr_b16 v[230:231], v237 offset:6400
    v_mfma_f32_16x16x32_bf16 a[104:107], v[208:211], v[180:183], a[104:107]
    v_cvt_pk_bf16_f32 v165, v247, v248
    v_mfma_f32_16x16x32_bf16 a[112:115], v[208:211], v[184:187], a[112:115]
    v_exp_f32 v247, v114
    v_mfma_f32_16x16x32_bf16 a[120:123], v[208:211], v[188:191], a[120:123]
    v_mfma_f32_16x16x32_bf16 a[100:103], v[212:215], v[176:179], a[100:103]
    v_add_u32 v232, 0xfffe8000, v232
    v_add_u32 v233, 0xfffe8000, v233
    ds_read_b128 v[208:211], v232 offset:12288
    v_cvt_pk_bf16_f32 v168, v245, v246
    v_mfma_f32_16x16x32_bf16 a[108:111], v[212:215], v[180:183], a[108:111]
    v_exp_f32 v248, v115
    v_mfma_f32_16x16x32_bf16 a[116:119], v[212:215], v[184:187], a[116:119]
    v_mfma_f32_16x16x32_bf16 a[124:127], v[212:215], v[188:191], a[124:127]
    s_waitcnt lgkmcnt(5)
    v_mfma_f32_16x16x32_bf16 a[128:131], v[216:219], v[176:179], a[128:131]
    ds_read_b128 v[212:215], v233 offset:12288
    v_mfma_f32_16x16x32_bf16 a[136:139], v[216:219], v[180:183], a[136:139]
    v_exp_f32 v245, v120
    v_mfma_f32_16x16x32_bf16 a[144:147], v[216:219], v[184:187], a[144:147]
    v_exp_f32 v246, v121
    v_mfma_f32_16x16x32_bf16 a[152:155], v[216:219], v[188:191], a[152:155]
    s_waitcnt vmcnt(18)
    s_barrier
    v_mfma_f32_16x16x32_bf16 a[132:135], v[220:223], v[176:179], a[132:135]
    ds_read_b128 v[216:219], v232 offset:12416
    v_mfma_f32_16x16x32_bf16 a[140:143], v[220:223], v[180:183], a[140:143]
    s_cmp_eq_u32 s33, 1
    s_cbranch_scc0 Lsb41
    v_accvgpr_read_b32 v238, a224
    v_accvgpr_read_b32 v239, a225
    v_accvgpr_read_b32 v240, a226
    v_accvgpr_read_b32 v241, a227
    v_accvgpr_read_b32 v242, a228
    v_accvgpr_read_b32 v243, a229
Lsb41:
    s_cmp_eq_u32 s33, 1
    s_cselect_b32 s64, s44, s40
    s_cselect_b32 s65, s45, s41
    s_mov_b32 s66, 0x60080
    s_mov_b32 s67, 0x00020000
    s_cselect_b32 s35, s37, s35
    s_add_u32 m0, s34, 122880
    s_nop 0
    buffer_load_dwordx4 v238, s[64:67], s35 offen offset:0 nt lds
    v_mfma_f32_16x16x32_bf16 a[148:151], v[220:223], v[184:187], a[148:151]
    v_cvt_pk_bf16_f32 v169, v247, v248
    v_mfma_f32_16x16x32_bf16 a[156:159], v[220:223], v[188:191], a[156:159]
    s_waitcnt lgkmcnt(3)
    v_mfma_f32_16x16x32_bf16 a[160:163], v[224:227], v[176:179], a[160:163]
    ds_read_b128 v[220:223], v233 offset:12416
    v_mfma_f32_16x16x32_bf16 a[168:171], v[224:227], v[180:183], a[168:171]
    v_exp_f32 v247, v122
    v_mfma_f32_16x16x32_bf16 a[176:179], v[224:227], v[184:187], a[176:179]
    v_cvt_pk_bf16_f32 v172, v245, v246
    v_mfma_f32_16x16x32_bf16 a[184:187], v[224:227], v[188:191], a[184:187]
    v_exp_f32 v248, v123
    v_mfma_f32_16x16x32_bf16 a[164:167], v[228:231], v[176:179], a[164:167]
    ds_read_b128 v[224:227], v232 offset:12544
    v_mfma_f32_16x16x32_bf16 a[172:175], v[228:231], v[180:183], a[172:175]
    v_exp_f32 v245, v100
    v_mfma_f32_16x16x32_bf16 a[180:183], v[228:231], v[184:187], a[180:183]
    buffer_load_dwordx4 v239, s[64:67], s35 offen offset:1024 nt lds
    v_mfma_f32_16x16x32_bf16 a[188:191], v[228:231], v[188:191], a[188:191]
    v_exp_f32 v246, v101
    v_mfma_f32_16x16x32_bf16 a[192:195], a[208:211], v[176:179], a[192:195]
    v_cvt_pk_bf16_f32 v173, v247, v248
    v_mfma_f32_16x16x32_bf16 a[196:199], a[208:211], v[180:183], a[196:199]
    v_exp_f32 v247, v102
    v_mfma_f32_16x16x32_bf16 a[200:203], a[208:211], v[184:187], a[200:203]
    v_cvt_pk_bf16_f32 v162, v245, v246
    v_mfma_f32_16x16x32_bf16 a[204:207], a[208:211], v[188:191], a[204:207]
    s_waitcnt lgkmcnt(3)
    v_mfma_f32_16x16x32_bf16 v[128:131], v[208:211], v[0:3], v[192:195]
    ds_read_b128 v[228:231], v233 offset:12544
    buffer_load_dwordx4 v240, s[64:67], s35 offen offset:2048 nt lds
    v_mfma_f32_16x16x32_bf16 v[136:139], v[208:211], v[4:7], v[196:199]
    v_exp_f32 v248, v103
    v_mfma_f32_16x16x32_bf16 v[144:147], v[208:211], v[8:11], v[200:203]
    v_exp_f32 v245, v108
    v_mfma_f32_16x16x32_bf16 v[152:155], v[208:211], v[12:15], v[204:207]
    v_mfma_f32_16x16x32_bf16 v[128:131], v[212:215], v[16:19], v[128:131]
    ds_read_b128 v[208:211], v232 offset:18432
    v_mfma_f32_16x16x32_bf16 v[136:139], v[212:215], v[20:23], v[136:139]
    v_exp_f32 v246, v109
    v_mfma_f32_16x16x32_bf16 v[144:147], v[212:215], v[24:27], v[144:147]
    v_cvt_pk_bf16_f32 v163, v247, v248
    v_mfma_f32_16x16x32_bf16 v[152:155], v[212:215], v[28:31], v[152:155]
    s_waitcnt lgkmcnt(3)
    v_mfma_f32_16x16x32_bf16 v[128:131], v[216:219], v[32:35], v[128:131]
    ds_read_b128 v[212:215], v233 offset:18432
    v_mfma_f32_16x16x32_bf16 v[136:139], v[216:219], v[36:39], v[136:139]
    v_exp_f32 v247, v110
    v_mfma_f32_16x16x32_bf16 v[144:147], v[216:219], v[40:43], v[144:147]
    s_add_u32 m0, s34, 125952
    s_nop 0
    buffer_load_dwordx4 v241, s[64:67], s35 offen offset:0 nt lds
    v_mfma_f32_16x16x32_bf16 v[152:155], v[216:219], v[44:47], v[152:155]
    v_cvt_pk_bf16_f32 v166, v245, v246
    v_mfma_f32_16x16x32_bf16 v[128:131], v[220:223], v[48:51], v[128:131]
    ds_read_b128 v[216:219], v232 offset:18560
    v_mfma_f32_16x16x32_bf16 v[136:139], v[220:223], v[52:55], v[136:139]
    v_exp_f32 v248, v111
    v_mfma_f32_16x16x32_bf16 v[144:147], v[220:223], v[56:59], v[144:147]
    v_exp_f32 v245, v116
    v_mfma_f32_16x16x32_bf16 v[152:155], v[220:223], v[60:63], v[152:155]
    s_waitcnt lgkmcnt(3)
    v_mfma_f32_16x16x32_bf16 v[128:131], v[224:227], v[64:67], v[128:131]
    ds_read_b128 v[220:223], v233 offset:18560
    v_mfma_f32_16x16x32_bf16 v[136:139], v[224:227], v[68:71], v[136:139]
    v_exp_f32 v246, v117
    v_mfma_f32_16x16x32_bf16 v[144:147], v[224:227], v[72:75], v[144:147]
    buffer_load_dwordx4 v242, s[64:67], s35 offen offset:1024 nt lds
    v_cvt_pk_bf16_f32 v167, v247, v248
    v_mfma_f32_16x16x32_bf16 v[152:155], v[224:227], v[76:79], v[152:155]
    v_exp_f32 v247, v118
    v_mfma_f32_16x16x32_bf16 v[128:131], v[228:231], v[80:83], v[128:131]
    ds_read_b128 v[224:227], v232 offset:18688
    v_cvt_pk_bf16_f32 v170, v245, v246
    v_mfma_f32_16x16x32_bf16 v[136:139], v[228:231], v[84:87], v[136:139]
    v_exp_f32 v248, v119
    v_mfma_f32_16x16x32_bf16 v[144:147], v[228:231], v[88:91], v[144:147]
    v_mfma_f32_16x16x32_bf16 v[152:155], v[228:231], v[92:95], v[152:155]
    s_waitcnt lgkmcnt(3)
    v_mfma_f32_16x16x32_bf16 v[132:135], v[208:211], v[0:3], v[192:195]
    ds_read_b128 v[228:231], v233 offset:18688
    v_mfma_f32_16x16x32_bf16 v[140:143], v[208:211], v[4:7], v[196:199]
    buffer_load_dwordx4 v243, s[64:67], s35 offen offset:2048 nt lds
    v_mfma_f32_16x16x32_bf16 v[148:151], v[208:211], v[8:11], v[200:203]
    v_exp_f32 v245, v124
    v_mfma_f32_16x16x32_bf16 v[156:159], v[208:211], v[12:15], v[204:207]
    v_exp_f32 v246, v125
    v_mfma_f32_16x16x32_bf16 v[132:135], v[212:215], v[16:19], v[132:135]
    ds_read_b64_tr_b16 v[208:209], v234 offset:24576
    ds_read_b64_tr_b16 v[210:211], v234 offset:30720
    v_mfma_f32_16x16x32_bf16 v[140:143], v[212:215], v[20:23], v[140:143]
    v_cvt_pk_bf16_f32 v171, v247, v248
    v_mfma_f32_16x16x32_bf16 v[148:151], v[212:215], v[24:27], v[148:151]
    v_exp_f32 v247, v126
    v_mfma_f32_16x16x32_bf16 v[156:159], v[212:215], v[28:31], v[156:159]
    v_cvt_pk_bf16_f32 v174, v245, v246
    s_waitcnt lgkmcnt(4)
    v_mfma_f32_16x16x32_bf16 v[132:135], v[216:219], v[32:35], v[132:135]
    ds_read_b64_tr_b16 v[212:213], v235 offset:24576
    ds_read_b64_tr_b16 v[214:215], v235 offset:30720
    v_mfma_f32_16x16x32_bf16 v[140:143], v[216:219], v[36:39], v[140:143]
    v_exp_f32 v248, v127
    v_mfma_f32_16x16x32_bf16 v[148:151], v[216:219], v[40:43], v[148:151]
    s_nop 0
    v_cvt_pk_bf16_f32 v175, v247, v248
    v_mfma_f32_16x16x32_bf16 v[156:159], v[216:219], v[44:47], v[156:159]
    v_mfma_f32_16x16x32_bf16 v[132:135], v[220:223], v[48:51], v[132:135]
    ds_read_b64_tr_b16 v[216:217], v236 offset:24576
    ds_read_b64_tr_b16 v[218:219], v236 offset:30720
    v_mfma_f32_16x16x32_bf16 v[140:143], v[220:223], v[52:55], v[140:143]
    v_or3_b32 v245, v160, v161, v162
    v_or3_b32 v245, v245, v163, v164
    v_mfma_f32_16x16x32_bf16 v[148:151], v[220:223], v[56:59], v[148:151]
    v_or3_b32 v245, v245, v165, v166
    v_mfma_f32_16x16x32_bf16 v[156:159], v[220:223], v[60:63], v[156:159]
    s_waitcnt lgkmcnt(6)
    v_mfma_f32_16x16x32_bf16 v[132:135], v[224:227], v[64:67], v[132:135]
    ds_read_b64_tr_b16 v[220:221], v237 offset:24576
    ds_read_b64_tr_b16 v[222:223], v237 offset:30720
    v_mfma_f32_16x16x32_bf16 v[140:143], v[224:227], v[68:71], v[140:143]
    v_or3_b32 v245, v245, v167, v168
    v_or3_b32 v245, v245, v169, v170
    v_mfma_f32_16x16x32_bf16 v[148:151], v[224:227], v[72:75], v[148:151]
    v_or3_b32 v245, v245, v171, v172
    v_mfma_f32_16x16x32_bf16 v[156:159], v[224:227], v[76:79], v[156:159]
    v_mfma_f32_16x16x32_bf16 v[132:135], v[228:231], v[80:83], v[132:135]
    ds_read_b64_tr_b16 v[224:225], v234 offset:24704
    ds_read_b64_tr_b16 v[226:227], v234 offset:30848
    v_or3_b32 v245, v245, v173, v174
    v_mfma_f32_16x16x32_bf16 v[140:143], v[228:231], v[84:87], v[140:143]
    v_or_b32 v245, v245, v175
    v_and_b32 v245, 0x40004000, v245
    v_mfma_f32_16x16x32_bf16 v[148:151], v[228:231], v[88:91], v[148:151]
    v_mfma_f32_16x16x32_bf16 v[156:159], v[228:231], v[92:95], v[156:159]
    v_cmp_ne_u32 vcc, 0, v245
    s_cbranch_vccnz Lrare_25
Lrare_25_back:
    s_waitcnt lgkmcnt(6)
    v_mfma_f32_16x16x32_bf16 a[0:3], v[208:211], v[160:163], a[0:3]
    ds_read_b64_tr_b16 v[228:229], v235 offset:24704
    ds_read_b64_tr_b16 v[230:231], v235 offset:30848
    v_mfma_f32_16x16x32_bf16 a[8:11], v[208:211], v[164:167], a[8:11]
    v_exp_f32 v245, v128
    v_mfma_f32_16x16x32_bf16 a[16:19], v[208:211], v[168:171], a[16:19]
    v_exp_f32 v246, v129
    v_mfma_f32_16x16x32_bf16 a[24:27], v[208:211], v[172:175], a[24:27]
    v_mfma_f32_16x16x32_bf16 a[4:7], v[212:215], v[160:163], a[4:7]
    ds_read_b64_tr_b16 v[208:209], v236 offset:24704
    ds_read_b64_tr_b16 v[210:211], v236 offset:30848
    v_mfma_f32_16x16x32_bf16 a[12:15], v[212:215], v[164:167], a[12:15]
    v_exp_f32 v247, v130
    v_mfma_f32_16x16x32_bf16 a[20:23], v[212:215], v[168:171], a[20:23]
    v_cvt_pk_bf16_f32 v176, v245, v246
    v_mfma_f32_16x16x32_bf16 a[28:31], v[212:215], v[172:175], a[28:31]
    s_waitcnt lgkmcnt(6)
    v_mfma_f32_16x16x32_bf16 a[32:35], v[216:219], v[160:163], a[32:35]
    ds_read_b64_tr_b16 v[212:213], v237 offset:24704
    ds_read_b64_tr_b16 v[214:215], v237 offset:30848
    v_mfma_f32_16x16x32_bf16 a[40:43], v[216:219], v[164:167], a[40:43]
    v_exp_f32 v248, v131
    v_mfma_f32_16x16x32_bf16 a[48:51], v[216:219], v[168:171], a[48:51]
    v_exp_f32 v245, v136
    v_mfma_f32_16x16x32_bf16 a[56:59], v[216:219], v[172:175], a[56:59]
    v_mfma_f32_16x16x32_bf16 a[36:39], v[220:223], v[160:163], a[36:39]
    ds_read_b64_tr_b16 v[216:217], v234 offset:24832
    ds_read_b64_tr_b16 v[218:219], v234 offset:30976
    v_mfma_f32_16x16x32_bf16 a[44:47], v[220:223], v[164:167], a[44:47]
    v_exp_f32 v246, v137
    v_mfma_f32_16x16x32_bf16 a[52:55], v[220:223], v[168:171], a[52:55]
    v_cvt_pk_bf16_f32 v177, v247, v248
    v_mfma_f32_16x16x32_bf16 a[60:63], v[220:223], v[172:175], a[60:63]
    s_waitcnt lgkmcnt(6)
    v_mfma_f32_16x16x32_bf16 a[64:67], v[224:227], v[160:163], a[64:67]
    ds_read_b64_tr_b16 v[220:221], v235 offset:24832
    ds_read_b64_tr_b16 v[222:223], v235 offset:30976
    v_mfma_f32_16x16x32_bf16 a[72:75], v[224:227], v[164:167], a[72:75]
    v_exp_f32 v247, v138
    v_mfma_f32_16x16x32_bf16 a[80:83], v[224:227], v[168:171], a[80:83]
    v_cvt_pk_bf16_f32 v180, v245, v246
    v_mfma_f32_16x16x32_bf16 a[88:91], v[224:227], v[172:175], a[88:91]
    v_exp_f32 v248, v139
    v_mfma_f32_16x16x32_bf16 a[68:71], v[228:231], v[160:163], a[68:71]
    ds_read_b64_tr_b16 v[224:225], v236 offset:24832
    ds_read_b64_tr_b16 v[226:227], v236 offset:30976
    v_mfma_f32_16x16x32_bf16 a[76:79], v[228:231], v[164:167], a[76:79]
    v_exp_f32 v245, v144
    v_mfma_f32_16x16x32_bf16 a[84:87], v[228:231], v[168:171], a[84:87]
    v_exp_f32 v246, v145
    v_mfma_f32_16x16x32_bf16 a[92:95], v[228:231], v[172:175], a[92:95]
    s_waitcnt lgkmcnt(6)
    v_mfma_f32_16x16x32_bf16 a[96:99], v[208:211], v[160:163], a[96:99]
    ds_read_b64_tr_b16 v[228:229], v237 offset:24832
    ds_read_b64_tr_b16 v[230:231], v237 offset:30976
    v_mfma_f32_16x16x32_bf16 a[104:107], v[208:211], v[164:167], a[104:107]
    v_cvt_pk_bf16_f32 v181, v247, v248
    v_mfma_f32_16x16x32_bf16 a[112:115], v[208:211], v[168:171], a[112:115]
    v_exp_f32 v247, v146
    v_mfma_f32_16x16x32_bf16 a[120:123], v[208:211], v[172:175], a[120:123]
    v_mfma_f32_16x16x32_bf16 a[100:103], v[212:215], v[160:163], a[100:103]
    ds_read_b128 v[208:211], v232 offset:36864
    v_cvt_pk_bf16_f32 v184, v245, v246
    v_mfma_f32_16x16x32_bf16 a[108:111], v[212:215], v[164:167], a[108:111]
    v_exp_f32 v248, v147
    v_mfma_f32_16x16x32_bf16 a[116:119], v[212:215], v[168:171], a[116:119]
    v_mfma_f32_16x16x32_bf16 a[124:127], v[212:215], v[172:175], a[124:127]
    s_waitcnt lgkmcnt(5)
    v_mfma_f32_16x16x32_bf16 a[128:131], v[216:219], v[160:163], a[128:131]
    ds_read_b128 v[212:215], v233 offset:36864
    v_mfma_f32_16x16x32_bf16 a[136:139], v[216:219], v[164:167], a[136:139]
    v_exp_f32 v245, v152
    v_mfma_f32_16x16x32_bf16 a[144:147], v[216:219], v[168:171], a[144:147]
    v_exp_f32 v246, v153
    v_mfma_f32_16x16x32_bf16 a[152:155], v[216:219], v[172:175], a[152:155]
    s_waitcnt vmcnt(18)
    s_barrier
    v_mfma_f32_16x16x32_bf16 a[132:135], v[220:223], v[160:163], a[132:135]
    ds_read_b128 v[216:219], v232 offset:36992
    v_mfma_f32_16x16x32_bf16 a[140:143], v[220:223], v[164:167], a[140:143]
    s_mul_i32 s62, s31, 384
    s_add_u32 s48, s20, s62
    s_addc_u32 s49, s21, 0
    s_sub_u32 s48, s48, 128
    s_subb_u32 s49, s49, 0
    s_mov_b32 s50, 0x80
    s_mov_b32 s51, 0x00020000
    s_sub_u32 s50, 0x780080, s62
    s_add_u32 s62, s30, 8
    s_lshl_b32 s62, s62, 2
    s_add_u32 s62, s62, s32
    s_mul_i32 s62, s62, 81920
    s_add_u32 s62, s62, 0x5800000
    s_add_u32 s52, s28, s62
    s_addc_u32 s53, s29, 0
    s_mov_b32 s54, 0x14000
    s_mov_b32 s55, 0x00020000
    s_cmp_eq_u32 s69, 0
    s_cselect_b32 s50, s50, 0
    s_cselect_b32 s54, s54, 0
    s_mul_i32 s36, s33, 393216
    v_accvgpr_read_b32 v238, a212
    v_accvgpr_read_b32 v239, a213
    v_accvgpr_read_b32 v240, a214
    v_accvgpr_read_b32 v241, a215
    v_accvgpr_read_b32 v242, a216
    v_accvgpr_read_b32 v243, a217
    s_add_u32 m0, s34, 0
    s_nop 0
    buffer_load_dwordx4 v238, s[48:51], s36 offen offset:0  lds
    v_mfma_f32_16x16x32_bf16 a[148:151], v[220:223], v[168:171], a[148:151]
    v_cvt_pk_bf16_f32 v185, v247, v248
    v_mfma_f32_16x16x32_bf16 a[156:159], v[220:223], v[172:175], a[156:159]
    s_waitcnt lgkmcnt(3)
    v_mfma_f32_16x16x32_bf16 a[160:163], v[224:227], v[160:163], a[160:163]
    ds_read_b128 v[220:223], v233 offset:36992
    v_mfma_f32_16x16x32_bf16 a[168:171], v[224:227], v[164:167], a[168:171]
    v_exp_f32 v247, v154
    v_mfma_f32_16x16x32_bf16 a[176:179], v[224:227], v[168:171], a[176:179]
    v_cvt_pk_bf16_f32 v188, v245, v246
    v_mfma_f32_16x16x32_bf16 a[184:187], v[224:227], v[172:175], a[184:187]
    v_exp_f32 v248, v155
    v_mfma_f32_16x16x32_bf16 a[164:167], v[228:231], v[160:163], a[164:167]
    ds_read_b128 v[224:227], v232 offset:37120
    v_mfma_f32_16x16x32_bf16 a[172:175], v[228:231], v[164:167], a[172:175]
    v_exp_f32 v245, v132
    v_mfma_f32_16x16x32_bf16 a[180:183], v[228:231], v[168:171], a[180:183]
    buffer_load_dwordx4 v239, s[48:51], s36 offen offset:1024  lds
    v_mfma_f32_16x16x32_bf16 a[188:191], v[228:231], v[172:175], a[188:191]
    v_exp_f32 v246, v133
    v_mfma_f32_16x16x32_bf16 a[192:195], a[208:211], v[160:163], a[192:195]
    v_cvt_pk_bf16_f32 v189, v247, v248
    v_mfma_f32_16x16x32_bf16 a[196:199], a[208:211], v[164:167], a[196:199]
    v_exp_f32 v247, v134
    v_mfma_f32_16x16x32_bf16 a[200:203], a[208:211], v[168:171], a[200:203]
    v_cvt_pk_bf16_f32 v178, v245, v246
    v_mfma_f32_16x16x32_bf16 a[204:207], a[208:211], v[172:175], a[204:207]
    s_waitcnt lgkmcnt(3)
    v_mfma_f32_16x16x32_bf16 v[96:99], v[208:211], v[0:3], v[192:195]
    ds_read_b128 v[228:231], v233 offset:37120
    buffer_load_dwordx4 v240, s[48:51], s36 offen offset:2048  lds
    v_mfma_f32_16x16x32_bf16 v[104:107], v[208:211], v[4:7], v[196:199]
    v_exp_f32 v248, v135
    v_mfma_f32_16x16x32_bf16 v[112:115], v[208:211], v[8:11], v[200:203]
    v_exp_f32 v245, v140
    v_mfma_f32_16x16x32_bf16 v[120:123], v[208:211], v[12:15], v[204:207]
    v_mfma_f32_16x16x32_bf16 v[96:99], v[212:215], v[16:19], v[96:99]
    ds_read_b128 v[208:211], v232 offset:43008
    v_mfma_f32_16x16x32_bf16 v[104:107], v[212:215], v[20:23], v[104:107]
    v_exp_f32 v246, v141
    v_mfma_f32_16x16x32_bf16 v[112:115], v[212:215], v[24:27], v[112:115]
    v_cvt_pk_bf16_f32 v179, v247, v248
    v_mfma_f32_16x16x32_bf16 v[120:123], v[212:215], v[28:31], v[120:123]
    s_waitcnt lgkmcnt(3)
    v_mfma_f32_16x16x32_bf16 v[96:99], v[216:219], v[32:35], v[96:99]
    ds_read_b128 v[212:215], v233 offset:43008
    v_mfma_f32_16x16x32_bf16 v[104:107], v[216:219], v[36:39], v[104:107]
    v_exp_f32 v247, v142
    v_mfma_f32_16x16x32_bf16 v[112:115], v[216:219], v[40:43], v[112:115]
    s_add_u32 m0, s34, 3072
    s_nop 0
    buffer_load_dwordx4 v241, s[48:51], s36 offen offset:0  lds
    v_mfma_f32_16x16x32_bf16 v[120:123], v[216:219], v[44:47], v[120:123]
    v_cvt_pk_bf16_f32 v182, v245, v246
    v_mfma_f32_16x16x32_bf16 v[96:99], v[220:223], v[48:51], v[96:99]
    ds_read_b128 v[216:219], v232 offset:43136
    v_mfma_f32_16x16x32_bf16 v[104:107], v[220:223], v[52:55], v[104:107]
    v_exp_f32 v248, v143
    v_mfma_f32_16x16x32_bf16 v[112:115], v[220:223], v[56:59], v[112:115]
    v_exp_f32 v245, v148
    v_mfma_f32_16x16x32_bf16 v[120:123], v[220:223], v[60:63], v[120:123]
    s_waitcnt lgkmcnt(3)
    v_mfma_f32_16x16x32_bf16 v[96:99], v[224:227], v[64:67], v[96:99]
    ds_read_b128 v[220:223], v233 offset:43136
    v_mfma_f32_16x16x32_bf16 v[104:107], v[224:227], v[68:71], v[104:107]
    v_exp_f32 v246, v149
    v_mfma_f32_16x16x32_bf16 v[112:115], v[224:227], v[72:75], v[112:115]
    buffer_load_dwordx4 v242, s[48:51], s36 offen offset:1024  lds
    v_cvt_pk_bf16_f32 v183, v247, v248
    v_mfma_f32_16x16x32_bf16 v[120:123], v[224:227], v[76:79], v[120:123]
    v_exp_f32 v247, v150
    v_mfma_f32_16x16x32_bf16 v[96:99], v[228:231], v[80:83], v[96:99]
    ds_read_b128 v[224:227], v232 offset:43264
    v_cvt_pk_bf16_f32 v186, v245, v246
    v_mfma_f32_16x16x32_bf16 v[104:107], v[228:231], v[84:87], v[104:107]
    v_exp_f32 v248, v151
    v_mfma_f32_16x16x32_bf16 v[112:115], v[228:231], v[88:91], v[112:115]
    v_mfma_f32_16x16x32_bf16 v[120:123], v[228:231], v[92:95], v[120:123]
    s_waitcnt lgkmcnt(3)
    v_mfma_f32_16x16x32_bf16 v[100:103], v[208:211], v[0:3], v[192:195]
    ds_read_b128 v[228:231], v233 offset:43264
    v_mfma_f32_16x16x32_bf16 v[108:111], v[208:211], v[4:7], v[196:199]
    buffer_load_dwordx4 v243, s[48:51], s36 offen offset:2048  lds
    s_add_u32 s36, s36, 786432
    v_mfma_f32_16x16x32_bf16 v[116:119], v[208:211], v[8:11], v[200:203]
    v_exp_f32 v245, v156
    v_mfma_f32_16x16x32_bf16 v[124:127], v[208:211], v[12:15], v[204:207]
    v_exp_f32 v246, v157
    v_mfma_f32_16x16x32_bf16 v[100:103], v[212:215], v[16:19], v[100:103]
    v_add_u32 v234, 0xc000, v234
    v_add_u32 v235, 0xc000, v235
    v_add_u32 v236, 0xc000, v236
    v_add_u32 v237, 0xc000, v237
    ds_read_b64_tr_b16 v[208:209], v234 offset:0
    ds_read_b64_tr_b16 v[210:211], v234 offset:6144
    v_mfma_f32_16x16x32_bf16 v[108:111], v[212:215], v[20:23], v[108:111]
    v_cvt_pk_bf16_f32 v187, v247, v248
    v_mfma_f32_16x16x32_bf16 v[116:119], v[212:215], v[24:27], v[116:119]
    v_exp_f32 v247, v158
    v_mfma_f32_16x16x32_bf16 v[124:127], v[212:215], v[28:31], v[124:127]
    v_cvt_pk_bf16_f32 v190, v245, v246
    s_waitcnt lgkmcnt(4)
    v_mfma_f32_16x16x32_bf16 v[100:103], v[216:219], v[32:35], v[100:103]
    ds_read_b64_tr_b16 v[212:213], v235 offset:0
    ds_read_b64_tr_b16 v[214:215], v235 offset:6144
    v_mfma_f32_16x16x32_bf16 v[108:111], v[216:219], v[36:39], v[108:111]
    v_exp_f32 v248, v159
    v_mfma_f32_16x16x32_bf16 v[116:119], v[216:219], v[40:43], v[116:119]
    s_nop 0
    v_cvt_pk_bf16_f32 v191, v247, v248
    v_mfma_f32_16x16x32_bf16 v[124:127], v[216:219], v[44:47], v[124:127]
    v_mfma_f32_16x16x32_bf16 v[100:103], v[220:223], v[48:51], v[100:103]
    ds_read_b64_tr_b16 v[216:217], v236 offset:0
    ds_read_b64_tr_b16 v[218:219], v236 offset:6144
    v_mfma_f32_16x16x32_bf16 v[108:111], v[220:223], v[52:55], v[108:111]
    v_or3_b32 v245, v176, v177, v178
    v_or3_b32 v245, v245, v179, v180
    v_mfma_f32_16x16x32_bf16 v[116:119], v[220:223], v[56:59], v[116:119]
    v_or3_b32 v245, v245, v181, v182
    v_mfma_f32_16x16x32_bf16 v[124:127], v[220:223], v[60:63], v[124:127]
    s_waitcnt lgkmcnt(6)
    v_mfma_f32_16x16x32_bf16 v[100:103], v[224:227], v[64:67], v[100:103]
    ds_read_b64_tr_b16 v[220:221], v237 offset:0
    ds_read_b64_tr_b16 v[222:223], v237 offset:6144
    v_mfma_f32_16x16x32_bf16 v[108:111], v[224:227], v[68:71], v[108:111]
    v_or3_b32 v245, v245, v183, v184
    v_or3_b32 v245, v245, v185, v186
    v_mfma_f32_16x16x32_bf16 v[116:119], v[224:227], v[72:75], v[116:119]
    v_or3_b32 v245, v245, v187, v188
    v_mfma_f32_16x16x32_bf16 v[124:127], v[224:227], v[76:79], v[124:127]
    v_mfma_f32_16x16x32_bf16 v[100:103], v[228:231], v[80:83], v[100:103]
    ds_read_b64_tr_b16 v[224:225], v234 offset:128
    ds_read_b64_tr_b16 v[226:227], v234 offset:6272
    v_or3_b32 v245, v245, v189, v190
    v_mfma_f32_16x16x32_bf16 v[108:111], v[228:231], v[84:87], v[108:111]
    v_or_b32 v245, v245, v191
    v_and_b32 v245, 0x40004000, v245
    v_mfma_f32_16x16x32_bf16 v[116:119], v[228:231], v[88:91], v[116:119]
    v_mfma_f32_16x16x32_bf16 v[124:127], v[228:231], v[92:95], v[124:127]
    v_cmp_ne_u32 vcc, 0, v245
    s_cbranch_vccnz Lrare_26
Lrare_26_back:
    s_waitcnt lgkmcnt(6)
    v_mfma_f32_16x16x32_bf16 a[0:3], v[208:211], v[176:179], a[0:3]
    ds_read_b64_tr_b16 v[228:229], v235 offset:128
    ds_read_b64_tr_b16 v[230:231], v235 offset:6272
    v_mfma_f32_16x16x32_bf16 a[8:11], v[208:211], v[180:183], a[8:11]
    v_exp_f32 v245, v96
    v_mfma_f32_16x16x32_bf16 a[16:19], v[208:211], v[184:187], a[16:19]
    v_exp_f32 v246, v97
    v_mfma_f32_16x16x32_bf16 a[24:27], v[208:211], v[188:191], a[24:27]
    v_mfma_f32_16x16x32_bf16 a[4:7], v[212:215], v[176:179], a[4:7]
    ds_read_b64_tr_b16 v[208:209], v236 offset:128
    ds_read_b64_tr_b16 v[210:211], v236 offset:6272
    v_mfma_f32_16x16x32_bf16 a[12:15], v[212:215], v[180:183], a[12:15]
    v_exp_f32 v247, v98
    v_mfma_f32_16x16x32_bf16 a[20:23], v[212:215], v[184:187], a[20:23]
    v_cvt_pk_bf16_f32 v160, v245, v246
    v_mfma_f32_16x16x32_bf16 a[28:31], v[212:215], v[188:191], a[28:31]
    s_waitcnt lgkmcnt(6)
    v_mfma_f32_16x16x32_bf16 a[32:35], v[216:219], v[176:179], a[32:35]
    ds_read_b64_tr_b16 v[212:213], v237 offset:128
    ds_read_b64_tr_b16 v[214:215], v237 offset:6272
    v_mfma_f32_16x16x32_bf16 a[40:43], v[216:219], v[180:183], a[40:43]
    v_exp_f32 v248, v99
    v_mfma_f32_16x16x32_bf16 a[48:51], v[216:219], v[184:187], a[48:51]
    v_exp_f32 v245, v104
    v_mfma_f32_16x16x32_bf16 a[56:59], v[216:219], v[188:191], a[56:59]
    v_mfma_f32_16x16x32_bf16 a[36:39], v[220:223], v[176:179], a[36:39]
    ds_read_b64_tr_b16 v[216:217], v234 offset:256
    ds_read_b64_tr_b16 v[218:219], v234 offset:6400
    v_mfma_f32_16x16x32_bf16 a[44:47], v[220:223], v[180:183], a[44:47]
    v_exp_f32 v246, v105
    v_mfma_f32_16x16x32_bf16 a[52:55], v[220:223], v[184:187], a[52:55]
    v_cvt_pk_bf16_f32 v161, v247, v248
    v_mfma_f32_16x16x32_bf16 a[60:63], v[220:223], v[188:191], a[60:63]
    s_waitcnt lgkmcnt(6)
    v_mfma_f32_16x16x32_bf16 a[64:67], v[224:227], v[176:179], a[64:67]
    ds_read_b64_tr_b16 v[220:221], v235 offset:256
    ds_read_b64_tr_b16 v[222:223], v235 offset:6400
    v_mfma_f32_16x16x32_bf16 a[72:75], v[224:227], v[180:183], a[72:75]
    v_exp_f32 v247, v106
    v_mfma_f32_16x16x32_bf16 a[80:83], v[224:227], v[184:187], a[80:83]
    v_cvt_pk_bf16_f32 v164, v245, v246
    v_mfma_f32_16x16x32_bf16 a[88:91], v[224:227], v[188:191], a[88:91]
    v_exp_f32 v248, v107
    v_mfma_f32_16x16x32_bf16 a[68:71], v[228:231], v[176:179], a[68:71]
    ds_read_b64_tr_b16 v[224:225], v236 offset:256
    ds_read_b64_tr_b16 v[226:227], v236 offset:6400
    v_mfma_f32_16x16x32_bf16 a[76:79], v[228:231], v[180:183], a[76:79]
    v_exp_f32 v245, v112
    v_mfma_f32_16x16x32_bf16 a[84:87], v[228:231], v[184:187], a[84:87]
    v_exp_f32 v246, v113
    v_mfma_f32_16x16x32_bf16 a[92:95], v[228:231], v[188:191], a[92:95]
    s_waitcnt lgkmcnt(6)
    v_mfma_f32_16x16x32_bf16 a[96:99], v[208:211], v[176:179], a[96:99]
    ds_read_b64_tr_b16 v[228:229], v237 offset:256
    ds_read_b64_tr_b16 v[230:231], v237 offset:6400
    v_mfma_f32_16x16x32_bf16 a[104:107], v[208:211], v[180:183], a[104:107]
    v_cvt_pk_bf16_f32 v165, v247, v248
    v_mfma_f32_16x16x32_bf16 a[112:115], v[208:211], v[184:187], a[112:115]
    v_exp_f32 v247, v114
    v_mfma_f32_16x16x32_bf16 a[120:123], v[208:211], v[188:191], a[120:123]
    v_mfma_f32_16x16x32_bf16 a[100:103], v[212:215], v[176:179], a[100:103]
    v_add_u32 v232, 0xc000, v232
    v_add_u32 v233, 0xc000, v233
    ds_read_b128 v[208:211], v232 offset:12288
    v_cvt_pk_bf16_f32 v168, v245, v246
    v_mfma_f32_16x16x32_bf16 a[108:111], v[212:215], v[180:183], a[108:111]
    v_exp_f32 v248, v115
    v_mfma_f32_16x16x32_bf16 a[116:119], v[212:215], v[184:187], a[116:119]
    v_mfma_f32_16x16x32_bf16 a[124:127], v[212:215], v[188:191], a[124:127]
    s_waitcnt lgkmcnt(5)
    v_mfma_f32_16x16x32_bf16 a[128:131], v[216:219], v[176:179], a[128:131]
    ds_read_b128 v[212:215], v233 offset:12288
    v_mfma_f32_16x16x32_bf16 a[136:139], v[216:219], v[180:183], a[136:139]
    v_exp_f32 v245, v120
    v_mfma_f32_16x16x32_bf16 a[144:147], v[216:219], v[184:187], a[144:147]
    v_exp_f32 v246, v121
    v_mfma_f32_16x16x32_bf16 a[152:155], v[216:219], v[188:191], a[152:155]
    s_waitcnt vmcnt(18)
    s_barrier
    v_mfma_f32_16x16x32_bf16 a[132:135], v[220:223], v[176:179], a[132:135]
    ds_read_b128 v[216:219], v232 offset:12416
    v_mfma_f32_16x16x32_bf16 a[140:143], v[220:223], v[180:183], a[140:143]
    s_add_u32 m0, s34, 24576
    s_nop 0
    buffer_load_dwordx4 v238, s[48:51], s36 offen offset:0  lds
    v_mfma_f32_16x16x32_bf16 a[148:151], v[220:223], v[184:187], a[148:151]
    v_cvt_pk_bf16_f32 v169, v247, v248
    v_mfma_f32_16x16x32_bf16 a[156:159], v[220:223], v[188:191], a[156:159]
    s_waitcnt lgkmcnt(3)
    v_mfma_f32_16x16x32_bf16 a[160:163], v[224:227], v[176:179], a[160:163]
    ds_read_b128 v[220:223], v233 offset:12416
    v_mfma_f32_16x16x32_bf16 a[168:171], v[224:227], v[180:183], a[168:171]
    v_exp_f32 v247, v122
    v_mfma_f32_16x16x32_bf16 a[176:179], v[224:227], v[184:187], a[176:179]
    v_cvt_pk_bf16_f32 v172, v245, v246
    v_mfma_f32_16x16x32_bf16 a[184:187], v[224:227], v[188:191], a[184:187]
    v_exp_f32 v248, v123
    v_mfma_f32_16x16x32_bf16 a[164:167], v[228:231], v[176:179], a[164:167]
    ds_read_b128 v[224:227], v232 offset:12544
    v_mfma_f32_16x16x32_bf16 a[172:175], v[228:231], v[180:183], a[172:175]
    v_exp_f32 v245, v100
    v_mfma_f32_16x16x32_bf16 a[180:183], v[228:231], v[184:187], a[180:183]
    buffer_load_dwordx4 v239, s[48:51], s36 offen offset:1024  lds
    v_mfma_f32_16x16x32_bf16 a[188:191], v[228:231], v[188:191], a[188:191]
    v_exp_f32 v246, v101
    v_mfma_f32_16x16x32_bf16 a[192:195], a[208:211], v[176:179], a[192:195]
    v_cvt_pk_bf16_f32 v173, v247, v248
    v_mfma_f32_16x16x32_bf16 a[196:199], a[208:211], v[180:183], a[196:199]
    v_exp_f32 v247, v102
    v_mfma_f32_16x16x32_bf16 a[200:203], a[208:211], v[184:187], a[200:203]
    v_cvt_pk_bf16_f32 v162, v245, v246
    v_mfma_f32_16x16x32_bf16 a[204:207], a[208:211], v[188:191], a[204:207]
    s_waitcnt lgkmcnt(3)
    v_mfma_f32_16x16x32_bf16 v[128:131], v[208:211], v[0:3], v[192:195]
    ds_read_b128 v[228:231], v233 offset:12544
    buffer_load_dwordx4 v240, s[48:51], s36 offen offset:2048  lds
    v_mfma_f32_16x16x32_bf16 v[136:139], v[208:211], v[4:7], v[196:199]
    v_exp_f32 v248, v103
    v_mfma_f32_16x16x32_bf16 v[144:147], v[208:211], v[8:11], v[200:203]
    v_exp_f32 v245, v108
    v_mfma_f32_16x16x32_bf16 v[152:155], v[208:211], v[12:15], v[204:207]
    v_mfma_f32_16x16x32_bf16 v[128:131], v[212:215], v[16:19], v[128:131]
    ds_read_b128 v[208:211], v232 offset:18432
    v_mfma_f32_16x16x32_bf16 v[136:139], v[212:215], v[20:23], v[136:139]
    v_exp_f32 v246, v109
    v_mfma_f32_16x16x32_bf16 v[144:147], v[212:215], v[24:27], v[144:147]
    v_cvt_pk_bf16_f32 v163, v247, v248
    v_mfma_f32_16x16x32_bf16 v[152:155], v[212:215], v[28:31], v[152:155]
    s_waitcnt lgkmcnt(3)
    v_mfma_f32_16x16x32_bf16 v[128:131], v[216:219], v[32:35], v[128:131]
    ds_read_b128 v[212:215], v233 offset:18432
    v_mfma_f32_16x16x32_bf16 v[136:139], v[216:219], v[36:39], v[136:139]
    v_exp_f32 v247, v110
    v_mfma_f32_16x16x32_bf16 v[144:147], v[216:219], v[40:43], v[144:147]
    s_add_u32 m0, s34, 27648
    s_nop 0
    buffer_load_dwordx4 v241, s[48:51], s36 offen offset:0  lds
    v_mfma_f32_16x16x32_bf16 v[152:155], v[216:219], v[44:47], v[152:155]
    v_cvt_pk_bf16_f32 v166, v245, v246
    v_mfma_f32_16x16x32_bf16 v[128:131], v[220:223], v[48:51], v[128:131]
    ds_read_b128 v[216:219], v232 offset:18560
    v_mfma_f32_16x16x32_bf16 v[136:139], v[220:223], v[52:55], v[136:139]
    v_exp_f32 v248, v111
    v_mfma_f32_16x16x32_bf16 v[144:147], v[220:223], v[56:59], v[144:147]
    v_exp_f32 v245, v116
    v_mfma_f32_16x16x32_bf16 v[152:155], v[220:223], v[60:63], v[152:155]
    s_waitcnt lgkmcnt(3)
    v_mfma_f32_16x16x32_bf16 v[128:131], v[224:227], v[64:67], v[128:131]
    ds_read_b128 v[220:223], v233 offset:18560
    v_mfma_f32_16x16x32_bf16 v[136:139], v[224:227], v[68:71], v[136:139]
    v_exp_f32 v246, v117
    v_mfma_f32_16x16x32_bf16 v[144:147], v[224:227], v[72:75], v[144:147]
    buffer_load_dwordx4 v242, s[48:51], s36 offen offset:1024  lds
    v_cvt_pk_bf16_f32 v167, v247, v248
    v_mfma_f32_16x16x32_bf16 v[152:155], v[224:227], v[76:79], v[152:155]
    v_exp_f32 v247, v118
    v_mfma_f32_16x16x32_bf16 v[128:131], v[228:231], v[80:83], v[128:131]
    ds_read_b128 v[224:227], v232 offset:18688
    v_cvt_pk_bf16_f32 v170, v245, v246
    v_mfma_f32_16x16x32_bf16 v[136:139], v[228:231], v[84:87], v[136:139]
    v_exp_f32 v248, v119
    v_mfma_f32_16x16x32_bf16 v[144:147], v[228:231], v[88:91], v[144:147]
    v_mfma_f32_16x16x32_bf16 v[152:155], v[228:231], v[92:95], v[152:155]
    s_waitcnt lgkmcnt(3)
    v_mfma_f32_16x16x32_bf16 v[132:135], v[208:211], v[0:3], v[192:195]
    ds_read_b128 v[228:231], v233 offset:18688
    v_mfma_f32_16x16x32_bf16 v[140:143], v[208:211], v[4:7], v[196:199]
    buffer_load_dwordx4 v243, s[48:51], s36 offen offset:2048  lds
    s_add_u32 s36, s36, 786432
    v_mfma_f32_16x16x32_bf16 v[148:151], v[208:211], v[8:11], v[200:203]
    v_exp_f32 v245, v124
    v_mfma_f32_16x16x32_bf16 v[156:159], v[208:211], v[12:15], v[204:207]
    v_exp_f32 v246, v125
    v_mfma_f32_16x16x32_bf16 v[132:135], v[212:215], v[16:19], v[132:135]
    ds_read_b64_tr_b16 v[208:209], v234 offset:24576
    ds_read_b64_tr_b16 v[210:211], v234 offset:30720
    v_mfma_f32_16x16x32_bf16 v[140:143], v[212:215], v[20:23], v[140:143]
    v_cvt_pk_bf16_f32 v171, v247, v248
    v_mfma_f32_16x16x32_bf16 v[148:151], v[212:215], v[24:27], v[148:151]
    v_exp_f32 v247, v126
    v_mfma_f32_16x16x32_bf16 v[156:159], v[212:215], v[28:31], v[156:159]
    v_cvt_pk_bf16_f32 v174, v245, v246
    s_waitcnt lgkmcnt(4)
    v_mfma_f32_16x16x32_bf16 v[132:135], v[216:219], v[32:35], v[132:135]
    ds_read_b64_tr_b16 v[212:213], v235 offset:24576
    ds_read_b64_tr_b16 v[214:215], v235 offset:30720
    v_mfma_f32_16x16x32_bf16 v[140:143], v[216:219], v[36:39], v[140:143]
    v_exp_f32 v248, v127
    v_mfma_f32_16x16x32_bf16 v[148:151], v[216:219], v[40:43], v[148:151]
    s_nop 0
    v_cvt_pk_bf16_f32 v175, v247, v248
    v_mfma_f32_16x16x32_bf16 v[156:159], v[216:219], v[44:47], v[156:159]
    v_mfma_f32_16x16x32_bf16 v[132:135], v[220:223], v[48:51], v[132:135]
    ds_read_b64_tr_b16 v[216:217], v236 offset:24576
    ds_read_b64_tr_b16 v[218:219], v236 offset:30720
    v_mfma_f32_16x16x32_bf16 v[140:143], v[220:223], v[52:55], v[140:143]
    v_or3_b32 v245, v160, v161, v162
    v_or3_b32 v245, v245, v163, v164
    v_mfma_f32_16x16x32_bf16 v[148:151], v[220:223], v[56:59], v[148:151]
    v_or3_b32 v245, v245, v165, v166
    v_mfma_f32_16x16x32_bf16 v[156:159], v[220:223], v[60:63], v[156:159]
    s_waitcnt lgkmcnt(6)
    v_mfma_f32_16x16x32_bf16 v[132:135], v[224:227], v[64:67], v[132:135]
    ds_read_b64_tr_b16 v[220:221], v237 offset:24576
    ds_read_b64_tr_b16 v[222:223], v237 offset:30720
    v_mfma_f32_16x16x32_bf16 v[140:143], v[224:227], v[68:71], v[140:143]
    v_or3_b32 v245, v245, v167, v168
    v_or3_b32 v245, v245, v169, v170
    v_mfma_f32_16x16x32_bf16 v[148:151], v[224:227], v[72:75], v[148:151]
    v_or3_b32 v245, v245, v171, v172
    v_mfma_f32_16x16x32_bf16 v[156:159], v[224:227], v[76:79], v[156:159]
    v_mfma_f32_16x16x32_bf16 v[132:135], v[228:231], v[80:83], v[132:135]
    ds_read_b64_tr_b16 v[224:225], v234 offset:24704
    ds_read_b64_tr_b16 v[226:227], v234 offset:30848
    v_or3_b32 v245, v245, v173, v174
    v_mfma_f32_16x16x32_bf16 v[140:143], v[228:231], v[84:87], v[140:143]
    v_or_b32 v245, v245, v175
    v_and_b32 v245, 0x40004000, v245
    v_mfma_f32_16x16x32_bf16 v[148:151], v[228:231], v[88:91], v[148:151]
    v_mfma_f32_16x16x32_bf16 v[156:159], v[228:231], v[92:95], v[156:159]
    v_cmp_ne_u32 vcc, 0, v245
    s_cbranch_vccnz Lrare_27
Lrare_27_back:
    s_waitcnt lgkmcnt(6)
    v_mfma_f32_16x16x32_bf16 a[0:3], v[208:211], v[160:163], a[0:3]
    ds_read_b64_tr_b16 v[228:229], v235 offset:24704
    ds_read_b64_tr_b16 v[230:231], v235 offset:30848
    v_mfma_f32_16x16x32_bf16 a[8:11], v[208:211], v[164:167], a[8:11]
    v_exp_f32 v245, v128
    v_mfma_f32_16x16x32_bf16 a[16:19], v[208:211], v[168:171], a[16:19]
    v_exp_f32 v246, v129
    v_mfma_f32_16x16x32_bf16 a[24:27], v[208:211], v[172:175], a[24:27]
    v_mfma_f32_16x16x32_bf16 a[4:7], v[212:215], v[160:163], a[4:7]
    ds_read_b64_tr_b16 v[208:209], v236 offset:24704
    ds_read_b64_tr_b16 v[210:211], v236 offset:30848
    v_mfma_f32_16x16x32_bf16 a[12:15], v[212:215], v[164:167], a[12:15]
    v_exp_f32 v247, v130
    v_mfma_f32_16x16x32_bf16 a[20:23], v[212:215], v[168:171], a[20:23]
    v_cvt_pk_bf16_f32 v176, v245, v246
    v_mfma_f32_16x16x32_bf16 a[28:31], v[212:215], v[172:175], a[28:31]
    s_mov_b32 s64, s26
    s_mov_b32 s65, s27
    s_mov_b32 s66, 256
    s_mov_b32 s67, 0x00020000
    s_lshr_b32 s68, s30, 2
    s_lshl_b32 s68, s68, 7
    s_and_b32 s63, s30, 3
    s_lshl_b32 s63, s63, 4
    s_add_u32 s68, s68, s63
    s_add_u32 s68, s68, 64
    v_mov_b32 v252, 0
    buffer_load_dword v253, v252, s[64:67], s68 offen sc1
    s_waitcnt lgkmcnt(6)
    v_mfma_f32_16x16x32_bf16 a[32:35], v[216:219], v[160:163], a[32:35]
    ds_read_b64_tr_b16 v[212:213], v237 offset:24704
    ds_read_b64_tr_b16 v[214:215], v237 offset:30848
    v_mfma_f32_16x16x32_bf16 a[40:43], v[216:219], v[164:167], a[40:43]
    v_exp_f32 v248, v131
    v_mfma_f32_16x16x32_bf16 a[48:51], v[216:219], v[168:171], a[48:51]
    v_exp_f32 v245, v136
    v_mfma_f32_16x16x32_bf16 a[56:59], v[216:219], v[172:175], a[56:59]
    v_mfma_f32_16x16x32_bf16 a[36:39], v[220:223], v[160:163], a[36:39]
    ds_read_b64_tr_b16 v[216:217], v234 offset:24832
    ds_read_b64_tr_b16 v[218:219], v234 offset:30976
    v_mfma_f32_16x16x32_bf16 a[44:47], v[220:223], v[164:167], a[44:47]
    v_exp_f32 v246, v137
    v_mfma_f32_16x16x32_bf16 a[52:55], v[220:223], v[168:171], a[52:55]
    v_cvt_pk_bf16_f32 v177, v247, v248
    v_mfma_f32_16x16x32_bf16 a[60:63], v[220:223], v[172:175], a[60:63]
    s_waitcnt lgkmcnt(6)
    v_mfma_f32_16x16x32_bf16 a[64:67], v[224:227], v[160:163], a[64:67]
    ds_read_b64_tr_b16 v[220:221], v235 offset:24832
    ds_read_b64_tr_b16 v[222:223], v235 offset:30976
    v_mfma_f32_16x16x32_bf16 a[72:75], v[224:227], v[164:167], a[72:75]
    v_exp_f32 v247, v138
    v_mfma_f32_16x16x32_bf16 a[80:83], v[224:227], v[168:171], a[80:83]
    v_cvt_pk_bf16_f32 v180, v245, v246
    v_mfma_f32_16x16x32_bf16 a[88:91], v[224:227], v[172:175], a[88:91]
    v_exp_f32 v248, v139
    v_mfma_f32_16x16x32_bf16 a[68:71], v[228:231], v[160:163], a[68:71]
    ds_read_b64_tr_b16 v[224:225], v236 offset:24832
    ds_read_b64_tr_b16 v[226:227], v236 offset:30976
    v_mfma_f32_16x16x32_bf16 a[76:79], v[228:231], v[164:167], a[76:79]
    v_exp_f32 v245, v144
    v_mfma_f32_16x16x32_bf16 a[84:87], v[228:231], v[168:171], a[84:87]
    v_exp_f32 v246, v145
    v_mfma_f32_16x16x32_bf16 a[92:95], v[228:231], v[172:175], a[92:95]
    s_waitcnt lgkmcnt(6)
    v_mfma_f32_16x16x32_bf16 a[96:99], v[208:211], v[160:163], a[96:99]
    ds_read_b64_tr_b16 v[228:229], v237 offset:24832
    ds_read_b64_tr_b16 v[230:231], v237 offset:30976
    v_mfma_f32_16x16x32_bf16 a[104:107], v[208:211], v[164:167], a[104:107]
    v_cvt_pk_bf16_f32 v181, v247, v248
    v_mfma_f32_16x16x32_bf16 a[112:115], v[208:211], v[168:171], a[112:115]
    v_exp_f32 v247, v146
    v_mfma_f32_16x16x32_bf16 a[120:123], v[208:211], v[172:175], a[120:123]
    v_mfma_f32_16x16x32_bf16 a[100:103], v[212:215], v[160:163], a[100:103]
    ds_read_b128 v[208:211], v232 offset:36864
    v_cvt_pk_bf16_f32 v184, v245, v246
    v_mfma_f32_16x16x32_bf16 a[108:111], v[212:215], v[164:167], a[108:111]
    v_exp_f32 v248, v147
    v_mfma_f32_16x16x32_bf16 a[116:119], v[212:215], v[168:171], a[116:119]
    v_mfma_f32_16x16x32_bf16 a[124:127], v[212:215], v[172:175], a[124:127]
    s_waitcnt lgkmcnt(5)
    v_mfma_f32_16x16x32_bf16 a[128:131], v[216:219], v[160:163], a[128:131]
    ds_read_b128 v[212:215], v233 offset:36864
    v_mfma_f32_16x16x32_bf16 a[136:139], v[216:219], v[164:167], a[136:139]
    v_exp_f32 v245, v152
    v_mfma_f32_16x16x32_bf16 a[144:147], v[216:219], v[168:171], a[144:147]
    v_exp_f32 v246, v153
    v_mfma_f32_16x16x32_bf16 a[152:155], v[216:219], v[172:175], a[152:155]
    s_waitcnt vmcnt(19)
    s_barrier
    v_mfma_f32_16x16x32_bf16 a[132:135], v[220:223], v[160:163], a[132:135]
    ds_read_b128 v[216:219], v232 offset:36992
    v_mfma_f32_16x16x32_bf16 a[140:143], v[220:223], v[164:167], a[140:143]
    s_add_u32 m0, s34, 49152
    s_nop 0
    buffer_load_dwordx4 v238, s[48:51], s36 offen offset:0  lds
    v_mfma_f32_16x16x32_bf16 a[148:151], v[220:223], v[168:171], a[148:151]
    v_cvt_pk_bf16_f32 v185, v247, v248
    v_mfma_f32_16x16x32_bf16 a[156:159], v[220:223], v[172:175], a[156:159]
    s_waitcnt lgkmcnt(3)
    v_mfma_f32_16x16x32_bf16 a[160:163], v[224:227], v[160:163], a[160:163]
    ds_read_b128 v[220:223], v233 offset:36992
    v_mfma_f32_16x16x32_bf16 a[168:171], v[224:227], v[164:167], a[168:171]
    v_exp_f32 v247, v154
    v_mfma_f32_16x16x32_bf16 a[176:179], v[224:227], v[168:171], a[176:179]
    v_cvt_pk_bf16_f32 v188, v245, v246
    v_mfma_f32_16x16x32_bf16 a[184:187], v[224:227], v[172:175], a[184:187]
    v_exp_f32 v248, v155
    v_mfma_f32_16x16x32_bf16 a[164:167], v[228:231], v[160:163], a[164:167]
    ds_read_b128 v[224:227], v232 offset:37120
    v_mfma_f32_16x16x32_bf16 a[172:175], v[228:231], v[164:167], a[172:175]
    v_exp_f32 v245, v132
    v_mfma_f32_16x16x32_bf16 a[180:183], v[228:231], v[168:171], a[180:183]
    buffer_load_dwordx4 v239, s[48:51], s36 offen offset:1024  lds
    v_mfma_f32_16x16x32_bf16 a[188:191], v[228:231], v[172:175], a[188:191]
    v_exp_f32 v246, v133
    v_mfma_f32_16x16x32_bf16 a[192:195], a[208:211], v[160:163], a[192:195]
    v_cvt_pk_bf16_f32 v189, v247, v248
    v_mfma_f32_16x16x32_bf16 a[196:199], a[208:211], v[164:167], a[196:199]
    v_exp_f32 v247, v134
    v_mfma_f32_16x16x32_bf16 a[200:203], a[208:211], v[168:171], a[200:203]
    v_cvt_pk_bf16_f32 v178, v245, v246
    v_mfma_f32_16x16x32_bf16 a[204:207], a[208:211], v[172:175], a[204:207]
    s_waitcnt lgkmcnt(3)
    v_mfma_f32_16x16x32_bf16 v[96:99], v[208:211], v[0:3], v[192:195]
    ds_read_b128 v[228:231], v233 offset:37120
    buffer_load_dwordx4 v240, s[48:51], s36 offen offset:2048  lds
    v_mfma_f32_16x16x32_bf16 v[104:107], v[208:211], v[4:7], v[196:199]
    v_exp_f32 v248, v135
    v_mfma_f32_16x16x32_bf16 v[112:115], v[208:211], v[8:11], v[200:203]
    v_exp_f32 v245, v140
    v_mfma_f32_16x16x32_bf16 v[120:123], v[208:211], v[12:15], v[204:207]
    v_mfma_f32_16x16x32_bf16 v[96:99], v[212:215], v[16:19], v[96:99]
    ds_read_b128 v[208:211], v232 offset:43008
    v_mfma_f32_16x16x32_bf16 v[104:107], v[212:215], v[20:23], v[104:107]
    v_exp_f32 v246, v141
    v_mfma_f32_16x16x32_bf16 v[112:115], v[212:215], v[24:27], v[112:115]
    v_cvt_pk_bf16_f32 v179, v247, v248
    v_mfma_f32_16x16x32_bf16 v[120:123], v[212:215], v[28:31], v[120:123]
    s_waitcnt lgkmcnt(3)
    v_mfma_f32_16x16x32_bf16 v[96:99], v[216:219], v[32:35], v[96:99]
    ds_read_b128 v[212:215], v233 offset:43008
    v_mfma_f32_16x16x32_bf16 v[104:107], v[216:219], v[36:39], v[104:107]
    v_exp_f32 v247, v142
    v_mfma_f32_16x16x32_bf16 v[112:115], v[216:219], v[40:43], v[112:115]
    s_add_u32 m0, s34, 52224
    s_nop 0
    buffer_load_dwordx4 v241, s[48:51], s36 offen offset:0  lds
    v_mfma_f32_16x16x32_bf16 v[120:123], v[216:219], v[44:47], v[120:123]
    v_cvt_pk_bf16_f32 v182, v245, v246
    v_mfma_f32_16x16x32_bf16 v[96:99], v[220:223], v[48:51], v[96:99]
    ds_read_b128 v[216:219], v232 offset:43136
    v_mfma_f32_16x16x32_bf16 v[104:107], v[220:223], v[52:55], v[104:107]
    v_exp_f32 v248, v143
    v_mfma_f32_16x16x32_bf16 v[112:115], v[220:223], v[56:59], v[112:115]
    v_exp_f32 v245, v148
    v_mfma_f32_16x16x32_bf16 v[120:123], v[220:223], v[60:63], v[120:123]
    s_waitcnt lgkmcnt(3)
    v_mfma_f32_16x16x32_bf16 v[96:99], v[224:227], v[64:67], v[96:99]
    ds_read_b128 v[220:223], v233 offset:43136
    v_mfma_f32_16x16x32_bf16 v[104:107], v[224:227], v[68:71], v[104:107]
    v_exp_f32 v246, v149
    v_mfma_f32_16x16x32_bf16 v[112:115], v[224:227], v[72:75], v[112:115]
    buffer_load_dwordx4 v242, s[48:51], s36 offen offset:1024  lds
    v_cvt_pk_bf16_f32 v183, v247, v248
    v_mfma_f32_16x16x32_bf16 v[120:123], v[224:227], v[76:79], v[120:123]
    v_exp_f32 v247, v150
    v_mfma_f32_16x16x32_bf16 v[96:99], v[228:231], v[80:83], v[96:99]
    ds_read_b128 v[224:227], v232 offset:43264
    v_cvt_pk_bf16_f32 v186, v245, v246
    v_mfma_f32_16x16x32_bf16 v[104:107], v[228:231], v[84:87], v[104:107]
    v_exp_f32 v248, v151
    v_mfma_f32_16x16x32_bf16 v[112:115], v[228:231], v[88:91], v[112:115]
    v_mfma_f32_16x16x32_bf16 v[120:123], v[228:231], v[92:95], v[120:123]
    s_waitcnt lgkmcnt(3)
    v_mfma_f32_16x16x32_bf16 v[100:103], v[208:211], v[0:3], v[192:195]
    ds_read_b128 v[228:231], v233 offset:43264
    v_mfma_f32_16x16x32_bf16 v[108:111], v[208:211], v[4:7], v[196:199]
    buffer_load_dwordx4 v243, s[48:51], s36 offen offset:2048  lds
    s_add_u32 s36, s36, 786432
    v_mfma_f32_16x16x32_bf16 v[116:119], v[208:211], v[8:11], v[200:203]
    v_exp_f32 v245, v156
    v_mfma_f32_16x16x32_bf16 v[124:127], v[208:211], v[12:15], v[204:207]
    v_exp_f32 v246, v157
    v_mfma_f32_16x16x32_bf16 v[100:103], v[212:215], v[16:19], v[100:103]
    v_add_u32 v234, 0xc000, v234
    v_add_u32 v235, 0xc000, v235
    v_add_u32 v236, 0xc000, v236
    v_add_u32 v237, 0xc000, v237
    ds_read_b64_tr_b16 v[208:209], v234 offset:0
    ds_read_b64_tr_b16 v[210:211], v234 offset:6144
    v_mfma_f32_16x16x32_bf16 v[108:111], v[212:215], v[20:23], v[108:111]
    v_cvt_pk_bf16_f32 v187, v247, v248
    v_mfma_f32_16x16x32_bf16 v[116:119], v[212:215], v[24:27], v[116:119]
    v_exp_f32 v247, v158
    v_mfma_f32_16x16x32_bf16 v[124:127], v[212:215], v[28:31], v[124:127]
    v_cvt_pk_bf16_f32 v190, v245, v246
    s_waitcnt lgkmcnt(4)
    v_mfma_f32_16x16x32_bf16 v[100:103], v[216:219], v[32:35], v[100:103]
    ds_read_b64_tr_b16 v[212:213], v235 offset:0
    ds_read_b64_tr_b16 v[214:215], v235 offset:6144
    v_mfma_f32_16x16x32_bf16 v[108:111], v[216:219], v[36:39], v[108:111]
    v_exp_f32 v248, v159
    v_mfma_f32_16x16x32_bf16 v[116:119], v[216:219], v[40:43], v[116:119]
    s_nop 0
    v_cvt_pk_bf16_f32 v191, v247, v248
    v_mfma_f32_16x16x32_bf16 v[124:127], v[216:219], v[44:47], v[124:127]
    v_mfma_f32_16x16x32_bf16 v[100:103], v[220:223], v[48:51], v[100:103]
    ds_read_b64_tr_b16 v[216:217], v236 offset:0
    ds_read_b64_tr_b16 v[218:219], v236 offset:6144
    v_mfma_f32_16x16x32_bf16 v[108:111], v[220:223], v[52:55], v[108:111]
    v_or3_b32 v245, v176, v177, v178
    v_or3_b32 v245, v245, v179, v180
    v_mfma_f32_16x16x32_bf16 v[116:119], v[220:223], v[56:59], v[116:119]
    v_or3_b32 v245, v245, v181, v182
    v_mfma_f32_16x16x32_bf16 v[124:127], v[220:223], v[60:63], v[124:127]
    s_waitcnt lgkmcnt(6)
    v_mfma_f32_16x16x32_bf16 v[100:103], v[224:227], v[64:67], v[100:103]
    ds_read_b64_tr_b16 v[220:221], v237 offset:0
    ds_read_b64_tr_b16 v[222:223], v237 offset:6144
    v_mfma_f32_16x16x32_bf16 v[108:111], v[224:227], v[68:71], v[108:111]
    v_or3_b32 v245, v245, v183, v184
    v_or3_b32 v245, v245, v185, v186
    v_mfma_f32_16x16x32_bf16 v[116:119], v[224:227], v[72:75], v[116:119]
    v_or3_b32 v245, v245, v187, v188
    v_mfma_f32_16x16x32_bf16 v[124:127], v[224:227], v[76:79], v[124:127]
    v_mfma_f32_16x16x32_bf16 v[100:103], v[228:231], v[80:83], v[100:103]
    ds_read_b64_tr_b16 v[224:225], v234 offset:128
    ds_read_b64_tr_b16 v[226:227], v234 offset:6272
    v_or3_b32 v245, v245, v189, v190
    v_mfma_f32_16x16x32_bf16 v[108:111], v[228:231], v[84:87], v[108:111]
    v_or_b32 v245, v245, v191
    v_and_b32 v245, 0x40004000, v245
    v_mfma_f32_16x16x32_bf16 v[116:119], v[228:231], v[88:91], v[116:119]
    v_mfma_f32_16x16x32_bf16 v[124:127], v[228:231], v[92:95], v[124:127]
    v_cmp_ne_u32 vcc, 0, v245
    s_cbranch_vccnz Lrare_28
Lrare_28_back:
    s_waitcnt lgkmcnt(6)
    v_mfma_f32_16x16x32_bf16 a[0:3], v[208:211], v[176:179], a[0:3]
    ds_read_b64_tr_b16 v[228:229], v235 offset:128
    ds_read_b64_tr_b16 v[230:231], v235 offset:6272
    v_mfma_f32_16x16x32_bf16 a[8:11], v[208:211], v[180:183], a[8:11]
    v_exp_f32 v245, v96
    v_mfma_f32_16x16x32_bf16 a[16:19], v[208:211], v[184:187], a[16:19]
    v_exp_f32 v246, v97
    v_mfma_f32_16x16x32_bf16 a[24:27], v[208:211], v[188:191], a[24:27]
    v_mfma_f32_16x16x32_bf16 a[4:7], v[212:215], v[176:179], a[4:7]
    ds_read_b64_tr_b16 v[208:209], v236 offset:128
    ds_read_b64_tr_b16 v[210:211], v236 offset:6272
    v_mfma_f32_16x16x32_bf16 a[12:15], v[212:215], v[180:183], a[12:15]
    v_exp_f32 v247, v98
    v_mfma_f32_16x16x32_bf16 a[20:23], v[212:215], v[184:187], a[20:23]
    v_cvt_pk_bf16_f32 v160, v245, v246
    v_mfma_f32_16x16x32_bf16 a[28:31], v[212:215], v[188:191], a[28:31]
    s_waitcnt lgkmcnt(6)
    v_mfma_f32_16x16x32_bf16 a[32:35], v[216:219], v[176:179], a[32:35]
    ds_read_b64_tr_b16 v[212:213], v237 offset:128
    ds_read_b64_tr_b16 v[214:215], v237 offset:6272
    v_mfma_f32_16x16x32_bf16 a[40:43], v[216:219], v[180:183], a[40:43]
    v_exp_f32 v248, v99
    v_mfma_f32_16x16x32_bf16 a[48:51], v[216:219], v[184:187], a[48:51]
    v_exp_f32 v245, v104
    v_mfma_f32_16x16x32_bf16 a[56:59], v[216:219], v[188:191], a[56:59]
    v_mfma_f32_16x16x32_bf16 a[36:39], v[220:223], v[176:179], a[36:39]
    ds_read_b64_tr_b16 v[216:217], v234 offset:256
    ds_read_b64_tr_b16 v[218:219], v234 offset:6400
    v_mfma_f32_16x16x32_bf16 a[44:47], v[220:223], v[180:183], a[44:47]
    v_exp_f32 v246, v105
    v_mfma_f32_16x16x32_bf16 a[52:55], v[220:223], v[184:187], a[52:55]
    v_cvt_pk_bf16_f32 v161, v247, v248
    v_mfma_f32_16x16x32_bf16 a[60:63], v[220:223], v[188:191], a[60:63]
    s_waitcnt lgkmcnt(6)
    v_mfma_f32_16x16x32_bf16 a[64:67], v[224:227], v[176:179], a[64:67]
    ds_read_b64_tr_b16 v[220:221], v235 offset:256
    ds_read_b64_tr_b16 v[222:223], v235 offset:6400
    v_mfma_f32_16x16x32_bf16 a[72:75], v[224:227], v[180:183], a[72:75]
    v_exp_f32 v247, v106
    v_mfma_f32_16x16x32_bf16 a[80:83], v[224:227], v[184:187], a[80:83]
    v_cvt_pk_bf16_f32 v164, v245, v246
    v_mfma_f32_16x16x32_bf16 a[88:91], v[224:227], v[188:191], a[88:91]
    v_exp_f32 v248, v107
    v_mfma_f32_16x16x32_bf16 a[68:71], v[228:231], v[176:179], a[68:71]
    ds_read_b64_tr_b16 v[224:225], v236 offset:256
    ds_read_b64_tr_b16 v[226:227], v236 offset:6400
    v_mfma_f32_16x16x32_bf16 a[76:79], v[228:231], v[180:183], a[76:79]
    v_exp_f32 v245, v112
    v_mfma_f32_16x16x32_bf16 a[84:87], v[228:231], v[184:187], a[84:87]
    v_exp_f32 v246, v113
    v_mfma_f32_16x16x32_bf16 a[92:95], v[228:231], v[188:191], a[92:95]
    s_waitcnt lgkmcnt(6)
    v_mfma_f32_16x16x32_bf16 a[96:99], v[208:211], v[176:179], a[96:99]
    ds_read_b64_tr_b16 v[228:229], v237 offset:256
    ds_read_b64_tr_b16 v[230:231], v237 offset:6400
    v_mfma_f32_16x16x32_bf16 a[104:107], v[208:211], v[180:183], a[104:107]
    v_cvt_pk_bf16_f32 v165, v247, v248
    v_mfma_f32_16x16x32_bf16 a[112:115], v[208:211], v[184:187], a[112:115]
    v_exp_f32 v247, v114
    v_mfma_f32_16x16x32_bf16 a[120:123], v[208:211], v[188:191], a[120:123]
    v_mfma_f32_16x16x32_bf16 a[100:103], v[212:215], v[176:179], a[100:103]
    v_add_u32 v232, 0xc000, v232
    v_add_u32 v233, 0xc000, v233
    ds_read_b128 v[208:211], v232 offset:12288
    v_cvt_pk_bf16_f32 v168, v245, v246
    v_mfma_f32_16x16x32_bf16 a[108:111], v[212:215], v[180:183], a[108:111]
    v_exp_f32 v248, v115
    v_mfma_f32_16x16x32_bf16 a[116:119], v[212:215], v[184:187], a[116:119]
    v_mfma_f32_16x16x32_bf16 a[124:127], v[212:215], v[188:191], a[124:127]
    s_waitcnt lgkmcnt(5)
    v_mfma_f32_16x16x32_bf16 a[128:131], v[216:219], v[176:179], a[128:131]
    ds_read_b128 v[212:215], v233 offset:12288
    v_mfma_f32_16x16x32_bf16 a[136:139], v[216:219], v[180:183], a[136:139]
    v_exp_f32 v245, v120
    v_mfma_f32_16x16x32_bf16 a[144:147], v[216:219], v[184:187], a[144:147]
    v_exp_f32 v246, v121
    v_mfma_f32_16x16x32_bf16 a[152:155], v[216:219], v[188:191], a[152:155]
    s_waitcnt vmcnt(19)
    s_barrier
    v_mfma_f32_16x16x32_bf16 a[132:135], v[220:223], v[176:179], a[132:135]
    ds_read_b128 v[216:219], v232 offset:12416
    v_mfma_f32_16x16x32_bf16 a[140:143], v[220:223], v[180:183], a[140:143]
    s_add_u32 m0, s34, 73728
    s_nop 0
    buffer_load_dwordx4 v238, s[48:51], s36 offen offset:0  lds
    v_mfma_f32_16x16x32_bf16 a[148:151], v[220:223], v[184:187], a[148:151]
    v_cvt_pk_bf16_f32 v169, v247, v248
    v_mfma_f32_16x16x32_bf16 a[156:159], v[220:223], v[188:191], a[156:159]
    s_waitcnt lgkmcnt(3)
    v_mfma_f32_16x16x32_bf16 a[160:163], v[224:227], v[176:179], a[160:163]
    ds_read_b128 v[220:223], v233 offset:12416
    v_mfma_f32_16x16x32_bf16 a[168:171], v[224:227], v[180:183], a[168:171]
    v_exp_f32 v247, v122
    v_mfma_f32_16x16x32_bf16 a[176:179], v[224:227], v[184:187], a[176:179]
    v_cvt_pk_bf16_f32 v172, v245, v246
    v_mfma_f32_16x16x32_bf16 a[184:187], v[224:227], v[188:191], a[184:187]
    v_exp_f32 v248, v123
    v_mfma_f32_16x16x32_bf16 a[164:167], v[228:231], v[176:179], a[164:167]
    ds_read_b128 v[224:227], v232 offset:12544
    v_mfma_f32_16x16x32_bf16 a[172:175], v[228:231], v[180:183], a[172:175]
    v_exp_f32 v245, v100
    v_mfma_f32_16x16x32_bf16 a[180:183], v[228:231], v[184:187], a[180:183]
    buffer_load_dwordx4 v239, s[48:51], s36 offen offset:1024  lds
    v_mfma_f32_16x16x32_bf16 a[188:191], v[228:231], v[188:191], a[188:191]
    v_exp_f32 v246, v101
    v_mfma_f32_16x16x32_bf16 a[192:195], a[208:211], v[176:179], a[192:195]
    v_cvt_pk_bf16_f32 v173, v247, v248
    v_mfma_f32_16x16x32_bf16 a[196:199], a[208:211], v[180:183], a[196:199]
    v_exp_f32 v247, v102
    v_mfma_f32_16x16x32_bf16 a[200:203], a[208:211], v[184:187], a[200:203]
    v_cvt_pk_bf16_f32 v162, v245, v246
    v_mfma_f32_16x16x32_bf16 a[204:207], a[208:211], v[188:191], a[204:207]
    s_waitcnt lgkmcnt(3)
    v_mfma_f32_16x16x32_bf16 v[128:131], v[208:211], v[0:3], v[192:195]
    ds_read_b128 v[228:231], v233 offset:12544
    buffer_load_dwordx4 v240, s[48:51], s36 offen offset:2048  lds
    v_mfma_f32_16x16x32_bf16 v[136:139], v[208:211], v[4:7], v[196:199]
    v_exp_f32 v248, v103
    v_mfma_f32_16x16x32_bf16 v[144:147], v[208:211], v[8:11], v[200:203]
    v_exp_f32 v245, v108
    v_mfma_f32_16x16x32_bf16 v[152:155], v[208:211], v[12:15], v[204:207]
    v_mfma_f32_16x16x32_bf16 v[128:131], v[212:215], v[16:19], v[128:131]
    ds_read_b128 v[208:211], v232 offset:18432
    v_mfma_f32_16x16x32_bf16 v[136:139], v[212:215], v[20:23], v[136:139]
    v_exp_f32 v246, v109
    v_mfma_f32_16x16x32_bf16 v[144:147], v[212:215], v[24:27], v[144:147]
    v_cvt_pk_bf16_f32 v163, v247, v248
    v_mfma_f32_16x16x32_bf16 v[152:155], v[212:215], v[28:31], v[152:155]
    s_waitcnt lgkmcnt(3)
    v_mfma_f32_16x16x32_bf16 v[128:131], v[216:219], v[32:35], v[128:131]
    ds_read_b128 v[212:215], v233 offset:18432
    v_mfma_f32_16x16x32_bf16 v[136:139], v[216:219], v[36:39], v[136:139]
    v_exp_f32 v247, v110
    v_mfma_f32_16x16x32_bf16 v[144:147], v[216:219], v[40:43], v[144:147]
    s_add_u32 m0, s34, 76800
    s_nop 0
    buffer_load_dwordx4 v241, s[48:51], s36 offen offset:0  lds
    v_mfma_f32_16x16x32_bf16 v[152:155], v[216:219], v[44:47], v[152:155]
    v_cvt_pk_bf16_f32 v166, v245, v246
    v_mfma_f32_16x16x32_bf16 v[128:131], v[220:223], v[48:51], v[128:131]
    ds_read_b128 v[216:219], v232 offset:18560
    v_mfma_f32_16x16x32_bf16 v[136:139], v[220:223], v[52:55], v[136:139]
    v_exp_f32 v248, v111
    v_mfma_f32_16x16x32_bf16 v[144:147], v[220:223], v[56:59], v[144:147]
    v_exp_f32 v245, v116
    v_mfma_f32_16x16x32_bf16 v[152:155], v[220:223], v[60:63], v[152:155]
    s_waitcnt lgkmcnt(3)
    v_mfma_f32_16x16x32_bf16 v[128:131], v[224:227], v[64:67], v[128:131]
    ds_read_b128 v[220:223], v233 offset:18560
    v_mfma_f32_16x16x32_bf16 v[136:139], v[224:227], v[68:71], v[136:139]
    v_exp_f32 v246, v117
    v_mfma_f32_16x16x32_bf16 v[144:147], v[224:227], v[72:75], v[144:147]
    buffer_load_dwordx4 v242, s[48:51], s36 offen offset:1024  lds
    v_cvt_pk_bf16_f32 v167, v247, v248
    v_mfma_f32_16x16x32_bf16 v[152:155], v[224:227], v[76:79], v[152:155]
    v_exp_f32 v247, v118
    v_mfma_f32_16x16x32_bf16 v[128:131], v[228:231], v[80:83], v[128:131]
    ds_read_b128 v[224:227], v232 offset:18688
    v_cvt_pk_bf16_f32 v170, v245, v246
    v_mfma_f32_16x16x32_bf16 v[136:139], v[228:231], v[84:87], v[136:139]
    v_exp_f32 v248, v119
    v_mfma_f32_16x16x32_bf16 v[144:147], v[228:231], v[88:91], v[144:147]
    v_mfma_f32_16x16x32_bf16 v[152:155], v[228:231], v[92:95], v[152:155]
    s_waitcnt lgkmcnt(3)
    v_mfma_f32_16x16x32_bf16 v[132:135], v[208:211], v[0:3], v[192:195]
    ds_read_b128 v[228:231], v233 offset:18688
    v_mfma_f32_16x16x32_bf16 v[140:143], v[208:211], v[4:7], v[196:199]
    buffer_load_dwordx4 v243, s[48:51], s36 offen offset:2048  lds
    s_add_u32 s36, s36, 786432
    v_mfma_f32_16x16x32_bf16 v[148:151], v[208:211], v[8:11], v[200:203]
    v_exp_f32 v245, v124
    v_mfma_f32_16x16x32_bf16 v[156:159], v[208:211], v[12:15], v[204:207]
    v_exp_f32 v246, v125
    v_mfma_f32_16x16x32_bf16 v[132:135], v[212:215], v[16:19], v[132:135]
    ds_read_b64_tr_b16 v[208:209], v234 offset:24576
    ds_read_b64_tr_b16 v[210:211], v234 offset:30720
    v_mfma_f32_16x16x32_bf16 v[140:143], v[212:215], v[20:23], v[140:143]
    v_cvt_pk_bf16_f32 v171, v247, v248
    v_mfma_f32_16x16x32_bf16 v[148:151], v[212:215], v[24:27], v[148:151]
    v_exp_f32 v247, v126
    v_mfma_f32_16x16x32_bf16 v[156:159], v[212:215], v[28:31], v[156:159]
    v_cvt_pk_bf16_f32 v174, v245, v246
    s_waitcnt lgkmcnt(4)
    v_mfma_f32_16x16x32_bf16 v[132:135], v[216:219], v[32:35], v[132:135]
    ds_read_b64_tr_b16 v[212:213], v235 offset:24576
    ds_read_b64_tr_b16 v[214:215], v235 offset:30720
    v_mfma_f32_16x16x32_bf16 v[140:143], v[216:219], v[36:39], v[140:143]
    v_exp_f32 v248, v127
    v_mfma_f32_16x16x32_bf16 v[148:151], v[216:219], v[40:43], v[148:151]
    s_nop 0
    v_cvt_pk_bf16_f32 v175, v247, v248
    v_mfma_f32_16x16x32_bf16 v[156:159], v[216:219], v[44:47], v[156:159]
    v_mfma_f32_16x16x32_bf16 v[132:135], v[220:223], v[48:51], v[132:135]
    ds_read_b64_tr_b16 v[216:217], v236 offset:24576
    ds_read_b64_tr_b16 v[218:219], v236 offset:30720
    v_mfma_f32_16x16x32_bf16 v[140:143], v[220:223], v[52:55], v[140:143]
    v_or3_b32 v245, v160, v161, v162
    v_or3_b32 v245, v245, v163, v164
    v_mfma_f32_16x16x32_bf16 v[148:151], v[220:223], v[56:59], v[148:151]
    v_or3_b32 v245, v245, v165, v166
    v_mfma_f32_16x16x32_bf16 v[156:159], v[220:223], v[60:63], v[156:159]
    s_waitcnt lgkmcnt(6)
    v_mfma_f32_16x16x32_bf16 v[132:135], v[224:227], v[64:67], v[132:135]
    ds_read_b64_tr_b16 v[220:221], v237 offset:24576
    ds_read_b64_tr_b16 v[222:223], v237 offset:30720
    v_mfma_f32_16x16x32_bf16 v[140:143], v[224:227], v[68:71], v[140:143]
    v_or3_b32 v245, v245, v167, v168
    v_or3_b32 v245, v245, v169, v170
    v_mfma_f32_16x16x32_bf16 v[148:151], v[224:227], v[72:75], v[148:151]
    v_or3_b32 v245, v245, v171, v172
    v_mfma_f32_16x16x32_bf16 v[156:159], v[224:227], v[76:79], v[156:159]
    v_mfma_f32_16x16x32_bf16 v[132:135], v[228:231], v[80:83], v[132:135]
    ds_read_b64_tr_b16 v[224:225], v234 offset:24704
    ds_read_b64_tr_b16 v[226:227], v234 offset:30848
    v_or3_b32 v245, v245, v173, v174
    v_mfma_f32_16x16x32_bf16 v[140:143], v[228:231], v[84:87], v[140:143]
    v_or_b32 v245, v245, v175
    v_and_b32 v245, 0x40004000, v245
    v_mfma_f32_16x16x32_bf16 v[148:151], v[228:231], v[88:91], v[148:151]
    v_mfma_f32_16x16x32_bf16 v[156:159], v[228:231], v[92:95], v[156:159]
    v_cmp_ne_u32 vcc, 0, v245
    s_cbranch_vccnz Lrare_29
Lrare_29_back:
    s_waitcnt vmcnt(12)
Lb_poll:
    v_readfirstlane_b32 s62, v253
    s_nop 3
    s_cmp_ge_u32 s62, 20
    s_cbranch_scc1 Lb_go
    s_sleep 4
    buffer_load_dword v253, v252, s[64:67], s68 offen sc1
    s_waitcnt vmcnt(0)
    s_branch Lb_poll
Lb_go:
    s_waitcnt lgkmcnt(6)
    v_mfma_f32_16x16x32_bf16 a[0:3], v[208:211], v[160:163], a[0:3]
    ds_read_b64_tr_b16 v[228:229], v235 offset:24704
    ds_read_b64_tr_b16 v[230:231], v235 offset:30848
    s_mov_b32 s63, 0
    buffer_load_dwordx4 v[0:3], v244, s[52:55], s63 offen offset:0 sc1
    v_mfma_f32_16x16x32_bf16 a[8:11], v[208:211], v[164:167], a[8:11]
    s_mov_b32 s63, 0
    buffer_load_dwordx4 v[16:19], v244, s[52:55], s63 offen offset:1024 sc1
    v_mfma_f32_16x16x32_bf16 a[16:19], v[208:211], v[168:171], a[16:19]
    v_exp_f32 v245, v128
    v_exp_f32 v246, v129
    v_mfma_f32_16x16x32_bf16 a[24:27], v[208:211], v[172:175], a[24:27]
    v_exp_f32 v247, v130
    v_cvt_pk_bf16_f32 v176, v245, v246
    v_mfma_f32_16x16x32_bf16 a[4:7], v[212:215], v[160:163], a[4:7]
    ds_read_b64_tr_b16 v[208:209], v236 offset:24704
    ds_read_b64_tr_b16 v[210:211], v236 offset:30848
    s_mov_b32 s63, 20480
    buffer_load_dwordx4 v[4:7], v244, s[52:55], s63 offen offset:0 sc1
    v_mfma_f32_16x16x32_bf16 a[12:15], v[212:215], v[164:167], a[12:15]
    s_mov_b32 s63, 20480
    buffer_load_dwordx4 v[20:23], v244, s[52:55], s63 offen offset:1024 sc1
    v_mfma_f32_16x16x32_bf16 a[20:23], v[212:215], v[168:171], a[20:23]
    v_exp_f32 v248, v131
    v_exp_f32 v245, v136
    v_mfma_f32_16x16x32_bf16 a[28:31], v[212:215], v[172:175], a[28:31]
    v_exp_f32 v246, v137
    v_cvt_pk_bf16_f32 v177, v247, v248
    s_waitcnt lgkmcnt(6)
    v_mfma_f32_16x16x32_bf16 a[32:35], v[216:219], v[160:163], a[32:35]
    ds_read_b64_tr_b16 v[212:213], v237 offset:24704
    ds_read_b64_tr_b16 v[214:215], v237 offset:30848
    s_mov_b32 s63, 40960
    buffer_load_dwordx4 v[8:11], v244, s[52:55], s63 offen offset:0 sc1
    s_mov_b32 s63, 40960
    buffer_load_dwordx4 v[24:27], v244, s[52:55], s63 offen offset:1024 sc1
    v_mfma_f32_16x16x32_bf16 a[40:43], v[216:219], v[164:167], a[40:43]
    v_exp_f32 v247, v138
    v_cvt_pk_bf16_f32 v180, v245, v246
    v_mfma_f32_16x16x32_bf16 a[48:51], v[216:219], v[168:171], a[48:51]
    v_exp_f32 v248, v139
    v_mfma_f32_16x16x32_bf16 a[56:59], v[216:219], v[172:175], a[56:59]
    v_exp_f32 v245, v144
    v_exp_f32 v246, v145
    v_mfma_f32_16x16x32_bf16 a[36:39], v[220:223], v[160:163], a[36:39]
    ds_read_b64_tr_b16 v[216:217], v234 offset:24832
    ds_read_b64_tr_b16 v[218:219], v234 offset:30976
    s_mov_b32 s63, 61440
    buffer_load_dwordx4 v[12:15], v244, s[52:55], s63 offen offset:0 sc1
    v_mfma_f32_16x16x32_bf16 a[44:47], v[220:223], v[164:167], a[44:47]
    s_mov_b32 s63, 61440
    buffer_load_dwordx4 v[28:31], v244, s[52:55], s63 offen offset:1024 sc1
    v_cvt_pk_bf16_f32 v181, v247, v248
    v_mfma_f32_16x16x32_bf16 a[52:55], v[220:223], v[168:171], a[52:55]
    v_exp_f32 v247, v146
    v_cvt_pk_bf16_f32 v184, v245, v246
    v_mfma_f32_16x16x32_bf16 a[60:63], v[220:223], v[172:175], a[60:63]
    v_exp_f32 v248, v147
    s_waitcnt lgkmcnt(6)
    v_mfma_f32_16x16x32_bf16 a[64:67], v[224:227], v[160:163], a[64:67]
    ds_read_b64_tr_b16 v[220:221], v235 offset:24832
    ds_read_b64_tr_b16 v[222:223], v235 offset:30976
    s_mov_b32 s63, 2048
    buffer_load_dwordx4 v[32:35], v244, s[52:55], s63 offen offset:0 sc1
    v_mfma_f32_16x16x32_bf16 a[72:75], v[224:227], v[164:167], a[72:75]
    s_mov_b32 s63, 2048
    buffer_load_dwordx4 v[48:51], v244, s[52:55], s63 offen offset:1024 sc1
    v_exp_f32 v245, v152
    v_mfma_f32_16x16x32_bf16 a[80:83], v[224:227], v[168:171], a[80:83]
    v_exp_f32 v246, v153
    v_cvt_pk_bf16_f32 v185, v247, v248
    v_mfma_f32_16x16x32_bf16 a[88:91], v[224:227], v[172:175], a[88:91]
    v_exp_f32 v247, v154
    v_cvt_pk_bf16_f32 v188, v245, v246
    s_barrier
    v_mfma_f32_16x16x32_bf16 a[68:71], v[228:231], v[160:163], a[68:71]
    ds_read_b64_tr_b16 v[224:225], v236 offset:24832
    ds_read_b64_tr_b16 v[226:227], v236 offset:30976
    s_mov_b32 s63, 22528
    buffer_load_dwordx4 v[36:39], v244, s[52:55], s63 offen offset:0 sc1
    v_mfma_f32_16x16x32_bf16 a[76:79], v[228:231], v[164:167], a[76:79]
    s_mov_b32 s63, 22528
    buffer_load_dwordx4 v[52:55], v244, s[52:55], s63 offen offset:1024 sc1
    v_mfma_f32_16x16x32_bf16 a[84:87], v[228:231], v[168:171], a[84:87]
    v_exp_f32 v248, v155
    v_exp_f32 v245, v132
    v_mfma_f32_16x16x32_bf16 a[92:95], v[228:231], v[172:175], a[92:95]
    v_exp_f32 v246, v133
    v_cvt_pk_bf16_f32 v189, v247, v248
    s_waitcnt lgkmcnt(6)
    v_mfma_f32_16x16x32_bf16 a[96:99], v[208:211], v[160:163], a[96:99]
    ds_read_b64_tr_b16 v[228:229], v237 offset:24832
    ds_read_b64_tr_b16 v[230:231], v237 offset:30976
    s_mov_b32 s63, 43008
    buffer_load_dwordx4 v[40:43], v244, s[52:55], s63 offen offset:0 sc1
    s_mov_b32 s63, 43008
    buffer_load_dwordx4 v[56:59], v244, s[52:55], s63 offen offset:1024 sc1
    v_mfma_f32_16x16x32_bf16 a[104:107], v[208:211], v[164:167], a[104:107]
    s_add_u32 m0, s34, 98304
    s_nop 0
    buffer_load_dwordx4 v238, s[48:51], s36 offen offset:0  lds
    v_mfma_f32_16x16x32_bf16 a[112:115], v[208:211], v[168:171], a[112:115]
    v_exp_f32 v247, v134
    v_cvt_pk_bf16_f32 v178, v245, v246
    v_mfma_f32_16x16x32_bf16 a[120:123], v[208:211], v[172:175], a[120:123]
    v_exp_f32 v248, v135
    v_exp_f32 v245, v140
    v_mfma_f32_16x16x32_bf16 a[100:103], v[212:215], v[160:163], a[100:103]
    ds_read_b64_tr_b16 v[208:209], v234 offset:36864
    ds_read_b64_tr_b16 v[210:211], v234 offset:43008
    s_mov_b32 s63, 63488
    buffer_load_dwordx4 v[44:47], v244, s[52:55], s63 offen offset:0 sc1
    s_mov_b32 s63, 63488
    buffer_load_dwordx4 v[60:63], v244, s[52:55], s63 offen offset:1024 sc1
    v_mfma_f32_16x16x32_bf16 a[108:111], v[212:215], v[164:167], a[108:111]
    buffer_load_dwordx4 v239, s[48:51], s36 offen offset:1024  lds
    v_exp_f32 v246, v141
    v_mfma_f32_16x16x32_bf16 a[116:119], v[212:215], v[168:171], a[116:119]
    v_cvt_pk_bf16_f32 v179, v247, v248
    v_exp_f32 v247, v142
    v_mfma_f32_16x16x32_bf16 a[124:127], v[212:215], v[172:175], a[124:127]
    v_cvt_pk_bf16_f32 v182, v245, v246
    v_exp_f32 v248, v143
    s_waitcnt lgkmcnt(6)
    v_mfma_f32_16x16x32_bf16 a[128:131], v[216:219], v[160:163], a[128:131]
    ds_read_b64_tr_b16 v[212:213], v235 offset:36864
    ds_read_b64_tr_b16 v[214:215], v235 offset:43008
    s_mov_b32 s63, 4096
    buffer_load_dwordx4 v[64:67], v244, s[52:55], s63 offen offset:0 sc1
    v_mfma_f32_16x16x32_bf16 a[136:139], v[216:219], v[164:167], a[136:139]
    s_mov_b32 s63, 4096
    buffer_load_dwordx4 v[80:83], v244, s[52:55], s63 offen offset:1024 sc1
    buffer_load_dwordx4 v240, s[48:51], s36 offen offset:2048  lds
    v_mfma_f32_16x16x32_bf16 a[144:147], v[216:219], v[168:171], a[144:147]
    v_exp_f32 v245, v148
    v_exp_f32 v246, v149
    v_mfma_f32_16x16x32_bf16 a[152:155], v[216:219], v[172:175], a[152:155]
    v_cvt_pk_bf16_f32 v183, v247, v248
    v_exp_f32 v247, v150
    v_mfma_f32_16x16x32_bf16 a[132:135], v[220:223], v[160:163], a[132:135]
    ds_read_b64_tr_b16 v[216:217], v236 offset:36864
    ds_read_b64_tr_b16 v[218:219], v236 offset:43008
    s_mov_b32 s63, 24576
    buffer_load_dwordx4 v[68:71], v244, s[52:55], s63 offen offset:0 sc1
    s_mov_b32 s63, 24576
    buffer_load_dwordx4 v[84:87], v244, s[52:55], s63 offen offset:1024 sc1
    v_mfma_f32_16x16x32_bf16 a[140:143], v[220:223], v[164:167], a[140:143]
    s_add_u32 m0, s34, 101376
    s_nop 0
    buffer_load_dwordx4 v241, s[48:51], s36 offen offset:0  lds
    v_cvt_pk_bf16_f32 v186, v245, v246
    v_mfma_f32_16x16x32_bf16 a[148:151], v[220:223], v[168:171], a[148:151]
    v_exp_f32 v248, v151
    v_exp_f32 v245, v156
    v_mfma_f32_16x16x32_bf16 a[156:159], v[220:223], v[172:175], a[156:159]
    v_exp_f32 v246, v157
    v_cvt_pk_bf16_f32 v187, v247, v248
    s_waitcnt lgkmcnt(6)
    v_mfma_f32_16x16x32_bf16 a[160:163], v[224:227], v[160:163], a[160:163]
    ds_read_b64_tr_b16 v[220:221], v237 offset:36864
    ds_read_b64_tr_b16 v[222:223], v237 offset:43008
    s_mov_b32 s63, 45056
    buffer_load_dwordx4 v[72:75], v244, s[52:55], s63 offen offset:0 sc1
    v_mfma_f32_16x16x32_bf16 a[168:171], v[224:227], v[164:167], a[168:171]
    s_mov_b32 s63, 45056
    buffer_load_dwordx4 v[88:91], v244, s[52:55], s63 offen offset:1024 sc1
    buffer_load_dwordx4 v242, s[48:51], s36 offen offset:1024  lds
    v_mfma_f32_16x16x32_bf16 a[176:179], v[224:227], v[168:171], a[176:179]
    v_exp_f32 v247, v158
    v_cvt_pk_bf16_f32 v190, v245, v246
    v_mfma_f32_16x16x32_bf16 a[184:187], v[224:227], v[172:175], a[184:187]
    v_exp_f32 v248, v159
    s_nop 0
    v_cvt_pk_bf16_f32 v191, v247, v248
    v_mfma_f32_16x16x32_bf16 a[164:167], v[228:231], v[160:163], a[164:167]
    ds_read_b64_tr_b16 v[224:225], v234 offset:36992
    ds_read_b64_tr_b16 v[226:227], v234 offset:43136
    s_mov_b32 s63, 65536
    buffer_load_dwordx4 v[76:79], v244, s[52:55], s63 offen offset:0 sc1
    v_mfma_f32_16x16x32_bf16 a[172:175], v[228:231], v[164:167], a[172:175]
    s_mov_b32 s63, 65536
    buffer_load_dwordx4 v[92:95], v244, s[52:55], s63 offen offset:1024 sc1
    v_mfma_f32_16x16x32_bf16 a[180:183], v[228:231], v[168:171], a[180:183]
    buffer_load_dwordx4 v243, s[48:51], s36 offen offset:2048  lds
    s_add_u32 s36, s36, 786432
    v_or3_b32 v245, v176, v177, v178
    v_mfma_f32_16x16x32_bf16 a[188:191], v[228:231], v[172:175], a[188:191]
    v_or3_b32 v245, v245, v179, v180
    v_or3_b32 v245, v245, v181, v182
    v_or3_b32 v245, v245, v183, v184
    v_mfma_f32_16x16x32_bf16 a[192:195], a[208:211], v[160:163], a[192:195]
    v_or3_b32 v245, v245, v185, v186
    v_or3_b32 v245, v245, v187, v188
    v_mfma_f32_16x16x32_bf16 a[196:199], a[208:211], v[164:167], a[196:199]
    v_or3_b32 v245, v245, v189, v190
    v_or_b32 v245, v245, v191
    v_mfma_f32_16x16x32_bf16 a[200:203], a[208:211], v[168:171], a[200:203]
    v_and_b32 v245, 0x40004000, v245
    v_mfma_f32_16x16x32_bf16 a[204:207], a[208:211], v[172:175], a[204:207]
    v_cmp_ne_u32 vcc, 0, v245
    s_cbranch_vccnz Lrare_f
Lrare_f_back:
    s_lshl_b32 s62, s69, 3
    s_add_u32 s62, s62, s30
    s_lshl_b32 s62, s62, 2
    s_add_u32 s62, s62, s32
    s_mul_i32 s62, s62, 786432
    s_mul_i32 s63, s31, 6144
    s_add_u32 s62, s62, s63
    s_add_u32 s56, s28, s62
    s_addc_u32 s57, s29, 0
    s_mov_b32 s58, 0x91800
    s_mov_b32 s59, 0x00020000
    v_mfma_f32_16x16x32_bf16 a[192:195], a[208:211], v[176:179], a[192:195]
    s_mov_b32 s63, 6144
    buffer_load_dwordx4 v[96:99], v244, s[52:55], s63 offen offset:0 sc1
    v_mfma_f32_16x16x32_bf16 a[196:199], a[208:211], v[180:183], a[196:199]
    s_mov_b32 s63, 6144
    buffer_load_dwordx4 v[112:115], v244, s[52:55], s63 offen offset:1024 sc1
    v_mfma_f32_16x16x32_bf16 a[200:203], a[208:211], v[184:187], a[200:203]
    s_mov_b32 s63, 26624
    buffer_load_dwordx4 v[100:103], v244, s[52:55], s63 offen offset:0 sc1
    v_mfma_f32_16x16x32_bf16 a[204:207], a[208:211], v[188:191], a[204:207]
    s_mov_b32 s63, 26624
    buffer_load_dwordx4 v[116:119], v244, s[52:55], s63 offen offset:1024 sc1
    s_waitcnt lgkmcnt(6)
    v_mfma_f32_16x16x32_bf16 a[0:3], v[208:211], v[176:179], a[0:3]
    ds_read_b64_tr_b16 v[228:229], v235 offset:36992
    ds_read_b64_tr_b16 v[230:231], v235 offset:43136
    s_mov_b32 s63, 47104
    buffer_load_dwordx4 v[104:107], v244, s[52:55], s63 offen offset:0 sc1
    v_mfma_f32_16x16x32_bf16 a[8:11], v[208:211], v[180:183], a[8:11]
    s_mov_b32 s63, 47104
    buffer_load_dwordx4 v[120:123], v244, s[52:55], s63 offen offset:1024 sc1
    v_mfma_f32_16x16x32_bf16 a[16:19], v[208:211], v[184:187], a[16:19]
    s_mov_b32 s63, 67584
    buffer_load_dwordx4 v[108:111], v244, s[52:55], s63 offen offset:0 sc1
    v_mfma_f32_16x16x32_bf16 a[24:27], v[208:211], v[188:191], a[24:27]
    s_mov_b32 s63, 67584
    buffer_load_dwordx4 v[124:127], v244, s[52:55], s63 offen offset:1024 sc1
    v_mfma_f32_16x16x32_bf16 a[4:7], v[212:215], v[176:179], a[4:7]
    ds_read_b64_tr_b16 v[208:209], v236 offset:36992
    ds_read_b64_tr_b16 v[210:211], v236 offset:43136
    s_mov_b32 s63, 8192
    buffer_load_dwordx4 v[128:131], v244, s[52:55], s63 offen offset:0 sc1
    v_mfma_f32_16x16x32_bf16 a[12:15], v[212:215], v[180:183], a[12:15]
    s_mov_b32 s63, 8192
    buffer_load_dwordx4 v[144:147], v244, s[52:55], s63 offen offset:1024 sc1
    v_mfma_f32_16x16x32_bf16 a[20:23], v[212:215], v[184:187], a[20:23]
    s_mov_b32 s63, 28672
    buffer_load_dwordx4 v[132:135], v244, s[52:55], s63 offen offset:0 sc1
    v_mfma_f32_16x16x32_bf16 a[28:31], v[212:215], v[188:191], a[28:31]
    s_mov_b32 s63, 28672
    buffer_load_dwordx4 v[148:151], v244, s[52:55], s63 offen offset:1024 sc1
    s_waitcnt lgkmcnt(6)
    v_mfma_f32_16x16x32_bf16 a[32:35], v[216:219], v[176:179], a[32:35]
    ds_read_b64_tr_b16 v[212:213], v237 offset:36992
    ds_read_b64_tr_b16 v[214:215], v237 offset:43136
    s_mov_b32 s63, 49152
    buffer_load_dwordx4 v[136:139], v244, s[52:55], s63 offen offset:0 sc1
    s_mov_b32 s63, 49152
    buffer_load_dwordx4 v[152:155], v244, s[52:55], s63 offen offset:1024 sc1
    v_mfma_f32_16x16x32_bf16 a[40:43], v[216:219], v[180:183], a[40:43]
    s_mov_b32 s63, 69632
    buffer_load_dwordx4 v[140:143], v244, s[52:55], s63 offen offset:0 sc1
    s_mov_b32 s63, 69632
    buffer_load_dwordx4 v[156:159], v244, s[52:55], s63 offen offset:1024 sc1
    v_mfma_f32_16x16x32_bf16 a[48:51], v[216:219], v[184:187], a[48:51]
    v_accvgpr_read_b32 v192, a192
    v_accvgpr_read_b32 v196, a196
    v_accvgpr_read_b32 v200, a200
    v_accvgpr_read_b32 v204, a204
    v_mfma_f32_16x16x32_bf16 a[56:59], v[216:219], v[188:191], a[56:59]
    v_rcp_f32 v192, v192
    v_rcp_f32 v196, v196
    v_mfma_f32_16x16x32_bf16 a[36:39], v[220:223], v[176:179], a[36:39]
    ds_read_b64_tr_b16 v[216:217], v234 offset:37120
    ds_read_b64_tr_b16 v[218:219], v234 offset:43264
    v_rcp_f32 v200, v200
    v_mfma_f32_16x16x32_bf16 a[44:47], v[220:223], v[180:183], a[44:47]
    v_rcp_f32 v204, v204
    v_mfma_f32_16x16x32_bf16 a[52:55], v[220:223], v[184:187], a[52:55]
    v_mov_b32 v193, v192
    v_mov_b32 v197, v196
    v_mfma_f32_16x16x32_bf16 a[60:63], v[220:223], v[188:191], a[60:63]
    v_mov_b32 v201, v200
    v_mov_b32 v205, v204
    s_waitcnt lgkmcnt(6)
    v_mfma_f32_16x16x32_bf16 a[64:67], v[224:227], v[176:179], a[64:67]
    ds_read_b64_tr_b16 v[220:221], v235 offset:37120
    ds_read_b64_tr_b16 v[222:223], v235 offset:43264
    v_accvgpr_read_b32 v160, a0
    v_accvgpr_read_b32 v161, a1
    v_accvgpr_read_b32 v162, a2
    v_accvgpr_read_b32 v163, a3
    v_accvgpr_read_b32 v164, a4
    v_accvgpr_read_b32 v165, a5
    v_accvgpr_read_b32 v166, a6
    v_accvgpr_read_b32 v167, a7
    v_pk_mul_f32 v[160:161], v[160:161], v[192:193]
    v_mfma_f32_16x16x32_bf16 a[72:75], v[224:227], v[180:183], a[72:75]
    v_pk_mul_f32 v[162:163], v[162:163], v[192:193]
    v_pk_mul_f32 v[164:165], v[164:165], v[192:193]
    v_pk_mul_f32 v[166:167], v[166:167], v[192:193]
    v_cvt_pk_bf16_f32 v160, v160, v161
    v_cvt_pk_bf16_f32 v161, v162, v163
    v_cvt_pk_bf16_f32 v162, v164, v165
    v_cvt_pk_bf16_f32 v163, v166, v167
    s_mov_b32 s63, 0
    buffer_store_dwordx4 v[160:163], v244, s[56:59], s63 offen offset:0 sc1
    v_mfma_f32_16x16x32_bf16 a[80:83], v[224:227], v[184:187], a[80:83]
    v_accvgpr_read_b32 v168, a8
    v_accvgpr_read_b32 v169, a9
    v_accvgpr_read_b32 v170, a10
    v_accvgpr_read_b32 v171, a11
    v_accvgpr_read_b32 v172, a12
    v_accvgpr_read_b32 v173, a13
    v_accvgpr_read_b32 v174, a14
    v_accvgpr_read_b32 v175, a15
    v_pk_mul_f32 v[168:169], v[168:169], v[196:197]
    v_mfma_f32_16x16x32_bf16 a[88:91], v[224:227], v[188:191], a[88:91]
    v_pk_mul_f32 v[170:171], v[170:171], v[196:197]
    v_pk_mul_f32 v[172:173], v[172:173], v[196:197]
    v_pk_mul_f32 v[174:175], v[174:175], v[196:197]
    v_cvt_pk_bf16_f32 v168, v168, v169
    v_cvt_pk_bf16_f32 v169, v170, v171
    v_cvt_pk_bf16_f32 v170, v172, v173
    v_cvt_pk_bf16_f32 v171, v174, v175
    s_mov_b32 s63, 196608
    buffer_store_dwordx4 v[168:171], v244, s[56:59], s63 offen offset:0 sc1
    v_mfma_f32_16x16x32_bf16 a[68:71], v[228:231], v[176:179], a[68:71]
    ds_read_b64_tr_b16 v[224:225], v236 offset:37120
    ds_read_b64_tr_b16 v[226:227], v236 offset:43264
    v_accvgpr_read_b32 v160, a16
    v_accvgpr_read_b32 v161, a17
    v_accvgpr_read_b32 v162, a18
    v_accvgpr_read_b32 v163, a19
    v_accvgpr_read_b32 v164, a20
    v_accvgpr_read_b32 v165, a21
    v_accvgpr_read_b32 v166, a22
    v_accvgpr_read_b32 v167, a23
    v_pk_mul_f32 v[160:161], v[160:161], v[200:201]
    v_mfma_f32_16x16x32_bf16 a[76:79], v[228:231], v[180:183], a[76:79]
    v_pk_mul_f32 v[162:163], v[162:163], v[200:201]
    v_pk_mul_f32 v[164:165], v[164:165], v[200:201]
    v_pk_mul_f32 v[166:167], v[166:167], v[200:201]
    v_cvt_pk_bf16_f32 v160, v160, v161
    v_cvt_pk_bf16_f32 v161, v162, v163
    v_cvt_pk_bf16_f32 v162, v164, v165
    v_cvt_pk_bf16_f32 v163, v166, v167
    s_mov_b32 s63, 393216
    buffer_store_dwordx4 v[160:163], v244, s[56:59], s63 offen offset:0 sc1
    v_mfma_f32_16x16x32_bf16 a[84:87], v[228:231], v[184:187], a[84:87]
    v_accvgpr_read_b32 v168, a24
    v_accvgpr_read_b32 v169, a25
    v_accvgpr_read_b32 v170, a26
    v_accvgpr_read_b32 v171, a27
    v_accvgpr_read_b32 v172, a28
    v_accvgpr_read_b32 v173, a29
    v_accvgpr_read_b32 v174, a30
    v_accvgpr_read_b32 v175, a31
    v_pk_mul_f32 v[168:169], v[168:169], v[204:205]
    v_mfma_f32_16x16x32_bf16 a[92:95], v[228:231], v[188:191], a[92:95]
    v_pk_mul_f32 v[170:171], v[170:171], v[204:205]
    v_pk_mul_f32 v[172:173], v[172:173], v[204:205]
    v_pk_mul_f32 v[174:175], v[174:175], v[204:205]
    v_cvt_pk_bf16_f32 v168, v168, v169
    v_cvt_pk_bf16_f32 v169, v170, v171
    v_cvt_pk_bf16_f32 v170, v172, v173
    v_cvt_pk_bf16_f32 v171, v174, v175
    s_mov_b32 s63, 589824
    buffer_store_dwordx4 v[168:171], v244, s[56:59], s63 offen offset:0 sc1
    s_waitcnt lgkmcnt(6)
    v_mfma_f32_16x16x32_bf16 a[96:99], v[208:211], v[176:179], a[96:99]
    ds_read_b64_tr_b16 v[228:229], v237 offset:37120
    ds_read_b64_tr_b16 v[230:231], v237 offset:43264
    v_accvgpr_read_b32 v160, a32
    v_accvgpr_read_b32 v161, a33
    v_accvgpr_read_b32 v162, a34
    v_accvgpr_read_b32 v163, a35
    v_accvgpr_read_b32 v164, a36
    v_accvgpr_read_b32 v165, a37
    v_accvgpr_read_b32 v166, a38
    v_accvgpr_read_b32 v167, a39
    v_pk_mul_f32 v[160:161], v[160:161], v[192:193]
    v_mfma_f32_16x16x32_bf16 a[104:107], v[208:211], v[180:183], a[104:107]
    v_pk_mul_f32 v[162:163], v[162:163], v[192:193]
    v_pk_mul_f32 v[164:165], v[164:165], v[192:193]
    v_pk_mul_f32 v[166:167], v[166:167], v[192:193]
    v_cvt_pk_bf16_f32 v160, v160, v161
    v_cvt_pk_bf16_f32 v161, v162, v163
    v_cvt_pk_bf16_f32 v162, v164, v165
    v_cvt_pk_bf16_f32 v163, v166, v167
    s_mov_b32 s63, 0
    buffer_store_dwordx4 v[160:163], v244, s[56:59], s63 offen offset:1024 sc1
    v_mfma_f32_16x16x32_bf16 a[112:115], v[208:211], v[184:187], a[112:115]
    v_accvgpr_read_b32 v168, a40
    v_accvgpr_read_b32 v169, a41
    v_accvgpr_read_b32 v170, a42
    v_accvgpr_read_b32 v171, a43
    v_accvgpr_read_b32 v172, a44
    v_accvgpr_read_b32 v173, a45
    v_accvgpr_read_b32 v174, a46
    v_accvgpr_read_b32 v175, a47
    v_pk_mul_f32 v[168:169], v[168:169], v[196:197]
    v_mfma_f32_16x16x32_bf16 a[120:123], v[208:211], v[188:191], a[120:123]
    v_pk_mul_f32 v[170:171], v[170:171], v[196:197]
    v_pk_mul_f32 v[172:173], v[172:173], v[196:197]
    v_pk_mul_f32 v[174:175], v[174:175], v[196:197]
    v_cvt_pk_bf16_f32 v168, v168, v169
    v_cvt_pk_bf16_f32 v169, v170, v171
    v_cvt_pk_bf16_f32 v170, v172, v173
    v_cvt_pk_bf16_f32 v171, v174, v175
    s_mov_b32 s63, 196608
    buffer_store_dwordx4 v[168:171], v244, s[56:59], s63 offen offset:1024 sc1
    v_mfma_f32_16x16x32_bf16 a[100:103], v[212:215], v[176:179], a[100:103]
    v_add_u32 v234, 0xfffe8000, v234
    v_add_u32 v235, 0xfffe8000, v235
    v_add_u32 v236, 0xfffe8000, v236
    v_add_u32 v237, 0xfffe8000, v237
    ds_read_b64_tr_b16 v[208:209], v234 offset:0
    ds_read_b64_tr_b16 v[210:211], v234 offset:6144
    v_accvgpr_read_b32 v160, a48
    v_accvgpr_read_b32 v161, a49
    v_accvgpr_read_b32 v162, a50
    v_accvgpr_read_b32 v163, a51
    v_accvgpr_read_b32 v164, a52
    v_accvgpr_read_b32 v165, a53
    v_accvgpr_read_b32 v166, a54
    v_accvgpr_read_b32 v167, a55
    v_pk_mul_f32 v[160:161], v[160:161], v[200:201]
    v_mfma_f32_16x16x32_bf16 a[108:111], v[212:215], v[180:183], a[108:111]
    v_pk_mul_f32 v[162:163], v[162:163], v[200:201]
    v_pk_mul_f32 v[164:165], v[164:165], v[200:201]
    v_pk_mul_f32 v[166:167], v[166:167], v[200:201]
    v_cvt_pk_bf16_f32 v160, v160, v161
    v_cvt_pk_bf16_f32 v161, v162, v163
    v_cvt_pk_bf16_f32 v162, v164, v165
    v_cvt_pk_bf16_f32 v163, v166, v167
    s_mov_b32 s63, 393216
    buffer_store_dwordx4 v[160:163], v244, s[56:59], s63 offen offset:1024 sc1
    v_mfma_f32_16x16x32_bf16 a[116:119], v[212:215], v[184:187], a[116:119]
    v_accvgpr_read_b32 v168, a56
    v_accvgpr_read_b32 v169, a57
    v_accvgpr_read_b32 v170, a58
    v_accvgpr_read_b32 v171, a59
    v_accvgpr_read_b32 v172, a60
    v_accvgpr_read_b32 v173, a61
    v_accvgpr_read_b32 v174, a62
    v_accvgpr_read_b32 v175, a63
    v_pk_mul_f32 v[168:169], v[168:169], v[204:205]
    v_mfma_f32_16x16x32_bf16 a[124:127], v[212:215], v[188:191], a[124:127]
    v_pk_mul_f32 v[170:171], v[170:171], v[204:205]
    v_pk_mul_f32 v[172:173], v[172:173], v[204:205]
    v_pk_mul_f32 v[174:175], v[174:175], v[204:205]
    v_cvt_pk_bf16_f32 v168, v168, v169
    v_cvt_pk_bf16_f32 v169, v170, v171
    v_cvt_pk_bf16_f32 v170, v172, v173
    v_cvt_pk_bf16_f32 v171, v174, v175
    s_mov_b32 s63, 589824
    buffer_store_dwordx4 v[168:171], v244, s[56:59], s63 offen offset:1024 sc1
    s_waitcnt lgkmcnt(6)
    v_mfma_f32_16x16x32_bf16 a[128:131], v[216:219], v[176:179], a[128:131]
    ds_read_b64_tr_b16 v[212:213], v235 offset:0
    ds_read_b64_tr_b16 v[214:215], v235 offset:6144
    v_accvgpr_read_b32 v160, a64
    v_accvgpr_read_b32 v161, a65
    v_accvgpr_read_b32 v162, a66
    v_accvgpr_read_b32 v163, a67
    v_accvgpr_read_b32 v164, a68
    v_accvgpr_read_b32 v165, a69
    v_accvgpr_read_b32 v166, a70
    v_accvgpr_read_b32 v167, a71
    v_pk_mul_f32 v[160:161], v[160:161], v[192:193]
    v_mfma_f32_16x16x32_bf16 a[136:139], v[216:219], v[180:183], a[136:139]
    v_pk_mul_f32 v[162:163], v[162:163], v[192:193]
    v_pk_mul_f32 v[164:165], v[164:165], v[192:193]
    v_pk_mul_f32 v[166:167], v[166:167], v[192:193]
    v_cvt_pk_bf16_f32 v160, v160, v161
    v_cvt_pk_bf16_f32 v161, v162, v163
    v_cvt_pk_bf16_f32 v162, v164, v165
    v_cvt_pk_bf16_f32 v163, v166, v167
    s_mov_b32 s63, 0
    buffer_store_dwordx4 v[160:163], v244, s[56:59], s63 offen offset:2048 sc1
    v_mfma_f32_16x16x32_bf16 a[144:147], v[216:219], v[184:187], a[144:147]
    v_accvgpr_read_b32 v168, a72
    v_accvgpr_read_b32 v169, a73
    v_accvgpr_read_b32 v170, a74
    v_accvgpr_read_b32 v171, a75
    v_accvgpr_read_b32 v172, a76
    v_accvgpr_read_b32 v173, a77
    v_accvgpr_read_b32 v174, a78
    v_accvgpr_read_b32 v175, a79
    v_pk_mul_f32 v[168:169], v[168:169], v[196:197]
    v_mfma_f32_16x16x32_bf16 a[152:155], v[216:219], v[188:191], a[152:155]
    v_pk_mul_f32 v[170:171], v[170:171], v[196:197]
    v_pk_mul_f32 v[172:173], v[172:173], v[196:197]
    v_pk_mul_f32 v[174:175], v[174:175], v[196:197]
    v_cvt_pk_bf16_f32 v168, v168, v169
    v_cvt_pk_bf16_f32 v169, v170, v171
    v_cvt_pk_bf16_f32 v170, v172, v173
    v_cvt_pk_bf16_f32 v171, v174, v175
    s_mov_b32 s63, 196608
    buffer_store_dwordx4 v[168:171], v244, s[56:59], s63 offen offset:2048 sc1
    v_mfma_f32_16x16x32_bf16 a[132:135], v[220:223], v[176:179], a[132:135]
    ds_read_b64_tr_b16 v[216:217], v236 offset:0
    ds_read_b64_tr_b16 v[218:219], v236 offset:6144
    v_accvgpr_read_b32 v160, a80
    v_accvgpr_read_b32 v161, a81
    v_accvgpr_read_b32 v162, a82
    v_accvgpr_read_b32 v163, a83
    v_accvgpr_read_b32 v164, a84
    v_accvgpr_read_b32 v165, a85
    v_accvgpr_read_b32 v166, a86
    v_accvgpr_read_b32 v167, a87
    v_pk_mul_f32 v[160:161], v[160:161], v[200:201]
    v_mfma_f32_16x16x32_bf16 a[140:143], v[220:223], v[180:183], a[140:143]
    v_pk_mul_f32 v[162:163], v[162:163], v[200:201]
    v_pk_mul_f32 v[164:165], v[164:165], v[200:201]
    v_pk_mul_f32 v[166:167], v[166:167], v[200:201]
    v_cvt_pk_bf16_f32 v160, v160, v161
    v_cvt_pk_bf16_f32 v161, v162, v163
    v_cvt_pk_bf16_f32 v162, v164, v165
    v_cvt_pk_bf16_f32 v163, v166, v167
    s_mov_b32 s63, 393216
    buffer_store_dwordx4 v[160:163], v244, s[56:59], s63 offen offset:2048 sc1
    v_mfma_f32_16x16x32_bf16 a[148:151], v[220:223], v[184:187], a[148:151]
    v_accvgpr_read_b32 v168, a88
    v_accvgpr_read_b32 v169, a89
    v_accvgpr_read_b32 v170, a90
    v_accvgpr_read_b32 v171, a91
    v_accvgpr_read_b32 v172, a92
    v_accvgpr_read_b32 v173, a93
    v_accvgpr_read_b32 v174, a94
    v_accvgpr_read_b32 v175, a95
    v_pk_mul_f32 v[168:169], v[168:169], v[204:205]
    v_mfma_f32_16x16x32_bf16 a[156:159], v[220:223], v[188:191], a[156:159]
    v_pk_mul_f32 v[170:171], v[170:171], v[204:205]
    v_pk_mul_f32 v[172:173], v[172:173], v[204:205]
    v_pk_mul_f32 v[174:175], v[174:175], v[204:205]
    v_cvt_pk_bf16_f32 v168, v168, v169
    v_cvt_pk_bf16_f32 v169, v170, v171
    v_cvt_pk_bf16_f32 v170, v172, v173
    v_cvt_pk_bf16_f32 v171, v174, v175
    s_mov_b32 s63, 589824
    buffer_store_dwordx4 v[168:171], v244, s[56:59], s63 offen offset:2048 sc1
    s_waitcnt lgkmcnt(6)
    v_mfma_f32_16x16x32_bf16 a[160:163], v[224:227], v[176:179], a[160:163]
    ds_read_b64_tr_b16 v[220:221], v237 offset:0
    ds_read_b64_tr_b16 v[222:223], v237 offset:6144
    v_accvgpr_read_b32 v160, a96
    v_accvgpr_read_b32 v161, a97
    v_accvgpr_read_b32 v162, a98
    v_accvgpr_read_b32 v163, a99
    v_accvgpr_read_b32 v164, a100
    v_accvgpr_read_b32 v165, a101
    v_accvgpr_read_b32 v166, a102
    v_accvgpr_read_b32 v167, a103
    v_pk_mul_f32 v[160:161], v[160:161], v[192:193]
    v_mfma_f32_16x16x32_bf16 a[168:171], v[224:227], v[180:183], a[168:171]
    v_pk_mul_f32 v[162:163], v[162:163], v[192:193]
    v_pk_mul_f32 v[164:165], v[164:165], v[192:193]
    v_pk_mul_f32 v[166:167], v[166:167], v[192:193]
    v_cvt_pk_bf16_f32 v160, v160, v161
    v_cvt_pk_bf16_f32 v161, v162, v163
    v_cvt_pk_bf16_f32 v162, v164, v165
    v_cvt_pk_bf16_f32 v163, v166, v167
    s_mov_b32 s63, 0
    buffer_store_dwordx4 v[160:163], v244, s[56:59], s63 offen offset:3072 sc1
    v_mfma_f32_16x16x32_bf16 a[176:179], v[224:227], v[184:187], a[176:179]
    v_accvgpr_read_b32 v168, a104
    v_accvgpr_read_b32 v169, a105
    v_accvgpr_read_b32 v170, a106
    v_accvgpr_read_b32 v171, a107
    v_accvgpr_read_b32 v172, a108
    v_accvgpr_read_b32 v173, a109
    v_accvgpr_read_b32 v174, a110
    v_accvgpr_read_b32 v175, a111
    v_pk_mul_f32 v[168:169], v[168:169], v[196:197]
    v_mfma_f32_16x16x32_bf16 a[184:187], v[224:227], v[188:191], a[184:187]
    v_pk_mul_f32 v[170:171], v[170:171], v[196:197]
    v_pk_mul_f32 v[172:173], v[172:173], v[196:197]
    v_pk_mul_f32 v[174:175], v[174:175], v[196:197]
    v_cvt_pk_bf16_f32 v168, v168, v169
    v_cvt_pk_bf16_f32 v169, v170, v171
    v_cvt_pk_bf16_f32 v170, v172, v173
    v_cvt_pk_bf16_f32 v171, v174, v175
    s_mov_b32 s63, 196608
    buffer_store_dwordx4 v[168:171], v244, s[56:59], s63 offen offset:3072 sc1
    v_mfma_f32_16x16x32_bf16 a[164:167], v[228:231], v[176:179], a[164:167]
    ds_read_b64_tr_b16 v[224:225], v234 offset:128
    ds_read_b64_tr_b16 v[226:227], v234 offset:6272
    v_accvgpr_read_b32 v160, a112
    v_accvgpr_read_b32 v161, a113
    v_accvgpr_read_b32 v162, a114
    v_accvgpr_read_b32 v163, a115
    v_accvgpr_read_b32 v164, a116
    v_accvgpr_read_b32 v165, a117
    v_accvgpr_read_b32 v166, a118
    v_accvgpr_read_b32 v167, a119
    v_pk_mul_f32 v[160:161], v[160:161], v[200:201]
    v_mfma_f32_16x16x32_bf16 a[172:175], v[228:231], v[180:183], a[172:175]
    v_pk_mul_f32 v[162:163], v[162:163], v[200:201]
    v_pk_mul_f32 v[164:165], v[164:165], v[200:201]
    v_pk_mul_f32 v[166:167], v[166:167], v[200:201]
    v_cvt_pk_bf16_f32 v160, v160, v161
    v_cvt_pk_bf16_f32 v161, v162, v163
    v_cvt_pk_bf16_f32 v162, v164, v165
    v_cvt_pk_bf16_f32 v163, v166, v167
    s_mov_b32 s63, 393216
    buffer_store_dwordx4 v[160:163], v244, s[56:59], s63 offen offset:3072 sc1
    v_mfma_f32_16x16x32_bf16 a[180:183], v[228:231], v[184:187], a[180:183]
    v_accvgpr_read_b32 v168, a120
    v_accvgpr_read_b32 v169, a121
    v_accvgpr_read_b32 v170, a122
    v_accvgpr_read_b32 v171, a123
    v_accvgpr_read_b32 v172, a124
    v_accvgpr_read_b32 v173, a125
    v_accvgpr_read_b32 v174, a126
    v_accvgpr_read_b32 v175, a127
    v_pk_mul_f32 v[168:169], v[168:169], v[204:205]
    v_mfma_f32_16x16x32_bf16 a[188:191], v[228:231], v[188:191], a[188:191]
    v_pk_mul_f32 v[170:171], v[170:171], v[204:205]
    v_pk_mul_f32 v[172:173], v[172:173], v[204:205]
    v_pk_mul_f32 v[174:175], v[174:175], v[204:205]
    v_cvt_pk_bf16_f32 v168, v168, v169
    v_cvt_pk_bf16_f32 v169, v170, v171
    v_cvt_pk_bf16_f32 v170, v172, v173
    v_cvt_pk_bf16_f32 v171, v174, v175
    s_mov_b32 s63, 589824
    buffer_store_dwordx4 v[168:171], v244, s[56:59], s63 offen offset:3072 sc1
    s_cmp_lg_u32 s69, 0
    s_cbranch_scc1 Ltail
    s_waitcnt vmcnt(54)
    s_waitcnt lgkmcnt(6)
    v_mfma_f32_16x16x32_bf16 a[0:3], v[208:211], v[0:3], 0
    ds_read_b64_tr_b16 v[228:229], v235 offset:128
    ds_read_b64_tr_b16 v[230:231], v235 offset:6272
    v_accvgpr_read_b32 v160, a128
    v_accvgpr_read_b32 v161, a129
    v_accvgpr_read_b32 v162, a130
    v_accvgpr_read_b32 v163, a131
    v_accvgpr_read_b32 v164, a132
    v_accvgpr_read_b32 v165, a133
    v_accvgpr_read_b32 v166, a134
    v_accvgpr_read_b32 v167, a135
    v_pk_mul_f32 v[160:161], v[160:161], v[192:193]
    v_mfma_f32_16x16x32_bf16 a[8:11], v[208:211], v[4:7], 0
    v_pk_mul_f32 v[162:163], v[162:163], v[192:193]
    v_pk_mul_f32 v[164:165], v[164:165], v[192:193]
    v_pk_mul_f32 v[166:167], v[166:167], v[192:193]
    v_cvt_pk_bf16_f32 v160, v160, v161
    v_cvt_pk_bf16_f32 v161, v162, v163
    v_cvt_pk_bf16_f32 v162, v164, v165
    v_cvt_pk_bf16_f32 v163, v166, v167
    s_mov_b32 s63, 4096
    buffer_store_dwordx4 v[160:163], v244, s[56:59], s63 offen offset:0 sc1
    v_mfma_f32_16x16x32_bf16 a[16:19], v[208:211], v[8:11], 0
    v_accvgpr_read_b32 v168, a136
    v_accvgpr_read_b32 v169, a137
    v_accvgpr_read_b32 v170, a138
    v_accvgpr_read_b32 v171, a139
    v_accvgpr_read_b32 v172, a140
    v_accvgpr_read_b32 v173, a141
    v_accvgpr_read_b32 v174, a142
    v_accvgpr_read_b32 v175, a143
    v_pk_mul_f32 v[168:169], v[168:169], v[196:197]
    v_mfma_f32_16x16x32_bf16 a[24:27], v[208:211], v[12:15], 0
    v_pk_mul_f32 v[170:171], v[170:171], v[196:197]
    v_pk_mul_f32 v[172:173], v[172:173], v[196:197]
    v_pk_mul_f32 v[174:175], v[174:175], v[196:197]
    v_cvt_pk_bf16_f32 v168, v168, v169
    v_cvt_pk_bf16_f32 v169, v170, v171
    v_cvt_pk_bf16_f32 v170, v172, v173
    v_cvt_pk_bf16_f32 v171, v174, v175
    s_mov_b32 s63, 200704
    buffer_store_dwordx4 v[168:171], v244, s[56:59], s63 offen offset:0 sc1
    v_mfma_f32_16x16x32_bf16 a[4:7], v[212:215], v[0:3], 0
    ds_read_b64_tr_b16 v[208:209], v236 offset:128
    ds_read_b64_tr_b16 v[210:211], v236 offset:6272
    v_accvgpr_read_b32 v160, a144
    v_accvgpr_read_b32 v161, a145
    v_accvgpr_read_b32 v162, a146
    v_accvgpr_read_b32 v163, a147
    v_accvgpr_read_b32 v164, a148
    v_accvgpr_read_b32 v165, a149
    v_accvgpr_read_b32 v166, a150
    v_accvgpr_read_b32 v167, a151
    v_pk_mul_f32 v[160:161], v[160:161], v[200:201]
    v_mfma_f32_16x16x32_bf16 a[12:15], v[212:215], v[4:7], 0
    v_pk_mul_f32 v[162:163], v[162:163], v[200:201]
    v_pk_mul_f32 v[164:165], v[164:165], v[200:201]
    v_pk_mul_f32 v[166:167], v[166:167], v[200:201]
    v_cvt_pk_bf16_f32 v160, v160, v161
    v_cvt_pk_bf16_f32 v161, v162, v163
    v_cvt_pk_bf16_f32 v162, v164, v165
    v_cvt_pk_bf16_f32 v163, v166, v167
    s_mov_b32 s63, 397312
    buffer_store_dwordx4 v[160:163], v244, s[56:59], s63 offen offset:0 sc1
    v_mfma_f32_16x16x32_bf16 a[20:23], v[212:215], v[8:11], 0
    v_accvgpr_read_b32 v168, a152
    v_accvgpr_read_b32 v169, a153
    v_accvgpr_read_b32 v170, a154
    v_accvgpr_read_b32 v171, a155
    v_accvgpr_read_b32 v172, a156
    v_accvgpr_read_b32 v173, a157
    v_accvgpr_read_b32 v174, a158
    v_accvgpr_read_b32 v175, a159
    v_pk_mul_f32 v[168:169], v[168:169], v[204:205]
    v_mfma_f32_16x16x32_bf16 a[28:31], v[212:215], v[12:15], 0
    v_pk_mul_f32 v[170:171], v[170:171], v[204:205]
    v_pk_mul_f32 v[172:173], v[172:173], v[204:205]
    v_pk_mul_f32 v[174:175], v[174:175], v[204:205]
    v_cvt_pk_bf16_f32 v168, v168, v169
    v_cvt_pk_bf16_f32 v169, v170, v171
    v_cvt_pk_bf16_f32 v170, v172, v173
    v_cvt_pk_bf16_f32 v171, v174, v175
    s_mov_b32 s63, 593920
    buffer_store_dwordx4 v[168:171], v244, s[56:59], s63 offen offset:0 sc1
    s_waitcnt lgkmcnt(6)
    v_mfma_f32_16x16x32_bf16 a[32:35], v[216:219], v[0:3], 0
    ds_read_b64_tr_b16 v[212:213], v237 offset:128
    ds_read_b64_tr_b16 v[214:215], v237 offset:6272
    v_accvgpr_read_b32 v160, a160
    v_accvgpr_read_b32 v161, a161
    v_accvgpr_read_b32 v162, a162
    v_accvgpr_read_b32 v163, a163
    v_accvgpr_read_b32 v164, a164
    v_accvgpr_read_b32 v165, a165
    v_accvgpr_read_b32 v166, a166
    v_accvgpr_read_b32 v167, a167
    v_pk_mul_f32 v[160:161], v[160:161], v[192:193]
    v_mfma_f32_16x16x32_bf16 a[40:43], v[216:219], v[4:7], 0
    v_pk_mul_f32 v[162:163], v[162:163], v[192:193]
    v_pk_mul_f32 v[164:165], v[164:165], v[192:193]
    v_pk_mul_f32 v[166:167], v[166:167], v[192:193]
    v_cvt_pk_bf16_f32 v160, v160, v161
    v_cvt_pk_bf16_f32 v161, v162, v163
    v_cvt_pk_bf16_f32 v162, v164, v165
    v_cvt_pk_bf16_f32 v163, v166, v167
    s_mov_b32 s63, 4096
    buffer_store_dwordx4 v[160:163], v244, s[56:59], s63 offen offset:1024 sc1
    v_mfma_f32_16x16x32_bf16 a[48:51], v[216:219], v[8:11], 0
    v_accvgpr_read_b32 v168, a168
    v_accvgpr_read_b32 v169, a169
    v_accvgpr_read_b32 v170, a170
    v_accvgpr_read_b32 v171, a171
    v_accvgpr_read_b32 v172, a172
    v_accvgpr_read_b32 v173, a173
    v_accvgpr_read_b32 v174, a174
    v_accvgpr_read_b32 v175, a175
    v_pk_mul_f32 v[168:169], v[168:169], v[196:197]
    v_mfma_f32_16x16x32_bf16 a[56:59], v[216:219], v[12:15], 0
    v_pk_mul_f32 v[170:171], v[170:171], v[196:197]
    v_pk_mul_f32 v[172:173], v[172:173], v[196:197]
    v_pk_mul_f32 v[174:175], v[174:175], v[196:197]
    v_cvt_pk_bf16_f32 v168, v168, v169
    v_cvt_pk_bf16_f32 v169, v170, v171
    v_cvt_pk_bf16_f32 v170, v172, v173
    v_cvt_pk_bf16_f32 v171, v174, v175
    s_mov_b32 s63, 200704
    buffer_store_dwordx4 v[168:171], v244, s[56:59], s63 offen offset:1024 sc1
    v_mfma_f32_16x16x32_bf16 a[36:39], v[220:223], v[0:3], 0
    ds_read_b64_tr_b16 v[216:217], v234 offset:256
    ds_read_b64_tr_b16 v[218:219], v234 offset:6400
    v_accvgpr_read_b32 v160, a176
    v_accvgpr_read_b32 v161, a177
    v_accvgpr_read_b32 v162, a178
    v_accvgpr_read_b32 v163, a179
    v_accvgpr_read_b32 v164, a180
    v_accvgpr_read_b32 v165, a181
    v_accvgpr_read_b32 v166, a182
    v_accvgpr_read_b32 v167, a183
    v_pk_mul_f32 v[160:161], v[160:161], v[200:201]
    v_mfma_f32_16x16x32_bf16 a[44:47], v[220:223], v[4:7], 0
    v_pk_mul_f32 v[162:163], v[162:163], v[200:201]
    v_pk_mul_f32 v[164:165], v[164:165], v[200:201]
    v_pk_mul_f32 v[166:167], v[166:167], v[200:201]
    v_cvt_pk_bf16_f32 v160, v160, v161
    v_cvt_pk_bf16_f32 v161, v162, v163
    v_cvt_pk_bf16_f32 v162, v164, v165
    v_cvt_pk_bf16_f32 v163, v166, v167
    s_mov_b32 s63, 397312
    buffer_store_dwordx4 v[160:163], v244, s[56:59], s63 offen offset:1024 sc1
    v_mfma_f32_16x16x32_bf16 a[52:55], v[220:223], v[8:11], 0
    v_accvgpr_read_b32 v168, a184
    v_accvgpr_read_b32 v169, a185
    v_accvgpr_read_b32 v170, a186
    v_accvgpr_read_b32 v171, a187
    v_accvgpr_read_b32 v172, a188
    v_accvgpr_read_b32 v173, a189
    v_accvgpr_read_b32 v174, a190
    v_accvgpr_read_b32 v175, a191
    v_pk_mul_f32 v[168:169], v[168:169], v[204:205]
    v_mfma_f32_16x16x32_bf16 a[60:63], v[220:223], v[12:15], 0
    v_pk_mul_f32 v[170:171], v[170:171], v[204:205]
    v_pk_mul_f32 v[172:173], v[172:173], v[204:205]
    v_pk_mul_f32 v[174:175], v[174:175], v[204:205]
    v_cvt_pk_bf16_f32 v168, v168, v169
    v_cvt_pk_bf16_f32 v169, v170, v171
    v_cvt_pk_bf16_f32 v170, v172, v173
    v_cvt_pk_bf16_f32 v171, v174, v175
    s_mov_b32 s63, 593920
    buffer_store_dwordx4 v[168:171], v244, s[56:59], s63 offen offset:1024 sc1
    s_waitcnt lgkmcnt(6)
    v_mfma_f32_16x16x32_bf16 a[64:67], v[224:227], v[0:3], 0
    ds_read_b64_tr_b16 v[220:221], v235 offset:256
    ds_read_b64_tr_b16 v[222:223], v235 offset:6400
    v_mfma_f32_16x16x32_bf16 a[72:75], v[224:227], v[4:7], 0
    v_mfma_f32_16x16x32_bf16 a[80:83], v[224:227], v[8:11], 0
    v_mfma_f32_16x16x32_bf16 a[88:91], v[224:227], v[12:15], 0
    v_mfma_f32_16x16x32_bf16 a[68:71], v[228:231], v[0:3], 0
    ds_read_b64_tr_b16 v[224:225], v236 offset:256
    ds_read_b64_tr_b16 v[226:227], v236 offset:6400
    v_mfma_f32_16x16x32_bf16 a[76:79], v[228:231], v[4:7], 0
    v_mfma_f32_16x16x32_bf16 a[84:87], v[228:231], v[8:11], 0
    v_mfma_f32_16x16x32_bf16 a[92:95], v[228:231], v[12:15], 0
    s_waitcnt lgkmcnt(6)
    v_mfma_f32_16x16x32_bf16 a[96:99], v[208:211], v[0:3], 0
    ds_read_b64_tr_b16 v[228:229], v237 offset:256
    ds_read_b64_tr_b16 v[230:231], v237 offset:6400
    v_mfma_f32_16x16x32_bf16 a[104:107], v[208:211], v[4:7], 0
    v_mfma_f32_16x16x32_bf16 a[112:115], v[208:211], v[8:11], 0
    v_mfma_f32_16x16x32_bf16 a[120:123], v[208:211], v[12:15], 0
    v_mfma_f32_16x16x32_bf16 a[100:103], v[212:215], v[0:3], 0
    ds_read_b64_tr_b16 v[208:209], v234 offset:12288
    ds_read_b64_tr_b16 v[210:211], v234 offset:18432
    v_mfma_f32_16x16x32_bf16 a[108:111], v[212:215], v[4:7], 0
    v_mfma_f32_16x16x32_bf16 a[116:119], v[212:215], v[8:11], 0
    v_mfma_f32_16x16x32_bf16 a[124:127], v[212:215], v[12:15], 0
    s_waitcnt lgkmcnt(6)
    v_mfma_f32_16x16x32_bf16 a[128:131], v[216:219], v[0:3], 0
    ds_read_b64_tr_b16 v[212:213], v235 offset:12288
    ds_read_b64_tr_b16 v[214:215], v235 offset:18432
    v_mfma_f32_16x16x32_bf16 a[136:139], v[216:219], v[4:7], 0
    v_mfma_f32_16x16x32_bf16 a[144:147], v[216:219], v[8:11], 0
    v_mfma_f32_16x16x32_bf16 a[152:155], v[216:219], v[12:15], 0
    s_barrier
    v_mfma_f32_16x16x32_bf16 a[132:135], v[220:223], v[0:3], 0
    ds_read_b64_tr_b16 v[216:217], v236 offset:12288
    ds_read_b64_tr_b16 v[218:219], v236 offset:18432
    v_mfma_f32_16x16x32_bf16 a[140:143], v[220:223], v[4:7], 0
    s_add_u32 m0, s34, 122880
    s_nop 0
    buffer_load_dwordx4 v238, s[48:51], s36 offen offset:0  lds
    v_mfma_f32_16x16x32_bf16 a[148:151], v[220:223], v[8:11], 0
    v_mfma_f32_16x16x32_bf16 a[156:159], v[220:223], v[12:15], 0
    s_waitcnt lgkmcnt(6)
    v_mfma_f32_16x16x32_bf16 a[160:163], v[224:227], v[0:3], 0
    ds_read_b64_tr_b16 v[220:221], v237 offset:12288
    ds_read_b64_tr_b16 v[222:223], v237 offset:18432
    v_mfma_f32_16x16x32_bf16 a[168:171], v[224:227], v[4:7], 0
    v_mfma_f32_16x16x32_bf16 a[176:179], v[224:227], v[8:11], 0
    v_mfma_f32_16x16x32_bf16 a[184:187], v[224:227], v[12:15], 0
    v_mfma_f32_16x16x32_bf16 a[164:167], v[228:231], v[0:3], 0
    ds_read_b64_tr_b16 v[224:225], v234 offset:12416
    ds_read_b64_tr_b16 v[226:227], v234 offset:18560
    buffer_load_dwordx4 v239, s[48:51], s36 offen offset:1024  lds
    v_mfma_f32_16x16x32_bf16 a[172:175], v[228:231], v[4:7], 0
    v_mfma_f32_16x16x32_bf16 a[180:183], v[228:231], v[8:11], 0
    v_mfma_f32_16x16x32_bf16 a[188:191], v[228:231], v[12:15], 0
    s_waitcnt lgkmcnt(6)
    v_mfma_f32_16x16x32_bf16 a[0:3], v[208:211], v[16:19], a[0:3]
    ds_read_b64_tr_b16 v[228:229], v235 offset:12416
    ds_read_b64_tr_b16 v[230:231], v235 offset:18560
    v_mfma_f32_16x16x32_bf16 a[8:11], v[208:211], v[20:23], a[8:11]
    v_mfma_f32_16x16x32_bf16 a[16:19], v[208:211], v[24:27], a[16:19]
    v_mfma_f32_16x16x32_bf16 a[24:27], v[208:211], v[28:31], a[24:27]
    v_mfma_f32_16x16x32_bf16 a[4:7], v[212:215], v[16:19], a[4:7]
    ds_read_b64_tr_b16 v[208:209], v236 offset:12416
    ds_read_b64_tr_b16 v[210:211], v236 offset:18560
    buffer_load_dwordx4 v240, s[48:51], s36 offen offset:2048  lds
    v_mfma_f32_16x16x32_bf16 a[12:15], v[212:215], v[20:23], a[12:15]
    v_mfma_f32_16x16x32_bf16 a[20:23], v[212:215], v[24:27], a[20:23]
    v_mfma_f32_16x16x32_bf16 a[28:31], v[212:215], v[28:31], a[28:31]
    s_waitcnt lgkmcnt(6)
    v_mfma_f32_16x16x32_bf16 a[32:35], v[216:219], v[16:19], a[32:35]
    ds_read_b64_tr_b16 v[212:213], v237 offset:12416
    ds_read_b64_tr_b16 v[214:215], v237 offset:18560
    v_mfma_f32_16x16x32_bf16 a[40:43], v[216:219], v[20:23], a[40:43]
    v_mfma_f32_16x16x32_bf16 a[48:51], v[216:219], v[24:27], a[48:51]
    v_mfma_f32_16x16x32_bf16 a[56:59], v[216:219], v[28:31], a[56:59]
    v_mfma_f32_16x16x32_bf16 a[36:39], v[220:223], v[16:19], a[36:39]
    ds_read_b64_tr_b16 v[216:217], v234 offset:12544
    ds_read_b64_tr_b16 v[218:219], v234 offset:18688
    v_mfma_f32_16x16x32_bf16 a[44:47], v[220:223], v[20:23], a[44:47]
    s_add_u32 m0, s34, 125952
    s_nop 0
    buffer_load_dwordx4 v241, s[48:51], s36 offen offset:0  lds
    v_mfma_f32_16x16x32_bf16 a[52:55], v[220:223], v[24:27], a[52:55]
    v_mfma_f32_16x16x32_bf16 a[60:63], v[220:223], v[28:31], a[60:63]
    s_waitcnt lgkmcnt(6)
    v_mfma_f32_16x16x32_bf16 a[64:67], v[224:227], v[16:19], a[64:67]
    ds_read_b64_tr_b16 v[220:221], v235 offset:12544
    ds_read_b64_tr_b16 v[222:223], v235 offset:18688
    v_mfma_f32_16x16x32_bf16 a[72:75], v[224:227], v[20:23], a[72:75]
    v_mfma_f32_16x16x32_bf16 a[80:83], v[224:227], v[24:27], a[80:83]
    v_mfma_f32_16x16x32_bf16 a[88:91], v[224:227], v[28:31], a[88:91]
    v_mfma_f32_16x16x32_bf16 a[68:71], v[228:231], v[16:19], a[68:71]
    ds_read_b64_tr_b16 v[224:225], v236 offset:12544
    ds_read_b64_tr_b16 v[226:227], v236 offset:18688
    buffer_load_dwordx4 v242, s[48:51], s36 offen offset:1024  lds
    v_mfma_f32_16x16x32_bf16 a[76:79], v[228:231], v[20:23], a[76:79]
    v_mfma_f32_16x16x32_bf16 a[84:87], v[228:231], v[24:27], a[84:87]
    v_mfma_f32_16x16x32_bf16 a[92:95], v[228:231], v[28:31], a[92:95]
    s_waitcnt lgkmcnt(6)
    v_mfma_f32_16x16x32_bf16 a[96:99], v[208:211], v[16:19], a[96:99]
    ds_read_b64_tr_b16 v[228:229], v237 offset:12544
    ds_read_b64_tr_b16 v[230:231], v237 offset:18688
    v_mfma_f32_16x16x32_bf16 a[104:107], v[208:211], v[20:23], a[104:107]
    v_mfma_f32_16x16x32_bf16 a[112:115], v[208:211], v[24:27], a[112:115]
    v_mfma_f32_16x16x32_bf16 a[120:123], v[208:211], v[28:31], a[120:123]
    v_mfma_f32_16x16x32_bf16 a[100:103], v[212:215], v[16:19], a[100:103]
    ds_read_b64_tr_b16 v[208:209], v234 offset:24576
    ds_read_b64_tr_b16 v[210:211], v234 offset:30720
    v_mfma_f32_16x16x32_bf16 a[108:111], v[212:215], v[20:23], a[108:111]
    buffer_load_dwordx4 v243, s[48:51], s36 offen offset:2048  lds
    s_add_u32 s36, s36, 786432
    v_mfma_f32_16x16x32_bf16 a[116:119], v[212:215], v[24:27], a[116:119]
    v_mfma_f32_16x16x32_bf16 a[124:127], v[212:215], v[28:31], a[124:127]
    s_waitcnt lgkmcnt(6)
    v_mfma_f32_16x16x32_bf16 a[128:131], v[216:219], v[16:19], a[128:131]
    ds_read_b64_tr_b16 v[212:213], v235 offset:24576
    ds_read_b64_tr_b16 v[214:215], v235 offset:30720
    v_mfma_f32_16x16x32_bf16 a[136:139], v[216:219], v[20:23], a[136:139]
    v_mfma_f32_16x16x32_bf16 a[144:147], v[216:219], v[24:27], a[144:147]
    v_mfma_f32_16x16x32_bf16 a[152:155], v[216:219], v[28:31], a[152:155]
    v_mfma_f32_16x16x32_bf16 a[132:135], v[220:223], v[16:19], a[132:135]
    ds_read_b64_tr_b16 v[216:217], v236 offset:24576
    ds_read_b64_tr_b16 v[218:219], v236 offset:30720
    v_mfma_f32_16x16x32_bf16 a[140:143], v[220:223], v[20:23], a[140:143]
    v_mfma_f32_16x16x32_bf16 a[148:151], v[220:223], v[24:27], a[148:151]
    v_mfma_f32_16x16x32_bf16 a[156:159], v[220:223], v[28:31], a[156:159]
    s_waitcnt lgkmcnt(6)
    v_mfma_f32_16x16x32_bf16 a[160:163], v[224:227], v[16:19], a[160:163]
    ds_read_b64_tr_b16 v[220:221], v237 offset:24576
    ds_read_b64_tr_b16 v[222:223], v237 offset:30720
    v_mfma_f32_16x16x32_bf16 a[168:171], v[224:227], v[20:23], a[168:171]
    v_mfma_f32_16x16x32_bf16 a[176:179], v[224:227], v[24:27], a[176:179]
    v_mfma_f32_16x16x32_bf16 a[184:187], v[224:227], v[28:31], a[184:187]
    v_mfma_f32_16x16x32_bf16 a[164:167], v[228:231], v[16:19], a[164:167]
    ds_read_b64_tr_b16 v[224:225], v234 offset:24704
    ds_read_b64_tr_b16 v[226:227], v234 offset:30848
    v_mfma_f32_16x16x32_bf16 a[172:175], v[228:231], v[20:23], a[172:175]
    v_mfma_f32_16x16x32_bf16 a[180:183], v[228:231], v[24:27], a[180:183]
    v_mfma_f32_16x16x32_bf16 a[188:191], v[228:231], v[28:31], a[188:191]
    s_waitcnt vmcnt(59)
    s_waitcnt lgkmcnt(6)
    v_mfma_f32_16x16x32_bf16 a[0:3], v[208:211], v[32:35], a[0:3]
    ds_read_b64_tr_b16 v[228:229], v235 offset:24704
    ds_read_b64_tr_b16 v[230:231], v235 offset:30848
    v_mfma_f32_16x16x32_bf16 a[8:11], v[208:211], v[36:39], a[8:11]
    s_mov_b32 s63, 10240
    buffer_load_dwordx4 v[0:3], v244, s[52:55], s63 offen offset:0 sc1
    v_mfma_f32_16x16x32_bf16 a[16:19], v[208:211], v[40:43], a[16:19]
    v_mfma_f32_16x16x32_bf16 a[24:27], v[208:211], v[44:47], a[24:27]
    v_mfma_f32_16x16x32_bf16 a[4:7], v[212:215], v[32:35], a[4:7]
    ds_read_b64_tr_b16 v[208:209], v236 offset:24704
    ds_read_b64_tr_b16 v[210:211], v236 offset:30848
    v_mfma_f32_16x16x32_bf16 a[12:15], v[212:215], v[36:39], a[12:15]
    s_mov_b32 s63, 10240
    buffer_load_dwordx4 v[16:19], v244, s[52:55], s63 offen offset:1024 sc1
    v_mfma_f32_16x16x32_bf16 a[20:23], v[212:215], v[40:43], a[20:23]
    v_mfma_f32_16x16x32_bf16 a[28:31], v[212:215], v[44:47], a[28:31]
    s_waitcnt lgkmcnt(6)
    v_mfma_f32_16x16x32_bf16 a[32:35], v[216:219], v[32:35], a[32:35]
    ds_read_b64_tr_b16 v[212:213], v237 offset:24704
    ds_read_b64_tr_b16 v[214:215], v237 offset:30848
    v_mfma_f32_16x16x32_bf16 a[40:43], v[216:219], v[36:39], a[40:43]
    s_mov_b32 s63, 30720
    buffer_load_dwordx4 v[4:7], v244, s[52:55], s63 offen offset:0 sc1
    v_mfma_f32_16x16x32_bf16 a[48:51], v[216:219], v[40:43], a[48:51]
    v_mfma_f32_16x16x32_bf16 a[56:59], v[216:219], v[44:47], a[56:59]
    v_mfma_f32_16x16x32_bf16 a[36:39], v[220:223], v[32:35], a[36:39]
    ds_read_b64_tr_b16 v[216:217], v234 offset:24832
    ds_read_b64_tr_b16 v[218:219], v234 offset:30976
    v_mfma_f32_16x16x32_bf16 a[44:47], v[220:223], v[36:39], a[44:47]
    s_mov_b32 s63, 30720
    buffer_load_dwordx4 v[20:23], v244, s[52:55], s63 offen offset:1024 sc1
    v_mfma_f32_16x16x32_bf16 a[52:55], v[220:223], v[40:43], a[52:55]
    v_mfma_f32_16x16x32_bf16 a[60:63], v[220:223], v[44:47], a[60:63]
    s_waitcnt lgkmcnt(6)
    v_mfma_f32_16x16x32_bf16 a[64:67], v[224:227], v[32:35], a[64:67]
    ds_read_b64_tr_b16 v[220:221], v235 offset:24832
    ds_read_b64_tr_b16 v[222:223], v235 offset:30976
    v_mfma_f32_16x16x32_bf16 a[72:75], v[224:227], v[36:39], a[72:75]
    s_mov_b32 s63, 51200
    buffer_load_dwordx4 v[8:11], v244, s[52:55], s63 offen offset:0 sc1
    v_mfma_f32_16x16x32_bf16 a[80:83], v[224:227], v[40:43], a[80:83]
    v_mfma_f32_16x16x32_bf16 a[88:91], v[224:227], v[44:47], a[88:91]
    v_mfma_f32_16x16x32_bf16 a[68:71], v[228:231], v[32:35], a[68:71]
    ds_read_b64_tr_b16 v[224:225], v236 offset:24832
    ds_read_b64_tr_b16 v[226:227], v236 offset:30976
    v_mfma_f32_16x16x32_bf16 a[76:79], v[228:231], v[36:39], a[76:79]
    s_mov_b32 s63, 51200
    buffer_load_dwordx4 v[24:27], v244, s[52:55], s63 offen offset:1024 sc1
    v_mfma_f32_16x16x32_bf16 a[84:87], v[228:231], v[40:43], a[84:87]
    v_mfma_f32_16x16x32_bf16 a[92:95], v[228:231], v[44:47], a[92:95]
    s_waitcnt lgkmcnt(6)
    v_mfma_f32_16x16x32_bf16 a[96:99], v[208:211], v[32:35], a[96:99]
    ds_read_b64_tr_b16 v[228:229], v237 offset:24832
    ds_read_b64_tr_b16 v[230:231], v237 offset:30976
    v_mfma_f32_16x16x32_bf16 a[104:107], v[208:211], v[36:39], a[104:107]
    s_mov_b32 s63, 71680
    buffer_load_dwordx4 v[12:15], v244, s[52:55], s63 offen offset:0 sc1
    v_mfma_f32_16x16x32_bf16 a[112:115], v[208:211], v[40:43], a[112:115]
    v_mfma_f32_16x16x32_bf16 a[120:123], v[208:211], v[44:47], a[120:123]
    v_mfma_f32_16x16x32_bf16 a[100:103], v[212:215], v[32:35], a[100:103]
    ds_read_b64_tr_b16 v[208:209], v234 offset:36864
    ds_read_b64_tr_b16 v[210:211], v234 offset:43008
    v_mfma_f32_16x16x32_bf16 a[108:111], v[212:215], v[36:39], a[108:111]
    s_mov_b32 s63, 71680
    buffer_load_dwordx4 v[28:31], v244, s[52:55], s63 offen offset:1024 sc1
    v_mfma_f32_16x16x32_bf16 a[116:119], v[212:215], v[40:43], a[116:119]
    v_mfma_f32_16x16x32_bf16 a[124:127], v[212:215], v[44:47], a[124:127]
    s_waitcnt lgkmcnt(6)
    v_mfma_f32_16x16x32_bf16 a[128:131], v[216:219], v[32:35], a[128:131]
    ds_read_b64_tr_b16 v[212:213], v235 offset:36864
    ds_read_b64_tr_b16 v[214:215], v235 offset:43008
    v_mfma_f32_16x16x32_bf16 a[136:139], v[216:219], v[36:39], a[136:139]
    v_mfma_f32_16x16x32_bf16 a[144:147], v[216:219], v[40:43], a[144:147]
    v_mfma_f32_16x16x32_bf16 a[152:155], v[216:219], v[44:47], a[152:155]
    s_barrier
    v_mfma_f32_16x16x32_bf16 a[132:135], v[220:223], v[32:35], a[132:135]
    ds_read_b64_tr_b16 v[216:217], v236 offset:36864
    ds_read_b64_tr_b16 v[218:219], v236 offset:43008
    v_mfma_f32_16x16x32_bf16 a[140:143], v[220:223], v[36:39], a[140:143]
    s_add_u32 m0, s34, 0
    s_nop 0
    buffer_load_dwordx4 v238, s[48:51], s36 offen offset:0  lds
    v_mfma_f32_16x16x32_bf16 a[148:151], v[220:223], v[40:43], a[148:151]
    v_mfma_f32_16x16x32_bf16 a[156:159], v[220:223], v[44:47], a[156:159]
    s_waitcnt lgkmcnt(6)
    v_mfma_f32_16x16x32_bf16 a[160:163], v[224:227], v[32:35], a[160:163]
    ds_read_b64_tr_b16 v[220:221], v237 offset:36864
    ds_read_b64_tr_b16 v[222:223], v237 offset:43008
    v_mfma_f32_16x16x32_bf16 a[168:171], v[224:227], v[36:39], a[168:171]
    v_mfma_f32_16x16x32_bf16 a[176:179], v[224:227], v[40:43], a[176:179]
    v_mfma_f32_16x16x32_bf16 a[184:187], v[224:227], v[44:47], a[184:187]
    v_mfma_f32_16x16x32_bf16 a[164:167], v[228:231], v[32:35], a[164:167]
    ds_read_b64_tr_b16 v[224:225], v234 offset:36992
    ds_read_b64_tr_b16 v[226:227], v234 offset:43136
    buffer_load_dwordx4 v239, s[48:51], s36 offen offset:1024  lds
    v_mfma_f32_16x16x32_bf16 a[172:175], v[228:231], v[36:39], a[172:175]
    v_mfma_f32_16x16x32_bf16 a[180:183], v[228:231], v[40:43], a[180:183]
    v_mfma_f32_16x16x32_bf16 a[188:191], v[228:231], v[44:47], a[188:191]
    s_waitcnt lgkmcnt(6)
    v_mfma_f32_16x16x32_bf16 a[0:3], v[208:211], v[48:51], a[0:3]
    ds_read_b64_tr_b16 v[228:229], v235 offset:36992
    ds_read_b64_tr_b16 v[230:231], v235 offset:43136
    v_mfma_f32_16x16x32_bf16 a[8:11], v[208:211], v[52:55], a[8:11]
    v_mfma_f32_16x16x32_bf16 a[16:19], v[208:211], v[56:59], a[16:19]
    v_mfma_f32_16x16x32_bf16 a[24:27], v[208:211], v[60:63], a[24:27]
    v_mfma_f32_16x16x32_bf16 a[4:7], v[212:215], v[48:51], a[4:7]
    ds_read_b64_tr_b16 v[208:209], v236 offset:36992
    ds_read_b64_tr_b16 v[210:211], v236 offset:43136
    buffer_load_dwordx4 v240, s[48:51], s36 offen offset:2048  lds
    v_mfma_f32_16x16x32_bf16 a[12:15], v[212:215], v[52:55], a[12:15]
    v_mfma_f32_16x16x32_bf16 a[20:23], v[212:215], v[56:59], a[20:23]
    v_mfma_f32_16x16x32_bf16 a[28:31], v[212:215], v[60:63], a[28:31]
    s_waitcnt lgkmcnt(6)
    v_mfma_f32_16x16x32_bf16 a[32:35], v[216:219], v[48:51], a[32:35]
    ds_read_b64_tr_b16 v[212:213], v237 offset:36992
    ds_read_b64_tr_b16 v[214:215], v237 offset:43136
    v_mfma_f32_16x16x32_bf16 a[40:43], v[216:219], v[52:55], a[40:43]
    v_mfma_f32_16x16x32_bf16 a[48:51], v[216:219], v[56:59], a[48:51]
    v_mfma_f32_16x16x32_bf16 a[56:59], v[216:219], v[60:63], a[56:59]
    v_mfma_f32_16x16x32_bf16 a[36:39], v[220:223], v[48:51], a[36:39]
    ds_read_b64_tr_b16 v[216:217], v234 offset:37120
    ds_read_b64_tr_b16 v[218:219], v234 offset:43264
    v_mfma_f32_16x16x32_bf16 a[44:47], v[220:223], v[52:55], a[44:47]
    s_add_u32 m0, s34, 3072
    s_nop 0
    buffer_load_dwordx4 v241, s[48:51], s36 offen offset:0  lds
    v_mfma_f32_16x16x32_bf16 a[52:55], v[220:223], v[56:59], a[52:55]
    v_mfma_f32_16x16x32_bf16 a[60:63], v[220:223], v[60:63], a[60:63]
    s_waitcnt lgkmcnt(6)
    v_mfma_f32_16x16x32_bf16 a[64:67], v[224:227], v[48:51], a[64:67]
    ds_read_b64_tr_b16 v[220:221], v235 offset:37120
    ds_read_b64_tr_b16 v[222:223], v235 offset:43264
    v_mfma_f32_16x16x32_bf16 a[72:75], v[224:227], v[52:55], a[72:75]
    v_mfma_f32_16x16x32_bf16 a[80:83], v[224:227], v[56:59], a[80:83]
    v_mfma_f32_16x16x32_bf16 a[88:91], v[224:227], v[60:63], a[88:91]
    v_mfma_f32_16x16x32_bf16 a[68:71], v[228:231], v[48:51], a[68:71]
    ds_read_b64_tr_b16 v[224:225], v236 offset:37120
    ds_read_b64_tr_b16 v[226:227], v236 offset:43264
    buffer_load_dwordx4 v242, s[48:51], s36 offen offset:1024  lds
    v_mfma_f32_16x16x32_bf16 a[76:79], v[228:231], v[52:55], a[76:79]
    v_mfma_f32_16x16x32_bf16 a[84:87], v[228:231], v[56:59], a[84:87]
    v_mfma_f32_16x16x32_bf16 a[92:95], v[228:231], v[60:63], a[92:95]
    s_waitcnt lgkmcnt(6)
    v_mfma_f32_16x16x32_bf16 a[96:99], v[208:211], v[48:51], a[96:99]
    ds_read_b64_tr_b16 v[228:229], v237 offset:37120
    ds_read_b64_tr_b16 v[230:231], v237 offset:43264
    v_mfma_f32_16x16x32_bf16 a[104:107], v[208:211], v[52:55], a[104:107]
    v_mfma_f32_16x16x32_bf16 a[112:115], v[208:211], v[56:59], a[112:115]
    v_mfma_f32_16x16x32_bf16 a[120:123], v[208:211], v[60:63], a[120:123]
    v_mfma_f32_16x16x32_bf16 a[100:103], v[212:215], v[48:51], a[100:103]
    v_add_u32 v234, 0xc000, v234
    v_add_u32 v235, 0xc000, v235
    v_add_u32 v236, 0xc000, v236
    v_add_u32 v237, 0xc000, v237
    ds_read_b64_tr_b16 v[208:209], v234 offset:0
    ds_read_b64_tr_b16 v[210:211], v234 offset:6144
    v_mfma_f32_16x16x32_bf16 a[108:111], v[212:215], v[52:55], a[108:111]
    buffer_load_dwordx4 v243, s[48:51], s36 offen offset:2048  lds
    s_add_u32 s36, s36, 786432
    v_mfma_f32_16x16x32_bf16 a[116:119], v[212:215], v[56:59], a[116:119]
    v_mfma_f32_16x16x32_bf16 a[124:127], v[212:215], v[60:63], a[124:127]
    s_waitcnt lgkmcnt(6)
    v_mfma_f32_16x16x32_bf16 a[128:131], v[216:219], v[48:51], a[128:131]
    ds_read_b64_tr_b16 v[212:213], v235 offset:0
    ds_read_b64_tr_b16 v[214:215], v235 offset:6144
    v_mfma_f32_16x16x32_bf16 a[136:139], v[216:219], v[52:55], a[136:139]
    v_mfma_f32_16x16x32_bf16 a[144:147], v[216:219], v[56:59], a[144:147]
    v_mfma_f32_16x16x32_bf16 a[152:155], v[216:219], v[60:63], a[152:155]
    v_mfma_f32_16x16x32_bf16 a[132:135], v[220:223], v[48:51], a[132:135]
    ds_read_b64_tr_b16 v[216:217], v236 offset:0
    ds_read_b64_tr_b16 v[218:219], v236 offset:6144
    v_mfma_f32_16x16x32_bf16 a[140:143], v[220:223], v[52:55], a[140:143]
    v_mfma_f32_16x16x32_bf16 a[148:151], v[220:223], v[56:59], a[148:151]
    v_mfma_f32_16x16x32_bf16 a[156:159], v[220:223], v[60:63], a[156:159]
    s_waitcnt lgkmcnt(6)
    v_mfma_f32_16x16x32_bf16 a[160:163], v[224:227], v[48:51], a[160:163]
    ds_read_b64_tr_b16 v[220:221], v237 offset:0
    ds_read_b64_tr_b16 v[222:223], v237 offset:6144
    v_mfma_f32_16x16x32_bf16 a[168:171], v[224:227], v[52:55], a[168:171]
    v_mfma_f32_16x16x32_bf16 a[176:179], v[224:227], v[56:59], a[176:179]
    v_mfma_f32_16x16x32_bf16 a[184:187], v[224:227], v[60:63], a[184:187]
    v_mfma_f32_16x16x32_bf16 a[164:167], v[228:231], v[48:51], a[164:167]
    ds_read_b64_tr_b16 v[224:225], v234 offset:128
    ds_read_b64_tr_b16 v[226:227], v234 offset:6272
    v_mfma_f32_16x16x32_bf16 a[172:175], v[228:231], v[52:55], a[172:175]
    v_mfma_f32_16x16x32_bf16 a[180:183], v[228:231], v[56:59], a[180:183]
    v_mfma_f32_16x16x32_bf16 a[188:191], v[228:231], v[60:63], a[188:191]
    s_mov_b32 s69, 1
    s_mov_b64 s[94:95], s[16:17]
    s_mov_b64 s[96:97], s[18:19]
    s_branch Lpass
Ltail:
    s_nop 7
    v_accvgpr_read_b32 v160, a128
    v_accvgpr_read_b32 v161, a129
    v_accvgpr_read_b32 v162, a130
    v_accvgpr_read_b32 v163, a131
    v_accvgpr_read_b32 v164, a132
    v_accvgpr_read_b32 v165, a133
    v_accvgpr_read_b32 v166, a134
    v_accvgpr_read_b32 v167, a135
    v_pk_mul_f32 v[160:161], v[160:161], v[192:193]
    v_pk_mul_f32 v[162:163], v[162:163], v[192:193]
    v_pk_mul_f32 v[164:165], v[164:165], v[192:193]
    v_pk_mul_f32 v[166:167], v[166:167], v[192:193]
    v_cvt_pk_bf16_f32 v160, v160, v161
    v_cvt_pk_bf16_f32 v161, v162, v163
    v_cvt_pk_bf16_f32 v162, v164, v165
    v_cvt_pk_bf16_f32 v163, v166, v167
    s_mov_b32 s63, 4096
    buffer_store_dwordx4 v[160:163], v244, s[56:59], s63 offen offset:0 sc1
    v_accvgpr_read_b32 v168, a136
    v_accvgpr_read_b32 v169, a137
    v_accvgpr_read_b32 v170, a138
    v_accvgpr_read_b32 v171, a139
    v_accvgpr_read_b32 v172, a140
    v_accvgpr_read_b32 v173, a141
    v_accvgpr_read_b32 v174, a142
    v_accvgpr_read_b32 v175, a143
    v_pk_mul_f32 v[168:169], v[168:169], v[196:197]
    v_pk_mul_f32 v[170:171], v[170:171], v[196:197]
    v_pk_mul_f32 v[172:173], v[172:173], v[196:197]
    v_pk_mul_f32 v[174:175], v[174:175], v[196:197]
    v_cvt_pk_bf16_f32 v168, v168, v169
    v_cvt_pk_bf16_f32 v169, v170, v171
    v_cvt_pk_bf16_f32 v170, v172, v173
    v_cvt_pk_bf16_f32 v171, v174, v175
    s_mov_b32 s63, 200704
    buffer_store_dwordx4 v[168:171], v244, s[56:59], s63 offen offset:0 sc1
    v_accvgpr_read_b32 v160, a144
    v_accvgpr_read_b32 v161, a145
    v_accvgpr_read_b32 v162, a146
    v_accvgpr_read_b32 v163, a147
    v_accvgpr_read_b32 v164, a148
    v_accvgpr_read_b32 v165, a149
    v_accvgpr_read_b32 v166, a150
    v_accvgpr_read_b32 v167, a151
    v_pk_mul_f32 v[160:161], v[160:161], v[200:201]
    v_pk_mul_f32 v[162:163], v[162:163], v[200:201]
    v_pk_mul_f32 v[164:165], v[164:165], v[200:201]
    v_pk_mul_f32 v[166:167], v[166:167], v[200:201]
    v_cvt_pk_bf16_f32 v160, v160, v161
    v_cvt_pk_bf16_f32 v161, v162, v163
    v_cvt_pk_bf16_f32 v162, v164, v165
    v_cvt_pk_bf16_f32 v163, v166, v167
    s_mov_b32 s63, 397312
    buffer_store_dwordx4 v[160:163], v244, s[56:59], s63 offen offset:0 sc1
    v_accvgpr_read_b32 v168, a152
    v_accvgpr_read_b32 v169, a153
    v_accvgpr_read_b32 v170, a154
    v_accvgpr_read_b32 v171, a155
    v_accvgpr_read_b32 v172, a156
    v_accvgpr_read_b32 v173, a157
    v_accvgpr_read_b32 v174, a158
    v_accvgpr_read_b32 v175, a159
    v_pk_mul_f32 v[168:169], v[168:169], v[204:205]
    v_pk_mul_f32 v[170:171], v[170:171], v[204:205]
    v_pk_mul_f32 v[172:173], v[172:173], v[204:205]
    v_pk_mul_f32 v[174:175], v[174:175], v[204:205]
    v_cvt_pk_bf16_f32 v168, v168, v169
    v_cvt_pk_bf16_f32 v169, v170, v171
    v_cvt_pk_bf16_f32 v170, v172, v173
    v_cvt_pk_bf16_f32 v171, v174, v175
    s_mov_b32 s63, 593920
    buffer_store_dwordx4 v[168:171], v244, s[56:59], s63 offen offset:0 sc1
    v_accvgpr_read_b32 v160, a160
    v_accvgpr_read_b32 v161, a161
    v_accvgpr_read_b32 v162, a162
    v_accvgpr_read_b32 v163, a163
    v_accvgpr_read_b32 v164, a164
    v_accvgpr_read_b32 v165, a165
    v_accvgpr_read_b32 v166, a166
    v_accvgpr_read_b32 v167, a167
    v_pk_mul_f32 v[160:161], v[160:161], v[192:193]
    v_pk_mul_f32 v[162:163], v[162:163], v[192:193]
    v_pk_mul_f32 v[164:165], v[164:165], v[192:193]
    v_pk_mul_f32 v[166:167], v[166:167], v[192:193]
    v_cvt_pk_bf16_f32 v160, v160, v161
    v_cvt_pk_bf16_f32 v161, v162, v163
    v_cvt_pk_bf16_f32 v162, v164, v165
    v_cvt_pk_bf16_f32 v163, v166, v167
    s_mov_b32 s63, 4096
    buffer_store_dwordx4 v[160:163], v244, s[56:59], s63 offen offset:1024 sc1
    v_accvgpr_read_b32 v168, a168
    v_accvgpr_read_b32 v169, a169
    v_accvgpr_read_b32 v170, a170
    v_accvgpr_read_b32 v171, a171
    v_accvgpr_read_b32 v172, a172
    v_accvgpr_read_b32 v173, a173
    v_accvgpr_read_b32 v174, a174
    v_accvgpr_read_b32 v175, a175
    v_pk_mul_f32 v[168:169], v[168:169], v[196:197]
    v_pk_mul_f32 v[170:171], v[170:171], v[196:197]
    v_pk_mul_f32 v[172:173], v[172:173], v[196:197]
    v_pk_mul_f32 v[174:175], v[174:175], v[196:197]
    v_cvt_pk_bf16_f32 v168, v168, v169
    v_cvt_pk_bf16_f32 v169, v170, v171
    v_cvt_pk_bf16_f32 v170, v172, v173
    v_cvt_pk_bf16_f32 v171, v174, v175
    s_mov_b32 s63, 200704
    buffer_store_dwordx4 v[168:171], v244, s[56:59], s63 offen offset:1024 sc1
    v_accvgpr_read_b32 v160, a176
    v_accvgpr_read_b32 v161, a177
    v_accvgpr_read_b32 v162, a178
    v_accvgpr_read_b32 v163, a179
    v_accvgpr_read_b32 v164, a180
    v_accvgpr_read_b32 v165, a181
    v_accvgpr_read_b32 v166, a182
    v_accvgpr_read_b32 v167, a183
    v_pk_mul_f32 v[160:161], v[160:161], v[200:201]
    v_pk_mul_f32 v[162:163], v[162:163], v[200:201]
    v_pk_mul_f32 v[164:165], v[164:165], v[200:201]
    v_pk_mul_f32 v[166:167], v[166:167], v[200:201]
    v_cvt_pk_bf16_f32 v160, v160, v161
    v_cvt_pk_bf16_f32 v161, v162, v163
    v_cvt_pk_bf16_f32 v162, v164, v165
    v_cvt_pk_bf16_f32 v163, v166, v167
    s_mov_b32 s63, 397312
    buffer_store_dwordx4 v[160:163], v244, s[56:59], s63 offen offset:1024 sc1
    v_accvgpr_read_b32 v168, a184
    v_accvgpr_read_b32 v169, a185
    v_accvgpr_read_b32 v170, a186
    v_accvgpr_read_b32 v171, a187
    v_accvgpr_read_b32 v172, a188
    v_accvgpr_read_b32 v173, a189
    v_accvgpr_read_b32 v174, a190
    v_accvgpr_read_b32 v175, a191
    v_pk_mul_f32 v[168:169], v[168:169], v[204:205]
    v_pk_mul_f32 v[170:171], v[170:171], v[204:205]
    v_pk_mul_f32 v[172:173], v[172:173], v[204:205]
    v_pk_mul_f32 v[174:175], v[174:175], v[204:205]
    v_cvt_pk_bf16_f32 v168, v168, v169
    v_cvt_pk_bf16_f32 v169, v170, v171
    v_cvt_pk_bf16_f32 v170, v172, v173
    v_cvt_pk_bf16_f32 v171, v174, v175
    s_mov_b32 s63, 593920
    buffer_store_dwordx4 v[168:171], v244, s[56:59], s63 offen offset:1024 sc1
    s_waitcnt lgkmcnt(0)
    v_lshrrev_b32 v233, 4, v244
    s_mov_b32 s60, s30
    s_mov_b32 s61, s31
    s_and_b32 s39, s2, 7
    s_lshr_b32 s30, s39, 2
    s_and_b32 s31, s39, 3
    s_lshr_b32 s39, s2, 3
    s_lshr_b32 s35, s39, 2
    s_and_b32 s36, s39, 3
    s_mul_i32 s34, s32, 10240
    v_lshrrev_b32 v234, 2, v233
    v_bfe_u32 v235, v234, 2, 1
    v_mul_u32_u24 v234, 320, v234
    v_and_b32 v232, 3, v233
    v_lshl_add_u32 v234, v232, 3, v234
    v_lshl_add_u32 v216, v235, 5, v234
    v_xor_b32 v235, 1, v235
    v_lshl_add_u32 v217, v235, 5, v234
    s_lshl_b32 s39, s32, 5
    v_add_u32 v234, 0, v233
    v_mul_u32_u24 v235, 3277, v234
    v_lshrrev_b32 v235, 16, v235
    v_mul_u32_u24 v232, 20, v235
    v_sub_u32 v234, v234, v232
    v_bfe_u32 v232, v235, 2, 1
    v_lshlrev_b32 v232, 1, v232
    v_xor_b32 v234, v234, v232
    v_add_u32 v235, s39, v235
    v_mul_u32_u24 v235, 1280, v235
    v_lshl_add_u32 v218, v234, 4, v235
    v_add_u32 v218, 0x80, v218
    v_add_u32 v234, 64, v233
    v_mul_u32_u24 v235, 3277, v234
    v_lshrrev_b32 v235, 16, v235
    v_mul_u32_u24 v232, 20, v235
    v_sub_u32 v234, v234, v232
    v_bfe_u32 v232, v235, 2, 1
    v_lshlrev_b32 v232, 1, v232
    v_xor_b32 v234, v234, v232
    v_add_u32 v235, s39, v235
    v_mul_u32_u24 v235, 1280, v235
    v_lshl_add_u32 v219, v234, 4, v235
    v_add_u32 v219, 0xfffffc80, v219
    v_add_u32 v234, 128, v233
    v_mul_u32_u24 v235, 3277, v234
    v_lshrrev_b32 v235, 16, v235
    v_mul_u32_u24 v232, 20, v235
    v_sub_u32 v234, v234, v232
    v_bfe_u32 v232, v235, 2, 1
    v_lshlrev_b32 v232, 1, v232
    v_xor_b32 v234, v234, v232
    v_add_u32 v235, s39, v235
    v_mul_u32_u24 v235, 1280, v235
    v_lshl_add_u32 v220, v234, 4, v235
    v_add_u32 v220, 0xfffff880, v220
    v_add_u32 v234, 192, v233
    v_mul_u32_u24 v235, 3277, v234
    v_lshrrev_b32 v235, 16, v235
    v_mul_u32_u24 v232, 20, v235
    v_sub_u32 v234, v234, v232
    v_bfe_u32 v232, v235, 2, 1
    v_lshlrev_b32 v232, 1, v232
    v_xor_b32 v234, v234, v232
    v_add_u32 v235, s39, v235
    v_mul_u32_u24 v235, 1280, v235
    v_lshl_add_u32 v221, v234, 4, v235
    v_add_u32 v221, 0xfffff480, v221
    v_add_u32 v234, 256, v233
    v_mul_u32_u24 v235, 3277, v234
    v_lshrrev_b32 v235, 16, v235
    v_mul_u32_u24 v232, 20, v235
    v_sub_u32 v234, v234, v232
    v_bfe_u32 v232, v235, 2, 1
    v_lshlrev_b32 v232, 1, v232
    v_xor_b32 v234, v234, v232
    v_add_u32 v235, s39, v235
    v_mul_u32_u24 v235, 1280, v235
    v_lshl_add_u32 v222, v234, 4, v235
    v_add_u32 v222, 0x80, v222
    v_add_u32 v234, 320, v233
    v_mul_u32_u24 v235, 3277, v234
    v_lshrrev_b32 v235, 16, v235
    v_mul_u32_u24 v232, 20, v235
    v_sub_u32 v234, v234, v232
    v_bfe_u32 v232, v235, 2, 1
    v_lshlrev_b32 v232, 1, v232
    v_xor_b32 v234, v234, v232
    v_add_u32 v235, s39, v235
    v_mul_u32_u24 v235, 1280, v235
    v_lshl_add_u32 v223, v234, 4, v235
    v_add_u32 v223, 0xfffffc80, v223
    v_add_u32 v234, 384, v233
    v_mul_u32_u24 v235, 3277, v234
    v_lshrrev_b32 v235, 16, v235
    v_mul_u32_u24 v232, 20, v235
    v_sub_u32 v234, v234, v232
    v_bfe_u32 v232, v235, 2, 1
    v_lshlrev_b32 v232, 1, v232
    v_xor_b32 v234, v234, v232
    v_add_u32 v235, s39, v235
    v_mul_u32_u24 v235, 1280, v235
    v_lshl_add_u32 v224, v234, 4, v235
    v_add_u32 v224, 0xfffff880, v224
    v_add_u32 v234, 448, v233
    v_mul_u32_u24 v235, 3277, v234
    v_lshrrev_b32 v235, 16, v235
    v_mul_u32_u24 v232, 20, v235
    v_sub_u32 v234, v234, v232
    v_bfe_u32 v232, v235, 2, 1
    v_lshlrev_b32 v232, 1, v232
    v_xor_b32 v234, v234, v232
    v_add_u32 v235, s39, v235
    v_mul_u32_u24 v235, 1280, v235
    v_lshl_add_u32 v225, v234, 4, v235
    v_add_u32 v225, 0xfffff480, v225
    v_add_u32 v234, 512, v233
    v_mul_u32_u24 v235, 3277, v234
    v_lshrrev_b32 v235, 16, v235
    v_mul_u32_u24 v232, 20, v235
    v_sub_u32 v234, v234, v232
    v_bfe_u32 v232, v235, 2, 1
    v_lshlrev_b32 v232, 1, v232
    v_xor_b32 v234, v234, v232
    v_add_u32 v235, s39, v235
    v_mul_u32_u24 v235, 1280, v235
    v_lshl_add_u32 v226, v234, 4, v235
    v_add_u32 v226, 0x80, v226
    v_add_u32 v234, 576, v233
    v_mul_u32_u24 v235, 3277, v234
    v_lshrrev_b32 v235, 16, v235
    v_mul_u32_u24 v232, 20, v235
    v_sub_u32 v234, v234, v232
    v_bfe_u32 v232, v235, 2, 1
    v_lshlrev_b32 v232, 1, v232
    v_xor_b32 v234, v234, v232
    v_add_u32 v235, s39, v235
    v_mul_u32_u24 v235, 1280, v235
    v_lshl_add_u32 v227, v234, 4, v235
    v_add_u32 v227, 0xfffffc80, v227
    v_lshlrev_b32 v239, 4, v233
    s_add_u32 s62, s31, 0
    s_and_b32 s62, s62, 3
    s_mul_i32 s62, s62, 196608
    v_add_u32 v228, s62, v239
    s_add_u32 s62, s31, 1
    s_and_b32 s62, s62, 3
    s_mul_i32 s62, s62, 196608
    v_add_u32 v229, s62, v239
    s_add_u32 s62, s31, 2
    s_and_b32 s62, s62, 3
    s_mul_i32 s62, s62, 196608
    v_add_u32 v230, s62, v239
    s_add_u32 s62, s31, 3
    s_and_b32 s62, s62, 3
    s_mul_i32 s62, s62, 196608
    v_add_u32 v231, s62, v239
    s_cmp_eq_u32 s30, 1
    s_cselect_b64 s[8:9], s[22:23], s[12:13]
    s_mul_i32 s39, s31, 1966080
    s_mul_i32 s62, s36, 320
    s_add_u32 s39, s39, s62
    s_add_u32 s40, s8, s39
    s_addc_u32 s41, s9, 0
    s_mov_b32 s42, 0x0
    s_mov_b32 s43, 0x00020000
    s_sub_u32 s40, s40, 128
    s_subb_u32 s41, s41, 0
    s_sub_u32 s42, 0x1e0080, s62
    s_lshl_b32 s39, s30, 3
    s_add_u32 s39, s39, s35
    s_lshl_b32 s39, s39, 2
    s_add_u32 s39, s39, s32
    s_mul_i32 s39, s39, 786432
    s_mul_i32 s62, s31, 49152
    s_add_u32 s39, s39, s62
    s_add_u32 s44, s28, s39
    s_addc_u32 s45, s29, 0
    s_mov_b32 s46, 0x9c000
    s_mov_b32 s47, 0x00020000
    s_lshl_b32 s39, s30, 3
    s_add_u32 s39, s39, s35
    s_lshl_b32 s39, s39, 2
    s_add_u32 s58, s39, s36
    s_mul_i32 s39, s58, 245760
    s_add_u32 s39, s39, 0x3000000
    s_add_u32 s48, s28, s39
    s_addc_u32 s49, s29, 0
    s_mov_b32 s50, 0x3c000
    s_mov_b32 s51, 0x00020000
    s_mov_b32 s37, 0
    s_mov_b32 s38, 0
    s_lshl_b32 s39, s30, 3
    s_add_u32 s39, s39, s35
    s_lshl_b32 s39, s39, 2
    s_add_u32 s39, s39, s36
    s_lshl_b32 s39, s39, 2
    s_add_u32 s39, s39, s32
    s_mul_i32 s39, s39, 196608
    s_mul_i32 s62, s31, 49152
    s_add_u32 s39, s39, s62
    s_add_u32 s52, s28, s39
    s_addc_u32 s53, s29, 0
    s_mov_b32 s54, 0xc000
    s_mov_b32 s55, 0x00020000
    v_lshlrev_b32 v236, 6, v233
    s_lshl_b32 s39, s35, 4
    s_lshl_b32 s62, s32, 2
    s_add_u32 s39, s39, s62
    v_lshrrev_b32 v234, 4, v233
    v_lshlrev_b32 v234, 7, v234
    v_bfe_u32 v235, v233, 2, 2
    v_add3_u32 v234, v234, v235, s39
    v_mul_u32_u24 v234, 1280, v234
    v_and_b32 v235, 3, v233
    v_mul_u32_u24 v235, 96, v235
    v_add3_u32 v237, v234, v235, 64
    v_add_u32 v237, 64, v237
    s_mov_b32 s56, 0
    s_mov_b32 s57, 0
    s_waitcnt vmcnt(0)
    s_barrier
    s_cmp_lg_u32 s32, 0
    s_cbranch_scc1 Lrs1
    s_lshl_b32 s62, s60, 11
    s_lshr_b32 s63, s61, 3
    s_add_u32 s63, s63, 4
    s_lshl_b32 s63, s63, 7
    s_add_u32 s62, s62, s63
    s_add_u32 s62, s62, 0x5d00000
    s_add_u32 s64, s28, s62
    s_addc_u32 s65, s29, 0
    s_mov_b32 s66, 4
    s_mov_b32 s67, 0x00020000
    v_mov_b32 v252, 0
    v_mov_b32 v253, 1
    s_mov_b64 exec, 1
    buffer_atomic_add v253, v252, s[64:67], 0 offen
    s_mov_b64 exec, -1
Lrs1:
    s_add_u32 m0, s34, 0
    s_nop 0
    buffer_load_dwordx4 v218, s[40:43], s37 offen offset:0  lds
    buffer_load_dwordx4 v219, s[40:43], s37 offen offset:1024  lds
    buffer_load_dwordx4 v220, s[40:43], s37 offen offset:2048  lds
    buffer_load_dwordx4 v221, s[40:43], s37 offen offset:3072  lds
    s_add_u32 m0, s34, 4096
    s_nop 0
    buffer_load_dwordx4 v222, s[40:43], s37 offen offset:0  lds
    buffer_load_dwordx4 v223, s[40:43], s37 offen offset:1024  lds
    buffer_load_dwordx4 v224, s[40:43], s37 offen offset:2048  lds
    buffer_load_dwordx4 v225, s[40:43], s37 offen offset:3072  lds
    s_add_u32 m0, s34, 8192
    s_nop 0
    buffer_load_dwordx4 v226, s[40:43], s37 offen offset:0  lds
    buffer_load_dwordx4 v227, s[40:43], s37 offen offset:1024  lds
    s_add_u32 s37, s37, 163840
    s_mov_b32 s56, 4096
    s_mov_b32 s57, 163840
    buffer_load_dword v238, v237, s[40:43], s57 offen
    s_add_u32 s57, s57, 655360
    v_accvgpr_write_b32 a0, 0
    v_accvgpr_write_b32 a1, 0
    v_accvgpr_write_b32 a2, 0
    v_accvgpr_write_b32 a3, 0
    v_accvgpr_write_b32 a4, 0
    v_accvgpr_write_b32 a5, 0
    v_accvgpr_write_b32 a6, 0
    v_accvgpr_write_b32 a7, 0
    v_accvgpr_write_b32 a8, 0
    v_accvgpr_write_b32 a9, 0
    v_accvgpr_write_b32 a10, 0
    v_accvgpr_write_b32 a11, 0
    v_accvgpr_write_b32 a12, 0
    v_accvgpr_write_b32 a13, 0
    v_accvgpr_write_b32 a14, 0
    v_accvgpr_write_b32 a15, 0
    v_accvgpr_write_b32 a16, 0
    v_accvgpr_write_b32 a17, 0
    v_accvgpr_write_b32 a18, 0
    v_accvgpr_write_b32 a19, 0
    v_accvgpr_write_b32 a20, 0
    v_accvgpr_write_b32 a21, 0
    v_accvgpr_write_b32 a22, 0
    v_accvgpr_write_b32 a23, 0
    v_accvgpr_write_b32 a24, 0
    v_accvgpr_write_b32 a25, 0
    v_accvgpr_write_b32 a26, 0
    v_accvgpr_write_b32 a27, 0
    v_accvgpr_write_b32 a28, 0
    v_accvgpr_write_b32 a29, 0
    v_accvgpr_write_b32 a30, 0
    v_accvgpr_write_b32 a31, 0
    v_accvgpr_write_b32 a32, 0
    v_accvgpr_write_b32 a33, 0
    v_accvgpr_write_b32 a34, 0
    v_accvgpr_write_b32 a35, 0
    v_accvgpr_write_b32 a36, 0
    v_accvgpr_write_b32 a37, 0
    v_accvgpr_write_b32 a38, 0
    v_accvgpr_write_b32 a39, 0
    v_accvgpr_write_b32 a40, 0
    v_accvgpr_write_b32 a41, 0
    v_accvgpr_write_b32 a42, 0
    v_accvgpr_write_b32 a43, 0
    v_accvgpr_write_b32 a44, 0
    v_accvgpr_write_b32 a45, 0
    v_accvgpr_write_b32 a46, 0
    v_accvgpr_write_b32 a47, 0
    v_accvgpr_write_b32 a48, 0
    v_accvgpr_write_b32 a49, 0
    v_accvgpr_write_b32 a50, 0
    v_accvgpr_write_b32 a51, 0
    v_accvgpr_write_b32 a52, 0
    v_accvgpr_write_b32 a53, 0
    v_accvgpr_write_b32 a54, 0
    v_accvgpr_write_b32 a55, 0
    v_accvgpr_write_b32 a56, 0
    v_accvgpr_write_b32 a57, 0
    v_accvgpr_write_b32 a58, 0
    v_accvgpr_write_b32 a59, 0
    v_accvgpr_write_b32 a60, 0
    v_accvgpr_write_b32 a61, 0
    v_accvgpr_write_b32 a62, 0
    v_accvgpr_write_b32 a63, 0
    v_accvgpr_write_b32 a64, 0
    v_accvgpr_write_b32 a65, 0
    v_accvgpr_write_b32 a66, 0
    v_accvgpr_write_b32 a67, 0
    v_accvgpr_write_b32 a68, 0
    v_accvgpr_write_b32 a69, 0
    v_accvgpr_write_b32 a70, 0
    v_accvgpr_write_b32 a71, 0
    v_accvgpr_write_b32 a72, 0
    v_accvgpr_write_b32 a73, 0
    v_accvgpr_write_b32 a74, 0
    v_accvgpr_write_b32 a75, 0
    v_accvgpr_write_b32 a76, 0
    v_accvgpr_write_b32 a77, 0
    v_accvgpr_write_b32 a78, 0
    v_accvgpr_write_b32 a79, 0
    v_accvgpr_write_b32 a80, 0
    v_accvgpr_write_b32 a81, 0
    v_accvgpr_write_b32 a82, 0
    v_accvgpr_write_b32 a83, 0
    v_accvgpr_write_b32 a84, 0
    v_accvgpr_write_b32 a85, 0
    v_accvgpr_write_b32 a86, 0
    v_accvgpr_write_b32 a87, 0
    v_accvgpr_write_b32 a88, 0
    v_accvgpr_write_b32 a89, 0
    v_accvgpr_write_b32 a90, 0
    v_accvgpr_write_b32 a91, 0
    v_accvgpr_write_b32 a92, 0
    v_accvgpr_write_b32 a93, 0
    v_accvgpr_write_b32 a94, 0
    v_accvgpr_write_b32 a95, 0
    v_accvgpr_write_b32 a96, 0
    v_accvgpr_write_b32 a97, 0
    v_accvgpr_write_b32 a98, 0
    v_accvgpr_write_b32 a99, 0
    v_accvgpr_write_b32 a100, 0
    v_accvgpr_write_b32 a101, 0
    v_accvgpr_write_b32 a102, 0
    v_accvgpr_write_b32 a103, 0
    v_accvgpr_write_b32 a104, 0
    v_accvgpr_write_b32 a105, 0
    v_accvgpr_write_b32 a106, 0
    v_accvgpr_write_b32 a107, 0
    v_accvgpr_write_b32 a108, 0
    v_accvgpr_write_b32 a109, 0
    v_accvgpr_write_b32 a110, 0
    v_accvgpr_write_b32 a111, 0
    v_accvgpr_write_b32 a112, 0
    v_accvgpr_write_b32 a113, 0
    v_accvgpr_write_b32 a114, 0
    v_accvgpr_write_b32 a115, 0
    v_accvgpr_write_b32 a116, 0
    v_accvgpr_write_b32 a117, 0
    v_accvgpr_write_b32 a118, 0
    v_accvgpr_write_b32 a119, 0
    v_accvgpr_write_b32 a120, 0
    v_accvgpr_write_b32 a121, 0
    v_accvgpr_write_b32 a122, 0
    v_accvgpr_write_b32 a123, 0
    v_accvgpr_write_b32 a124, 0
    v_accvgpr_write_b32 a125, 0
    v_accvgpr_write_b32 a126, 0
    v_accvgpr_write_b32 a127, 0
    v_accvgpr_write_b32 a128, 0
    v_accvgpr_write_b32 a129, 0
    v_accvgpr_write_b32 a130, 0
    v_accvgpr_write_b32 a131, 0
    v_accvgpr_write_b32 a132, 0
    v_accvgpr_write_b32 a133, 0
    v_accvgpr_write_b32 a134, 0
    v_accvgpr_write_b32 a135, 0
    v_accvgpr_write_b32 a136, 0
    v_accvgpr_write_b32 a137, 0
    v_accvgpr_write_b32 a138, 0
    v_accvgpr_write_b32 a139, 0
    v_accvgpr_write_b32 a140, 0
    v_accvgpr_write_b32 a141, 0
    v_accvgpr_write_b32 a142, 0
    v_accvgpr_write_b32 a143, 0
    v_accvgpr_write_b32 a144, 0
    v_accvgpr_write_b32 a145, 0
    v_accvgpr_write_b32 a146, 0
    v_accvgpr_write_b32 a147, 0
    v_accvgpr_write_b32 a148, 0
    v_accvgpr_write_b32 a149, 0
    v_accvgpr_write_b32 a150, 0
    v_accvgpr_write_b32 a151, 0
    v_accvgpr_write_b32 a152, 0
    v_accvgpr_write_b32 a153, 0
    v_accvgpr_write_b32 a154, 0
    v_accvgpr_write_b32 a155, 0
    v_accvgpr_write_b32 a156, 0
    v_accvgpr_write_b32 a157, 0
    v_accvgpr_write_b32 a158, 0
    v_accvgpr_write_b32 a159, 0
    s_cmp_lg_u32 s32, 0
    s_cbranch_scc1 Lo_wait
    s_mov_b32 s64, s26
    s_mov_b32 s65, s27
    s_mov_b32 s66, 256
    s_mov_b32 s67, 0x00020000
    s_lshr_b32 s39, s35, 2
    s_lshl_b32 s39, s39, 7
    s_and_b32 s63, s35, 3
    s_lshl_b32 s63, s63, 4
    s_add_u32 s39, s39, s63
    v_mov_b32 v232, 0
    s_mov_b64 exec, 1
Lo_p1:
    buffer_load_dword v234, v232, s[64:67], s39 offen sc1
    s_waitcnt vmcnt(0)
    v_readfirstlane_b32 s62, v234
    s_nop 3
    s_cmp_ge_u32 s62, 20
    s_cbranch_scc1 Lo_p1_go
    s_sleep 2
    s_branch Lo_p1
Lo_p1_go:
    s_lshl_b32 s62, s35, 11
    s_lshl_b32 s63, s30, 2
    s_add_u32 s63, s63, s31
    s_lshl_b32 s63, s63, 7
    s_add_u32 s62, s62, s63
    s_add_u32 s62, s62, 0x5d00000
    s_add_u32 s64, s28, s62
    s_addc_u32 s65, s29, 0
    s_mov_b32 s66, 4
    s_mov_b32 s39, 0
Lo_p2:
    buffer_load_dword v234, v232, s[64:67], s39 offen sc1
    s_waitcnt vmcnt(0)
    v_readfirstlane_b32 s62, v234
    s_nop 3
    s_cmp_ge_u32 s62, 8
    s_cbranch_scc1 Lo_p2_go
    s_sleep 2
    s_branch Lo_p2
Lo_p2_go:
    s_mov_b64 exec, -1
Lo_wait:
    s_barrier
    buffer_load_dwordx4 v[0:3], v228, s[44:47], s38 offen sc1
    buffer_load_dwordx4 v[4:7], v229, s[44:47], s38 offen sc1
    buffer_load_dwordx4 v[8:11], v230, s[44:47], s38 offen sc1
    buffer_load_dwordx4 v[12:15], v231, s[44:47], s38 offen sc1
    s_add_u32 s38, s38, 1024
    buffer_load_dwordx4 v[16:19], v228, s[44:47], s38 offen sc1
    buffer_load_dwordx4 v[20:23], v229, s[44:47], s38 offen sc1
    buffer_load_dwordx4 v[24:27], v230, s[44:47], s38 offen sc1
    buffer_load_dwordx4 v[28:31], v231, s[44:47], s38 offen sc1
    s_add_u32 s38, s38, 1024
    buffer_load_dwordx4 v[32:35], v228, s[44:47], s38 offen sc1
    buffer_load_dwordx4 v[36:39], v229, s[44:47], s38 offen sc1
    buffer_load_dwordx4 v[40:43], v230, s[44:47], s38 offen sc1
    buffer_load_dwordx4 v[44:47], v231, s[44:47], s38 offen sc1
    s_add_u32 s38, s38, 1024
    buffer_load_dwordx4 v[48:51], v228, s[44:47], s38 offen sc1
    buffer_load_dwordx4 v[52:55], v229, s[44:47], s38 offen sc1
    buffer_load_dwordx4 v[56:59], v230, s[44:47], s38 offen sc1
    buffer_load_dwordx4 v[60:63], v231, s[44:47], s38 offen sc1
    s_add_u32 s38, s38, 1024
    buffer_load_dword v238, v236, s[52:55], s56 offen sc1
    s_add_u32 s56, s56, 4096
    buffer_load_dword v238, v236, s[52:55], s56 offen sc1
    s_add_u32 s56, s56, 4096
    s_mov_b32 s37, 491520
    s_mov_b32 s38, 16384
    s_waitcnt vmcnt(2)
    s_barrier
    ds_read_b64_tr_b16 v[192:193], v216 offset:0
    ds_read_b64_tr_b16 v[194:195], v216 offset:5120
    ds_read_b64_tr_b16 v[196:197], v217 offset:0
    ds_read_b64_tr_b16 v[198:199], v217 offset:5120
    ds_read_b64_tr_b16 v[200:201], v216 offset:64
    ds_read_b64_tr_b16 v[202:203], v216 offset:5184
    ds_read_b64_tr_b16 v[204:205], v217 offset:64
    ds_read_b64_tr_b16 v[206:207], v217 offset:5184
    ds_read_b64_tr_b16 v[208:209], v216 offset:128
    ds_read_b64_tr_b16 v[210:211], v216 offset:5248
    s_waitcnt lgkmcnt(6)
    v_mfma_f32_16x16x32_bf16 a[0:3], v[192:195], v[0:3], a[0:3]
    ds_read_b64_tr_b16 v[212:213], v217 offset:128
    ds_read_b64_tr_b16 v[214:215], v217 offset:5248
    v_mfma_f32_16x16x32_bf16 a[8:11], v[192:195], v[4:7], a[8:11]
    s_add_u32 m0, s34, 40960
    s_nop 0
    s_mov_b32 s59, 163840
    buffer_load_dwordx4 v218, s[40:43], s59 offen offset:0  lds
    v_mfma_f32_16x16x32_bf16 a[16:19], v[192:195], v[8:11], a[16:19]
    s_mov_b32 s59, 163840
    buffer_load_dwordx4 v219, s[40:43], s59 offen offset:1024  lds
    v_mfma_f32_16x16x32_bf16 a[24:27], v[192:195], v[12:15], a[24:27]
    v_mfma_f32_16x16x32_bf16 a[4:7], v[196:199], v[0:3], a[4:7]
    ds_read_b64_tr_b16 v[192:193], v216 offset:192
    ds_read_b64_tr_b16 v[194:195], v216 offset:5312
    s_mov_b32 s59, 163840
    buffer_load_dwordx4 v220, s[40:43], s59 offen offset:2048  lds
    v_mfma_f32_16x16x32_bf16 a[12:15], v[196:199], v[4:7], a[12:15]
    s_mov_b32 s59, 163840
    buffer_load_dwordx4 v221, s[40:43], s59 offen offset:3072  lds
    v_mfma_f32_16x16x32_bf16 a[20:23], v[196:199], v[8:11], a[20:23]
    v_mfma_f32_16x16x32_bf16 a[28:31], v[196:199], v[12:15], a[28:31]
    s_waitcnt lgkmcnt(6)
    v_mfma_f32_16x16x32_bf16 a[32:35], v[200:203], v[0:3], a[32:35]
    ds_read_b64_tr_b16 v[196:197], v217 offset:192
    ds_read_b64_tr_b16 v[198:199], v217 offset:5312
    v_mfma_f32_16x16x32_bf16 a[40:43], v[200:203], v[4:7], a[40:43]
    s_add_u32 m0, s34, 45056
    s_nop 0
    s_mov_b32 s59, 163840
    buffer_load_dwordx4 v222, s[40:43], s59 offen offset:0  lds
    v_mfma_f32_16x16x32_bf16 a[48:51], v[200:203], v[8:11], a[48:51]
    v_mfma_f32_16x16x32_bf16 a[56:59], v[200:203], v[12:15], a[56:59]
    v_mfma_f32_16x16x32_bf16 a[36:39], v[204:207], v[0:3], a[36:39]
    ds_read_b64_tr_b16 v[200:201], v216 offset:256
    ds_read_b64_tr_b16 v[202:203], v216 offset:5376
    s_mov_b32 s59, 163840
    buffer_load_dwordx4 v223, s[40:43], s59 offen offset:1024  lds
    v_mfma_f32_16x16x32_bf16 a[44:47], v[204:207], v[4:7], a[44:47]
    s_mov_b32 s59, 163840
    buffer_load_dwordx4 v224, s[40:43], s59 offen offset:2048  lds
    v_mfma_f32_16x16x32_bf16 a[52:55], v[204:207], v[8:11], a[52:55]
    v_mfma_f32_16x16x32_bf16 a[60:63], v[204:207], v[12:15], a[60:63]
    s_waitcnt lgkmcnt(6)
    v_mfma_f32_16x16x32_bf16 a[64:67], v[208:211], v[0:3], a[64:67]
    ds_read_b64_tr_b16 v[204:205], v217 offset:256
    ds_read_b64_tr_b16 v[206:207], v217 offset:5376
    s_mov_b32 s59, 163840
    buffer_load_dwordx4 v225, s[40:43], s59 offen offset:3072  lds
    v_mfma_f32_16x16x32_bf16 a[72:75], v[208:211], v[4:7], a[72:75]
    v_mfma_f32_16x16x32_bf16 a[80:83], v[208:211], v[8:11], a[80:83]
    v_mfma_f32_16x16x32_bf16 a[88:91], v[208:211], v[12:15], a[88:91]
    v_mfma_f32_16x16x32_bf16 a[68:71], v[212:215], v[0:3], a[68:71]
    ds_read_b64_tr_b16 v[208:209], v216 offset:10240
    ds_read_b64_tr_b16 v[210:211], v216 offset:15360
    v_mfma_f32_16x16x32_bf16 a[76:79], v[212:215], v[4:7], a[76:79]
    s_add_u32 m0, s34, 49152
    s_nop 0
    s_mov_b32 s59, 163840
    buffer_load_dwordx4 v226, s[40:43], s59 offen offset:0  lds
    v_mfma_f32_16x16x32_bf16 a[84:87], v[212:215], v[8:11], a[84:87]
    s_mov_b32 s59, 163840
    buffer_load_dwordx4 v227, s[40:43], s59 offen offset:1024  lds
    v_mfma_f32_16x16x32_bf16 a[92:95], v[212:215], v[12:15], a[92:95]
    s_waitcnt lgkmcnt(6)
    v_mfma_f32_16x16x32_bf16 a[96:99], v[192:195], v[0:3], a[96:99]
    ds_read_b64_tr_b16 v[212:213], v217 offset:10240
    ds_read_b64_tr_b16 v[214:215], v217 offset:15360
    s_mov_b32 s59, 4096
    buffer_load_dwordx4 v[64:67], v228, s[44:47], s59 offen sc1
    v_mfma_f32_16x16x32_bf16 a[104:107], v[192:195], v[4:7], a[104:107]
    s_mov_b32 s59, 4096
    buffer_load_dwordx4 v[68:71], v229, s[44:47], s59 offen sc1
    v_mfma_f32_16x16x32_bf16 a[112:115], v[192:195], v[8:11], a[112:115]
    v_mfma_f32_16x16x32_bf16 a[120:123], v[192:195], v[12:15], a[120:123]
    v_mfma_f32_16x16x32_bf16 a[100:103], v[196:199], v[0:3], a[100:103]
    ds_read_b64_tr_b16 v[192:193], v216 offset:10304
    ds_read_b64_tr_b16 v[194:195], v216 offset:15424
    s_mov_b32 s59, 4096
    buffer_load_dwordx4 v[72:75], v230, s[44:47], s59 offen sc1
    v_mfma_f32_16x16x32_bf16 a[108:111], v[196:199], v[4:7], a[108:111]
    v_mfma_f32_16x16x32_bf16 a[116:119], v[196:199], v[8:11], a[116:119]
    v_mfma_f32_16x16x32_bf16 a[124:127], v[196:199], v[12:15], a[124:127]
    s_waitcnt lgkmcnt(6)
    v_mfma_f32_16x16x32_bf16 a[128:131], v[200:203], v[0:3], a[128:131]
    ds_read_b64_tr_b16 v[196:197], v217 offset:10304
    ds_read_b64_tr_b16 v[198:199], v217 offset:15424
    s_mov_b32 s59, 4096
    buffer_load_dwordx4 v[76:79], v231, s[44:47], s59 offen sc1
    v_mfma_f32_16x16x32_bf16 a[136:139], v[200:203], v[4:7], a[136:139]
    s_mov_b32 s59, 5120
    buffer_load_dwordx4 v[80:83], v228, s[44:47], s59 offen sc1
    v_mfma_f32_16x16x32_bf16 a[144:147], v[200:203], v[8:11], a[144:147]
    v_mfma_f32_16x16x32_bf16 a[152:155], v[200:203], v[12:15], a[152:155]
    v_mfma_f32_16x16x32_bf16 a[132:135], v[204:207], v[0:3], a[132:135]
    ds_read_b64_tr_b16 v[200:201], v216 offset:10368
    ds_read_b64_tr_b16 v[202:203], v216 offset:15488
    s_mov_b32 s59, 5120
    buffer_load_dwordx4 v[84:87], v229, s[44:47], s59 offen sc1
    v_mfma_f32_16x16x32_bf16 a[140:143], v[204:207], v[4:7], a[140:143]
    v_mfma_f32_16x16x32_bf16 a[148:151], v[204:207], v[8:11], a[148:151]
    v_mfma_f32_16x16x32_bf16 a[156:159], v[204:207], v[12:15], a[156:159]
    s_waitcnt lgkmcnt(6)
    v_mfma_f32_16x16x32_bf16 a[0:3], v[208:211], v[16:19], a[0:3]
    ds_read_b64_tr_b16 v[204:205], v217 offset:10368
    ds_read_b64_tr_b16 v[206:207], v217 offset:15488
    s_mov_b32 s59, 5120
    buffer_load_dwordx4 v[88:91], v230, s[44:47], s59 offen sc1
    v_mfma_f32_16x16x32_bf16 a[8:11], v[208:211], v[20:23], a[8:11]
    s_mov_b32 s59, 5120
    buffer_load_dwordx4 v[92:95], v231, s[44:47], s59 offen sc1
    v_mfma_f32_16x16x32_bf16 a[16:19], v[208:211], v[24:27], a[16:19]
    v_mfma_f32_16x16x32_bf16 a[24:27], v[208:211], v[28:31], a[24:27]
    v_mfma_f32_16x16x32_bf16 a[4:7], v[212:215], v[16:19], a[4:7]
    ds_read_b64_tr_b16 v[208:209], v216 offset:10432
    ds_read_b64_tr_b16 v[210:211], v216 offset:15552
    s_mov_b32 s59, 6144
    buffer_load_dwordx4 v[96:99], v228, s[44:47], s59 offen sc1
    v_mfma_f32_16x16x32_bf16 a[12:15], v[212:215], v[20:23], a[12:15]
    s_mov_b32 s59, 6144
    buffer_load_dwordx4 v[100:103], v229, s[44:47], s59 offen sc1
    v_mfma_f32_16x16x32_bf16 a[20:23], v[212:215], v[24:27], a[20:23]
    v_mfma_f32_16x16x32_bf16 a[28:31], v[212:215], v[28:31], a[28:31]
    s_waitcnt lgkmcnt(6)
    v_mfma_f32_16x16x32_bf16 a[32:35], v[192:195], v[16:19], a[32:35]
    ds_read_b64_tr_b16 v[212:213], v217 offset:10432
    ds_read_b64_tr_b16 v[214:215], v217 offset:15552
    s_mov_b32 s59, 6144
    buffer_load_dwordx4 v[104:107], v230, s[44:47], s59 offen sc1
    v_mfma_f32_16x16x32_bf16 a[40:43], v[192:195], v[20:23], a[40:43]
    v_mfma_f32_16x16x32_bf16 a[48:51], v[192:195], v[24:27], a[48:51]
    v_mfma_f32_16x16x32_bf16 a[56:59], v[192:195], v[28:31], a[56:59]
    v_mfma_f32_16x16x32_bf16 a[36:39], v[196:199], v[16:19], a[36:39]
    ds_read_b64_tr_b16 v[192:193], v216 offset:10496
    ds_read_b64_tr_b16 v[194:195], v216 offset:15616
    s_mov_b32 s59, 6144
    buffer_load_dwordx4 v[108:111], v231, s[44:47], s59 offen sc1
    v_mfma_f32_16x16x32_bf16 a[44:47], v[196:199], v[20:23], a[44:47]
    s_mov_b32 s59, 7168
    buffer_load_dwordx4 v[112:115], v228, s[44:47], s59 offen sc1
    v_mfma_f32_16x16x32_bf16 a[52:55], v[196:199], v[24:27], a[52:55]
    v_mfma_f32_16x16x32_bf16 a[60:63], v[196:199], v[28:31], a[60:63]
    s_waitcnt lgkmcnt(6)
    v_mfma_f32_16x16x32_bf16 a[64:67], v[200:203], v[16:19], a[64:67]
    ds_read_b64_tr_b16 v[196:197], v217 offset:10496
    ds_read_b64_tr_b16 v[198:199], v217 offset:15616
    s_mov_b32 s59, 7168
    buffer_load_dwordx4 v[116:119], v229, s[44:47], s59 offen sc1
    v_mfma_f32_16x16x32_bf16 a[72:75], v[200:203], v[20:23], a[72:75]
    v_mfma_f32_16x16x32_bf16 a[80:83], v[200:203], v[24:27], a[80:83]
    v_mfma_f32_16x16x32_bf16 a[88:91], v[200:203], v[28:31], a[88:91]
    v_mfma_f32_16x16x32_bf16 a[68:71], v[204:207], v[16:19], a[68:71]
    ds_read_b64_tr_b16 v[200:201], v216 offset:20480
    ds_read_b64_tr_b16 v[202:203], v216 offset:25600
    s_mov_b32 s59, 7168
    buffer_load_dwordx4 v[120:123], v230, s[44:47], s59 offen sc1
    v_mfma_f32_16x16x32_bf16 a[76:79], v[204:207], v[20:23], a[76:79]
    s_mov_b32 s59, 7168
    buffer_load_dwordx4 v[124:127], v231, s[44:47], s59 offen sc1
    v_mfma_f32_16x16x32_bf16 a[84:87], v[204:207], v[24:27], a[84:87]
    v_mfma_f32_16x16x32_bf16 a[92:95], v[204:207], v[28:31], a[92:95]
    s_waitcnt lgkmcnt(6)
    v_mfma_f32_16x16x32_bf16 a[96:99], v[208:211], v[16:19], a[96:99]
    ds_read_b64_tr_b16 v[204:205], v217 offset:20480
    ds_read_b64_tr_b16 v[206:207], v217 offset:25600
    v_mfma_f32_16x16x32_bf16 a[104:107], v[208:211], v[20:23], a[104:107]
    buffer_load_dword v238, v237, s[40:43], s57 offen
    s_add_u32 s57, s57, 655360
    v_mfma_f32_16x16x32_bf16 a[112:115], v[208:211], v[24:27], a[112:115]
    v_mfma_f32_16x16x32_bf16 a[120:123], v[208:211], v[28:31], a[120:123]
    v_mfma_f32_16x16x32_bf16 a[100:103], v[212:215], v[16:19], a[100:103]
    ds_read_b64_tr_b16 v[208:209], v216 offset:20544
    ds_read_b64_tr_b16 v[210:211], v216 offset:25664
    v_mfma_f32_16x16x32_bf16 a[108:111], v[212:215], v[20:23], a[108:111]
    s_add_u32 m0, s34, 81920
    s_nop 0
    s_mov_b32 s59, 327680
    buffer_load_dwordx4 v218, s[40:43], s59 offen offset:0  lds
    v_mfma_f32_16x16x32_bf16 a[116:119], v[212:215], v[24:27], a[116:119]
    s_mov_b32 s59, 327680
    buffer_load_dwordx4 v219, s[40:43], s59 offen offset:1024  lds
    v_mfma_f32_16x16x32_bf16 a[124:127], v[212:215], v[28:31], a[124:127]
    s_waitcnt lgkmcnt(6)
    v_mfma_f32_16x16x32_bf16 a[128:131], v[192:195], v[16:19], a[128:131]
    ds_read_b64_tr_b16 v[212:213], v217 offset:20544
    ds_read_b64_tr_b16 v[214:215], v217 offset:25664
    s_mov_b32 s59, 327680
    buffer_load_dwordx4 v220, s[40:43], s59 offen offset:2048  lds
    v_mfma_f32_16x16x32_bf16 a[136:139], v[192:195], v[20:23], a[136:139]
    s_mov_b32 s59, 327680
    buffer_load_dwordx4 v221, s[40:43], s59 offen offset:3072  lds
    v_mfma_f32_16x16x32_bf16 a[144:147], v[192:195], v[24:27], a[144:147]
    v_mfma_f32_16x16x32_bf16 a[152:155], v[192:195], v[28:31], a[152:155]
    v_mfma_f32_16x16x32_bf16 a[132:135], v[196:199], v[16:19], a[132:135]
    ds_read_b64_tr_b16 v[192:193], v216 offset:20608
    ds_read_b64_tr_b16 v[194:195], v216 offset:25728
    v_mfma_f32_16x16x32_bf16 a[140:143], v[196:199], v[20:23], a[140:143]
    s_add_u32 m0, s34, 86016
    s_nop 0
    s_mov_b32 s59, 327680
    buffer_load_dwordx4 v222, s[40:43], s59 offen offset:0  lds
    v_mfma_f32_16x16x32_bf16 a[148:151], v[196:199], v[24:27], a[148:151]
    v_mfma_f32_16x16x32_bf16 a[156:159], v[196:199], v[28:31], a[156:159]
    s_waitcnt lgkmcnt(6)
    v_mfma_f32_16x16x32_bf16 a[0:3], v[200:203], v[32:35], a[0:3]
    ds_read_b64_tr_b16 v[196:197], v217 offset:20608
    ds_read_b64_tr_b16 v[198:199], v217 offset:25728
    s_mov_b32 s59, 327680
    buffer_load_dwordx4 v223, s[40:43], s59 offen offset:1024  lds
    v_mfma_f32_16x16x32_bf16 a[8:11], v[200:203], v[36:39], a[8:11]
    s_mov_b32 s59, 327680
    buffer_load_dwordx4 v224, s[40:43], s59 offen offset:2048  lds
    v_mfma_f32_16x16x32_bf16 a[16:19], v[200:203], v[40:43], a[16:19]
    v_mfma_f32_16x16x32_bf16 a[24:27], v[200:203], v[44:47], a[24:27]
    v_mfma_f32_16x16x32_bf16 a[4:7], v[204:207], v[32:35], a[4:7]
    ds_read_b64_tr_b16 v[200:201], v216 offset:20672
    ds_read_b64_tr_b16 v[202:203], v216 offset:25792
    s_mov_b32 s59, 327680
    buffer_load_dwordx4 v225, s[40:43], s59 offen offset:3072  lds
    v_mfma_f32_16x16x32_bf16 a[12:15], v[204:207], v[36:39], a[12:15]
    v_mfma_f32_16x16x32_bf16 a[20:23], v[204:207], v[40:43], a[20:23]
    v_mfma_f32_16x16x32_bf16 a[28:31], v[204:207], v[44:47], a[28:31]
    s_waitcnt lgkmcnt(6)
    v_mfma_f32_16x16x32_bf16 a[32:35], v[208:211], v[32:35], a[32:35]
    ds_read_b64_tr_b16 v[204:205], v217 offset:20672
    ds_read_b64_tr_b16 v[206:207], v217 offset:25792
    v_mfma_f32_16x16x32_bf16 a[40:43], v[208:211], v[36:39], a[40:43]
    s_add_u32 m0, s34, 90112
    s_nop 0
    s_mov_b32 s59, 327680
    buffer_load_dwordx4 v226, s[40:43], s59 offen offset:0  lds
    v_mfma_f32_16x16x32_bf16 a[48:51], v[208:211], v[40:43], a[48:51]
    s_mov_b32 s59, 327680
    buffer_load_dwordx4 v227, s[40:43], s59 offen offset:1024  lds
    v_mfma_f32_16x16x32_bf16 a[56:59], v[208:211], v[44:47], a[56:59]
    v_mfma_f32_16x16x32_bf16 a[36:39], v[212:215], v[32:35], a[36:39]
    ds_read_b64_tr_b16 v[208:209], v216 offset:20736
    ds_read_b64_tr_b16 v[210:211], v216 offset:25856
    s_mov_b32 s59, 8192
    buffer_load_dwordx4 v[128:131], v228, s[44:47], s59 offen sc1
    v_mfma_f32_16x16x32_bf16 a[44:47], v[212:215], v[36:39], a[44:47]
    s_mov_b32 s59, 8192
    buffer_load_dwordx4 v[132:135], v229, s[44:47], s59 offen sc1
    v_mfma_f32_16x16x32_bf16 a[52:55], v[212:215], v[40:43], a[52:55]
    v_mfma_f32_16x16x32_bf16 a[60:63], v[212:215], v[44:47], a[60:63]
    s_waitcnt lgkmcnt(6)
    v_mfma_f32_16x16x32_bf16 a[64:67], v[192:195], v[32:35], a[64:67]
    ds_read_b64_tr_b16 v[212:213], v217 offset:20736
    ds_read_b64_tr_b16 v[214:215], v217 offset:25856
    s_mov_b32 s59, 8192
    buffer_load_dwordx4 v[136:139], v230, s[44:47], s59 offen sc1
    v_mfma_f32_16x16x32_bf16 a[72:75], v[192:195], v[36:39], a[72:75]
    v_mfma_f32_16x16x32_bf16 a[80:83], v[192:195], v[40:43], a[80:83]
    v_mfma_f32_16x16x32_bf16 a[88:91], v[192:195], v[44:47], a[88:91]
    v_mfma_f32_16x16x32_bf16 a[68:71], v[196:199], v[32:35], a[68:71]
    ds_read_b64_tr_b16 v[192:193], v216 offset:30720
    ds_read_b64_tr_b16 v[194:195], v216 offset:35840
    s_mov_b32 s59, 8192
    buffer_load_dwordx4 v[140:143], v231, s[44:47], s59 offen sc1
    v_mfma_f32_16x16x32_bf16 a[76:79], v[196:199], v[36:39], a[76:79]
    s_mov_b32 s59, 9216
    buffer_load_dwordx4 v[144:147], v228, s[44:47], s59 offen sc1
    v_mfma_f32_16x16x32_bf16 a[84:87], v[196:199], v[40:43], a[84:87]
    v_mfma_f32_16x16x32_bf16 a[92:95], v[196:199], v[44:47], a[92:95]
    s_waitcnt lgkmcnt(6)
    v_mfma_f32_16x16x32_bf16 a[96:99], v[200:203], v[32:35], a[96:99]
    ds_read_b64_tr_b16 v[196:197], v217 offset:30720
    ds_read_b64_tr_b16 v[198:199], v217 offset:35840
    s_mov_b32 s59, 9216
    buffer_load_dwordx4 v[148:151], v229, s[44:47], s59 offen sc1
    v_mfma_f32_16x16x32_bf16 a[104:107], v[200:203], v[36:39], a[104:107]
    v_mfma_f32_16x16x32_bf16 a[112:115], v[200:203], v[40:43], a[112:115]
    v_mfma_f32_16x16x32_bf16 a[120:123], v[200:203], v[44:47], a[120:123]
    v_mfma_f32_16x16x32_bf16 a[100:103], v[204:207], v[32:35], a[100:103]
    ds_read_b64_tr_b16 v[200:201], v216 offset:30784
    ds_read_b64_tr_b16 v[202:203], v216 offset:35904
    s_mov_b32 s59, 9216
    buffer_load_dwordx4 v[152:155], v230, s[44:47], s59 offen sc1
    v_mfma_f32_16x16x32_bf16 a[108:111], v[204:207], v[36:39], a[108:111]
    s_mov_b32 s59, 9216
    buffer_load_dwordx4 v[156:159], v231, s[44:47], s59 offen sc1
    v_mfma_f32_16x16x32_bf16 a[116:119], v[204:207], v[40:43], a[116:119]
    buffer_load_dword v238, v236, s[52:55], s56 offen sc1
    s_add_u32 s56, s56, 4096
    v_mfma_f32_16x16x32_bf16 a[124:127], v[204:207], v[44:47], a[124:127]
    s_waitcnt lgkmcnt(6)
    v_mfma_f32_16x16x32_bf16 a[128:131], v[208:211], v[32:35], a[128:131]
    ds_read_b64_tr_b16 v[204:205], v217 offset:30784
    ds_read_b64_tr_b16 v[206:207], v217 offset:35904
    s_mov_b32 s59, 10240
    buffer_load_dwordx4 v[160:163], v228, s[44:47], s59 offen sc1
    v_mfma_f32_16x16x32_bf16 a[136:139], v[208:211], v[36:39], a[136:139]
    s_mov_b32 s59, 10240
    buffer_load_dwordx4 v[164:167], v229, s[44:47], s59 offen sc1
    v_mfma_f32_16x16x32_bf16 a[144:147], v[208:211], v[40:43], a[144:147]
    v_mfma_f32_16x16x32_bf16 a[152:155], v[208:211], v[44:47], a[152:155]
    v_mfma_f32_16x16x32_bf16 a[132:135], v[212:215], v[32:35], a[132:135]
    ds_read_b64_tr_b16 v[208:209], v216 offset:30848
    ds_read_b64_tr_b16 v[210:211], v216 offset:35968
    s_mov_b32 s59, 10240
    buffer_load_dwordx4 v[168:171], v230, s[44:47], s59 offen sc1
    v_mfma_f32_16x16x32_bf16 a[140:143], v[212:215], v[36:39], a[140:143]
    v_mfma_f32_16x16x32_bf16 a[148:151], v[212:215], v[40:43], a[148:151]
    v_mfma_f32_16x16x32_bf16 a[156:159], v[212:215], v[44:47], a[156:159]
    s_waitcnt lgkmcnt(6)
    v_mfma_f32_16x16x32_bf16 a[0:3], v[192:195], v[48:51], a[0:3]
    ds_read_b64_tr_b16 v[212:213], v217 offset:30848
    ds_read_b64_tr_b16 v[214:215], v217 offset:35968
    s_mov_b32 s59, 10240
    buffer_load_dwordx4 v[172:175], v231, s[44:47], s59 offen sc1
    v_mfma_f32_16x16x32_bf16 a[8:11], v[192:195], v[52:55], a[8:11]
    s_mov_b32 s59, 11264
    buffer_load_dwordx4 v[176:179], v228, s[44:47], s59 offen sc1
    v_mfma_f32_16x16x32_bf16 a[16:19], v[192:195], v[56:59], a[16:19]
    v_mfma_f32_16x16x32_bf16 a[24:27], v[192:195], v[60:63], a[24:27]
    s_waitcnt vmcnt(41)
    s_barrier
    v_mfma_f32_16x16x32_bf16 a[4:7], v[196:199], v[48:51], a[4:7]
    ds_read_b64_tr_b16 v[192:193], v216 offset:30912
    ds_read_b64_tr_b16 v[194:195], v216 offset:36032
    s_mov_b32 s59, 11264
    buffer_load_dwordx4 v[180:183], v229, s[44:47], s59 offen sc1
    v_mfma_f32_16x16x32_bf16 a[12:15], v[196:199], v[52:55], a[12:15]
    v_mfma_f32_16x16x32_bf16 a[20:23], v[196:199], v[56:59], a[20:23]
    v_mfma_f32_16x16x32_bf16 a[28:31], v[196:199], v[60:63], a[28:31]
    s_waitcnt lgkmcnt(6)
    v_mfma_f32_16x16x32_bf16 a[32:35], v[200:203], v[48:51], a[32:35]
    ds_read_b64_tr_b16 v[196:197], v217 offset:30912
    ds_read_b64_tr_b16 v[198:199], v217 offset:36032
    s_mov_b32 s59, 11264
    buffer_load_dwordx4 v[184:187], v230, s[44:47], s59 offen sc1
    v_mfma_f32_16x16x32_bf16 a[40:43], v[200:203], v[52:55], a[40:43]
    s_mov_b32 s59, 11264
    buffer_load_dwordx4 v[188:191], v231, s[44:47], s59 offen sc1
    v_mfma_f32_16x16x32_bf16 a[48:51], v[200:203], v[56:59], a[48:51]
    v_mfma_f32_16x16x32_bf16 a[56:59], v[200:203], v[60:63], a[56:59]
    v_mfma_f32_16x16x32_bf16 a[36:39], v[204:207], v[48:51], a[36:39]
    ds_read_b64_tr_b16 v[200:201], v216 offset:30976
    ds_read_b64_tr_b16 v[202:203], v216 offset:36096
    v_mfma_f32_16x16x32_bf16 a[44:47], v[204:207], v[52:55], a[44:47]
    buffer_load_dword v238, v237, s[40:43], s57 offen
    s_add_u32 s57, s57, 655360
    v_mfma_f32_16x16x32_bf16 a[52:55], v[204:207], v[56:59], a[52:55]
    v_mfma_f32_16x16x32_bf16 a[60:63], v[204:207], v[60:63], a[60:63]
    s_waitcnt lgkmcnt(6)
    v_mfma_f32_16x16x32_bf16 a[64:67], v[208:211], v[48:51], a[64:67]
    ds_read_b64_tr_b16 v[204:205], v217 offset:30976
    ds_read_b64_tr_b16 v[206:207], v217 offset:36096
    s_mov_b32 s59, 12288
    buffer_load_dwordx4 v[0:3], v228, s[44:47], s59 offen sc1
    v_mfma_f32_16x16x32_bf16 a[72:75], v[208:211], v[52:55], a[72:75]
    v_mfma_f32_16x16x32_bf16 a[80:83], v[208:211], v[56:59], a[80:83]
    v_mfma_f32_16x16x32_bf16 a[88:91], v[208:211], v[60:63], a[88:91]
    v_mfma_f32_16x16x32_bf16 a[68:71], v[212:215], v[48:51], a[68:71]
    v_add_u32 v216, 0xa000, v216
    v_add_u32 v217, 0xa000, v217
    ds_read_b64_tr_b16 v[208:209], v216 offset:0
    ds_read_b64_tr_b16 v[210:211], v216 offset:5120
    s_mov_b32 s59, 12288
    buffer_load_dwordx4 v[4:7], v229, s[44:47], s59 offen sc1
    v_mfma_f32_16x16x32_bf16 a[76:79], v[212:215], v[52:55], a[76:79]
    v_mfma_f32_16x16x32_bf16 a[84:87], v[212:215], v[56:59], a[84:87]
    v_mfma_f32_16x16x32_bf16 a[92:95], v[212:215], v[60:63], a[92:95]
    s_waitcnt lgkmcnt(6)
    v_mfma_f32_16x16x32_bf16 a[96:99], v[192:195], v[48:51], a[96:99]
    ds_read_b64_tr_b16 v[212:213], v217 offset:0
    ds_read_b64_tr_b16 v[214:215], v217 offset:5120
    s_mov_b32 s59, 12288
    buffer_load_dwordx4 v[8:11], v230, s[44:47], s59 offen sc1
    v_mfma_f32_16x16x32_bf16 a[104:107], v[192:195], v[52:55], a[104:107]
    v_mfma_f32_16x16x32_bf16 a[112:115], v[192:195], v[56:59], a[112:115]
    v_mfma_f32_16x16x32_bf16 a[120:123], v[192:195], v[60:63], a[120:123]
    v_mfma_f32_16x16x32_bf16 a[100:103], v[196:199], v[48:51], a[100:103]
    ds_read_b64_tr_b16 v[192:193], v216 offset:64
    ds_read_b64_tr_b16 v[194:195], v216 offset:5184
    s_mov_b32 s59, 12288
    buffer_load_dwordx4 v[12:15], v231, s[44:47], s59 offen sc1
    v_mfma_f32_16x16x32_bf16 a[108:111], v[196:199], v[52:55], a[108:111]
    v_mfma_f32_16x16x32_bf16 a[116:119], v[196:199], v[56:59], a[116:119]
    v_mfma_f32_16x16x32_bf16 a[124:127], v[196:199], v[60:63], a[124:127]
    s_waitcnt lgkmcnt(6)
    v_mfma_f32_16x16x32_bf16 a[128:131], v[200:203], v[48:51], a[128:131]
    ds_read_b64_tr_b16 v[196:197], v217 offset:64
    ds_read_b64_tr_b16 v[198:199], v217 offset:5184
    s_mov_b32 s59, 13312
    buffer_load_dwordx4 v[16:19], v228, s[44:47], s59 offen sc1
    v_mfma_f32_16x16x32_bf16 a[136:139], v[200:203], v[52:55], a[136:139]
    v_mfma_f32_16x16x32_bf16 a[144:147], v[200:203], v[56:59], a[144:147]
    v_mfma_f32_16x16x32_bf16 a[152:155], v[200:203], v[60:63], a[152:155]
    v_mfma_f32_16x16x32_bf16 a[132:135], v[204:207], v[48:51], a[132:135]
    ds_read_b64_tr_b16 v[200:201], v216 offset:128
    ds_read_b64_tr_b16 v[202:203], v216 offset:5248
    s_mov_b32 s59, 13312
    buffer_load_dwordx4 v[20:23], v229, s[44:47], s59 offen sc1
    v_mfma_f32_16x16x32_bf16 a[140:143], v[204:207], v[52:55], a[140:143]
    v_mfma_f32_16x16x32_bf16 a[148:151], v[204:207], v[56:59], a[148:151]
    v_mfma_f32_16x16x32_bf16 a[156:159], v[204:207], v[60:63], a[156:159]
    s_waitcnt vmcnt(35)
    s_waitcnt lgkmcnt(6)
    v_mfma_f32_16x16x32_bf16 a[0:3], v[208:211], v[64:67], a[0:3]
    ds_read_b64_tr_b16 v[204:205], v217 offset:128
    ds_read_b64_tr_b16 v[206:207], v217 offset:5248
    s_mov_b32 s59, 13312
    buffer_load_dwordx4 v[24:27], v230, s[44:47], s59 offen sc1
    v_mfma_f32_16x16x32_bf16 a[8:11], v[208:211], v[68:71], a[8:11]
    v_mfma_f32_16x16x32_bf16 a[16:19], v[208:211], v[72:75], a[16:19]
    v_mfma_f32_16x16x32_bf16 a[24:27], v[208:211], v[76:79], a[24:27]
    v_mfma_f32_16x16x32_bf16 a[4:7], v[212:215], v[64:67], a[4:7]
    ds_read_b64_tr_b16 v[208:209], v216 offset:192
    ds_read_b64_tr_b16 v[210:211], v216 offset:5312
    s_mov_b32 s59, 13312
    buffer_load_dwordx4 v[28:31], v231, s[44:47], s59 offen sc1
    v_mfma_f32_16x16x32_bf16 a[12:15], v[212:215], v[68:71], a[12:15]
    v_mfma_f32_16x16x32_bf16 a[20:23], v[212:215], v[72:75], a[20:23]
    v_mfma_f32_16x16x32_bf16 a[28:31], v[212:215], v[76:79], a[28:31]
    s_waitcnt lgkmcnt(6)
    v_mfma_f32_16x16x32_bf16 a[32:35], v[192:195], v[64:67], a[32:35]
    ds_read_b64_tr_b16 v[212:213], v217 offset:192
    ds_read_b64_tr_b16 v[214:215], v217 offset:5312
    s_mov_b32 s59, 14336
    buffer_load_dwordx4 v[32:35], v228, s[44:47], s59 offen sc1
    v_mfma_f32_16x16x32_bf16 a[40:43], v[192:195], v[68:71], a[40:43]
    v_mfma_f32_16x16x32_bf16 a[48:51], v[192:195], v[72:75], a[48:51]
    v_mfma_f32_16x16x32_bf16 a[56:59], v[192:195], v[76:79], a[56:59]
    v_mfma_f32_16x16x32_bf16 a[36:39], v[196:199], v[64:67], a[36:39]
    ds_read_b64_tr_b16 v[192:193], v216 offset:256
    ds_read_b64_tr_b16 v[194:195], v216 offset:5376
    s_mov_b32 s59, 14336
    buffer_load_dwordx4 v[36:39], v229, s[44:47], s59 offen sc1
    v_mfma_f32_16x16x32_bf16 a[44:47], v[196:199], v[68:71], a[44:47]
    v_mfma_f32_16x16x32_bf16 a[52:55], v[196:199], v[72:75], a[52:55]
    v_mfma_f32_16x16x32_bf16 a[60:63], v[196:199], v[76:79], a[60:63]
    s_waitcnt lgkmcnt(6)
    v_mfma_f32_16x16x32_bf16 a[64:67], v[200:203], v[64:67], a[64:67]
    ds_read_b64_tr_b16 v[196:197], v217 offset:256
    ds_read_b64_tr_b16 v[198:199], v217 offset:5376
    s_mov_b32 s59, 14336
    buffer_load_dwordx4 v[40:43], v230, s[44:47], s59 offen sc1
    v_mfma_f32_16x16x32_bf16 a[72:75], v[200:203], v[68:71], a[72:75]
    v_mfma_f32_16x16x32_bf16 a[80:83], v[200:203], v[72:75], a[80:83]
    v_mfma_f32_16x16x32_bf16 a[88:91], v[200:203], v[76:79], a[88:91]
    s_waitcnt vmcnt(29)
    s_barrier
    v_mfma_f32_16x16x32_bf16 a[68:71], v[204:207], v[64:67], a[68:71]
    ds_read_b64_tr_b16 v[200:201], v216 offset:10240
    ds_read_b64_tr_b16 v[202:203], v216 offset:15360
    s_mov_b32 s59, 14336
    buffer_load_dwordx4 v[44:47], v231, s[44:47], s59 offen sc1
    v_mfma_f32_16x16x32_bf16 a[76:79], v[204:207], v[68:71], a[76:79]
    s_add_u32 m0, s34, 0
    s_nop 0
    buffer_load_dwordx4 v218, s[40:43], s37 offen offset:0  lds
    v_mfma_f32_16x16x32_bf16 a[84:87], v[204:207], v[72:75], a[84:87]
    v_mfma_f32_16x16x32_bf16 a[92:95], v[204:207], v[76:79], a[92:95]
    s_waitcnt lgkmcnt(6)
    v_mfma_f32_16x16x32_bf16 a[96:99], v[208:211], v[64:67], a[96:99]
    ds_read_b64_tr_b16 v[204:205], v217 offset:10240
    ds_read_b64_tr_b16 v[206:207], v217 offset:15360
    s_mov_b32 s59, 15360
    buffer_load_dwordx4 v[48:51], v228, s[44:47], s59 offen sc1
    v_mfma_f32_16x16x32_bf16 a[104:107], v[208:211], v[68:71], a[104:107]
    v_mfma_f32_16x16x32_bf16 a[112:115], v[208:211], v[72:75], a[112:115]
    v_mfma_f32_16x16x32_bf16 a[120:123], v[208:211], v[76:79], a[120:123]
    v_mfma_f32_16x16x32_bf16 a[100:103], v[212:215], v[64:67], a[100:103]
    ds_read_b64_tr_b16 v[208:209], v216 offset:10304
    ds_read_b64_tr_b16 v[210:211], v216 offset:15424
    s_mov_b32 s59, 15360
    buffer_load_dwordx4 v[52:55], v229, s[44:47], s59 offen sc1
    v_mfma_f32_16x16x32_bf16 a[108:111], v[212:215], v[68:71], a[108:111]
    buffer_load_dwordx4 v219, s[40:43], s37 offen offset:1024  lds
    v_mfma_f32_16x16x32_bf16 a[116:119], v[212:215], v[72:75], a[116:119]
    v_mfma_f32_16x16x32_bf16 a[124:127], v[212:215], v[76:79], a[124:127]
    s_waitcnt lgkmcnt(6)
    v_mfma_f32_16x16x32_bf16 a[128:131], v[192:195], v[64:67], a[128:131]
    ds_read_b64_tr_b16 v[212:213], v217 offset:10304
    ds_read_b64_tr_b16 v[214:215], v217 offset:15424
    s_mov_b32 s59, 15360
    buffer_load_dwordx4 v[56:59], v230, s[44:47], s59 offen sc1
    v_mfma_f32_16x16x32_bf16 a[136:139], v[192:195], v[68:71], a[136:139]
    v_mfma_f32_16x16x32_bf16 a[144:147], v[192:195], v[72:75], a[144:147]
    v_mfma_f32_16x16x32_bf16 a[152:155], v[192:195], v[76:79], a[152:155]
    v_mfma_f32_16x16x32_bf16 a[132:135], v[196:199], v[64:67], a[132:135]
    ds_read_b64_tr_b16 v[192:193], v216 offset:10368
    ds_read_b64_tr_b16 v[194:195], v216 offset:15488
    s_mov_b32 s59, 15360
    buffer_load_dwordx4 v[60:63], v231, s[44:47], s59 offen sc1
    v_mfma_f32_16x16x32_bf16 a[140:143], v[196:199], v[68:71], a[140:143]
    buffer_load_dwordx4 v220, s[40:43], s37 offen offset:2048  lds
    v_mfma_f32_16x16x32_bf16 a[148:151], v[196:199], v[72:75], a[148:151]
    v_mfma_f32_16x16x32_bf16 a[156:159], v[196:199], v[76:79], a[156:159]
    s_waitcnt lgkmcnt(6)
    v_mfma_f32_16x16x32_bf16 a[0:3], v[200:203], v[80:83], a[0:3]
    ds_read_b64_tr_b16 v[196:197], v217 offset:10368
    ds_read_b64_tr_b16 v[198:199], v217 offset:15488
    buffer_load_dwordx4 v[64:67], v228, s[44:47], s38 offen sc1
    v_mfma_f32_16x16x32_bf16 a[8:11], v[200:203], v[84:87], a[8:11]
    v_mfma_f32_16x16x32_bf16 a[16:19], v[200:203], v[88:91], a[16:19]
    v_mfma_f32_16x16x32_bf16 a[24:27], v[200:203], v[92:95], a[24:27]
    v_mfma_f32_16x16x32_bf16 a[4:7], v[204:207], v[80:83], a[4:7]
    ds_read_b64_tr_b16 v[200:201], v216 offset:10432
    ds_read_b64_tr_b16 v[202:203], v216 offset:15552
    buffer_load_dwordx4 v221, s[40:43], s37 offen offset:3072  lds
    v_mfma_f32_16x16x32_bf16 a[12:15], v[204:207], v[84:87], a[12:15]
    v_mfma_f32_16x16x32_bf16 a[20:23], v[204:207], v[88:91], a[20:23]
    v_mfma_f32_16x16x32_bf16 a[28:31], v[204:207], v[92:95], a[28:31]
    s_waitcnt lgkmcnt(6)
    v_mfma_f32_16x16x32_bf16 a[32:35], v[208:211], v[80:83], a[32:35]
    ds_read_b64_tr_b16 v[204:205], v217 offset:10432
    ds_read_b64_tr_b16 v[206:207], v217 offset:15552
    buffer_load_dwordx4 v[68:71], v229, s[44:47], s38 offen sc1
    v_mfma_f32_16x16x32_bf16 a[40:43], v[208:211], v[84:87], a[40:43]
    v_mfma_f32_16x16x32_bf16 a[48:51], v[208:211], v[88:91], a[48:51]
    v_mfma_f32_16x16x32_bf16 a[56:59], v[208:211], v[92:95], a[56:59]
    v_mfma_f32_16x16x32_bf16 a[36:39], v[212:215], v[80:83], a[36:39]
    ds_read_b64_tr_b16 v[208:209], v216 offset:10496
    ds_read_b64_tr_b16 v[210:211], v216 offset:15616
    v_mfma_f32_16x16x32_bf16 a[44:47], v[212:215], v[84:87], a[44:47]
    s_add_u32 m0, s34, 4096
    s_nop 0
    buffer_load_dwordx4 v222, s[40:43], s37 offen offset:0  lds
    v_mfma_f32_16x16x32_bf16 a[52:55], v[212:215], v[88:91], a[52:55]
    v_mfma_f32_16x16x32_bf16 a[60:63], v[212:215], v[92:95], a[60:63]
    s_waitcnt lgkmcnt(6)
    v_mfma_f32_16x16x32_bf16 a[64:67], v[192:195], v[80:83], a[64:67]
    ds_read_b64_tr_b16 v[212:213], v217 offset:10496
    ds_read_b64_tr_b16 v[214:215], v217 offset:15616
    buffer_load_dwordx4 v[72:75], v230, s[44:47], s38 offen sc1
    v_mfma_f32_16x16x32_bf16 a[72:75], v[192:195], v[84:87], a[72:75]
    v_mfma_f32_16x16x32_bf16 a[80:83], v[192:195], v[88:91], a[80:83]
    v_mfma_f32_16x16x32_bf16 a[88:91], v[192:195], v[92:95], a[88:91]
    v_mfma_f32_16x16x32_bf16 a[68:71], v[196:199], v[80:83], a[68:71]
    ds_read_b64_tr_b16 v[192:193], v216 offset:20480
    ds_read_b64_tr_b16 v[194:195], v216 offset:25600
    buffer_load_dwordx4 v223, s[40:43], s37 offen offset:1024  lds
    v_mfma_f32_16x16x32_bf16 a[76:79], v[196:199], v[84:87], a[76:79]
    v_mfma_f32_16x16x32_bf16 a[84:87], v[196:199], v[88:91], a[84:87]
    v_mfma_f32_16x16x32_bf16 a[92:95], v[196:199], v[92:95], a[92:95]
    s_waitcnt lgkmcnt(6)
    v_mfma_f32_16x16x32_bf16 a[96:99], v[200:203], v[80:83], a[96:99]
    ds_read_b64_tr_b16 v[196:197], v217 offset:20480
    ds_read_b64_tr_b16 v[198:199], v217 offset:25600
    buffer_load_dwordx4 v[76:79], v231, s[44:47], s38 offen sc1
    s_add_u32 s38, s38, 1024
    v_mfma_f32_16x16x32_bf16 a[104:107], v[200:203], v[84:87], a[104:107]
    v_mfma_f32_16x16x32_bf16 a[112:115], v[200:203], v[88:91], a[112:115]
    v_mfma_f32_16x16x32_bf16 a[120:123], v[200:203], v[92:95], a[120:123]
    v_mfma_f32_16x16x32_bf16 a[100:103], v[204:207], v[80:83], a[100:103]
    ds_read_b64_tr_b16 v[200:201], v216 offset:20544
    ds_read_b64_tr_b16 v[202:203], v216 offset:25664
    buffer_load_dwordx4 v224, s[40:43], s37 offen offset:2048  lds
    v_mfma_f32_16x16x32_bf16 a[108:111], v[204:207], v[84:87], a[108:111]
    v_mfma_f32_16x16x32_bf16 a[116:119], v[204:207], v[88:91], a[116:119]
    v_mfma_f32_16x16x32_bf16 a[124:127], v[204:207], v[92:95], a[124:127]
    s_waitcnt lgkmcnt(6)
    v_mfma_f32_16x16x32_bf16 a[128:131], v[208:211], v[80:83], a[128:131]
    ds_read_b64_tr_b16 v[204:205], v217 offset:20544
    ds_read_b64_tr_b16 v[206:207], v217 offset:25664
    v_mfma_f32_16x16x32_bf16 a[136:139], v[208:211], v[84:87], a[136:139]
    v_mfma_f32_16x16x32_bf16 a[144:147], v[208:211], v[88:91], a[144:147]
    v_mfma_f32_16x16x32_bf16 a[152:155], v[208:211], v[92:95], a[152:155]
    v_mfma_f32_16x16x32_bf16 a[132:135], v[212:215], v[80:83], a[132:135]
    ds_read_b64_tr_b16 v[208:209], v216 offset:20608
    ds_read_b64_tr_b16 v[210:211], v216 offset:25728
    buffer_load_dwordx4 v225, s[40:43], s37 offen offset:3072  lds
    v_mfma_f32_16x16x32_bf16 a[140:143], v[212:215], v[84:87], a[140:143]
    v_mfma_f32_16x16x32_bf16 a[148:151], v[212:215], v[88:91], a[148:151]
    v_mfma_f32_16x16x32_bf16 a[156:159], v[212:215], v[92:95], a[156:159]
    s_waitcnt lgkmcnt(6)
    v_mfma_f32_16x16x32_bf16 a[0:3], v[192:195], v[96:99], a[0:3]
    ds_read_b64_tr_b16 v[212:213], v217 offset:20608
    ds_read_b64_tr_b16 v[214:215], v217 offset:25728
    buffer_load_dwordx4 v[80:83], v228, s[44:47], s38 offen sc1
    v_mfma_f32_16x16x32_bf16 a[8:11], v[192:195], v[100:103], a[8:11]
    v_mfma_f32_16x16x32_bf16 a[16:19], v[192:195], v[104:107], a[16:19]
    v_mfma_f32_16x16x32_bf16 a[24:27], v[192:195], v[108:111], a[24:27]
    v_mfma_f32_16x16x32_bf16 a[4:7], v[196:199], v[96:99], a[4:7]
    ds_read_b64_tr_b16 v[192:193], v216 offset:20672
    ds_read_b64_tr_b16 v[194:195], v216 offset:25792
    v_mfma_f32_16x16x32_bf16 a[12:15], v[196:199], v[100:103], a[12:15]
    s_add_u32 m0, s34, 8192
    s_nop 0
    buffer_load_dwordx4 v226, s[40:43], s37 offen offset:0  lds
    v_mfma_f32_16x16x32_bf16 a[20:23], v[196:199], v[104:107], a[20:23]
    v_mfma_f32_16x16x32_bf16 a[28:31], v[196:199], v[108:111], a[28:31]
    s_waitcnt lgkmcnt(6)
    v_mfma_f32_16x16x32_bf16 a[32:35], v[200:203], v[96:99], a[32:35]
    ds_read_b64_tr_b16 v[196:197], v217 offset:20672
    ds_read_b64_tr_b16 v[198:199], v217 offset:25792
    buffer_load_dwordx4 v[84:87], v229, s[44:47], s38 offen sc1
    v_mfma_f32_16x16x32_bf16 a[40:43], v[200:203], v[100:103], a[40:43]
    v_mfma_f32_16x16x32_bf16 a[48:51], v[200:203], v[104:107], a[48:51]
    v_mfma_f32_16x16x32_bf16 a[56:59], v[200:203], v[108:111], a[56:59]
    v_mfma_f32_16x16x32_bf16 a[36:39], v[204:207], v[96:99], a[36:39]
    ds_read_b64_tr_b16 v[200:201], v216 offset:20736
    ds_read_b64_tr_b16 v[202:203], v216 offset:25856
    buffer_load_dwordx4 v227, s[40:43], s37 offen offset:1024  lds
    s_add_u32 s37, s37, 163840
    v_mfma_f32_16x16x32_bf16 a[44:47], v[204:207], v[100:103], a[44:47]
    v_mfma_f32_16x16x32_bf16 a[52:55], v[204:207], v[104:107], a[52:55]
    v_mfma_f32_16x16x32_bf16 a[60:63], v[204:207], v[108:111], a[60:63]
    s_waitcnt lgkmcnt(6)
    v_mfma_f32_16x16x32_bf16 a[64:67], v[208:211], v[96:99], a[64:67]
    ds_read_b64_tr_b16 v[204:205], v217 offset:20736
    ds_read_b64_tr_b16 v[206:207], v217 offset:25856
    buffer_load_dwordx4 v[88:91], v230, s[44:47], s38 offen sc1
    v_mfma_f32_16x16x32_bf16 a[72:75], v[208:211], v[100:103], a[72:75]
    v_mfma_f32_16x16x32_bf16 a[80:83], v[208:211], v[104:107], a[80:83]
    v_mfma_f32_16x16x32_bf16 a[88:91], v[208:211], v[108:111], a[88:91]
    v_mfma_f32_16x16x32_bf16 a[68:71], v[212:215], v[96:99], a[68:71]
    ds_read_b64_tr_b16 v[208:209], v216 offset:30720
    ds_read_b64_tr_b16 v[210:211], v216 offset:35840
    v_mfma_f32_16x16x32_bf16 a[76:79], v[212:215], v[100:103], a[76:79]
    v_mfma_f32_16x16x32_bf16 a[84:87], v[212:215], v[104:107], a[84:87]
    v_mfma_f32_16x16x32_bf16 a[92:95], v[212:215], v[108:111], a[92:95]
    s_waitcnt lgkmcnt(6)
    v_mfma_f32_16x16x32_bf16 a[96:99], v[192:195], v[96:99], a[96:99]
    ds_read_b64_tr_b16 v[212:213], v217 offset:30720
    ds_read_b64_tr_b16 v[214:215], v217 offset:35840
    buffer_load_dwordx4 v[92:95], v231, s[44:47], s38 offen sc1
    s_add_u32 s38, s38, 1024
    v_mfma_f32_16x16x32_bf16 a[104:107], v[192:195], v[100:103], a[104:107]
    v_mfma_f32_16x16x32_bf16 a[112:115], v[192:195], v[104:107], a[112:115]
    v_mfma_f32_16x16x32_bf16 a[120:123], v[192:195], v[108:111], a[120:123]
    v_mfma_f32_16x16x32_bf16 a[100:103], v[196:199], v[96:99], a[100:103]
    ds_read_b64_tr_b16 v[192:193], v216 offset:30784
    ds_read_b64_tr_b16 v[194:195], v216 offset:35904
    v_mfma_f32_16x16x32_bf16 a[108:111], v[196:199], v[100:103], a[108:111]
    buffer_load_dword v238, v236, s[52:55], s56 offen sc1
    s_add_u32 s56, s56, 4096
    v_mfma_f32_16x16x32_bf16 a[116:119], v[196:199], v[104:107], a[116:119]
    v_mfma_f32_16x16x32_bf16 a[124:127], v[196:199], v[108:111], a[124:127]
    s_waitcnt lgkmcnt(6)
    v_mfma_f32_16x16x32_bf16 a[128:131], v[200:203], v[96:99], a[128:131]
    ds_read_b64_tr_b16 v[196:197], v217 offset:30784
    ds_read_b64_tr_b16 v[198:199], v217 offset:35904
    v_mfma_f32_16x16x32_bf16 a[136:139], v[200:203], v[100:103], a[136:139]
    v_mfma_f32_16x16x32_bf16 a[144:147], v[200:203], v[104:107], a[144:147]
    v_mfma_f32_16x16x32_bf16 a[152:155], v[200:203], v[108:111], a[152:155]
    v_mfma_f32_16x16x32_bf16 a[132:135], v[204:207], v[96:99], a[132:135]
    ds_read_b64_tr_b16 v[200:201], v216 offset:30848
    ds_read_b64_tr_b16 v[202:203], v216 offset:35968
    v_mfma_f32_16x16x32_bf16 a[140:143], v[204:207], v[100:103], a[140:143]
    v_mfma_f32_16x16x32_bf16 a[148:151], v[204:207], v[104:107], a[148:151]
    v_mfma_f32_16x16x32_bf16 a[156:159], v[204:207], v[108:111], a[156:159]
    s_waitcnt lgkmcnt(6)
    v_mfma_f32_16x16x32_bf16 a[0:3], v[208:211], v[112:115], a[0:3]
    ds_read_b64_tr_b16 v[204:205], v217 offset:30848
    ds_read_b64_tr_b16 v[206:207], v217 offset:35968
    buffer_load_dwordx4 v[96:99], v228, s[44:47], s38 offen sc1
    v_mfma_f32_16x16x32_bf16 a[8:11], v[208:211], v[116:119], a[8:11]
    v_mfma_f32_16x16x32_bf16 a[16:19], v[208:211], v[120:123], a[16:19]
    v_mfma_f32_16x16x32_bf16 a[24:27], v[208:211], v[124:127], a[24:27]
    v_mfma_f32_16x16x32_bf16 a[4:7], v[212:215], v[112:115], a[4:7]
    ds_read_b64_tr_b16 v[208:209], v216 offset:30912
    ds_read_b64_tr_b16 v[210:211], v216 offset:36032
    v_mfma_f32_16x16x32_bf16 a[12:15], v[212:215], v[116:119], a[12:15]
    v_mfma_f32_16x16x32_bf16 a[20:23], v[212:215], v[120:123], a[20:23]
    v_mfma_f32_16x16x32_bf16 a[28:31], v[212:215], v[124:127], a[28:31]
    s_waitcnt lgkmcnt(6)
    v_mfma_f32_16x16x32_bf16 a[32:35], v[192:195], v[112:115], a[32:35]
    ds_read_b64_tr_b16 v[212:213], v217 offset:30912
    ds_read_b64_tr_b16 v[214:215], v217 offset:36032
    buffer_load_dwordx4 v[100:103], v229, s[44:47], s38 offen sc1
    v_mfma_f32_16x16x32_bf16 a[40:43], v[192:195], v[116:119], a[40:43]
    v_mfma_f32_16x16x32_bf16 a[48:51], v[192:195], v[120:123], a[48:51]
    v_mfma_f32_16x16x32_bf16 a[56:59], v[192:195], v[124:127], a[56:59]
    v_mfma_f32_16x16x32_bf16 a[36:39], v[196:199], v[112:115], a[36:39]
    ds_read_b64_tr_b16 v[192:193], v216 offset:30976
    ds_read_b64_tr_b16 v[194:195], v216 offset:36096
    v_mfma_f32_16x16x32_bf16 a[44:47], v[196:199], v[116:119], a[44:47]
    v_mfma_f32_16x16x32_bf16 a[52:55], v[196:199], v[120:123], a[52:55]
    v_mfma_f32_16x16x32_bf16 a[60:63], v[196:199], v[124:127], a[60:63]
    s_waitcnt lgkmcnt(6)
    v_mfma_f32_16x16x32_bf16 a[64:67], v[200:203], v[112:115], a[64:67]
    ds_read_b64_tr_b16 v[196:197], v217 offset:30976
    ds_read_b64_tr_b16 v[198:199], v217 offset:36096
    buffer_load_dwordx4 v[104:107], v230, s[44:47], s38 offen sc1
    v_mfma_f32_16x16x32_bf16 a[72:75], v[200:203], v[116:119], a[72:75]
    v_mfma_f32_16x16x32_bf16 a[80:83], v[200:203], v[120:123], a[80:83]
    v_mfma_f32_16x16x32_bf16 a[88:91], v[200:203], v[124:127], a[88:91]
    v_mfma_f32_16x16x32_bf16 a[68:71], v[204:207], v[112:115], a[68:71]
    v_add_u32 v216, 0xa000, v216
    v_add_u32 v217, 0xa000, v217
    ds_read_b64_tr_b16 v[200:201], v216 offset:0
    ds_read_b64_tr_b16 v[202:203], v216 offset:5120
    v_mfma_f32_16x16x32_bf16 a[76:79], v[204:207], v[116:119], a[76:79]
    v_mfma_f32_16x16x32_bf16 a[84:87], v[204:207], v[120:123], a[84:87]
    v_mfma_f32_16x16x32_bf16 a[92:95], v[204:207], v[124:127], a[92:95]
    s_waitcnt lgkmcnt(6)
    v_mfma_f32_16x16x32_bf16 a[96:99], v[208:211], v[112:115], a[96:99]
    ds_read_b64_tr_b16 v[204:205], v217 offset:0
    ds_read_b64_tr_b16 v[206:207], v217 offset:5120
    buffer_load_dwordx4 v[108:111], v231, s[44:47], s38 offen sc1
    s_add_u32 s38, s38, 1024
    v_mfma_f32_16x16x32_bf16 a[104:107], v[208:211], v[116:119], a[104:107]
    v_mfma_f32_16x16x32_bf16 a[112:115], v[208:211], v[120:123], a[112:115]
    v_mfma_f32_16x16x32_bf16 a[120:123], v[208:211], v[124:127], a[120:123]
    v_mfma_f32_16x16x32_bf16 a[100:103], v[212:215], v[112:115], a[100:103]
    ds_read_b64_tr_b16 v[208:209], v216 offset:64
    ds_read_b64_tr_b16 v[210:211], v216 offset:5184
    v_mfma_f32_16x16x32_bf16 a[108:111], v[212:215], v[116:119], a[108:111]
    v_mfma_f32_16x16x32_bf16 a[116:119], v[212:215], v[120:123], a[116:119]
    v_mfma_f32_16x16x32_bf16 a[124:127], v[212:215], v[124:127], a[124:127]
    s_waitcnt lgkmcnt(6)
    v_mfma_f32_16x16x32_bf16 a[128:131], v[192:195], v[112:115], a[128:131]
    ds_read_b64_tr_b16 v[212:213], v217 offset:64
    ds_read_b64_tr_b16 v[214:215], v217 offset:5184
    v_mfma_f32_16x16x32_bf16 a[136:139], v[192:195], v[116:119], a[136:139]
    v_mfma_f32_16x16x32_bf16 a[144:147], v[192:195], v[120:123], a[144:147]
    v_mfma_f32_16x16x32_bf16 a[152:155], v[192:195], v[124:127], a[152:155]
    v_mfma_f32_16x16x32_bf16 a[132:135], v[196:199], v[112:115], a[132:135]
    ds_read_b64_tr_b16 v[192:193], v216 offset:128
    ds_read_b64_tr_b16 v[194:195], v216 offset:5248
    v_mfma_f32_16x16x32_bf16 a[140:143], v[196:199], v[116:119], a[140:143]
    v_mfma_f32_16x16x32_bf16 a[148:151], v[196:199], v[120:123], a[148:151]
    v_mfma_f32_16x16x32_bf16 a[156:159], v[196:199], v[124:127], a[156:159]
    s_waitcnt vmcnt(40)
    s_waitcnt lgkmcnt(6)
    v_mfma_f32_16x16x32_bf16 a[0:3], v[200:203], v[128:131], a[0:3]
    ds_read_b64_tr_b16 v[196:197], v217 offset:128
    ds_read_b64_tr_b16 v[198:199], v217 offset:5248
    buffer_load_dwordx4 v[112:115], v228, s[44:47], s38 offen sc1
    v_mfma_f32_16x16x32_bf16 a[8:11], v[200:203], v[132:135], a[8:11]
    v_mfma_f32_16x16x32_bf16 a[16:19], v[200:203], v[136:139], a[16:19]
    v_mfma_f32_16x16x32_bf16 a[24:27], v[200:203], v[140:143], a[24:27]
    v_mfma_f32_16x16x32_bf16 a[4:7], v[204:207], v[128:131], a[4:7]
    ds_read_b64_tr_b16 v[200:201], v216 offset:192
    ds_read_b64_tr_b16 v[202:203], v216 offset:5312
    v_mfma_f32_16x16x32_bf16 a[12:15], v[204:207], v[132:135], a[12:15]
    v_mfma_f32_16x16x32_bf16 a[20:23], v[204:207], v[136:139], a[20:23]
    v_mfma_f32_16x16x32_bf16 a[28:31], v[204:207], v[140:143], a[28:31]
    s_waitcnt lgkmcnt(6)
    v_mfma_f32_16x16x32_bf16 a[32:35], v[208:211], v[128:131], a[32:35]
    ds_read_b64_tr_b16 v[204:205], v217 offset:192
    ds_read_b64_tr_b16 v[206:207], v217 offset:5312
    buffer_load_dwordx4 v[116:119], v229, s[44:47], s38 offen sc1
    v_mfma_f32_16x16x32_bf16 a[40:43], v[208:211], v[132:135], a[40:43]
    v_mfma_f32_16x16x32_bf16 a[48:51], v[208:211], v[136:139], a[48:51]
    v_mfma_f32_16x16x32_bf16 a[56:59], v[208:211], v[140:143], a[56:59]
    v_mfma_f32_16x16x32_bf16 a[36:39], v[212:215], v[128:131], a[36:39]
    ds_read_b64_tr_b16 v[208:209], v216 offset:256
    ds_read_b64_tr_b16 v[210:211], v216 offset:5376
    v_mfma_f32_16x16x32_bf16 a[44:47], v[212:215], v[132:135], a[44:47]
    v_mfma_f32_16x16x32_bf16 a[52:55], v[212:215], v[136:139], a[52:55]
    v_mfma_f32_16x16x32_bf16 a[60:63], v[212:215], v[140:143], a[60:63]
    s_waitcnt lgkmcnt(6)
    v_mfma_f32_16x16x32_bf16 a[64:67], v[192:195], v[128:131], a[64:67]
    ds_read_b64_tr_b16 v[212:213], v217 offset:256
    ds_read_b64_tr_b16 v[214:215], v217 offset:5376
    buffer_load_dwordx4 v[120:123], v230, s[44:47], s38 offen sc1
    v_mfma_f32_16x16x32_bf16 a[72:75], v[192:195], v[132:135], a[72:75]
    v_mfma_f32_16x16x32_bf16 a[80:83], v[192:195], v[136:139], a[80:83]
    v_mfma_f32_16x16x32_bf16 a[88:91], v[192:195], v[140:143], a[88:91]
    s_waitcnt vmcnt(10)
    s_barrier
    v_mfma_f32_16x16x32_bf16 a[68:71], v[196:199], v[128:131], a[68:71]
    ds_read_b64_tr_b16 v[192:193], v216 offset:10240
    ds_read_b64_tr_b16 v[194:195], v216 offset:15360
    v_mfma_f32_16x16x32_bf16 a[76:79], v[196:199], v[132:135], a[76:79]
    s_add_u32 m0, s34, 40960
    s_nop 0
    buffer_load_dwordx4 v218, s[40:43], s37 offen offset:0  lds
    v_mfma_f32_16x16x32_bf16 a[84:87], v[196:199], v[136:139], a[84:87]
    v_mfma_f32_16x16x32_bf16 a[92:95], v[196:199], v[140:143], a[92:95]
    s_waitcnt lgkmcnt(6)
    v_mfma_f32_16x16x32_bf16 a[96:99], v[200:203], v[128:131], a[96:99]
    ds_read_b64_tr_b16 v[196:197], v217 offset:10240
    ds_read_b64_tr_b16 v[198:199], v217 offset:15360
    buffer_load_dwordx4 v[124:127], v231, s[44:47], s38 offen sc1
    s_add_u32 s38, s38, 1024
    v_mfma_f32_16x16x32_bf16 a[104:107], v[200:203], v[132:135], a[104:107]
    v_mfma_f32_16x16x32_bf16 a[112:115], v[200:203], v[136:139], a[112:115]
    v_mfma_f32_16x16x32_bf16 a[120:123], v[200:203], v[140:143], a[120:123]
    v_mfma_f32_16x16x32_bf16 a[100:103], v[204:207], v[128:131], a[100:103]
    ds_read_b64_tr_b16 v[200:201], v216 offset:10304
    ds_read_b64_tr_b16 v[202:203], v216 offset:15424
    buffer_load_dwordx4 v219, s[40:43], s37 offen offset:1024  lds
    v_mfma_f32_16x16x32_bf16 a[108:111], v[204:207], v[132:135], a[108:111]
    v_mfma_f32_16x16x32_bf16 a[116:119], v[204:207], v[136:139], a[116:119]
    v_mfma_f32_16x16x32_bf16 a[124:127], v[204:207], v[140:143], a[124:127]
    s_waitcnt lgkmcnt(6)
    v_mfma_f32_16x16x32_bf16 a[128:131], v[208:211], v[128:131], a[128:131]
    ds_read_b64_tr_b16 v[204:205], v217 offset:10304
    ds_read_b64_tr_b16 v[206:207], v217 offset:15424
    v_mfma_f32_16x16x32_bf16 a[136:139], v[208:211], v[132:135], a[136:139]
    v_mfma_f32_16x16x32_bf16 a[144:147], v[208:211], v[136:139], a[144:147]
    v_mfma_f32_16x16x32_bf16 a[152:155], v[208:211], v[140:143], a[152:155]
    v_mfma_f32_16x16x32_bf16 a[132:135], v[212:215], v[128:131], a[132:135]
    ds_read_b64_tr_b16 v[208:209], v216 offset:10368
    ds_read_b64_tr_b16 v[210:211], v216 offset:15488
    buffer_load_dwordx4 v220, s[40:43], s37 offen offset:2048  lds
    v_mfma_f32_16x16x32_bf16 a[140:143], v[212:215], v[132:135], a[140:143]
    v_mfma_f32_16x16x32_bf16 a[148:151], v[212:215], v[136:139], a[148:151]
    v_mfma_f32_16x16x32_bf16 a[156:159], v[212:215], v[140:143], a[156:159]
    s_waitcnt lgkmcnt(6)
    v_mfma_f32_16x16x32_bf16 a[0:3], v[192:195], v[144:147], a[0:3]
    ds_read_b64_tr_b16 v[212:213], v217 offset:10368
    ds_read_b64_tr_b16 v[214:215], v217 offset:15488
    buffer_load_dwordx4 v[128:131], v228, s[44:47], s38 offen sc1
    v_mfma_f32_16x16x32_bf16 a[8:11], v[192:195], v[148:151], a[8:11]
    v_mfma_f32_16x16x32_bf16 a[16:19], v[192:195], v[152:155], a[16:19]
    v_mfma_f32_16x16x32_bf16 a[24:27], v[192:195], v[156:159], a[24:27]
    v_mfma_f32_16x16x32_bf16 a[4:7], v[196:199], v[144:147], a[4:7]
    ds_read_b64_tr_b16 v[192:193], v216 offset:10432
    ds_read_b64_tr_b16 v[194:195], v216 offset:15552
    buffer_load_dwordx4 v221, s[40:43], s37 offen offset:3072  lds
    v_mfma_f32_16x16x32_bf16 a[12:15], v[196:199], v[148:151], a[12:15]
    v_mfma_f32_16x16x32_bf16 a[20:23], v[196:199], v[152:155], a[20:23]
    v_mfma_f32_16x16x32_bf16 a[28:31], v[196:199], v[156:159], a[28:31]
    s_waitcnt lgkmcnt(6)
    v_mfma_f32_16x16x32_bf16 a[32:35], v[200:203], v[144:147], a[32:35]
    ds_read_b64_tr_b16 v[196:197], v217 offset:10432
    ds_read_b64_tr_b16 v[198:199], v217 offset:15552
    buffer_load_dwordx4 v[132:135], v229, s[44:47], s38 offen sc1
    v_mfma_f32_16x16x32_bf16 a[40:43], v[200:203], v[148:151], a[40:43]
    v_mfma_f32_16x16x32_bf16 a[48:51], v[200:203], v[152:155], a[48:51]
    v_mfma_f32_16x16x32_bf16 a[56:59], v[200:203], v[156:159], a[56:59]
    v_mfma_f32_16x16x32_bf16 a[36:39], v[204:207], v[144:147], a[36:39]
    ds_read_b64_tr_b16 v[200:201], v216 offset:10496
    ds_read_b64_tr_b16 v[202:203], v216 offset:15616
    v_mfma_f32_16x16x32_bf16 a[44:47], v[204:207], v[148:151], a[44:47]
    s_add_u32 m0, s34, 45056
    s_nop 0
    buffer_load_dwordx4 v222, s[40:43], s37 offen offset:0  lds
    v_mfma_f32_16x16x32_bf16 a[52:55], v[204:207], v[152:155], a[52:55]
    v_mfma_f32_16x16x32_bf16 a[60:63], v[204:207], v[156:159], a[60:63]
    s_waitcnt lgkmcnt(6)
    v_mfma_f32_16x16x32_bf16 a[64:67], v[208:211], v[144:147], a[64:67]
    ds_read_b64_tr_b16 v[204:205], v217 offset:10496
    ds_read_b64_tr_b16 v[206:207], v217 offset:15616
    buffer_load_dwordx4 v[136:139], v230, s[44:47], s38 offen sc1
    v_mfma_f32_16x16x32_bf16 a[72:75], v[208:211], v[148:151], a[72:75]
    v_mfma_f32_16x16x32_bf16 a[80:83], v[208:211], v[152:155], a[80:83]
    v_mfma_f32_16x16x32_bf16 a[88:91], v[208:211], v[156:159], a[88:91]
    v_mfma_f32_16x16x32_bf16 a[68:71], v[212:215], v[144:147], a[68:71]
    ds_read_b64_tr_b16 v[208:209], v216 offset:20480
    ds_read_b64_tr_b16 v[210:211], v216 offset:25600
    buffer_load_dwordx4 v223, s[40:43], s37 offen offset:1024  lds
    v_mfma_f32_16x16x32_bf16 a[76:79], v[212:215], v[148:151], a[76:79]
    v_mfma_f32_16x16x32_bf16 a[84:87], v[212:215], v[152:155], a[84:87]
    v_mfma_f32_16x16x32_bf16 a[92:95], v[212:215], v[156:159], a[92:95]
    s_waitcnt lgkmcnt(6)
    v_mfma_f32_16x16x32_bf16 a[96:99], v[192:195], v[144:147], a[96:99]
    ds_read_b64_tr_b16 v[212:213], v217 offset:20480
    ds_read_b64_tr_b16 v[214:215], v217 offset:25600
    buffer_load_dwordx4 v[140:143], v231, s[44:47], s38 offen sc1
    s_add_u32 s38, s38, 1024
    v_mfma_f32_16x16x32_bf16 a[104:107], v[192:195], v[148:151], a[104:107]
    v_mfma_f32_16x16x32_bf16 a[112:115], v[192:195], v[152:155], a[112:115]
    v_mfma_f32_16x16x32_bf16 a[120:123], v[192:195], v[156:159], a[120:123]
    v_mfma_f32_16x16x32_bf16 a[100:103], v[196:199], v[144:147], a[100:103]
    ds_read_b64_tr_b16 v[192:193], v216 offset:20544
    ds_read_b64_tr_b16 v[194:195], v216 offset:25664
    buffer_load_dwordx4 v224, s[40:43], s37 offen offset:2048  lds
    v_mfma_f32_16x16x32_bf16 a[108:111], v[196:199], v[148:151], a[108:111]
    v_mfma_f32_16x16x32_bf16 a[116:119], v[196:199], v[152:155], a[116:119]
    v_mfma_f32_16x16x32_bf16 a[124:127], v[196:199], v[156:159], a[124:127]
    s_waitcnt lgkmcnt(6)
    v_mfma_f32_16x16x32_bf16 a[128:131], v[200:203], v[144:147], a[128:131]
    ds_read_b64_tr_b16 v[196:197], v217 offset:20544
    ds_read_b64_tr_b16 v[198:199], v217 offset:25664
    v_mfma_f32_16x16x32_bf16 a[136:139], v[200:203], v[148:151], a[136:139]
    v_mfma_f32_16x16x32_bf16 a[144:147], v[200:203], v[152:155], a[144:147]
    v_mfma_f32_16x16x32_bf16 a[152:155], v[200:203], v[156:159], a[152:155]
    v_mfma_f32_16x16x32_bf16 a[132:135], v[204:207], v[144:147], a[132:135]
    ds_read_b64_tr_b16 v[200:201], v216 offset:20608
    ds_read_b64_tr_b16 v[202:203], v216 offset:25728
    buffer_load_dwordx4 v225, s[40:43], s37 offen offset:3072  lds
    v_mfma_f32_16x16x32_bf16 a[140:143], v[204:207], v[148:151], a[140:143]
    v_mfma_f32_16x16x32_bf16 a[148:151], v[204:207], v[152:155], a[148:151]
    v_mfma_f32_16x16x32_bf16 a[156:159], v[204:207], v[156:159], a[156:159]
    s_waitcnt lgkmcnt(6)
    v_mfma_f32_16x16x32_bf16 a[0:3], v[208:211], v[160:163], a[0:3]
    ds_read_b64_tr_b16 v[204:205], v217 offset:20608
    ds_read_b64_tr_b16 v[206:207], v217 offset:25728
    buffer_load_dwordx4 v[144:147], v228, s[44:47], s38 offen sc1
    v_mfma_f32_16x16x32_bf16 a[8:11], v[208:211], v[164:167], a[8:11]
    v_mfma_f32_16x16x32_bf16 a[16:19], v[208:211], v[168:171], a[16:19]
    v_mfma_f32_16x16x32_bf16 a[24:27], v[208:211], v[172:175], a[24:27]
    v_mfma_f32_16x16x32_bf16 a[4:7], v[212:215], v[160:163], a[4:7]
    ds_read_b64_tr_b16 v[208:209], v216 offset:20672
    ds_read_b64_tr_b16 v[210:211], v216 offset:25792
    v_mfma_f32_16x16x32_bf16 a[12:15], v[212:215], v[164:167], a[12:15]
    s_add_u32 m0, s34, 49152
    s_nop 0
    buffer_load_dwordx4 v226, s[40:43], s37 offen offset:0  lds
    v_mfma_f32_16x16x32_bf16 a[20:23], v[212:215], v[168:171], a[20:23]
    v_mfma_f32_16x16x32_bf16 a[28:31], v[212:215], v[172:175], a[28:31]
    s_waitcnt lgkmcnt(6)
    v_mfma_f32_16x16x32_bf16 a[32:35], v[192:195], v[160:163], a[32:35]
    ds_read_b64_tr_b16 v[212:213], v217 offset:20672
    ds_read_b64_tr_b16 v[214:215], v217 offset:25792
    buffer_load_dwordx4 v[148:151], v229, s[44:47], s38 offen sc1
    v_mfma_f32_16x16x32_bf16 a[40:43], v[192:195], v[164:167], a[40:43]
    v_mfma_f32_16x16x32_bf16 a[48:51], v[192:195], v[168:171], a[48:51]
    v_mfma_f32_16x16x32_bf16 a[56:59], v[192:195], v[172:175], a[56:59]
    v_mfma_f32_16x16x32_bf16 a[36:39], v[196:199], v[160:163], a[36:39]
    ds_read_b64_tr_b16 v[192:193], v216 offset:20736
    ds_read_b64_tr_b16 v[194:195], v216 offset:25856
    buffer_load_dwordx4 v227, s[40:43], s37 offen offset:1024  lds
    s_add_u32 s37, s37, 163840
    v_mfma_f32_16x16x32_bf16 a[44:47], v[196:199], v[164:167], a[44:47]
    v_mfma_f32_16x16x32_bf16 a[52:55], v[196:199], v[168:171], a[52:55]
    v_mfma_f32_16x16x32_bf16 a[60:63], v[196:199], v[172:175], a[60:63]
    s_waitcnt lgkmcnt(6)
    v_mfma_f32_16x16x32_bf16 a[64:67], v[200:203], v[160:163], a[64:67]
    ds_read_b64_tr_b16 v[196:197], v217 offset:20736
    ds_read_b64_tr_b16 v[198:199], v217 offset:25856
    buffer_load_dwordx4 v[152:155], v230, s[44:47], s38 offen sc1
    v_mfma_f32_16x16x32_bf16 a[72:75], v[200:203], v[164:167], a[72:75]
    v_mfma_f32_16x16x32_bf16 a[80:83], v[200:203], v[168:171], a[80:83]
    v_mfma_f32_16x16x32_bf16 a[88:91], v[200:203], v[172:175], a[88:91]
    v_mfma_f32_16x16x32_bf16 a[68:71], v[204:207], v[160:163], a[68:71]
    ds_read_b64_tr_b16 v[200:201], v216 offset:30720
    ds_read_b64_tr_b16 v[202:203], v216 offset:35840
    v_mfma_f32_16x16x32_bf16 a[76:79], v[204:207], v[164:167], a[76:79]
    v_mfma_f32_16x16x32_bf16 a[84:87], v[204:207], v[168:171], a[84:87]
    v_mfma_f32_16x16x32_bf16 a[92:95], v[204:207], v[172:175], a[92:95]
    s_waitcnt lgkmcnt(6)
    v_mfma_f32_16x16x32_bf16 a[96:99], v[208:211], v[160:163], a[96:99]
    ds_read_b64_tr_b16 v[204:205], v217 offset:30720
    ds_read_b64_tr_b16 v[206:207], v217 offset:35840
    buffer_load_dwordx4 v[156:159], v231, s[44:47], s38 offen sc1
    s_add_u32 s38, s38, 1024
    v_mfma_f32_16x16x32_bf16 a[104:107], v[208:211], v[164:167], a[104:107]
    v_mfma_f32_16x16x32_bf16 a[112:115], v[208:211], v[168:171], a[112:115]
    v_mfma_f32_16x16x32_bf16 a[120:123], v[208:211], v[172:175], a[120:123]
    v_mfma_f32_16x16x32_bf16 a[100:103], v[212:215], v[160:163], a[100:103]
    ds_read_b64_tr_b16 v[208:209], v216 offset:30784
    ds_read_b64_tr_b16 v[210:211], v216 offset:35904
    v_mfma_f32_16x16x32_bf16 a[108:111], v[212:215], v[164:167], a[108:111]
    buffer_load_dword v238, v236, s[52:55], s56 offen sc1
    s_add_u32 s56, s56, 4096
    v_mfma_f32_16x16x32_bf16 a[116:119], v[212:215], v[168:171], a[116:119]
    v_mfma_f32_16x16x32_bf16 a[124:127], v[212:215], v[172:175], a[124:127]
    s_waitcnt lgkmcnt(6)
    v_mfma_f32_16x16x32_bf16 a[128:131], v[192:195], v[160:163], a[128:131]
    ds_read_b64_tr_b16 v[212:213], v217 offset:30784
    ds_read_b64_tr_b16 v[214:215], v217 offset:35904
    v_mfma_f32_16x16x32_bf16 a[136:139], v[192:195], v[164:167], a[136:139]
    v_mfma_f32_16x16x32_bf16 a[144:147], v[192:195], v[168:171], a[144:147]
    v_mfma_f32_16x16x32_bf16 a[152:155], v[192:195], v[172:175], a[152:155]
    v_mfma_f32_16x16x32_bf16 a[132:135], v[196:199], v[160:163], a[132:135]
    ds_read_b64_tr_b16 v[192:193], v216 offset:30848
    ds_read_b64_tr_b16 v[194:195], v216 offset:35968
    v_mfma_f32_16x16x32_bf16 a[140:143], v[196:199], v[164:167], a[140:143]
    v_mfma_f32_16x16x32_bf16 a[148:151], v[196:199], v[168:171], a[148:151]
    v_mfma_f32_16x16x32_bf16 a[156:159], v[196:199], v[172:175], a[156:159]
    s_waitcnt lgkmcnt(6)
    v_mfma_f32_16x16x32_bf16 a[0:3], v[200:203], v[176:179], a[0:3]
    ds_read_b64_tr_b16 v[196:197], v217 offset:30848
    ds_read_b64_tr_b16 v[198:199], v217 offset:35968
    buffer_load_dwordx4 v[160:163], v228, s[44:47], s38 offen sc1
    v_mfma_f32_16x16x32_bf16 a[8:11], v[200:203], v[180:183], a[8:11]
    v_mfma_f32_16x16x32_bf16 a[16:19], v[200:203], v[184:187], a[16:19]
    v_mfma_f32_16x16x32_bf16 a[24:27], v[200:203], v[188:191], a[24:27]
    v_mfma_f32_16x16x32_bf16 a[4:7], v[204:207], v[176:179], a[4:7]
    ds_read_b64_tr_b16 v[200:201], v216 offset:30912
    ds_read_b64_tr_b16 v[202:203], v216 offset:36032
    v_mfma_f32_16x16x32_bf16 a[12:15], v[204:207], v[180:183], a[12:15]
    v_mfma_f32_16x16x32_bf16 a[20:23], v[204:207], v[184:187], a[20:23]
    v_mfma_f32_16x16x32_bf16 a[28:31], v[204:207], v[188:191], a[28:31]
    s_waitcnt lgkmcnt(6)
    v_mfma_f32_16x16x32_bf16 a[32:35], v[208:211], v[176:179], a[32:35]
    ds_read_b64_tr_b16 v[204:205], v217 offset:30912
    ds_read_b64_tr_b16 v[206:207], v217 offset:36032
    buffer_load_dwordx4 v[164:167], v229, s[44:47], s38 offen sc1
    v_mfma_f32_16x16x32_bf16 a[40:43], v[208:211], v[180:183], a[40:43]
    v_mfma_f32_16x16x32_bf16 a[48:51], v[208:211], v[184:187], a[48:51]
    v_mfma_f32_16x16x32_bf16 a[56:59], v[208:211], v[188:191], a[56:59]
    v_mfma_f32_16x16x32_bf16 a[36:39], v[212:215], v[176:179], a[36:39]
    ds_read_b64_tr_b16 v[208:209], v216 offset:30976
    ds_read_b64_tr_b16 v[210:211], v216 offset:36096
    v_mfma_f32_16x16x32_bf16 a[44:47], v[212:215], v[180:183], a[44:47]
    v_mfma_f32_16x16x32_bf16 a[52:55], v[212:215], v[184:187], a[52:55]
    v_mfma_f32_16x16x32_bf16 a[60:63], v[212:215], v[188:191], a[60:63]
    s_waitcnt lgkmcnt(6)
    v_mfma_f32_16x16x32_bf16 a[64:67], v[192:195], v[176:179], a[64:67]
    ds_read_b64_tr_b16 v[212:213], v217 offset:30976
    ds_read_b64_tr_b16 v[214:215], v217 offset:36096
    buffer_load_dwordx4 v[168:171], v230, s[44:47], s38 offen sc1
    v_mfma_f32_16x16x32_bf16 a[72:75], v[192:195], v[180:183], a[72:75]
    v_mfma_f32_16x16x32_bf16 a[80:83], v[192:195], v[184:187], a[80:83]
    v_mfma_f32_16x16x32_bf16 a[88:91], v[192:195], v[188:191], a[88:91]
    v_mfma_f32_16x16x32_bf16 a[68:71], v[196:199], v[176:179], a[68:71]
    v_add_u32 v216, 0xfffec000, v216
    v_add_u32 v217, 0xfffec000, v217
    ds_read_b64_tr_b16 v[192:193], v216 offset:0
    ds_read_b64_tr_b16 v[194:195], v216 offset:5120
    v_mfma_f32_16x16x32_bf16 a[76:79], v[196:199], v[180:183], a[76:79]
    v_mfma_f32_16x16x32_bf16 a[84:87], v[196:199], v[184:187], a[84:87]
    v_mfma_f32_16x16x32_bf16 a[92:95], v[196:199], v[188:191], a[92:95]
    s_waitcnt lgkmcnt(6)
    v_mfma_f32_16x16x32_bf16 a[96:99], v[200:203], v[176:179], a[96:99]
    ds_read_b64_tr_b16 v[196:197], v217 offset:0
    ds_read_b64_tr_b16 v[198:199], v217 offset:5120
    buffer_load_dwordx4 v[172:175], v231, s[44:47], s38 offen sc1
    s_add_u32 s38, s38, 1024
    v_mfma_f32_16x16x32_bf16 a[104:107], v[200:203], v[180:183], a[104:107]
    v_mfma_f32_16x16x32_bf16 a[112:115], v[200:203], v[184:187], a[112:115]
    v_mfma_f32_16x16x32_bf16 a[120:123], v[200:203], v[188:191], a[120:123]
    v_mfma_f32_16x16x32_bf16 a[100:103], v[204:207], v[176:179], a[100:103]
    ds_read_b64_tr_b16 v[200:201], v216 offset:64
    ds_read_b64_tr_b16 v[202:203], v216 offset:5184
    v_mfma_f32_16x16x32_bf16 a[108:111], v[204:207], v[180:183], a[108:111]
    v_mfma_f32_16x16x32_bf16 a[116:119], v[204:207], v[184:187], a[116:119]
    v_mfma_f32_16x16x32_bf16 a[124:127], v[204:207], v[188:191], a[124:127]
    s_waitcnt lgkmcnt(6)
    v_mfma_f32_16x16x32_bf16 a[128:131], v[208:211], v[176:179], a[128:131]
    ds_read_b64_tr_b16 v[204:205], v217 offset:64
    ds_read_b64_tr_b16 v[206:207], v217 offset:5184
    v_mfma_f32_16x16x32_bf16 a[136:139], v[208:211], v[180:183], a[136:139]
    v_mfma_f32_16x16x32_bf16 a[144:147], v[208:211], v[184:187], a[144:147]
    v_mfma_f32_16x16x32_bf16 a[152:155], v[208:211], v[188:191], a[152:155]
    v_mfma_f32_16x16x32_bf16 a[132:135], v[212:215], v[176:179], a[132:135]
    ds_read_b64_tr_b16 v[208:209], v216 offset:128
    ds_read_b64_tr_b16 v[210:211], v216 offset:5248
    v_mfma_f32_16x16x32_bf16 a[140:143], v[212:215], v[180:183], a[140:143]
    v_mfma_f32_16x16x32_bf16 a[148:151], v[212:215], v[184:187], a[148:151]
    v_mfma_f32_16x16x32_bf16 a[156:159], v[212:215], v[188:191], a[156:159]
    s_mov_b32 s33, 3
Loploop:
    s_waitcnt lgkmcnt(6)
    v_mfma_f32_16x16x32_bf16 a[0:3], v[192:195], v[0:3], a[0:3]
    ds_read_b64_tr_b16 v[212:213], v217 offset:128
    ds_read_b64_tr_b16 v[214:215], v217 offset:5248
    buffer_load_dwordx4 v[176:179], v228, s[44:47], s38 offen sc1
    v_mfma_f32_16x16x32_bf16 a[8:11], v[192:195], v[4:7], a[8:11]
    v_mfma_f32_16x16x32_bf16 a[16:19], v[192:195], v[8:11], a[16:19]
    v_mfma_f32_16x16x32_bf16 a[24:27], v[192:195], v[12:15], a[24:27]
    v_mfma_f32_16x16x32_bf16 a[4:7], v[196:199], v[0:3], a[4:7]
    ds_read_b64_tr_b16 v[192:193], v216 offset:192
    ds_read_b64_tr_b16 v[194:195], v216 offset:5312
    v_mfma_f32_16x16x32_bf16 a[12:15], v[196:199], v[4:7], a[12:15]
    v_mfma_f32_16x16x32_bf16 a[20:23], v[196:199], v[8:11], a[20:23]
    v_mfma_f32_16x16x32_bf16 a[28:31], v[196:199], v[12:15], a[28:31]
    s_waitcnt lgkmcnt(6)
    v_mfma_f32_16x16x32_bf16 a[32:35], v[200:203], v[0:3], a[32:35]
    ds_read_b64_tr_b16 v[196:197], v217 offset:192
    ds_read_b64_tr_b16 v[198:199], v217 offset:5312
    buffer_load_dwordx4 v[180:183], v229, s[44:47], s38 offen sc1
    v_mfma_f32_16x16x32_bf16 a[40:43], v[200:203], v[4:7], a[40:43]
    v_mfma_f32_16x16x32_bf16 a[48:51], v[200:203], v[8:11], a[48:51]
    v_mfma_f32_16x16x32_bf16 a[56:59], v[200:203], v[12:15], a[56:59]
    v_mfma_f32_16x16x32_bf16 a[36:39], v[204:207], v[0:3], a[36:39]
    ds_read_b64_tr_b16 v[200:201], v216 offset:256
    ds_read_b64_tr_b16 v[202:203], v216 offset:5376
    v_mfma_f32_16x16x32_bf16 a[44:47], v[204:207], v[4:7], a[44:47]
    v_mfma_f32_16x16x32_bf16 a[52:55], v[204:207], v[8:11], a[52:55]
    v_mfma_f32_16x16x32_bf16 a[60:63], v[204:207], v[12:15], a[60:63]
    s_waitcnt lgkmcnt(6)
    v_mfma_f32_16x16x32_bf16 a[64:67], v[208:211], v[0:3], a[64:67]
    ds_read_b64_tr_b16 v[204:205], v217 offset:256
    ds_read_b64_tr_b16 v[206:207], v217 offset:5376
    buffer_load_dwordx4 v[184:187], v230, s[44:47], s38 offen sc1
    v_mfma_f32_16x16x32_bf16 a[72:75], v[208:211], v[4:7], a[72:75]
    v_mfma_f32_16x16x32_bf16 a[80:83], v[208:211], v[8:11], a[80:83]
    v_mfma_f32_16x16x32_bf16 a[88:91], v[208:211], v[12:15], a[88:91]
    s_waitcnt vmcnt(10)
    s_barrier
    v_mfma_f32_16x16x32_bf16 a[68:71], v[212:215], v[0:3], a[68:71]
    ds_read_b64_tr_b16 v[208:209], v216 offset:10240
    ds_read_b64_tr_b16 v[210:211], v216 offset:15360
    v_mfma_f32_16x16x32_bf16 a[76:79], v[212:215], v[4:7], a[76:79]
    s_add_u32 m0, s34, 81920
    s_nop 0
    buffer_load_dwordx4 v218, s[40:43], s37 offen offset:0  lds
    v_mfma_f32_16x16x32_bf16 a[84:87], v[212:215], v[8:11], a[84:87]
    v_mfma_f32_16x16x32_bf16 a[92:95], v[212:215], v[12:15], a[92:95]
    s_waitcnt lgkmcnt(6)
    v_mfma_f32_16x16x32_bf16 a[96:99], v[192:195], v[0:3], a[96:99]
    ds_read_b64_tr_b16 v[212:213], v217 offset:10240
    ds_read_b64_tr_b16 v[214:215], v217 offset:15360
    buffer_load_dwordx4 v[188:191], v231, s[44:47], s38 offen sc1
    s_add_u32 s38, s38, 1024
    v_mfma_f32_16x16x32_bf16 a[104:107], v[192:195], v[4:7], a[104:107]
    v_mfma_f32_16x16x32_bf16 a[112:115], v[192:195], v[8:11], a[112:115]
    v_mfma_f32_16x16x32_bf16 a[120:123], v[192:195], v[12:15], a[120:123]
    v_mfma_f32_16x16x32_bf16 a[100:103], v[196:199], v[0:3], a[100:103]
    ds_read_b64_tr_b16 v[192:193], v216 offset:10304
    ds_read_b64_tr_b16 v[194:195], v216 offset:15424
    buffer_load_dwordx4 v219, s[40:43], s37 offen offset:1024  lds
    v_mfma_f32_16x16x32_bf16 a[108:111], v[196:199], v[4:7], a[108:111]
    v_mfma_f32_16x16x32_bf16 a[116:119], v[196:199], v[8:11], a[116:119]
    v_mfma_f32_16x16x32_bf16 a[124:127], v[196:199], v[12:15], a[124:127]
    s_cmp_eq_u32 s33, 1
    s_cselect_b32 s46, 0, s46
    s_waitcnt lgkmcnt(6)
    v_mfma_f32_16x16x32_bf16 a[128:131], v[200:203], v[0:3], a[128:131]
    ds_read_b64_tr_b16 v[196:197], v217 offset:10304
    ds_read_b64_tr_b16 v[198:199], v217 offset:15424
    v_mfma_f32_16x16x32_bf16 a[136:139], v[200:203], v[4:7], a[136:139]
    v_mfma_f32_16x16x32_bf16 a[144:147], v[200:203], v[8:11], a[144:147]
    v_mfma_f32_16x16x32_bf16 a[152:155], v[200:203], v[12:15], a[152:155]
    v_mfma_f32_16x16x32_bf16 a[132:135], v[204:207], v[0:3], a[132:135]
    ds_read_b64_tr_b16 v[200:201], v216 offset:10368
    ds_read_b64_tr_b16 v[202:203], v216 offset:15488
    buffer_load_dwordx4 v220, s[40:43], s37 offen offset:2048  lds
    v_mfma_f32_16x16x32_bf16 a[140:143], v[204:207], v[4:7], a[140:143]
    v_mfma_f32_16x16x32_bf16 a[148:151], v[204:207], v[8:11], a[148:151]
    v_mfma_f32_16x16x32_bf16 a[156:159], v[204:207], v[12:15], a[156:159]
    s_waitcnt lgkmcnt(6)
    v_mfma_f32_16x16x32_bf16 a[0:3], v[208:211], v[16:19], a[0:3]
    ds_read_b64_tr_b16 v[204:205], v217 offset:10368
    ds_read_b64_tr_b16 v[206:207], v217 offset:15488
    buffer_load_dwordx4 v[0:3], v228, s[44:47], s38 offen sc1
    v_mfma_f32_16x16x32_bf16 a[8:11], v[208:211], v[20:23], a[8:11]
    v_mfma_f32_16x16x32_bf16 a[16:19], v[208:211], v[24:27], a[16:19]
    v_mfma_f32_16x16x32_bf16 a[24:27], v[208:211], v[28:31], a[24:27]
    v_mfma_f32_16x16x32_bf16 a[4:7], v[212:215], v[16:19], a[4:7]
    ds_read_b64_tr_b16 v[208:209], v216 offset:10432
    ds_read_b64_tr_b16 v[210:211], v216 offset:15552
    buffer_load_dwordx4 v221, s[40:43], s37 offen offset:3072  lds
    v_mfma_f32_16x16x32_bf16 a[12:15], v[212:215], v[20:23], a[12:15]
    v_mfma_f32_16x16x32_bf16 a[20:23], v[212:215], v[24:27], a[20:23]
    v_mfma_f32_16x16x32_bf16 a[28:31], v[212:215], v[28:31], a[28:31]
    s_waitcnt lgkmcnt(6)
    v_mfma_f32_16x16x32_bf16 a[32:35], v[192:195], v[16:19], a[32:35]
    ds_read_b64_tr_b16 v[212:213], v217 offset:10432
    ds_read_b64_tr_b16 v[214:215], v217 offset:15552
    buffer_load_dwordx4 v[4:7], v229, s[44:47], s38 offen sc1
    v_mfma_f32_16x16x32_bf16 a[40:43], v[192:195], v[20:23], a[40:43]
    v_mfma_f32_16x16x32_bf16 a[48:51], v[192:195], v[24:27], a[48:51]
    v_mfma_f32_16x16x32_bf16 a[56:59], v[192:195], v[28:31], a[56:59]
    v_mfma_f32_16x16x32_bf16 a[36:39], v[196:199], v[16:19], a[36:39]
    ds_read_b64_tr_b16 v[192:193], v216 offset:10496
    ds_read_b64_tr_b16 v[194:195], v216 offset:15616
    v_mfma_f32_16x16x32_bf16 a[44:47], v[196:199], v[20:23], a[44:47]
    s_add_u32 m0, s34, 86016
    s_nop 0
    buffer_load_dwordx4 v222, s[40:43], s37 offen offset:0  lds
    v_mfma_f32_16x16x32_bf16 a[52:55], v[196:199], v[24:27], a[52:55]
    v_mfma_f32_16x16x32_bf16 a[60:63], v[196:199], v[28:31], a[60:63]
    s_waitcnt lgkmcnt(6)
    v_mfma_f32_16x16x32_bf16 a[64:67], v[200:203], v[16:19], a[64:67]
    ds_read_b64_tr_b16 v[196:197], v217 offset:10496
    ds_read_b64_tr_b16 v[198:199], v217 offset:15616
    buffer_load_dwordx4 v[8:11], v230, s[44:47], s38 offen sc1
    v_mfma_f32_16x16x32_bf16 a[72:75], v[200:203], v[20:23], a[72:75]
    v_mfma_f32_16x16x32_bf16 a[80:83], v[200:203], v[24:27], a[80:83]
    v_mfma_f32_16x16x32_bf16 a[88:91], v[200:203], v[28:31], a[88:91]
    v_mfma_f32_16x16x32_bf16 a[68:71], v[204:207], v[16:19], a[68:71]
    ds_read_b64_tr_b16 v[200:201], v216 offset:20480
    ds_read_b64_tr_b16 v[202:203], v216 offset:25600
    buffer_load_dwordx4 v223, s[40:43], s37 offen offset:1024  lds
    v_mfma_f32_16x16x32_bf16 a[76:79], v[204:207], v[20:23], a[76:79]
    v_mfma_f32_16x16x32_bf16 a[84:87], v[204:207], v[24:27], a[84:87]
    v_mfma_f32_16x16x32_bf16 a[92:95], v[204:207], v[28:31], a[92:95]
    s_waitcnt lgkmcnt(6)
    v_mfma_f32_16x16x32_bf16 a[96:99], v[208:211], v[16:19], a[96:99]
    ds_read_b64_tr_b16 v[204:205], v217 offset:20480
    ds_read_b64_tr_b16 v[206:207], v217 offset:25600
    buffer_load_dwordx4 v[12:15], v231, s[44:47], s38 offen sc1
    s_add_u32 s38, s38, 1024
    v_mfma_f32_16x16x32_bf16 a[104:107], v[208:211], v[20:23], a[104:107]
    v_mfma_f32_16x16x32_bf16 a[112:115], v[208:211], v[24:27], a[112:115]
    v_mfma_f32_16x16x32_bf16 a[120:123], v[208:211], v[28:31], a[120:123]
    v_mfma_f32_16x16x32_bf16 a[100:103], v[212:215], v[16:19], a[100:103]
    ds_read_b64_tr_b16 v[208:209], v216 offset:20544
    ds_read_b64_tr_b16 v[210:211], v216 offset:25664
    buffer_load_dwordx4 v224, s[40:43], s37 offen offset:2048  lds
    v_mfma_f32_16x16x32_bf16 a[108:111], v[212:215], v[20:23], a[108:111]
    v_mfma_f32_16x16x32_bf16 a[116:119], v[212:215], v[24:27], a[116:119]
    v_mfma_f32_16x16x32_bf16 a[124:127], v[212:215], v[28:31], a[124:127]
    s_waitcnt lgkmcnt(6)
    v_mfma_f32_16x16x32_bf16 a[128:131], v[192:195], v[16:19], a[128:131]
    ds_read_b64_tr_b16 v[212:213], v217 offset:20544
    ds_read_b64_tr_b16 v[214:215], v217 offset:25664
    v_mfma_f32_16x16x32_bf16 a[136:139], v[192:195], v[20:23], a[136:139]
    v_mfma_f32_16x16x32_bf16 a[144:147], v[192:195], v[24:27], a[144:147]
    v_mfma_f32_16x16x32_bf16 a[152:155], v[192:195], v[28:31], a[152:155]
    v_mfma_f32_16x16x32_bf16 a[132:135], v[196:199], v[16:19], a[132:135]
    ds_read_b64_tr_b16 v[192:193], v216 offset:20608
    ds_read_b64_tr_b16 v[194:195], v216 offset:25728
    buffer_load_dwordx4 v225, s[40:43], s37 offen offset:3072  lds
    v_mfma_f32_16x16x32_bf16 a[140:143], v[196:199], v[20:23], a[140:143]
    v_mfma_f32_16x16x32_bf16 a[148:151], v[196:199], v[24:27], a[148:151]
    v_mfma_f32_16x16x32_bf16 a[156:159], v[196:199], v[28:31], a[156:159]
    s_waitcnt lgkmcnt(6)
    v_mfma_f32_16x16x32_bf16 a[0:3], v[200:203], v[32:35], a[0:3]
    ds_read_b64_tr_b16 v[196:197], v217 offset:20608
    ds_read_b64_tr_b16 v[198:199], v217 offset:25728
    buffer_load_dwordx4 v[16:19], v228, s[44:47], s38 offen sc1
    v_mfma_f32_16x16x32_bf16 a[8:11], v[200:203], v[36:39], a[8:11]
    v_mfma_f32_16x16x32_bf16 a[16:19], v[200:203], v[40:43], a[16:19]
    v_mfma_f32_16x16x32_bf16 a[24:27], v[200:203], v[44:47], a[24:27]
    v_mfma_f32_16x16x32_bf16 a[4:7], v[204:207], v[32:35], a[4:7]
    ds_read_b64_tr_b16 v[200:201], v216 offset:20672
    ds_read_b64_tr_b16 v[202:203], v216 offset:25792
    v_mfma_f32_16x16x32_bf16 a[12:15], v[204:207], v[36:39], a[12:15]
    s_add_u32 m0, s34, 90112
    s_nop 0
    buffer_load_dwordx4 v226, s[40:43], s37 offen offset:0  lds
    v_mfma_f32_16x16x32_bf16 a[20:23], v[204:207], v[40:43], a[20:23]
    v_mfma_f32_16x16x32_bf16 a[28:31], v[204:207], v[44:47], a[28:31]
    s_waitcnt lgkmcnt(6)
    v_mfma_f32_16x16x32_bf16 a[32:35], v[208:211], v[32:35], a[32:35]
    ds_read_b64_tr_b16 v[204:205], v217 offset:20672
    ds_read_b64_tr_b16 v[206:207], v217 offset:25792
    buffer_load_dwordx4 v[20:23], v229, s[44:47], s38 offen sc1
    v_mfma_f32_16x16x32_bf16 a[40:43], v[208:211], v[36:39], a[40:43]
    v_mfma_f32_16x16x32_bf16 a[48:51], v[208:211], v[40:43], a[48:51]
    v_mfma_f32_16x16x32_bf16 a[56:59], v[208:211], v[44:47], a[56:59]
    v_mfma_f32_16x16x32_bf16 a[36:39], v[212:215], v[32:35], a[36:39]
    ds_read_b64_tr_b16 v[208:209], v216 offset:20736
    ds_read_b64_tr_b16 v[210:211], v216 offset:25856
    buffer_load_dwordx4 v227, s[40:43], s37 offen offset:1024  lds
    s_add_u32 s37, s37, 163840
    v_mfma_f32_16x16x32_bf16 a[44:47], v[212:215], v[36:39], a[44:47]
    v_mfma_f32_16x16x32_bf16 a[52:55], v[212:215], v[40:43], a[52:55]
    v_mfma_f32_16x16x32_bf16 a[60:63], v[212:215], v[44:47], a[60:63]
    s_waitcnt lgkmcnt(6)
    v_mfma_f32_16x16x32_bf16 a[64:67], v[192:195], v[32:35], a[64:67]
    ds_read_b64_tr_b16 v[212:213], v217 offset:20736
    ds_read_b64_tr_b16 v[214:215], v217 offset:25856
    buffer_load_dwordx4 v[24:27], v230, s[44:47], s38 offen sc1
    v_mfma_f32_16x16x32_bf16 a[72:75], v[192:195], v[36:39], a[72:75]
    v_mfma_f32_16x16x32_bf16 a[80:83], v[192:195], v[40:43], a[80:83]
    v_mfma_f32_16x16x32_bf16 a[88:91], v[192:195], v[44:47], a[88:91]
    v_mfma_f32_16x16x32_bf16 a[68:71], v[196:199], v[32:35], a[68:71]
    ds_read_b64_tr_b16 v[192:193], v216 offset:30720
    ds_read_b64_tr_b16 v[194:195], v216 offset:35840
    v_mfma_f32_16x16x32_bf16 a[76:79], v[196:199], v[36:39], a[76:79]
    v_mfma_f32_16x16x32_bf16 a[84:87], v[196:199], v[40:43], a[84:87]
    v_mfma_f32_16x16x32_bf16 a[92:95], v[196:199], v[44:47], a[92:95]
    s_waitcnt lgkmcnt(6)
    v_mfma_f32_16x16x32_bf16 a[96:99], v[200:203], v[32:35], a[96:99]
    ds_read_b64_tr_b16 v[196:197], v217 offset:30720
    ds_read_b64_tr_b16 v[198:199], v217 offset:35840
    buffer_load_dwordx4 v[28:31], v231, s[44:47], s38 offen sc1
    s_add_u32 s38, s38, 1024
    v_mfma_f32_16x16x32_bf16 a[104:107], v[200:203], v[36:39], a[104:107]
    v_mfma_f32_16x16x32_bf16 a[112:115], v[200:203], v[40:43], a[112:115]
    v_mfma_f32_16x16x32_bf16 a[120:123], v[200:203], v[44:47], a[120:123]
    v_mfma_f32_16x16x32_bf16 a[100:103], v[204:207], v[32:35], a[100:103]
    ds_read_b64_tr_b16 v[200:201], v216 offset:30784
    ds_read_b64_tr_b16 v[202:203], v216 offset:35904
    v_mfma_f32_16x16x32_bf16 a[108:111], v[204:207], v[36:39], a[108:111]
    buffer_load_dword v238, v236, s[52:55], s56 offen sc1
    s_add_u32 s56, s56, 4096
    v_mfma_f32_16x16x32_bf16 a[116:119], v[204:207], v[40:43], a[116:119]
    v_mfma_f32_16x16x32_bf16 a[124:127], v[204:207], v[44:47], a[124:127]
    s_waitcnt lgkmcnt(6)
    v_mfma_f32_16x16x32_bf16 a[128:131], v[208:211], v[32:35], a[128:131]
    ds_read_b64_tr_b16 v[204:205], v217 offset:30784
    ds_read_b64_tr_b16 v[206:207], v217 offset:35904
    v_mfma_f32_16x16x32_bf16 a[136:139], v[208:211], v[36:39], a[136:139]
    v_mfma_f32_16x16x32_bf16 a[144:147], v[208:211], v[40:43], a[144:147]
    v_mfma_f32_16x16x32_bf16 a[152:155], v[208:211], v[44:47], a[152:155]
    v_mfma_f32_16x16x32_bf16 a[132:135], v[212:215], v[32:35], a[132:135]
    ds_read_b64_tr_b16 v[208:209], v216 offset:30848
    ds_read_b64_tr_b16 v[210:211], v216 offset:35968
    v_mfma_f32_16x16x32_bf16 a[140:143], v[212:215], v[36:39], a[140:143]
    v_mfma_f32_16x16x32_bf16 a[148:151], v[212:215], v[40:43], a[148:151]
    v_mfma_f32_16x16x32_bf16 a[156:159], v[212:215], v[44:47], a[156:159]
    s_waitcnt lgkmcnt(6)
    v_mfma_f32_16x16x32_bf16 a[0:3], v[192:195], v[48:51], a[0:3]
    ds_read_b64_tr_b16 v[212:213], v217 offset:30848
    ds_read_b64_tr_b16 v[214:215], v217 offset:35968
    buffer_load_dwordx4 v[32:35], v228, s[44:47], s38 offen sc1
    v_mfma_f32_16x16x32_bf16 a[8:11], v[192:195], v[52:55], a[8:11]
    v_mfma_f32_16x16x32_bf16 a[16:19], v[192:195], v[56:59], a[16:19]
    v_mfma_f32_16x16x32_bf16 a[24:27], v[192:195], v[60:63], a[24:27]
    v_mfma_f32_16x16x32_bf16 a[4:7], v[196:199], v[48:51], a[4:7]
    ds_read_b64_tr_b16 v[192:193], v216 offset:30912
    ds_read_b64_tr_b16 v[194:195], v216 offset:36032
    v_mfma_f32_16x16x32_bf16 a[12:15], v[196:199], v[52:55], a[12:15]
    v_mfma_f32_16x16x32_bf16 a[20:23], v[196:199], v[56:59], a[20:23]
    v_mfma_f32_16x16x32_bf16 a[28:31], v[196:199], v[60:63], a[28:31]
    s_waitcnt lgkmcnt(6)
    v_mfma_f32_16x16x32_bf16 a[32:35], v[200:203], v[48:51], a[32:35]
    ds_read_b64_tr_b16 v[196:197], v217 offset:30912
    ds_read_b64_tr_b16 v[198:199], v217 offset:36032
    buffer_load_dwordx4 v[36:39], v229, s[44:47], s38 offen sc1
    v_mfma_f32_16x16x32_bf16 a[40:43], v[200:203], v[52:55], a[40:43]
    v_mfma_f32_16x16x32_bf16 a[48:51], v[200:203], v[56:59], a[48:51]
    v_mfma_f32_16x16x32_bf16 a[56:59], v[200:203], v[60:63], a[56:59]
    v_mfma_f32_16x16x32_bf16 a[36:39], v[204:207], v[48:51], a[36:39]
    ds_read_b64_tr_b16 v[200:201], v216 offset:30976
    ds_read_b64_tr_b16 v[202:203], v216 offset:36096
    v_mfma_f32_16x16x32_bf16 a[44:47], v[204:207], v[52:55], a[44:47]
    v_mfma_f32_16x16x32_bf16 a[52:55], v[204:207], v[56:59], a[52:55]
    v_mfma_f32_16x16x32_bf16 a[60:63], v[204:207], v[60:63], a[60:63]
    s_waitcnt lgkmcnt(6)
    v_mfma_f32_16x16x32_bf16 a[64:67], v[208:211], v[48:51], a[64:67]
    ds_read_b64_tr_b16 v[204:205], v217 offset:30976
    ds_read_b64_tr_b16 v[206:207], v217 offset:36096
    buffer_load_dwordx4 v[40:43], v230, s[44:47], s38 offen sc1
    v_mfma_f32_16x16x32_bf16 a[72:75], v[208:211], v[52:55], a[72:75]
    v_mfma_f32_16x16x32_bf16 a[80:83], v[208:211], v[56:59], a[80:83]
    v_mfma_f32_16x16x32_bf16 a[88:91], v[208:211], v[60:63], a[88:91]
    v_mfma_f32_16x16x32_bf16 a[68:71], v[212:215], v[48:51], a[68:71]
    v_add_u32 v216, 0xa000, v216
    v_add_u32 v217, 0xa000, v217
    ds_read_b64_tr_b16 v[208:209], v216 offset:0
    ds_read_b64_tr_b16 v[210:211], v216 offset:5120
    v_mfma_f32_16x16x32_bf16 a[76:79], v[212:215], v[52:55], a[76:79]
    v_mfma_f32_16x16x32_bf16 a[84:87], v[212:215], v[56:59], a[84:87]
    v_mfma_f32_16x16x32_bf16 a[92:95], v[212:215], v[60:63], a[92:95]
    s_waitcnt lgkmcnt(6)
    v_mfma_f32_16x16x32_bf16 a[96:99], v[192:195], v[48:51], a[96:99]
    ds_read_b64_tr_b16 v[212:213], v217 offset:0
    ds_read_b64_tr_b16 v[214:215], v217 offset:5120
    buffer_load_dwordx4 v[44:47], v231, s[44:47], s38 offen sc1
    s_add_u32 s38, s38, 1024
    v_mfma_f32_16x16x32_bf16 a[104:107], v[192:195], v[52:55], a[104:107]
    v_mfma_f32_16x16x32_bf16 a[112:115], v[192:195], v[56:59], a[112:115]
    v_mfma_f32_16x16x32_bf16 a[120:123], v[192:195], v[60:63], a[120:123]
    v_mfma_f32_16x16x32_bf16 a[100:103], v[196:199], v[48:51], a[100:103]
    ds_read_b64_tr_b16 v[192:193], v216 offset:64
    ds_read_b64_tr_b16 v[194:195], v216 offset:5184
    v_mfma_f32_16x16x32_bf16 a[108:111], v[196:199], v[52:55], a[108:111]
    v_mfma_f32_16x16x32_bf16 a[116:119], v[196:199], v[56:59], a[116:119]
    v_mfma_f32_16x16x32_bf16 a[124:127], v[196:199], v[60:63], a[124:127]
    s_waitcnt lgkmcnt(6)
    v_mfma_f32_16x16x32_bf16 a[128:131], v[200:203], v[48:51], a[128:131]
    ds_read_b64_tr_b16 v[196:197], v217 offset:64
    ds_read_b64_tr_b16 v[198:199], v217 offset:5184
    v_mfma_f32_16x16x32_bf16 a[136:139], v[200:203], v[52:55], a[136:139]
    v_mfma_f32_16x16x32_bf16 a[144:147], v[200:203], v[56:59], a[144:147]
    v_mfma_f32_16x16x32_bf16 a[152:155], v[200:203], v[60:63], a[152:155]
    v_mfma_f32_16x16x32_bf16 a[132:135], v[204:207], v[48:51], a[132:135]
    ds_read_b64_tr_b16 v[200:201], v216 offset:128
    ds_read_b64_tr_b16 v[202:203], v216 offset:5248
    v_mfma_f32_16x16x32_bf16 a[140:143], v[204:207], v[52:55], a[140:143]
    v_mfma_f32_16x16x32_bf16 a[148:151], v[204:207], v[56:59], a[148:151]
    v_mfma_f32_16x16x32_bf16 a[156:159], v[204:207], v[60:63], a[156:159]
    s_waitcnt lgkmcnt(6)
    v_mfma_f32_16x16x32_bf16 a[0:3], v[208:211], v[64:67], a[0:3]
    ds_read_b64_tr_b16 v[204:205], v217 offset:128
    ds_read_b64_tr_b16 v[206:207], v217 offset:5248
    buffer_load_dwordx4 v[48:51], v228, s[44:47], s38 offen sc1
    v_mfma_f32_16x16x32_bf16 a[8:11], v[208:211], v[68:71], a[8:11]
    v_mfma_f32_16x16x32_bf16 a[16:19], v[208:211], v[72:75], a[16:19]
    v_mfma_f32_16x16x32_bf16 a[24:27], v[208:211], v[76:79], a[24:27]
    v_mfma_f32_16x16x32_bf16 a[4:7], v[212:215], v[64:67], a[4:7]
    ds_read_b64_tr_b16 v[208:209], v216 offset:192
    ds_read_b64_tr_b16 v[210:211], v216 offset:5312
    v_mfma_f32_16x16x32_bf16 a[12:15], v[212:215], v[68:71], a[12:15]
    v_mfma_f32_16x16x32_bf16 a[20:23], v[212:215], v[72:75], a[20:23]
    v_mfma_f32_16x16x32_bf16 a[28:31], v[212:215], v[76:79], a[28:31]
    s_waitcnt lgkmcnt(6)
    v_mfma_f32_16x16x32_bf16 a[32:35], v[192:195], v[64:67], a[32:35]
    ds_read_b64_tr_b16 v[212:213], v217 offset:192
    ds_read_b64_tr_b16 v[214:215], v217 offset:5312
    buffer_load_dwordx4 v[52:55], v229, s[44:47], s38 offen sc1
    v_mfma_f32_16x16x32_bf16 a[40:43], v[192:195], v[68:71], a[40:43]
    v_mfma_f32_16x16x32_bf16 a[48:51], v[192:195], v[72:75], a[48:51]
    v_mfma_f32_16x16x32_bf16 a[56:59], v[192:195], v[76:79], a[56:59]
    v_mfma_f32_16x16x32_bf16 a[36:39], v[196:199], v[64:67], a[36:39]
    ds_read_b64_tr_b16 v[192:193], v216 offset:256
    ds_read_b64_tr_b16 v[194:195], v216 offset:5376
    v_mfma_f32_16x16x32_bf16 a[44:47], v[196:199], v[68:71], a[44:47]
    v_mfma_f32_16x16x32_bf16 a[52:55], v[196:199], v[72:75], a[52:55]
    v_mfma_f32_16x16x32_bf16 a[60:63], v[196:199], v[76:79], a[60:63]
    s_waitcnt lgkmcnt(6)
    v_mfma_f32_16x16x32_bf16 a[64:67], v[200:203], v[64:67], a[64:67]
    ds_read_b64_tr_b16 v[196:197], v217 offset:256
    ds_read_b64_tr_b16 v[198:199], v217 offset:5376
    buffer_load_dwordx4 v[56:59], v230, s[44:47], s38 offen sc1
    v_mfma_f32_16x16x32_bf16 a[72:75], v[200:203], v[68:71], a[72:75]
    v_mfma_f32_16x16x32_bf16 a[80:83], v[200:203], v[72:75], a[80:83]
    v_mfma_f32_16x16x32_bf16 a[88:91], v[200:203], v[76:79], a[88:91]
    s_waitcnt vmcnt(10)
    s_barrier
    v_mfma_f32_16x16x32_bf16 a[68:71], v[204:207], v[64:67], a[68:71]
    ds_read_b64_tr_b16 v[200:201], v216 offset:10240
    ds_read_b64_tr_b16 v[202:203], v216 offset:15360
    v_mfma_f32_16x16x32_bf16 a[76:79], v[204:207], v[68:71], a[76:79]
    s_add_u32 m0, s34, 0
    s_nop 0
    buffer_load_dwordx4 v218, s[40:43], s37 offen offset:0  lds
    v_mfma_f32_16x16x32_bf16 a[84:87], v[204:207], v[72:75], a[84:87]
    v_mfma_f32_16x16x32_bf16 a[92:95], v[204:207], v[76:79], a[92:95]
    s_waitcnt lgkmcnt(6)
    v_mfma_f32_16x16x32_bf16 a[96:99], v[208:211], v[64:67], a[96:99]
    ds_read_b64_tr_b16 v[204:205], v217 offset:10240
    ds_read_b64_tr_b16 v[206:207], v217 offset:15360
    buffer_load_dwordx4 v[60:63], v231, s[44:47], s38 offen sc1
    s_add_u32 s38, s38, 1024
    v_mfma_f32_16x16x32_bf16 a[104:107], v[208:211], v[68:71], a[104:107]
    v_mfma_f32_16x16x32_bf16 a[112:115], v[208:211], v[72:75], a[112:115]
    v_mfma_f32_16x16x32_bf16 a[120:123], v[208:211], v[76:79], a[120:123]
    v_mfma_f32_16x16x32_bf16 a[100:103], v[212:215], v[64:67], a[100:103]
    ds_read_b64_tr_b16 v[208:209], v216 offset:10304
    ds_read_b64_tr_b16 v[210:211], v216 offset:15424
    buffer_load_dwordx4 v219, s[40:43], s37 offen offset:1024  lds
    v_mfma_f32_16x16x32_bf16 a[108:111], v[212:215], v[68:71], a[108:111]
    v_mfma_f32_16x16x32_bf16 a[116:119], v[212:215], v[72:75], a[116:119]
    v_mfma_f32_16x16x32_bf16 a[124:127], v[212:215], v[76:79], a[124:127]
    s_waitcnt lgkmcnt(6)
    v_mfma_f32_16x16x32_bf16 a[128:131], v[192:195], v[64:67], a[128:131]
    ds_read_b64_tr_b16 v[212:213], v217 offset:10304
    ds_read_b64_tr_b16 v[214:215], v217 offset:15424
    v_mfma_f32_16x16x32_bf16 a[136:139], v[192:195], v[68:71], a[136:139]
    v_mfma_f32_16x16x32_bf16 a[144:147], v[192:195], v[72:75], a[144:147]
    v_mfma_f32_16x16x32_bf16 a[152:155], v[192:195], v[76:79], a[152:155]
    v_mfma_f32_16x16x32_bf16 a[132:135], v[196:199], v[64:67], a[132:135]
    ds_read_b64_tr_b16 v[192:193], v216 offset:10368
    ds_read_b64_tr_b16 v[194:195], v216 offset:15488
    buffer_load_dwordx4 v220, s[40:43], s37 offen offset:2048  lds
    v_mfma_f32_16x16x32_bf16 a[140:143], v[196:199], v[68:71], a[140:143]
    v_mfma_f32_16x16x32_bf16 a[148:151], v[196:199], v[72:75], a[148:151]
    v_mfma_f32_16x16x32_bf16 a[156:159], v[196:199], v[76:79], a[156:159]
    s_waitcnt lgkmcnt(6)
    v_mfma_f32_16x16x32_bf16 a[0:3], v[200:203], v[80:83], a[0:3]
    ds_read_b64_tr_b16 v[196:197], v217 offset:10368
    ds_read_b64_tr_b16 v[198:199], v217 offset:15488
    buffer_load_dwordx4 v[64:67], v228, s[44:47], s38 offen sc1
    v_mfma_f32_16x16x32_bf16 a[8:11], v[200:203], v[84:87], a[8:11]
    v_mfma_f32_16x16x32_bf16 a[16:19], v[200:203], v[88:91], a[16:19]
    v_mfma_f32_16x16x32_bf16 a[24:27], v[200:203], v[92:95], a[24:27]
    v_mfma_f32_16x16x32_bf16 a[4:7], v[204:207], v[80:83], a[4:7]
    ds_read_b64_tr_b16 v[200:201], v216 offset:10432
    ds_read_b64_tr_b16 v[202:203], v216 offset:15552
    buffer_load_dwordx4 v221, s[40:43], s37 offen offset:3072  lds
    v_mfma_f32_16x16x32_bf16 a[12:15], v[204:207], v[84:87], a[12:15]
    v_mfma_f32_16x16x32_bf16 a[20:23], v[204:207], v[88:91], a[20:23]
    v_mfma_f32_16x16x32_bf16 a[28:31], v[204:207], v[92:95], a[28:31]
    s_waitcnt lgkmcnt(6)
    v_mfma_f32_16x16x32_bf16 a[32:35], v[208:211], v[80:83], a[32:35]
    ds_read_b64_tr_b16 v[204:205], v217 offset:10432
    ds_read_b64_tr_b16 v[206:207], v217 offset:15552
    buffer_load_dwordx4 v[68:71], v229, s[44:47], s38 offen sc1
    v_mfma_f32_16x16x32_bf16 a[40:43], v[208:211], v[84:87], a[40:43]
    v_mfma_f32_16x16x32_bf16 a[48:51], v[208:211], v[88:91], a[48:51]
    v_mfma_f32_16x16x32_bf16 a[56:59], v[208:211], v[92:95], a[56:59]
    v_mfma_f32_16x16x32_bf16 a[36:39], v[212:215], v[80:83], a[36:39]
    ds_read_b64_tr_b16 v[208:209], v216 offset:10496
    ds_read_b64_tr_b16 v[210:211], v216 offset:15616
    v_mfma_f32_16x16x32_bf16 a[44:47], v[212:215], v[84:87], a[44:47]
    s_add_u32 m0, s34, 4096
    s_nop 0
    buffer_load_dwordx4 v222, s[40:43], s37 offen offset:0  lds
    v_mfma_f32_16x16x32_bf16 a[52:55], v[212:215], v[88:91], a[52:55]
    v_mfma_f32_16x16x32_bf16 a[60:63], v[212:215], v[92:95], a[60:63]
    s_waitcnt lgkmcnt(6)
    v_mfma_f32_16x16x32_bf16 a[64:67], v[192:195], v[80:83], a[64:67]
    ds_read_b64_tr_b16 v[212:213], v217 offset:10496
    ds_read_b64_tr_b16 v[214:215], v217 offset:15616
    buffer_load_dwordx4 v[72:75], v230, s[44:47], s38 offen sc1
    v_mfma_f32_16x16x32_bf16 a[72:75], v[192:195], v[84:87], a[72:75]
    v_mfma_f32_16x16x32_bf16 a[80:83], v[192:195], v[88:91], a[80:83]
    v_mfma_f32_16x16x32_bf16 a[88:91], v[192:195], v[92:95], a[88:91]
    v_mfma_f32_16x16x32_bf16 a[68:71], v[196:199], v[80:83], a[68:71]
    ds_read_b64_tr_b16 v[192:193], v216 offset:20480
    ds_read_b64_tr_b16 v[194:195], v216 offset:25600
    buffer_load_dwordx4 v223, s[40:43], s37 offen offset:1024  lds
    v_mfma_f32_16x16x32_bf16 a[76:79], v[196:199], v[84:87], a[76:79]
    v_mfma_f32_16x16x32_bf16 a[84:87], v[196:199], v[88:91], a[84:87]
    v_mfma_f32_16x16x32_bf16 a[92:95], v[196:199], v[92:95], a[92:95]
    s_waitcnt lgkmcnt(6)
    v_mfma_f32_16x16x32_bf16 a[96:99], v[200:203], v[80:83], a[96:99]
    ds_read_b64_tr_b16 v[196:197], v217 offset:20480
    ds_read_b64_tr_b16 v[198:199], v217 offset:25600
    buffer_load_dwordx4 v[76:79], v231, s[44:47], s38 offen sc1
    s_add_u32 s38, s38, 1024
    v_mfma_f32_16x16x32_bf16 a[104:107], v[200:203], v[84:87], a[104:107]
    v_mfma_f32_16x16x32_bf16 a[112:115], v[200:203], v[88:91], a[112:115]
    v_mfma_f32_16x16x32_bf16 a[120:123], v[200:203], v[92:95], a[120:123]
    v_mfma_f32_16x16x32_bf16 a[100:103], v[204:207], v[80:83], a[100:103]
    ds_read_b64_tr_b16 v[200:201], v216 offset:20544
    ds_read_b64_tr_b16 v[202:203], v216 offset:25664
    buffer_load_dwordx4 v224, s[40:43], s37 offen offset:2048  lds
    v_mfma_f32_16x16x32_bf16 a[108:111], v[204:207], v[84:87], a[108:111]
    v_mfma_f32_16x16x32_bf16 a[116:119], v[204:207], v[88:91], a[116:119]
    v_mfma_f32_16x16x32_bf16 a[124:127], v[204:207], v[92:95], a[124:127]
    s_waitcnt lgkmcnt(6)
    v_mfma_f32_16x16x32_bf16 a[128:131], v[208:211], v[80:83], a[128:131]
    ds_read_b64_tr_b16 v[204:205], v217 offset:20544
    ds_read_b64_tr_b16 v[206:207], v217 offset:25664
    v_mfma_f32_16x16x32_bf16 a[136:139], v[208:211], v[84:87], a[136:139]
    v_mfma_f32_16x16x32_bf16 a[144:147], v[208:211], v[88:91], a[144:147]
    v_mfma_f32_16x16x32_bf16 a[152:155], v[208:211], v[92:95], a[152:155]
    v_mfma_f32_16x16x32_bf16 a[132:135], v[212:215], v[80:83], a[132:135]
    ds_read_b64_tr_b16 v[208:209], v216 offset:20608
    ds_read_b64_tr_b16 v[210:211], v216 offset:25728
    buffer_load_dwordx4 v225, s[40:43], s37 offen offset:3072  lds
    v_mfma_f32_16x16x32_bf16 a[140:143], v[212:215], v[84:87], a[140:143]
    v_mfma_f32_16x16x32_bf16 a[148:151], v[212:215], v[88:91], a[148:151]
    v_mfma_f32_16x16x32_bf16 a[156:159], v[212:215], v[92:95], a[156:159]
    s_waitcnt lgkmcnt(6)
    v_mfma_f32_16x16x32_bf16 a[0:3], v[192:195], v[96:99], a[0:3]
    ds_read_b64_tr_b16 v[212:213], v217 offset:20608
    ds_read_b64_tr_b16 v[214:215], v217 offset:25728
    buffer_load_dwordx4 v[80:83], v228, s[44:47], s38 offen sc1
    v_mfma_f32_16x16x32_bf16 a[8:11], v[192:195], v[100:103], a[8:11]
    v_mfma_f32_16x16x32_bf16 a[16:19], v[192:195], v[104:107], a[16:19]
    v_mfma_f32_16x16x32_bf16 a[24:27], v[192:195], v[108:111], a[24:27]
    v_mfma_f32_16x16x32_bf16 a[4:7], v[196:199], v[96:99], a[4:7]
    ds_read_b64_tr_b16 v[192:193], v216 offset:20672
    ds_read_b64_tr_b16 v[194:195], v216 offset:25792
    v_mfma_f32_16x16x32_bf16 a[12:15], v[196:199], v[100:103], a[12:15]
    s_add_u32 m0, s34, 8192
    s_nop 0
    buffer_load_dwordx4 v226, s[40:43], s37 offen offset:0  lds
    v_mfma_f32_16x16x32_bf16 a[20:23], v[196:199], v[104:107], a[20:23]
    v_mfma_f32_16x16x32_bf16 a[28:31], v[196:199], v[108:111], a[28:31]
    s_waitcnt lgkmcnt(6)
    v_mfma_f32_16x16x32_bf16 a[32:35], v[200:203], v[96:99], a[32:35]
    ds_read_b64_tr_b16 v[196:197], v217 offset:20672
    ds_read_b64_tr_b16 v[198:199], v217 offset:25792
    buffer_load_dwordx4 v[84:87], v229, s[44:47], s38 offen sc1
    v_mfma_f32_16x16x32_bf16 a[40:43], v[200:203], v[100:103], a[40:43]
    v_mfma_f32_16x16x32_bf16 a[48:51], v[200:203], v[104:107], a[48:51]
    v_mfma_f32_16x16x32_bf16 a[56:59], v[200:203], v[108:111], a[56:59]
    v_mfma_f32_16x16x32_bf16 a[36:39], v[204:207], v[96:99], a[36:39]
    ds_read_b64_tr_b16 v[200:201], v216 offset:20736
    ds_read_b64_tr_b16 v[202:203], v216 offset:25856
    buffer_load_dwordx4 v227, s[40:43], s37 offen offset:1024  lds
    s_add_u32 s37, s37, 163840
    v_mfma_f32_16x16x32_bf16 a[44:47], v[204:207], v[100:103], a[44:47]
    v_mfma_f32_16x16x32_bf16 a[52:55], v[204:207], v[104:107], a[52:55]
    v_mfma_f32_16x16x32_bf16 a[60:63], v[204:207], v[108:111], a[60:63]
    s_waitcnt lgkmcnt(6)
    v_mfma_f32_16x16x32_bf16 a[64:67], v[208:211], v[96:99], a[64:67]
    ds_read_b64_tr_b16 v[204:205], v217 offset:20736
    ds_read_b64_tr_b16 v[206:207], v217 offset:25856
    buffer_load_dwordx4 v[88:91], v230, s[44:47], s38 offen sc1
    v_mfma_f32_16x16x32_bf16 a[72:75], v[208:211], v[100:103], a[72:75]
    v_mfma_f32_16x16x32_bf16 a[80:83], v[208:211], v[104:107], a[80:83]
    v_mfma_f32_16x16x32_bf16 a[88:91], v[208:211], v[108:111], a[88:91]
    v_mfma_f32_16x16x32_bf16 a[68:71], v[212:215], v[96:99], a[68:71]
    ds_read_b64_tr_b16 v[208:209], v216 offset:30720
    ds_read_b64_tr_b16 v[210:211], v216 offset:35840
    v_mfma_f32_16x16x32_bf16 a[76:79], v[212:215], v[100:103], a[76:79]
    v_mfma_f32_16x16x32_bf16 a[84:87], v[212:215], v[104:107], a[84:87]
    v_mfma_f32_16x16x32_bf16 a[92:95], v[212:215], v[108:111], a[92:95]
    s_waitcnt lgkmcnt(6)
    v_mfma_f32_16x16x32_bf16 a[96:99], v[192:195], v[96:99], a[96:99]
    ds_read_b64_tr_b16 v[212:213], v217 offset:30720
    ds_read_b64_tr_b16 v[214:215], v217 offset:35840
    buffer_load_dwordx4 v[92:95], v231, s[44:47], s38 offen sc1
    s_add_u32 s38, s38, 1024
    v_mfma_f32_16x16x32_bf16 a[104:107], v[192:195], v[100:103], a[104:107]
    v_mfma_f32_16x16x32_bf16 a[112:115], v[192:195], v[104:107], a[112:115]
    v_mfma_f32_16x16x32_bf16 a[120:123], v[192:195], v[108:111], a[120:123]
    v_mfma_f32_16x16x32_bf16 a[100:103], v[196:199], v[96:99], a[100:103]
    ds_read_b64_tr_b16 v[192:193], v216 offset:30784
    ds_read_b64_tr_b16 v[194:195], v216 offset:35904
    v_mfma_f32_16x16x32_bf16 a[108:111], v[196:199], v[100:103], a[108:111]
    buffer_load_dword v238, v236, s[52:55], s56 offen sc1
    s_add_u32 s56, s56, 4096
    v_mfma_f32_16x16x32_bf16 a[116:119], v[196:199], v[104:107], a[116:119]
    v_mfma_f32_16x16x32_bf16 a[124:127], v[196:199], v[108:111], a[124:127]
    s_waitcnt lgkmcnt(6)
    v_mfma_f32_16x16x32_bf16 a[128:131], v[200:203], v[96:99], a[128:131]
    ds_read_b64_tr_b16 v[196:197], v217 offset:30784
    ds_read_b64_tr_b16 v[198:199], v217 offset:35904
    v_mfma_f32_16x16x32_bf16 a[136:139], v[200:203], v[100:103], a[136:139]
    v_mfma_f32_16x16x32_bf16 a[144:147], v[200:203], v[104:107], a[144:147]
    v_mfma_f32_16x16x32_bf16 a[152:155], v[200:203], v[108:111], a[152:155]
    v_mfma_f32_16x16x32_bf16 a[132:135], v[204:207], v[96:99], a[132:135]
    ds_read_b64_tr_b16 v[200:201], v216 offset:30848
    ds_read_b64_tr_b16 v[202:203], v216 offset:35968
    v_mfma_f32_16x16x32_bf16 a[140:143], v[204:207], v[100:103], a[140:143]
    v_mfma_f32_16x16x32_bf16 a[148:151], v[204:207], v[104:107], a[148:151]
    v_mfma_f32_16x16x32_bf16 a[156:159], v[204:207], v[108:111], a[156:159]
    s_waitcnt lgkmcnt(6)
    v_mfma_f32_16x16x32_bf16 a[0:3], v[208:211], v[112:115], a[0:3]
    ds_read_b64_tr_b16 v[204:205], v217 offset:30848
    ds_read_b64_tr_b16 v[206:207], v217 offset:35968
    buffer_load_dwordx4 v[96:99], v228, s[44:47], s38 offen sc1
    v_mfma_f32_16x16x32_bf16 a[8:11], v[208:211], v[116:119], a[8:11]
    v_mfma_f32_16x16x32_bf16 a[16:19], v[208:211], v[120:123], a[16:19]
    v_mfma_f32_16x16x32_bf16 a[24:27], v[208:211], v[124:127], a[24:27]
    v_mfma_f32_16x16x32_bf16 a[4:7], v[212:215], v[112:115], a[4:7]
    ds_read_b64_tr_b16 v[208:209], v216 offset:30912
    ds_read_b64_tr_b16 v[210:211], v216 offset:36032
    v_mfma_f32_16x16x32_bf16 a[12:15], v[212:215], v[116:119], a[12:15]
    v_mfma_f32_16x16x32_bf16 a[20:23], v[212:215], v[120:123], a[20:23]
    v_mfma_f32_16x16x32_bf16 a[28:31], v[212:215], v[124:127], a[28:31]
    s_waitcnt lgkmcnt(6)
    v_mfma_f32_16x16x32_bf16 a[32:35], v[192:195], v[112:115], a[32:35]
    ds_read_b64_tr_b16 v[212:213], v217 offset:30912
    ds_read_b64_tr_b16 v[214:215], v217 offset:36032
    buffer_load_dwordx4 v[100:103], v229, s[44:47], s38 offen sc1
    v_mfma_f32_16x16x32_bf16 a[40:43], v[192:195], v[116:119], a[40:43]
    v_mfma_f32_16x16x32_bf16 a[48:51], v[192:195], v[120:123], a[48:51]
    v_mfma_f32_16x16x32_bf16 a[56:59], v[192:195], v[124:127], a[56:59]
    v_mfma_f32_16x16x32_bf16 a[36:39], v[196:199], v[112:115], a[36:39]
    ds_read_b64_tr_b16 v[192:193], v216 offset:30976
    ds_read_b64_tr_b16 v[194:195], v216 offset:36096
    v_mfma_f32_16x16x32_bf16 a[44:47], v[196:199], v[116:119], a[44:47]
    v_mfma_f32_16x16x32_bf16 a[52:55], v[196:199], v[120:123], a[52:55]
    v_mfma_f32_16x16x32_bf16 a[60:63], v[196:199], v[124:127], a[60:63]
    s_waitcnt lgkmcnt(6)
    v_mfma_f32_16x16x32_bf16 a[64:67], v[200:203], v[112:115], a[64:67]
    ds_read_b64_tr_b16 v[196:197], v217 offset:30976
    ds_read_b64_tr_b16 v[198:199], v217 offset:36096
    buffer_load_dwordx4 v[104:107], v230, s[44:47], s38 offen sc1
    v_mfma_f32_16x16x32_bf16 a[72:75], v[200:203], v[116:119], a[72:75]
    v_mfma_f32_16x16x32_bf16 a[80:83], v[200:203], v[120:123], a[80:83]
    v_mfma_f32_16x16x32_bf16 a[88:91], v[200:203], v[124:127], a[88:91]
    v_mfma_f32_16x16x32_bf16 a[68:71], v[204:207], v[112:115], a[68:71]
    v_add_u32 v216, 0xa000, v216
    v_add_u32 v217, 0xa000, v217
    ds_read_b64_tr_b16 v[200:201], v216 offset:0
    ds_read_b64_tr_b16 v[202:203], v216 offset:5120
    v_mfma_f32_16x16x32_bf16 a[76:79], v[204:207], v[116:119], a[76:79]
    v_mfma_f32_16x16x32_bf16 a[84:87], v[204:207], v[120:123], a[84:87]
    v_mfma_f32_16x16x32_bf16 a[92:95], v[204:207], v[124:127], a[92:95]
    s_waitcnt lgkmcnt(6)
    v_mfma_f32_16x16x32_bf16 a[96:99], v[208:211], v[112:115], a[96:99]
    ds_read_b64_tr_b16 v[204:205], v217 offset:0
    ds_read_b64_tr_b16 v[206:207], v217 offset:5120
    buffer_load_dwordx4 v[108:111], v231, s[44:47], s38 offen sc1
    s_add_u32 s38, s38, 1024
    v_mfma_f32_16x16x32_bf16 a[104:107], v[208:211], v[116:119], a[104:107]
    v_mfma_f32_16x16x32_bf16 a[112:115], v[208:211], v[120:123], a[112:115]
    v_mfma_f32_16x16x32_bf16 a[120:123], v[208:211], v[124:127], a[120:123]
    v_mfma_f32_16x16x32_bf16 a[100:103], v[212:215], v[112:115], a[100:103]
    ds_read_b64_tr_b16 v[208:209], v216 offset:64
    ds_read_b64_tr_b16 v[210:211], v216 offset:5184
    v_mfma_f32_16x16x32_bf16 a[108:111], v[212:215], v[116:119], a[108:111]
    v_mfma_f32_16x16x32_bf16 a[116:119], v[212:215], v[120:123], a[116:119]
    v_mfma_f32_16x16x32_bf16 a[124:127], v[212:215], v[124:127], a[124:127]
    s_waitcnt lgkmcnt(6)
    v_mfma_f32_16x16x32_bf16 a[128:131], v[192:195], v[112:115], a[128:131]
    ds_read_b64_tr_b16 v[212:213], v217 offset:64
    ds_read_b64_tr_b16 v[214:215], v217 offset:5184
    v_mfma_f32_16x16x32_bf16 a[136:139], v[192:195], v[116:119], a[136:139]
    v_mfma_f32_16x16x32_bf16 a[144:147], v[192:195], v[120:123], a[144:147]
    v_mfma_f32_16x16x32_bf16 a[152:155], v[192:195], v[124:127], a[152:155]
    v_mfma_f32_16x16x32_bf16 a[132:135], v[196:199], v[112:115], a[132:135]
    ds_read_b64_tr_b16 v[192:193], v216 offset:128
    ds_read_b64_tr_b16 v[194:195], v216 offset:5248
    v_mfma_f32_16x16x32_bf16 a[140:143], v[196:199], v[116:119], a[140:143]
    v_mfma_f32_16x16x32_bf16 a[148:151], v[196:199], v[120:123], a[148:151]
    v_mfma_f32_16x16x32_bf16 a[156:159], v[196:199], v[124:127], a[156:159]
    s_waitcnt lgkmcnt(6)
    v_mfma_f32_16x16x32_bf16 a[0:3], v[200:203], v[128:131], a[0:3]
    ds_read_b64_tr_b16 v[196:197], v217 offset:128
    ds_read_b64_tr_b16 v[198:199], v217 offset:5248
    buffer_load_dwordx4 v[112:115], v228, s[44:47], s38 offen sc1
    v_mfma_f32_16x16x32_bf16 a[8:11], v[200:203], v[132:135], a[8:11]
    v_mfma_f32_16x16x32_bf16 a[16:19], v[200:203], v[136:139], a[16:19]
    v_mfma_f32_16x16x32_bf16 a[24:27], v[200:203], v[140:143], a[24:27]
    v_mfma_f32_16x16x32_bf16 a[4:7], v[204:207], v[128:131], a[4:7]
    ds_read_b64_tr_b16 v[200:201], v216 offset:192
    ds_read_b64_tr_b16 v[202:203], v216 offset:5312
    v_mfma_f32_16x16x32_bf16 a[12:15], v[204:207], v[132:135], a[12:15]
    v_mfma_f32_16x16x32_bf16 a[20:23], v[204:207], v[136:139], a[20:23]
    v_mfma_f32_16x16x32_bf16 a[28:31], v[204:207], v[140:143], a[28:31]
    s_waitcnt lgkmcnt(6)
    v_mfma_f32_16x16x32_bf16 a[32:35], v[208:211], v[128:131], a[32:35]
    ds_read_b64_tr_b16 v[204:205], v217 offset:192
    ds_read_b64_tr_b16 v[206:207], v217 offset:5312
    buffer_load_dwordx4 v[116:119], v229, s[44:47], s38 offen sc1
    v_mfma_f32_16x16x32_bf16 a[40:43], v[208:211], v[132:135], a[40:43]
    v_mfma_f32_16x16x32_bf16 a[48:51], v[208:211], v[136:139], a[48:51]
    v_mfma_f32_16x16x32_bf16 a[56:59], v[208:211], v[140:143], a[56:59]
    v_mfma_f32_16x16x32_bf16 a[36:39], v[212:215], v[128:131], a[36:39]
    ds_read_b64_tr_b16 v[208:209], v216 offset:256
    ds_read_b64_tr_b16 v[210:211], v216 offset:5376
    v_mfma_f32_16x16x32_bf16 a[44:47], v[212:215], v[132:135], a[44:47]
    v_mfma_f32_16x16x32_bf16 a[52:55], v[212:215], v[136:139], a[52:55]
    v_mfma_f32_16x16x32_bf16 a[60:63], v[212:215], v[140:143], a[60:63]
    s_waitcnt lgkmcnt(6)
    v_mfma_f32_16x16x32_bf16 a[64:67], v[192:195], v[128:131], a[64:67]
    ds_read_b64_tr_b16 v[212:213], v217 offset:256
    ds_read_b64_tr_b16 v[214:215], v217 offset:5376
    buffer_load_dwordx4 v[120:123], v230, s[44:47], s38 offen sc1
    v_mfma_f32_16x16x32_bf16 a[72:75], v[192:195], v[132:135], a[72:75]
    v_mfma_f32_16x16x32_bf16 a[80:83], v[192:195], v[136:139], a[80:83]
    v_mfma_f32_16x16x32_bf16 a[88:91], v[192:195], v[140:143], a[88:91]
    s_waitcnt vmcnt(10)
    s_barrier
    v_mfma_f32_16x16x32_bf16 a[68:71], v[196:199], v[128:131], a[68:71]
    ds_read_b64_tr_b16 v[192:193], v216 offset:10240
    ds_read_b64_tr_b16 v[194:195], v216 offset:15360
    v_mfma_f32_16x16x32_bf16 a[76:79], v[196:199], v[132:135], a[76:79]
    s_add_u32 m0, s34, 40960
    s_nop 0
    buffer_load_dwordx4 v218, s[40:43], s37 offen offset:0  lds
    v_mfma_f32_16x16x32_bf16 a[84:87], v[196:199], v[136:139], a[84:87]
    v_mfma_f32_16x16x32_bf16 a[92:95], v[196:199], v[140:143], a[92:95]
    s_waitcnt lgkmcnt(6)
    v_mfma_f32_16x16x32_bf16 a[96:99], v[200:203], v[128:131], a[96:99]
    ds_read_b64_tr_b16 v[196:197], v217 offset:10240
    ds_read_b64_tr_b16 v[198:199], v217 offset:15360
    buffer_load_dwordx4 v[124:127], v231, s[44:47], s38 offen sc1
    s_add_u32 s38, s38, 1024
    v_mfma_f32_16x16x32_bf16 a[104:107], v[200:203], v[132:135], a[104:107]
    v_mfma_f32_16x16x32_bf16 a[112:115], v[200:203], v[136:139], a[112:115]
    v_mfma_f32_16x16x32_bf16 a[120:123], v[200:203], v[140:143], a[120:123]
    v_mfma_f32_16x16x32_bf16 a[100:103], v[204:207], v[128:131], a[100:103]
    ds_read_b64_tr_b16 v[200:201], v216 offset:10304
    ds_read_b64_tr_b16 v[202:203], v216 offset:15424
    buffer_load_dwordx4 v219, s[40:43], s37 offen offset:1024  lds
    v_mfma_f32_16x16x32_bf16 a[108:111], v[204:207], v[132:135], a[108:111]
    v_mfma_f32_16x16x32_bf16 a[116:119], v[204:207], v[136:139], a[116:119]
    v_mfma_f32_16x16x32_bf16 a[124:127], v[204:207], v[140:143], a[124:127]
    s_waitcnt lgkmcnt(6)
    v_mfma_f32_16x16x32_bf16 a[128:131], v[208:211], v[128:131], a[128:131]
    ds_read_b64_tr_b16 v[204:205], v217 offset:10304
    ds_read_b64_tr_b16 v[206:207], v217 offset:15424
    v_mfma_f32_16x16x32_bf16 a[136:139], v[208:211], v[132:135], a[136:139]
    v_mfma_f32_16x16x32_bf16 a[144:147], v[208:211], v[136:139], a[144:147]
    v_mfma_f32_16x16x32_bf16 a[152:155], v[208:211], v[140:143], a[152:155]
    v_mfma_f32_16x16x32_bf16 a[132:135], v[212:215], v[128:131], a[132:135]
    ds_read_b64_tr_b16 v[208:209], v216 offset:10368
    ds_read_b64_tr_b16 v[210:211], v216 offset:15488
    buffer_load_dwordx4 v220, s[40:43], s37 offen offset:2048  lds
    v_mfma_f32_16x16x32_bf16 a[140:143], v[212:215], v[132:135], a[140:143]
    v_mfma_f32_16x16x32_bf16 a[148:151], v[212:215], v[136:139], a[148:151]
    v_mfma_f32_16x16x32_bf16 a[156:159], v[212:215], v[140:143], a[156:159]
    s_waitcnt lgkmcnt(6)
    v_mfma_f32_16x16x32_bf16 a[0:3], v[192:195], v[144:147], a[0:3]
    ds_read_b64_tr_b16 v[212:213], v217 offset:10368
    ds_read_b64_tr_b16 v[214:215], v217 offset:15488
    buffer_load_dwordx4 v[128:131], v228, s[44:47], s38 offen sc1
    v_mfma_f32_16x16x32_bf16 a[8:11], v[192:195], v[148:151], a[8:11]
    v_mfma_f32_16x16x32_bf16 a[16:19], v[192:195], v[152:155], a[16:19]
    v_mfma_f32_16x16x32_bf16 a[24:27], v[192:195], v[156:159], a[24:27]
    v_mfma_f32_16x16x32_bf16 a[4:7], v[196:199], v[144:147], a[4:7]
    ds_read_b64_tr_b16 v[192:193], v216 offset:10432
    ds_read_b64_tr_b16 v[194:195], v216 offset:15552
    buffer_load_dwordx4 v221, s[40:43], s37 offen offset:3072  lds
    v_mfma_f32_16x16x32_bf16 a[12:15], v[196:199], v[148:151], a[12:15]
    v_mfma_f32_16x16x32_bf16 a[20:23], v[196:199], v[152:155], a[20:23]
    v_mfma_f32_16x16x32_bf16 a[28:31], v[196:199], v[156:159], a[28:31]
    s_waitcnt lgkmcnt(6)
    v_mfma_f32_16x16x32_bf16 a[32:35], v[200:203], v[144:147], a[32:35]
    ds_read_b64_tr_b16 v[196:197], v217 offset:10432
    ds_read_b64_tr_b16 v[198:199], v217 offset:15552
    buffer_load_dwordx4 v[132:135], v229, s[44:47], s38 offen sc1
    v_mfma_f32_16x16x32_bf16 a[40:43], v[200:203], v[148:151], a[40:43]
    v_mfma_f32_16x16x32_bf16 a[48:51], v[200:203], v[152:155], a[48:51]
    v_mfma_f32_16x16x32_bf16 a[56:59], v[200:203], v[156:159], a[56:59]
    v_mfma_f32_16x16x32_bf16 a[36:39], v[204:207], v[144:147], a[36:39]
    ds_read_b64_tr_b16 v[200:201], v216 offset:10496
    ds_read_b64_tr_b16 v[202:203], v216 offset:15616
    v_mfma_f32_16x16x32_bf16 a[44:47], v[204:207], v[148:151], a[44:47]
    s_add_u32 m0, s34, 45056
    s_nop 0
    buffer_load_dwordx4 v222, s[40:43], s37 offen offset:0  lds
    v_mfma_f32_16x16x32_bf16 a[52:55], v[204:207], v[152:155], a[52:55]
    v_mfma_f32_16x16x32_bf16 a[60:63], v[204:207], v[156:159], a[60:63]
    s_waitcnt lgkmcnt(6)
    v_mfma_f32_16x16x32_bf16 a[64:67], v[208:211], v[144:147], a[64:67]
    ds_read_b64_tr_b16 v[204:205], v217 offset:10496
    ds_read_b64_tr_b16 v[206:207], v217 offset:15616
    buffer_load_dwordx4 v[136:139], v230, s[44:47], s38 offen sc1
    v_mfma_f32_16x16x32_bf16 a[72:75], v[208:211], v[148:151], a[72:75]
    v_mfma_f32_16x16x32_bf16 a[80:83], v[208:211], v[152:155], a[80:83]
    v_mfma_f32_16x16x32_bf16 a[88:91], v[208:211], v[156:159], a[88:91]
    v_mfma_f32_16x16x32_bf16 a[68:71], v[212:215], v[144:147], a[68:71]
    ds_read_b64_tr_b16 v[208:209], v216 offset:20480
    ds_read_b64_tr_b16 v[210:211], v216 offset:25600
    buffer_load_dwordx4 v223, s[40:43], s37 offen offset:1024  lds
    v_mfma_f32_16x16x32_bf16 a[76:79], v[212:215], v[148:151], a[76:79]
    v_mfma_f32_16x16x32_bf16 a[84:87], v[212:215], v[152:155], a[84:87]
    v_mfma_f32_16x16x32_bf16 a[92:95], v[212:215], v[156:159], a[92:95]
    s_waitcnt lgkmcnt(6)
    v_mfma_f32_16x16x32_bf16 a[96:99], v[192:195], v[144:147], a[96:99]
    ds_read_b64_tr_b16 v[212:213], v217 offset:20480
    ds_read_b64_tr_b16 v[214:215], v217 offset:25600
    buffer_load_dwordx4 v[140:143], v231, s[44:47], s38 offen sc1
    s_add_u32 s38, s38, 1024
    v_mfma_f32_16x16x32_bf16 a[104:107], v[192:195], v[148:151], a[104:107]
    v_mfma_f32_16x16x32_bf16 a[112:115], v[192:195], v[152:155], a[112:115]
    v_mfma_f32_16x16x32_bf16 a[120:123], v[192:195], v[156:159], a[120:123]
    v_mfma_f32_16x16x32_bf16 a[100:103], v[196:199], v[144:147], a[100:103]
    ds_read_b64_tr_b16 v[192:193], v216 offset:20544
    ds_read_b64_tr_b16 v[194:195], v216 offset:25664
    buffer_load_dwordx4 v224, s[40:43], s37 offen offset:2048  lds
    v_mfma_f32_16x16x32_bf16 a[108:111], v[196:199], v[148:151], a[108:111]
    v_mfma_f32_16x16x32_bf16 a[116:119], v[196:199], v[152:155], a[116:119]
    v_mfma_f32_16x16x32_bf16 a[124:127], v[196:199], v[156:159], a[124:127]
    s_waitcnt lgkmcnt(6)
    v_mfma_f32_16x16x32_bf16 a[128:131], v[200:203], v[144:147], a[128:131]
    ds_read_b64_tr_b16 v[196:197], v217 offset:20544
    ds_read_b64_tr_b16 v[198:199], v217 offset:25664
    v_mfma_f32_16x16x32_bf16 a[136:139], v[200:203], v[148:151], a[136:139]
    v_mfma_f32_16x16x32_bf16 a[144:147], v[200:203], v[152:155], a[144:147]
    v_mfma_f32_16x16x32_bf16 a[152:155], v[200:203], v[156:159], a[152:155]
    v_mfma_f32_16x16x32_bf16 a[132:135], v[204:207], v[144:147], a[132:135]
    ds_read_b64_tr_b16 v[200:201], v216 offset:20608
    ds_read_b64_tr_b16 v[202:203], v216 offset:25728
    buffer_load_dwordx4 v225, s[40:43], s37 offen offset:3072  lds
    v_mfma_f32_16x16x32_bf16 a[140:143], v[204:207], v[148:151], a[140:143]
    v_mfma_f32_16x16x32_bf16 a[148:151], v[204:207], v[152:155], a[148:151]
    v_mfma_f32_16x16x32_bf16 a[156:159], v[204:207], v[156:159], a[156:159]
    s_waitcnt lgkmcnt(6)
    v_mfma_f32_16x16x32_bf16 a[0:3], v[208:211], v[160:163], a[0:3]
    ds_read_b64_tr_b16 v[204:205], v217 offset:20608
    ds_read_b64_tr_b16 v[206:207], v217 offset:25728
    buffer_load_dwordx4 v[144:147], v228, s[44:47], s38 offen sc1
    v_mfma_f32_16x16x32_bf16 a[8:11], v[208:211], v[164:167], a[8:11]
    v_mfma_f32_16x16x32_bf16 a[16:19], v[208:211], v[168:171], a[16:19]
    v_mfma_f32_16x16x32_bf16 a[24:27], v[208:211], v[172:175], a[24:27]
    v_mfma_f32_16x16x32_bf16 a[4:7], v[212:215], v[160:163], a[4:7]
    ds_read_b64_tr_b16 v[208:209], v216 offset:20672
    ds_read_b64_tr_b16 v[210:211], v216 offset:25792
    v_mfma_f32_16x16x32_bf16 a[12:15], v[212:215], v[164:167], a[12:15]
    s_add_u32 m0, s34, 49152
    s_nop 0
    buffer_load_dwordx4 v226, s[40:43], s37 offen offset:0  lds
    v_mfma_f32_16x16x32_bf16 a[20:23], v[212:215], v[168:171], a[20:23]
    v_mfma_f32_16x16x32_bf16 a[28:31], v[212:215], v[172:175], a[28:31]
    s_waitcnt lgkmcnt(6)
    v_mfma_f32_16x16x32_bf16 a[32:35], v[192:195], v[160:163], a[32:35]
    ds_read_b64_tr_b16 v[212:213], v217 offset:20672
    ds_read_b64_tr_b16 v[214:215], v217 offset:25792
    buffer_load_dwordx4 v[148:151], v229, s[44:47], s38 offen sc1
    v_mfma_f32_16x16x32_bf16 a[40:43], v[192:195], v[164:167], a[40:43]
    v_mfma_f32_16x16x32_bf16 a[48:51], v[192:195], v[168:171], a[48:51]
    v_mfma_f32_16x16x32_bf16 a[56:59], v[192:195], v[172:175], a[56:59]
    v_mfma_f32_16x16x32_bf16 a[36:39], v[196:199], v[160:163], a[36:39]
    ds_read_b64_tr_b16 v[192:193], v216 offset:20736
    ds_read_b64_tr_b16 v[194:195], v216 offset:25856
    buffer_load_dwordx4 v227, s[40:43], s37 offen offset:1024  lds
    s_add_u32 s37, s37, 163840
    v_mfma_f32_16x16x32_bf16 a[44:47], v[196:199], v[164:167], a[44:47]
    v_mfma_f32_16x16x32_bf16 a[52:55], v[196:199], v[168:171], a[52:55]
    v_mfma_f32_16x16x32_bf16 a[60:63], v[196:199], v[172:175], a[60:63]
    s_waitcnt lgkmcnt(6)
    v_mfma_f32_16x16x32_bf16 a[64:67], v[200:203], v[160:163], a[64:67]
    ds_read_b64_tr_b16 v[196:197], v217 offset:20736
    ds_read_b64_tr_b16 v[198:199], v217 offset:25856
    buffer_load_dwordx4 v[152:155], v230, s[44:47], s38 offen sc1
    v_mfma_f32_16x16x32_bf16 a[72:75], v[200:203], v[164:167], a[72:75]
    v_mfma_f32_16x16x32_bf16 a[80:83], v[200:203], v[168:171], a[80:83]
    v_mfma_f32_16x16x32_bf16 a[88:91], v[200:203], v[172:175], a[88:91]
    v_mfma_f32_16x16x32_bf16 a[68:71], v[204:207], v[160:163], a[68:71]
    ds_read_b64_tr_b16 v[200:201], v216 offset:30720
    ds_read_b64_tr_b16 v[202:203], v216 offset:35840
    v_mfma_f32_16x16x32_bf16 a[76:79], v[204:207], v[164:167], a[76:79]
    v_mfma_f32_16x16x32_bf16 a[84:87], v[204:207], v[168:171], a[84:87]
    v_mfma_f32_16x16x32_bf16 a[92:95], v[204:207], v[172:175], a[92:95]
    s_waitcnt lgkmcnt(6)
    v_mfma_f32_16x16x32_bf16 a[96:99], v[208:211], v[160:163], a[96:99]
    ds_read_b64_tr_b16 v[204:205], v217 offset:30720
    ds_read_b64_tr_b16 v[206:207], v217 offset:35840
    buffer_load_dwordx4 v[156:159], v231, s[44:47], s38 offen sc1
    s_add_u32 s38, s38, 1024
    v_mfma_f32_16x16x32_bf16 a[104:107], v[208:211], v[164:167], a[104:107]
    v_mfma_f32_16x16x32_bf16 a[112:115], v[208:211], v[168:171], a[112:115]
    v_mfma_f32_16x16x32_bf16 a[120:123], v[208:211], v[172:175], a[120:123]
    v_mfma_f32_16x16x32_bf16 a[100:103], v[212:215], v[160:163], a[100:103]
    ds_read_b64_tr_b16 v[208:209], v216 offset:30784
    ds_read_b64_tr_b16 v[210:211], v216 offset:35904
    v_mfma_f32_16x16x32_bf16 a[108:111], v[212:215], v[164:167], a[108:111]
    buffer_load_dword v238, v236, s[52:55], s56 offen sc1
    s_add_u32 s56, s56, 4096
    v_mfma_f32_16x16x32_bf16 a[116:119], v[212:215], v[168:171], a[116:119]
    v_mfma_f32_16x16x32_bf16 a[124:127], v[212:215], v[172:175], a[124:127]
    s_waitcnt lgkmcnt(6)
    v_mfma_f32_16x16x32_bf16 a[128:131], v[192:195], v[160:163], a[128:131]
    ds_read_b64_tr_b16 v[212:213], v217 offset:30784
    ds_read_b64_tr_b16 v[214:215], v217 offset:35904
    v_mfma_f32_16x16x32_bf16 a[136:139], v[192:195], v[164:167], a[136:139]
    v_mfma_f32_16x16x32_bf16 a[144:147], v[192:195], v[168:171], a[144:147]
    v_mfma_f32_16x16x32_bf16 a[152:155], v[192:195], v[172:175], a[152:155]
    v_mfma_f32_16x16x32_bf16 a[132:135], v[196:199], v[160:163], a[132:135]
    ds_read_b64_tr_b16 v[192:193], v216 offset:30848
    ds_read_b64_tr_b16 v[194:195], v216 offset:35968
    v_mfma_f32_16x16x32_bf16 a[140:143], v[196:199], v[164:167], a[140:143]
    v_mfma_f32_16x16x32_bf16 a[148:151], v[196:199], v[168:171], a[148:151]
    v_mfma_f32_16x16x32_bf16 a[156:159], v[196:199], v[172:175], a[156:159]
    s_waitcnt lgkmcnt(6)
    v_mfma_f32_16x16x32_bf16 a[0:3], v[200:203], v[176:179], a[0:3]
    ds_read_b64_tr_b16 v[196:197], v217 offset:30848
    ds_read_b64_tr_b16 v[198:199], v217 offset:35968
    buffer_load_dwordx4 v[160:163], v228, s[44:47], s38 offen sc1
    v_mfma_f32_16x16x32_bf16 a[8:11], v[200:203], v[180:183], a[8:11]
    v_mfma_f32_16x16x32_bf16 a[16:19], v[200:203], v[184:187], a[16:19]
    v_mfma_f32_16x16x32_bf16 a[24:27], v[200:203], v[188:191], a[24:27]
    v_mfma_f32_16x16x32_bf16 a[4:7], v[204:207], v[176:179], a[4:7]
    ds_read_b64_tr_b16 v[200:201], v216 offset:30912
    ds_read_b64_tr_b16 v[202:203], v216 offset:36032
    v_mfma_f32_16x16x32_bf16 a[12:15], v[204:207], v[180:183], a[12:15]
    v_mfma_f32_16x16x32_bf16 a[20:23], v[204:207], v[184:187], a[20:23]
    v_mfma_f32_16x16x32_bf16 a[28:31], v[204:207], v[188:191], a[28:31]
    s_waitcnt lgkmcnt(6)
    v_mfma_f32_16x16x32_bf16 a[32:35], v[208:211], v[176:179], a[32:35]
    ds_read_b64_tr_b16 v[204:205], v217 offset:30912
    ds_read_b64_tr_b16 v[206:207], v217 offset:36032
    buffer_load_dwordx4 v[164:167], v229, s[44:47], s38 offen sc1
    v_mfma_f32_16x16x32_bf16 a[40:43], v[208:211], v[180:183], a[40:43]
    v_mfma_f32_16x16x32_bf16 a[48:51], v[208:211], v[184:187], a[48:51]
    v_mfma_f32_16x16x32_bf16 a[56:59], v[208:211], v[188:191], a[56:59]
    v_mfma_f32_16x16x32_bf16 a[36:39], v[212:215], v[176:179], a[36:39]
    ds_read_b64_tr_b16 v[208:209], v216 offset:30976
    ds_read_b64_tr_b16 v[210:211], v216 offset:36096
    v_mfma_f32_16x16x32_bf16 a[44:47], v[212:215], v[180:183], a[44:47]
    v_mfma_f32_16x16x32_bf16 a[52:55], v[212:215], v[184:187], a[52:55]
    v_mfma_f32_16x16x32_bf16 a[60:63], v[212:215], v[188:191], a[60:63]
    s_waitcnt lgkmcnt(6)
    v_mfma_f32_16x16x32_bf16 a[64:67], v[192:195], v[176:179], a[64:67]
    ds_read_b64_tr_b16 v[212:213], v217 offset:30976
    ds_read_b64_tr_b16 v[214:215], v217 offset:36096
    buffer_load_dwordx4 v[168:171], v230, s[44:47], s38 offen sc1
    v_mfma_f32_16x16x32_bf16 a[72:75], v[192:195], v[180:183], a[72:75]
    v_mfma_f32_16x16x32_bf16 a[80:83], v[192:195], v[184:187], a[80:83]
    v_mfma_f32_16x16x32_bf16 a[88:91], v[192:195], v[188:191], a[88:91]
    v_mfma_f32_16x16x32_bf16 a[68:71], v[196:199], v[176:179], a[68:71]
    v_add_u32 v216, 0xfffec000, v216
    v_add_u32 v217, 0xfffec000, v217
    ds_read_b64_tr_b16 v[192:193], v216 offset:0
    ds_read_b64_tr_b16 v[194:195], v216 offset:5120
    v_mfma_f32_16x16x32_bf16 a[76:79], v[196:199], v[180:183], a[76:79]
    v_mfma_f32_16x16x32_bf16 a[84:87], v[196:199], v[184:187], a[84:87]
    v_mfma_f32_16x16x32_bf16 a[92:95], v[196:199], v[188:191], a[92:95]
    s_waitcnt lgkmcnt(6)
    v_mfma_f32_16x16x32_bf16 a[96:99], v[200:203], v[176:179], a[96:99]
    ds_read_b64_tr_b16 v[196:197], v217 offset:0
    ds_read_b64_tr_b16 v[198:199], v217 offset:5120
    buffer_load_dwordx4 v[172:175], v231, s[44:47], s38 offen sc1
    s_add_u32 s38, s38, 1024
    v_mfma_f32_16x16x32_bf16 a[104:107], v[200:203], v[180:183], a[104:107]
    v_mfma_f32_16x16x32_bf16 a[112:115], v[200:203], v[184:187], a[112:115]
    v_mfma_f32_16x16x32_bf16 a[120:123], v[200:203], v[188:191], a[120:123]
    v_mfma_f32_16x16x32_bf16 a[100:103], v[204:207], v[176:179], a[100:103]
    ds_read_b64_tr_b16 v[200:201], v216 offset:64
    ds_read_b64_tr_b16 v[202:203], v216 offset:5184
    v_mfma_f32_16x16x32_bf16 a[108:111], v[204:207], v[180:183], a[108:111]
    v_mfma_f32_16x16x32_bf16 a[116:119], v[204:207], v[184:187], a[116:119]
    v_mfma_f32_16x16x32_bf16 a[124:127], v[204:207], v[188:191], a[124:127]
    s_waitcnt lgkmcnt(6)
    v_mfma_f32_16x16x32_bf16 a[128:131], v[208:211], v[176:179], a[128:131]
    ds_read_b64_tr_b16 v[204:205], v217 offset:64
    ds_read_b64_tr_b16 v[206:207], v217 offset:5184
    v_mfma_f32_16x16x32_bf16 a[136:139], v[208:211], v[180:183], a[136:139]
    v_mfma_f32_16x16x32_bf16 a[144:147], v[208:211], v[184:187], a[144:147]
    v_mfma_f32_16x16x32_bf16 a[152:155], v[208:211], v[188:191], a[152:155]
    v_mfma_f32_16x16x32_bf16 a[132:135], v[212:215], v[176:179], a[132:135]
    ds_read_b64_tr_b16 v[208:209], v216 offset:128
    ds_read_b64_tr_b16 v[210:211], v216 offset:5248
    v_mfma_f32_16x16x32_bf16 a[140:143], v[212:215], v[180:183], a[140:143]
    v_mfma_f32_16x16x32_bf16 a[148:151], v[212:215], v[184:187], a[148:151]
    v_mfma_f32_16x16x32_bf16 a[156:159], v[212:215], v[188:191], a[156:159]
    s_sub_u32 s33, s33, 1
    s_cmp_lg_u32 s33, 0
    s_cbranch_scc1 Loploop
    s_waitcnt vmcnt(0) lgkmcnt(0)
    s_nop 7
    s_add_u32 s62, s31, 1
    s_and_b32 s62, s62, 3
    s_mul_i32 s62, s62, 12
    s_add_u32 s62, s62, s32
    s_add_u32 s62, s62, 0
    s_mul_i32 s62, s62, 5120
    v_accvgpr_read_b32 v0, a8
    v_accvgpr_read_b32 v1, a9
    v_accvgpr_read_b32 v2, a10
    v_accvgpr_read_b32 v3, a11
    v_accvgpr_read_b32 v4, a12
    v_accvgpr_read_b32 v5, a13
    v_accvgpr_read_b32 v6, a14
    v_accvgpr_read_b32 v7, a15
    v_cvt_pk_bf16_f32 v0, v0, v1
    v_cvt_pk_bf16_f32 v1, v2, v3
    v_cvt_pk_bf16_f32 v2, v4, v5
    v_cvt_pk_bf16_f32 v3, v6, v7
    buffer_store_dwordx4 v[0:3], v239, s[48:51], s62 offen offset:0 sc1
    v_accvgpr_read_b32 v8, a40
    v_accvgpr_read_b32 v9, a41
    v_accvgpr_read_b32 v10, a42
    v_accvgpr_read_b32 v11, a43
    v_accvgpr_read_b32 v12, a44
    v_accvgpr_read_b32 v13, a45
    v_accvgpr_read_b32 v14, a46
    v_accvgpr_read_b32 v15, a47
    v_cvt_pk_bf16_f32 v8, v8, v9
    v_cvt_pk_bf16_f32 v9, v10, v11
    v_cvt_pk_bf16_f32 v10, v12, v13
    v_cvt_pk_bf16_f32 v11, v14, v15
    buffer_store_dwordx4 v[8:11], v239, s[48:51], s62 offen offset:1024 sc1
    v_accvgpr_read_b32 v16, a72
    v_accvgpr_read_b32 v17, a73
    v_accvgpr_read_b32 v18, a74
    v_accvgpr_read_b32 v19, a75
    v_accvgpr_read_b32 v20, a76
    v_accvgpr_read_b32 v21, a77
    v_accvgpr_read_b32 v22, a78
    v_accvgpr_read_b32 v23, a79
    v_cvt_pk_bf16_f32 v16, v16, v17
    v_cvt_pk_bf16_f32 v17, v18, v19
    v_cvt_pk_bf16_f32 v18, v20, v21
    v_cvt_pk_bf16_f32 v19, v22, v23
    buffer_store_dwordx4 v[16:19], v239, s[48:51], s62 offen offset:2048 sc1
    v_accvgpr_read_b32 v24, a104
    v_accvgpr_read_b32 v25, a105
    v_accvgpr_read_b32 v26, a106
    v_accvgpr_read_b32 v27, a107
    v_accvgpr_read_b32 v28, a108
    v_accvgpr_read_b32 v29, a109
    v_accvgpr_read_b32 v30, a110
    v_accvgpr_read_b32 v31, a111
    v_cvt_pk_bf16_f32 v24, v24, v25
    v_cvt_pk_bf16_f32 v25, v26, v27
    v_cvt_pk_bf16_f32 v26, v28, v29
    v_cvt_pk_bf16_f32 v27, v30, v31
    buffer_store_dwordx4 v[24:27], v239, s[48:51], s62 offen offset:3072 sc1
    v_accvgpr_read_b32 v32, a136
    v_accvgpr_read_b32 v33, a137
    v_accvgpr_read_b32 v34, a138
    v_accvgpr_read_b32 v35, a139
    v_accvgpr_read_b32 v36, a140
    v_accvgpr_read_b32 v37, a141
    v_accvgpr_read_b32 v38, a142
    v_accvgpr_read_b32 v39, a143
    v_cvt_pk_bf16_f32 v32, v32, v33
    v_cvt_pk_bf16_f32 v33, v34, v35
    v_cvt_pk_bf16_f32 v34, v36, v37
    v_cvt_pk_bf16_f32 v35, v38, v39
    s_add_u32 s62, s62, 4096
    buffer_store_dwordx4 v[32:35], v239, s[48:51], s62 offen offset:0 sc1
    s_add_u32 s62, s31, 2
    s_and_b32 s62, s62, 3
    s_mul_i32 s62, s62, 12
    s_add_u32 s62, s62, s32
    s_add_u32 s62, s62, 4
    s_mul_i32 s62, s62, 5120
    v_accvgpr_read_b32 v40, a16
    v_accvgpr_read_b32 v41, a17
    v_accvgpr_read_b32 v42, a18
    v_accvgpr_read_b32 v43, a19
    v_accvgpr_read_b32 v44, a20
    v_accvgpr_read_b32 v45, a21
    v_accvgpr_read_b32 v46, a22
    v_accvgpr_read_b32 v47, a23
    v_cvt_pk_bf16_f32 v40, v40, v41
    v_cvt_pk_bf16_f32 v41, v42, v43
    v_cvt_pk_bf16_f32 v42, v44, v45
    v_cvt_pk_bf16_f32 v43, v46, v47
    buffer_store_dwordx4 v[40:43], v239, s[48:51], s62 offen offset:0 sc1
    v_accvgpr_read_b32 v48, a48
    v_accvgpr_read_b32 v49, a49
    v_accvgpr_read_b32 v50, a50
    v_accvgpr_read_b32 v51, a51
    v_accvgpr_read_b32 v52, a52
    v_accvgpr_read_b32 v53, a53
    v_accvgpr_read_b32 v54, a54
    v_accvgpr_read_b32 v55, a55
    v_cvt_pk_bf16_f32 v48, v48, v49
    v_cvt_pk_bf16_f32 v49, v50, v51
    v_cvt_pk_bf16_f32 v50, v52, v53
    v_cvt_pk_bf16_f32 v51, v54, v55
    buffer_store_dwordx4 v[48:51], v239, s[48:51], s62 offen offset:1024 sc1
    v_accvgpr_read_b32 v56, a80
    v_accvgpr_read_b32 v57, a81
    v_accvgpr_read_b32 v58, a82
    v_accvgpr_read_b32 v59, a83
    v_accvgpr_read_b32 v60, a84
    v_accvgpr_read_b32 v61, a85
    v_accvgpr_read_b32 v62, a86
    v_accvgpr_read_b32 v63, a87
    v_cvt_pk_bf16_f32 v56, v56, v57
    v_cvt_pk_bf16_f32 v57, v58, v59
    v_cvt_pk_bf16_f32 v58, v60, v61
    v_cvt_pk_bf16_f32 v59, v62, v63
    buffer_store_dwordx4 v[56:59], v239, s[48:51], s62 offen offset:2048 sc1
    v_accvgpr_read_b32 v64, a112
    v_accvgpr_read_b32 v65, a113
    v_accvgpr_read_b32 v66, a114
    v_accvgpr_read_b32 v67, a115
    v_accvgpr_read_b32 v68, a116
    v_accvgpr_read_b32 v69, a117
    v_accvgpr_read_b32 v70, a118
    v_accvgpr_read_b32 v71, a119
    v_cvt_pk_bf16_f32 v64, v64, v65
    v_cvt_pk_bf16_f32 v65, v66, v67
    v_cvt_pk_bf16_f32 v66, v68, v69
    v_cvt_pk_bf16_f32 v67, v70, v71
    buffer_store_dwordx4 v[64:67], v239, s[48:51], s62 offen offset:3072 sc1
    v_accvgpr_read_b32 v72, a144
    v_accvgpr_read_b32 v73, a145
    v_accvgpr_read_b32 v74, a146
    v_accvgpr_read_b32 v75, a147
    v_accvgpr_read_b32 v76, a148
    v_accvgpr_read_b32 v77, a149
    v_accvgpr_read_b32 v78, a150
    v_accvgpr_read_b32 v79, a151
    v_cvt_pk_bf16_f32 v72, v72, v73
    v_cvt_pk_bf16_f32 v73, v74, v75
    v_cvt_pk_bf16_f32 v74, v76, v77
    v_cvt_pk_bf16_f32 v75, v78, v79
    s_add_u32 s62, s62, 4096
    buffer_store_dwordx4 v[72:75], v239, s[48:51], s62 offen offset:0 sc1
    s_add_u32 s62, s31, 3
    s_and_b32 s62, s62, 3
    s_mul_i32 s62, s62, 12
    s_add_u32 s62, s62, s32
    s_add_u32 s62, s62, 8
    s_mul_i32 s62, s62, 5120
    v_accvgpr_read_b32 v80, a24
    v_accvgpr_read_b32 v81, a25
    v_accvgpr_read_b32 v82, a26
    v_accvgpr_read_b32 v83, a27
    v_accvgpr_read_b32 v84, a28
    v_accvgpr_read_b32 v85, a29
    v_accvgpr_read_b32 v86, a30
    v_accvgpr_read_b32 v87, a31
    v_cvt_pk_bf16_f32 v80, v80, v81
    v_cvt_pk_bf16_f32 v81, v82, v83
    v_cvt_pk_bf16_f32 v82, v84, v85
    v_cvt_pk_bf16_f32 v83, v86, v87
    buffer_store_dwordx4 v[80:83], v239, s[48:51], s62 offen offset:0 sc1
    v_accvgpr_read_b32 v88, a56
    v_accvgpr_read_b32 v89, a57
    v_accvgpr_read_b32 v90, a58
    v_accvgpr_read_b32 v91, a59
    v_accvgpr_read_b32 v92, a60
    v_accvgpr_read_b32 v93, a61
    v_accvgpr_read_b32 v94, a62
    v_accvgpr_read_b32 v95, a63
    v_cvt_pk_bf16_f32 v88, v88, v89
    v_cvt_pk_bf16_f32 v89, v90, v91
    v_cvt_pk_bf16_f32 v90, v92, v93
    v_cvt_pk_bf16_f32 v91, v94, v95
    buffer_store_dwordx4 v[88:91], v239, s[48:51], s62 offen offset:1024 sc1
    v_accvgpr_read_b32 v96, a88
    v_accvgpr_read_b32 v97, a89
    v_accvgpr_read_b32 v98, a90
    v_accvgpr_read_b32 v99, a91
    v_accvgpr_read_b32 v100, a92
    v_accvgpr_read_b32 v101, a93
    v_accvgpr_read_b32 v102, a94
    v_accvgpr_read_b32 v103, a95
    v_cvt_pk_bf16_f32 v96, v96, v97
    v_cvt_pk_bf16_f32 v97, v98, v99
    v_cvt_pk_bf16_f32 v98, v100, v101
    v_cvt_pk_bf16_f32 v99, v102, v103
    buffer_store_dwordx4 v[96:99], v239, s[48:51], s62 offen offset:2048 sc1
    v_accvgpr_read_b32 v104, a120
    v_accvgpr_read_b32 v105, a121
    v_accvgpr_read_b32 v106, a122
    v_accvgpr_read_b32 v107, a123
    v_accvgpr_read_b32 v108, a124
    v_accvgpr_read_b32 v109, a125
    v_accvgpr_read_b32 v110, a126
    v_accvgpr_read_b32 v111, a127
    v_cvt_pk_bf16_f32 v104, v104, v105
    v_cvt_pk_bf16_f32 v105, v106, v107
    v_cvt_pk_bf16_f32 v106, v108, v109
    v_cvt_pk_bf16_f32 v107, v110, v111
    buffer_store_dwordx4 v[104:107], v239, s[48:51], s62 offen offset:3072 sc1
    v_accvgpr_read_b32 v112, a152
    v_accvgpr_read_b32 v113, a153
    v_accvgpr_read_b32 v114, a154
    v_accvgpr_read_b32 v115, a155
    v_accvgpr_read_b32 v116, a156
    v_accvgpr_read_b32 v117, a157
    v_accvgpr_read_b32 v118, a158
    v_accvgpr_read_b32 v119, a159
    v_cvt_pk_bf16_f32 v112, v112, v113
    v_cvt_pk_bf16_f32 v113, v114, v115
    v_cvt_pk_bf16_f32 v114, v116, v117
    v_cvt_pk_bf16_f32 v115, v118, v119
    s_add_u32 s62, s62, 4096
    buffer_store_dwordx4 v[112:115], v239, s[48:51], s62 offen offset:0 sc1
    v_accvgpr_read_b32 v128, a0
    v_accvgpr_read_b32 v129, a1
    v_accvgpr_read_b32 v130, a2
    v_accvgpr_read_b32 v131, a3
    v_accvgpr_read_b32 v132, a4
    v_accvgpr_read_b32 v133, a5
    v_accvgpr_read_b32 v134, a6
    v_accvgpr_read_b32 v135, a7
    v_accvgpr_read_b32 v136, a32
    v_accvgpr_read_b32 v137, a33
    v_accvgpr_read_b32 v138, a34
    v_accvgpr_read_b32 v139, a35
    v_accvgpr_read_b32 v140, a36
    v_accvgpr_read_b32 v141, a37
    v_accvgpr_read_b32 v142, a38
    v_accvgpr_read_b32 v143, a39
    v_accvgpr_read_b32 v144, a64
    v_accvgpr_read_b32 v145, a65
    v_accvgpr_read_b32 v146, a66
    v_accvgpr_read_b32 v147, a67
    v_accvgpr_read_b32 v148, a68
    v_accvgpr_read_b32 v149, a69
    v_accvgpr_read_b32 v150, a70
    v_accvgpr_read_b32 v151, a71
    v_accvgpr_read_b32 v152, a96
    v_accvgpr_read_b32 v153, a97
    v_accvgpr_read_b32 v154, a98
    v_accvgpr_read_b32 v155, a99
    v_accvgpr_read_b32 v156, a100
    v_accvgpr_read_b32 v157, a101
    v_accvgpr_read_b32 v158, a102
    v_accvgpr_read_b32 v159, a103
    v_accvgpr_read_b32 v160, a128
    v_accvgpr_read_b32 v161, a129
    v_accvgpr_read_b32 v162, a130
    v_accvgpr_read_b32 v163, a131
    v_accvgpr_read_b32 v164, a132
    v_accvgpr_read_b32 v165, a133
    v_accvgpr_read_b32 v166, a134
    v_accvgpr_read_b32 v167, a135
    v_add_u32 v228, 0, v239
    v_add_u32 v229, 20480, v239
    v_add_u32 v230, 40960, v239
    s_lshl_b32 s62, s35, 11
    s_lshl_b32 s63, s30, 2
    s_add_u32 s63, s63, s36
    s_lshl_b32 s63, s63, 7
    s_add_u32 s62, s62, s63
    s_add_u32 s62, s62, 0x5d00400
    s_add_u32 s52, s28, s62
    s_addc_u32 s53, s29, 0
    s_mov_b32 s54, 4
    s_mov_b32 s55, 0x00020000
    v_mov_b32 v232, 0
    v_mov_b32 v233, 1
    s_waitcnt vmcnt(0)
    s_barrier
    s_cmp_lg_u32 s32, 0
    s_cbranch_scc1 Lop_wait
    s_mov_b64 exec, 1
    buffer_atomic_add v233, v232, s[52:55], 0 offen
Lop_poll:
    buffer_load_dword v234, v232, s[52:55], 0 offen sc1
    s_waitcnt vmcnt(0)
    v_readfirstlane_b32 s62, v234
    s_nop 3
    s_cmp_ge_u32 s62, 4
    s_cbranch_scc1 Lop_go
    s_sleep 2
    s_branch Lop_poll
Lop_go:
    s_mov_b64 exec, -1
Lop_wait:
    s_barrier
    s_mul_i32 s62, s31, 12
    s_add_u32 s62, s62, s32
    s_mul_i32 s62, s62, 5120
    s_add_u32 s63, s62, 4096
    buffer_load_dwordx4 v[0:3], v228, s[48:51], s62 offen offset:0 sc1
    buffer_load_dwordx4 v[4:7], v229, s[48:51], s62 offen offset:0 sc1
    buffer_load_dwordx4 v[8:11], v230, s[48:51], s62 offen offset:0 sc1
    buffer_load_dwordx4 v[12:15], v228, s[48:51], s62 offen offset:1024 sc1
    buffer_load_dwordx4 v[16:19], v229, s[48:51], s62 offen offset:1024 sc1
    buffer_load_dwordx4 v[20:23], v230, s[48:51], s62 offen offset:1024 sc1
    buffer_load_dwordx4 v[24:27], v228, s[48:51], s62 offen offset:2048 sc1
    buffer_load_dwordx4 v[28:31], v229, s[48:51], s62 offen offset:2048 sc1
    buffer_load_dwordx4 v[32:35], v230, s[48:51], s62 offen offset:2048 sc1
    buffer_load_dwordx4 v[36:39], v228, s[48:51], s62 offen offset:3072 sc1
    buffer_load_dwordx4 v[40:43], v229, s[48:51], s62 offen offset:3072 sc1
    buffer_load_dwordx4 v[44:47], v230, s[48:51], s62 offen offset:3072 sc1
    buffer_load_dwordx4 v[48:51], v228, s[48:51], s63 offen offset:0 sc1
    buffer_load_dwordx4 v[52:55], v229, s[48:51], s63 offen offset:0 sc1
    buffer_load_dwordx4 v[56:59], v230, s[48:51], s63 offen offset:0 sc1
    s_lshl_b32 s62, s35, 8
    s_lshl_b32 s63, s32, 6
    s_add_u32 s62, s62, s63
    s_lshl_b32 s63, s31, 4
    s_add_u32 s62, s62, s63
    s_mul_i32 s62, s62, 2560
    s_mul_i32 s63, s30, 1280
    s_add_u32 s62, s62, s63
    s_mul_i32 s63, s36, 320
    s_add_u32 s62, s62, s63
    s_mov_b32 s52, s24
    s_mov_b32 s53, s25
    s_mov_b32 s54, 0x500000
    v_lshrrev_b32 v232, 4, v239
    v_and_b32 v233, 15, v232
    v_mul_u32_u24 v233, 2560, v233
    v_lshrrev_b32 v232, 4, v232
    v_lshl_add_u32 v233, v232, 4, v233
    s_waitcnt vmcnt(12)
    v_lshlrev_b32 v64, 16, v0
    v_and_b32 v65, 0xffff0000, v0
    v_lshlrev_b32 v66, 16, v1
    v_and_b32 v67, 0xffff0000, v1
    v_lshlrev_b32 v68, 16, v2
    v_and_b32 v69, 0xffff0000, v2
    v_lshlrev_b32 v70, 16, v3
    v_and_b32 v71, 0xffff0000, v3
    v_add_f32 v128, v128, v64
    v_add_f32 v129, v129, v65
    v_add_f32 v130, v130, v66
    v_add_f32 v131, v131, v67
    v_add_f32 v132, v132, v68
    v_add_f32 v133, v133, v69
    v_add_f32 v134, v134, v70
    v_add_f32 v135, v135, v71
    v_lshlrev_b32 v64, 16, v4
    v_and_b32 v65, 0xffff0000, v4
    v_lshlrev_b32 v66, 16, v5
    v_and_b32 v67, 0xffff0000, v5
    v_lshlrev_b32 v68, 16, v6
    v_and_b32 v69, 0xffff0000, v6
    v_lshlrev_b32 v70, 16, v7
    v_and_b32 v71, 0xffff0000, v7
    v_add_f32 v128, v128, v64
    v_add_f32 v129, v129, v65
    v_add_f32 v130, v130, v66
    v_add_f32 v131, v131, v67
    v_add_f32 v132, v132, v68
    v_add_f32 v133, v133, v69
    v_add_f32 v134, v134, v70
    v_add_f32 v135, v135, v71
    v_lshlrev_b32 v64, 16, v8
    v_and_b32 v65, 0xffff0000, v8
    v_lshlrev_b32 v66, 16, v9
    v_and_b32 v67, 0xffff0000, v9
    v_lshlrev_b32 v68, 16, v10
    v_and_b32 v69, 0xffff0000, v10
    v_lshlrev_b32 v70, 16, v11
    v_and_b32 v71, 0xffff0000, v11
    v_add_f32 v128, v128, v64
    v_add_f32 v129, v129, v65
    v_add_f32 v130, v130, v66
    v_add_f32 v131, v131, v67
    v_add_f32 v132, v132, v68
    v_add_f32 v133, v133, v69
    v_add_f32 v134, v134, v70
    v_add_f32 v135, v135, v71
    v_cvt_pk_bf16_f32 v128, v128, v129
    v_cvt_pk_bf16_f32 v129, v130, v131
    v_cvt_pk_bf16_f32 v130, v132, v133
    v_cvt_pk_bf16_f32 v131, v134, v135
    s_nop 1
    v_permlane32_swap_b32 v128, v130
    v_permlane32_swap_b32 v129, v131
    s_nop 0
    v_permlane16_swap_b32 v128, v130
    v_permlane16_swap_b32 v129, v131
    buffer_store_dwordx4 v[128:131], v233, s[52:55], s62 offen offset:0
    s_waitcnt vmcnt(10)
    v_lshlrev_b32 v64, 16, v12
    v_and_b32 v65, 0xffff0000, v12
    v_lshlrev_b32 v66, 16, v13
    v_and_b32 v67, 0xffff0000, v13
    v_lshlrev_b32 v68, 16, v14
    v_and_b32 v69, 0xffff0000, v14
    v_lshlrev_b32 v70, 16, v15
    v_and_b32 v71, 0xffff0000, v15
    v_add_f32 v136, v136, v64
    v_add_f32 v137, v137, v65
    v_add_f32 v138, v138, v66
    v_add_f32 v139, v139, v67
    v_add_f32 v140, v140, v68
    v_add_f32 v141, v141, v69
    v_add_f32 v142, v142, v70
    v_add_f32 v143, v143, v71
    v_lshlrev_b32 v64, 16, v16
    v_and_b32 v65, 0xffff0000, v16
    v_lshlrev_b32 v66, 16, v17
    v_and_b32 v67, 0xffff0000, v17
    v_lshlrev_b32 v68, 16, v18
    v_and_b32 v69, 0xffff0000, v18
    v_lshlrev_b32 v70, 16, v19
    v_and_b32 v71, 0xffff0000, v19
    v_add_f32 v136, v136, v64
    v_add_f32 v137, v137, v65
    v_add_f32 v138, v138, v66
    v_add_f32 v139, v139, v67
    v_add_f32 v140, v140, v68
    v_add_f32 v141, v141, v69
    v_add_f32 v142, v142, v70
    v_add_f32 v143, v143, v71
    v_lshlrev_b32 v64, 16, v20
    v_and_b32 v65, 0xffff0000, v20
    v_lshlrev_b32 v66, 16, v21
    v_and_b32 v67, 0xffff0000, v21
    v_lshlrev_b32 v68, 16, v22
    v_and_b32 v69, 0xffff0000, v22
    v_lshlrev_b32 v70, 16, v23
    v_and_b32 v71, 0xffff0000, v23
    v_add_f32 v136, v136, v64
    v_add_f32 v137, v137, v65
    v_add_f32 v138, v138, v66
    v_add_f32 v139, v139, v67
    v_add_f32 v140, v140, v68
    v_add_f32 v141, v141, v69
    v_add_f32 v142, v142, v70
    v_add_f32 v143, v143, v71
    v_cvt_pk_bf16_f32 v136, v136, v137
    v_cvt_pk_bf16_f32 v137, v138, v139
    v_cvt_pk_bf16_f32 v138, v140, v141
    v_cvt_pk_bf16_f32 v139, v142, v143
    s_nop 1
    v_permlane32_swap_b32 v136, v138
    v_permlane32_swap_b32 v137, v139
    s_nop 0
    v_permlane16_swap_b32 v136, v138
    v_permlane16_swap_b32 v137, v139
    buffer_store_dwordx4 v[136:139], v233, s[52:55], s62 offen offset:64
    s_waitcnt vmcnt(8)
    v_lshlrev_b32 v64, 16, v24
    v_and_b32 v65, 0xffff0000, v24
    v_lshlrev_b32 v66, 16, v25
    v_and_b32 v67, 0xffff0000, v25
    v_lshlrev_b32 v68, 16, v26
    v_and_b32 v69, 0xffff0000, v26
    v_lshlrev_b32 v70, 16, v27
    v_and_b32 v71, 0xffff0000, v27
    v_add_f32 v144, v144, v64
    v_add_f32 v145, v145, v65
    v_add_f32 v146, v146, v66
    v_add_f32 v147, v147, v67
    v_add_f32 v148, v148, v68
    v_add_f32 v149, v149, v69
    v_add_f32 v150, v150, v70
    v_add_f32 v151, v151, v71
    v_lshlrev_b32 v64, 16, v28
    v_and_b32 v65, 0xffff0000, v28
    v_lshlrev_b32 v66, 16, v29
    v_and_b32 v67, 0xffff0000, v29
    v_lshlrev_b32 v68, 16, v30
    v_and_b32 v69, 0xffff0000, v30
    v_lshlrev_b32 v70, 16, v31
    v_and_b32 v71, 0xffff0000, v31
    v_add_f32 v144, v144, v64
    v_add_f32 v145, v145, v65
    v_add_f32 v146, v146, v66
    v_add_f32 v147, v147, v67
    v_add_f32 v148, v148, v68
    v_add_f32 v149, v149, v69
    v_add_f32 v150, v150, v70
    v_add_f32 v151, v151, v71
    v_lshlrev_b32 v64, 16, v32
    v_and_b32 v65, 0xffff0000, v32
    v_lshlrev_b32 v66, 16, v33
    v_and_b32 v67, 0xffff0000, v33
    v_lshlrev_b32 v68, 16, v34
    v_and_b32 v69, 0xffff0000, v34
    v_lshlrev_b32 v70, 16, v35
    v_and_b32 v71, 0xffff0000, v35
    v_add_f32 v144, v144, v64
    v_add_f32 v145, v145, v65
    v_add_f32 v146, v146, v66
    v_add_f32 v147, v147, v67
    v_add_f32 v148, v148, v68
    v_add_f32 v149, v149, v69
    v_add_f32 v150, v150, v70
    v_add_f32 v151, v151, v71
    v_cvt_pk_bf16_f32 v144, v144, v145
    v_cvt_pk_bf16_f32 v145, v146, v147
    v_cvt_pk_bf16_f32 v146, v148, v149
    v_cvt_pk_bf16_f32 v147, v150, v151
    s_nop 1
    v_permlane32_swap_b32 v144, v146
    v_permlane32_swap_b32 v145, v147
    s_nop 0
    v_permlane16_swap_b32 v144, v146
    v_permlane16_swap_b32 v145, v147
    buffer_store_dwordx4 v[144:147], v233, s[52:55], s62 offen offset:128
    s_waitcnt vmcnt(6)
    v_lshlrev_b32 v64, 16, v36
    v_and_b32 v65, 0xffff0000, v36
    v_lshlrev_b32 v66, 16, v37
    v_and_b32 v67, 0xffff0000, v37
    v_lshlrev_b32 v68, 16, v38
    v_and_b32 v69, 0xffff0000, v38
    v_lshlrev_b32 v70, 16, v39
    v_and_b32 v71, 0xffff0000, v39
    v_add_f32 v152, v152, v64
    v_add_f32 v153, v153, v65
    v_add_f32 v154, v154, v66
    v_add_f32 v155, v155, v67
    v_add_f32 v156, v156, v68
    v_add_f32 v157, v157, v69
    v_add_f32 v158, v158, v70
    v_add_f32 v159, v159, v71
    v_lshlrev_b32 v64, 16, v40
    v_and_b32 v65, 0xffff0000, v40
    v_lshlrev_b32 v66, 16, v41
    v_and_b32 v67, 0xffff0000, v41
    v_lshlrev_b32 v68, 16, v42
    v_and_b32 v69, 0xffff0000, v42
    v_lshlrev_b32 v70, 16, v43
    v_and_b32 v71, 0xffff0000, v43
    v_add_f32 v152, v152, v64
    v_add_f32 v153, v153, v65
    v_add_f32 v154, v154, v66
    v_add_f32 v155, v155, v67
    v_add_f32 v156, v156, v68
    v_add_f32 v157, v157, v69
    v_add_f32 v158, v158, v70
    v_add_f32 v159, v159, v71
    v_lshlrev_b32 v64, 16, v44
    v_and_b32 v65, 0xffff0000, v44
    v_lshlrev_b32 v66, 16, v45
    v_and_b32 v67, 0xffff0000, v45
    v_lshlrev_b32 v68, 16, v46
    v_and_b32 v69, 0xffff0000, v46
    v_lshlrev_b32 v70, 16, v47
    v_and_b32 v71, 0xffff0000, v47
    v_add_f32 v152, v152, v64
    v_add_f32 v153, v153, v65
    v_add_f32 v154, v154, v66
    v_add_f32 v155, v155, v67
    v_add_f32 v156, v156, v68
    v_add_f32 v157, v157, v69
    v_add_f32 v158, v158, v70
    v_add_f32 v159, v159, v71
    v_cvt_pk_bf16_f32 v152, v152, v153
    v_cvt_pk_bf16_f32 v153, v154, v155
    v_cvt_pk_bf16_f32 v154, v156, v157
    v_cvt_pk_bf16_f32 v155, v158, v159
    s_nop 1
    v_permlane32_swap_b32 v152, v154
    v_permlane32_swap_b32 v153, v155
    s_nop 0
    v_permlane16_swap_b32 v152, v154
    v_permlane16_swap_b32 v153, v155
    buffer_store_dwordx4 v[152:155], v233, s[52:55], s62 offen offset:192
    s_waitcnt vmcnt(4)
    v_lshlrev_b32 v64, 16, v48
    v_and_b32 v65, 0xffff0000, v48
    v_lshlrev_b32 v66, 16, v49
    v_and_b32 v67, 0xffff0000, v49
    v_lshlrev_b32 v68, 16, v50
    v_and_b32 v69, 0xffff0000, v50
    v_lshlrev_b32 v70, 16, v51
    v_and_b32 v71, 0xffff0000, v51
    v_add_f32 v160, v160, v64
    v_add_f32 v161, v161, v65
    v_add_f32 v162, v162, v66
    v_add_f32 v163, v163, v67
    v_add_f32 v164, v164, v68
    v_add_f32 v165, v165, v69
    v_add_f32 v166, v166, v70
    v_add_f32 v167, v167, v71
    v_lshlrev_b32 v64, 16, v52
    v_and_b32 v65, 0xffff0000, v52
    v_lshlrev_b32 v66, 16, v53
    v_and_b32 v67, 0xffff0000, v53
    v_lshlrev_b32 v68, 16, v54
    v_and_b32 v69, 0xffff0000, v54
    v_lshlrev_b32 v70, 16, v55
    v_and_b32 v71, 0xffff0000, v55
    v_add_f32 v160, v160, v64
    v_add_f32 v161, v161, v65
    v_add_f32 v162, v162, v66
    v_add_f32 v163, v163, v67
    v_add_f32 v164, v164, v68
    v_add_f32 v165, v165, v69
    v_add_f32 v166, v166, v70
    v_add_f32 v167, v167, v71
    v_lshlrev_b32 v64, 16, v56
    v_and_b32 v65, 0xffff0000, v56
    v_lshlrev_b32 v66, 16, v57
    v_and_b32 v67, 0xffff0000, v57
    v_lshlrev_b32 v68, 16, v58
    v_and_b32 v69, 0xffff0000, v58
    v_lshlrev_b32 v70, 16, v59
    v_and_b32 v71, 0xffff0000, v59
    v_add_f32 v160, v160, v64
    v_add_f32 v161, v161, v65
    v_add_f32 v162, v162, v66
    v_add_f32 v163, v163, v67
    v_add_f32 v164, v164, v68
    v_add_f32 v165, v165, v69
    v_add_f32 v166, v166, v70
    v_add_f32 v167, v167, v71
    v_cvt_pk_bf16_f32 v160, v160, v161
    v_cvt_pk_bf16_f32 v161, v162, v163
    v_cvt_pk_bf16_f32 v162, v164, v165
    v_cvt_pk_bf16_f32 v163, v166, v167
    s_nop 1
    v_permlane32_swap_b32 v160, v162
    v_permlane32_swap_b32 v161, v163
    s_nop 0
    v_permlane16_swap_b32 v160, v162
    v_permlane16_swap_b32 v161, v163
    buffer_store_dwordx4 v[160:163], v233, s[52:55], s62 offen offset:256
    s_waitcnt vmcnt(0) lgkmcnt(0)
attn_done:
    s_endpgm
Lrare_0:
    s_mov_b32 s39, 0
    s_branch Lrareblk_1_1
Lrare_L1:
    s_mov_b32 s39, 1
    s_branch Lrareblk_1_1
Lrare_L3:
    s_mov_b32 s39, 2
    s_branch Lrareblk_1_1
Lrare_L5:
    s_mov_b32 s39, 3
    s_branch Lrareblk_1_1
Lrare_26:
    s_mov_b32 s39, 4
    s_branch Lrareblk_1_1
Lrare_28:
    s_mov_b32 s39, 5
    s_branch Lrareblk_1_1
Lrareblk_1_1:
    s_nop 7
    v_max3_f32 v249, v128, v129, v130
    v_max3_f32 v249, v249, v131, v132
    v_max3_f32 v249, v249, v133, v134
    v_max_f32 v249, v249, v135
    v_mov_b32 v245, v249
    s_nop 1
    v_permlane32_swap_b32 v249, v245
    v_max_f32 v249, v249, v245
    v_mov_b32 v245, v249
    s_nop 1
    v_permlane16_swap_b32 v249, v245
    v_max_f32 v249, v249, v245
    v_add_f32 v249, 0x40e00000, v249
    v_max_f32 v249, 0, v249
    v_sub_f32 v250, 0, v249
    v_exp_f32 v250, v250
    v_sub_f32 v128, v128, v249
    v_sub_f32 v129, v129, v249
    v_sub_f32 v130, v130, v249
    v_sub_f32 v131, v131, v249
    v_sub_f32 v132, v132, v249
    v_sub_f32 v133, v133, v249
    v_sub_f32 v134, v134, v249
    v_sub_f32 v135, v135, v249
    v_sub_f32 v96, v96, v249
    v_sub_f32 v97, v97, v249
    v_sub_f32 v98, v98, v249
    v_sub_f32 v99, v99, v249
    v_sub_f32 v100, v100, v249
    v_sub_f32 v101, v101, v249
    v_sub_f32 v102, v102, v249
    v_sub_f32 v103, v103, v249
    v_sub_f32 v192, v192, v249
    v_sub_f32 v193, v193, v249
    v_sub_f32 v194, v194, v249
    v_sub_f32 v195, v195, v249
    v_accvgpr_read_b32 v245, a0
    v_accvgpr_read_b32 v246, a1
    v_accvgpr_read_b32 v247, a2
    v_accvgpr_read_b32 v248, a3
    v_mul_f32 v245, v245, v250
    v_mul_f32 v246, v246, v250
    v_mul_f32 v247, v247, v250
    v_mul_f32 v248, v248, v250
    v_accvgpr_write_b32 a0, v245
    v_accvgpr_write_b32 a1, v246
    v_accvgpr_write_b32 a2, v247
    v_accvgpr_write_b32 a3, v248
    v_accvgpr_read_b32 v245, a4
    v_accvgpr_read_b32 v246, a5
    v_accvgpr_read_b32 v247, a6
    v_accvgpr_read_b32 v248, a7
    v_mul_f32 v245, v245, v250
    v_mul_f32 v246, v246, v250
    v_mul_f32 v247, v247, v250
    v_mul_f32 v248, v248, v250
    v_accvgpr_write_b32 a4, v245
    v_accvgpr_write_b32 a5, v246
    v_accvgpr_write_b32 a6, v247
    v_accvgpr_write_b32 a7, v248
    v_accvgpr_read_b32 v245, a32
    v_accvgpr_read_b32 v246, a33
    v_accvgpr_read_b32 v247, a34
    v_accvgpr_read_b32 v248, a35
    v_mul_f32 v245, v245, v250
    v_mul_f32 v246, v246, v250
    v_mul_f32 v247, v247, v250
    v_mul_f32 v248, v248, v250
    v_accvgpr_write_b32 a32, v245
    v_accvgpr_write_b32 a33, v246
    v_accvgpr_write_b32 a34, v247
    v_accvgpr_write_b32 a35, v248
    v_accvgpr_read_b32 v245, a36
    v_accvgpr_read_b32 v246, a37
    v_accvgpr_read_b32 v247, a38
    v_accvgpr_read_b32 v248, a39
    v_mul_f32 v245, v245, v250
    v_mul_f32 v246, v246, v250
    v_mul_f32 v247, v247, v250
    v_mul_f32 v248, v248, v250
    v_accvgpr_write_b32 a36, v245
    v_accvgpr_write_b32 a37, v246
    v_accvgpr_write_b32 a38, v247
    v_accvgpr_write_b32 a39, v248
    v_accvgpr_read_b32 v245, a64
    v_accvgpr_read_b32 v246, a65
    v_accvgpr_read_b32 v247, a66
    v_accvgpr_read_b32 v248, a67
    v_mul_f32 v245, v245, v250
    v_mul_f32 v246, v246, v250
    v_mul_f32 v247, v247, v250
    v_mul_f32 v248, v248, v250
    v_accvgpr_write_b32 a64, v245
    v_accvgpr_write_b32 a65, v246
    v_accvgpr_write_b32 a66, v247
    v_accvgpr_write_b32 a67, v248
    v_accvgpr_read_b32 v245, a68
    v_accvgpr_read_b32 v246, a69
    v_accvgpr_read_b32 v247, a70
    v_accvgpr_read_b32 v248, a71
    v_mul_f32 v245, v245, v250
    v_mul_f32 v246, v246, v250
    v_mul_f32 v247, v247, v250
    v_mul_f32 v248, v248, v250
    v_accvgpr_write_b32 a68, v245
    v_accvgpr_write_b32 a69, v246
    v_accvgpr_write_b32 a70, v247
    v_accvgpr_write_b32 a71, v248
    v_accvgpr_read_b32 v245, a96
    v_accvgpr_read_b32 v246, a97
    v_accvgpr_read_b32 v247, a98
    v_accvgpr_read_b32 v248, a99
    v_mul_f32 v245, v245, v250
    v_mul_f32 v246, v246, v250
    v_mul_f32 v247, v247, v250
    v_mul_f32 v248, v248, v250
    v_accvgpr_write_b32 a96, v245
    v_accvgpr_write_b32 a97, v246
    v_accvgpr_write_b32 a98, v247
    v_accvgpr_write_b32 a99, v248
    v_accvgpr_read_b32 v245, a100
    v_accvgpr_read_b32 v246, a101
    v_accvgpr_read_b32 v247, a102
    v_accvgpr_read_b32 v248, a103
    v_mul_f32 v245, v245, v250
    v_mul_f32 v246, v246, v250
    v_mul_f32 v247, v247, v250
    v_mul_f32 v248, v248, v250
    v_accvgpr_write_b32 a100, v245
    v_accvgpr_write_b32 a101, v246
    v_accvgpr_write_b32 a102, v247
    v_accvgpr_write_b32 a103, v248
    v_accvgpr_read_b32 v245, a128
    v_accvgpr_read_b32 v246, a129
    v_accvgpr_read_b32 v247, a130
    v_accvgpr_read_b32 v248, a131
    v_mul_f32 v245, v245, v250
    v_mul_f32 v246, v246, v250
    v_mul_f32 v247, v247, v250
    v_mul_f32 v248, v248, v250
    v_accvgpr_write_b32 a128, v245
    v_accvgpr_write_b32 a129, v246
    v_accvgpr_write_b32 a130, v247
    v_accvgpr_write_b32 a131, v248
    v_accvgpr_read_b32 v245, a132
    v_accvgpr_read_b32 v246, a133
    v_accvgpr_read_b32 v247, a134
    v_accvgpr_read_b32 v248, a135
    v_mul_f32 v245, v245, v250
    v_mul_f32 v246, v246, v250
    v_mul_f32 v247, v247, v250
    v_mul_f32 v248, v248, v250
    v_accvgpr_write_b32 a132, v245
    v_accvgpr_write_b32 a133, v246
    v_accvgpr_write_b32 a134, v247
    v_accvgpr_write_b32 a135, v248
    v_accvgpr_read_b32 v245, a160
    v_accvgpr_read_b32 v246, a161
    v_accvgpr_read_b32 v247, a162
    v_accvgpr_read_b32 v248, a163
    v_mul_f32 v245, v245, v250
    v_mul_f32 v246, v246, v250
    v_mul_f32 v247, v247, v250
    v_mul_f32 v248, v248, v250
    v_accvgpr_write_b32 a160, v245
    v_accvgpr_write_b32 a161, v246
    v_accvgpr_write_b32 a162, v247
    v_accvgpr_write_b32 a163, v248
    v_accvgpr_read_b32 v245, a164
    v_accvgpr_read_b32 v246, a165
    v_accvgpr_read_b32 v247, a166
    v_accvgpr_read_b32 v248, a167
    v_mul_f32 v245, v245, v250
    v_mul_f32 v246, v246, v250
    v_mul_f32 v247, v247, v250
    v_mul_f32 v248, v248, v250
    v_accvgpr_write_b32 a164, v245
    v_accvgpr_write_b32 a165, v246
    v_accvgpr_write_b32 a166, v247
    v_accvgpr_write_b32 a167, v248
    v_accvgpr_read_b32 v245, a192
    v_accvgpr_read_b32 v246, a193
    v_accvgpr_read_b32 v247, a194
    v_accvgpr_read_b32 v248, a195
    v_mul_f32 v245, v245, v250
    v_mul_f32 v246, v246, v250
    v_mul_f32 v247, v247, v250
    v_mul_f32 v248, v248, v250
    v_accvgpr_write_b32 a192, v245
    v_accvgpr_write_b32 a193, v246
    v_accvgpr_write_b32 a194, v247
    v_accvgpr_write_b32 a195, v248
    v_exp_f32 v245, v128
    v_exp_f32 v246, v129
    v_exp_f32 v247, v130
    v_cvt_pk_bf16_f32 v176, v245, v246
    v_exp_f32 v248, v131
    v_exp_f32 v245, v132
    v_exp_f32 v246, v133
    v_cvt_pk_bf16_f32 v177, v247, v248
    v_exp_f32 v247, v134
    v_cvt_pk_bf16_f32 v178, v245, v246
    v_exp_f32 v248, v135
    s_nop 0
    v_cvt_pk_bf16_f32 v179, v247, v248
    v_max3_f32 v249, v136, v137, v138
    v_max3_f32 v249, v249, v139, v140
    v_max3_f32 v249, v249, v141, v142
    v_max_f32 v249, v249, v143
    v_mov_b32 v245, v249
    s_nop 1
    v_permlane32_swap_b32 v249, v245
    v_max_f32 v249, v249, v245
    v_mov_b32 v245, v249
    s_nop 1
    v_permlane16_swap_b32 v249, v245
    v_max_f32 v249, v249, v245
    v_add_f32 v249, 0x40e00000, v249
    v_max_f32 v249, 0, v249
    v_sub_f32 v250, 0, v249
    v_exp_f32 v250, v250
    v_sub_f32 v136, v136, v249
    v_sub_f32 v137, v137, v249
    v_sub_f32 v138, v138, v249
    v_sub_f32 v139, v139, v249
    v_sub_f32 v140, v140, v249
    v_sub_f32 v141, v141, v249
    v_sub_f32 v142, v142, v249
    v_sub_f32 v143, v143, v249
    v_sub_f32 v104, v104, v249
    v_sub_f32 v105, v105, v249
    v_sub_f32 v106, v106, v249
    v_sub_f32 v107, v107, v249
    v_sub_f32 v108, v108, v249
    v_sub_f32 v109, v109, v249
    v_sub_f32 v110, v110, v249
    v_sub_f32 v111, v111, v249
    v_sub_f32 v196, v196, v249
    v_sub_f32 v197, v197, v249
    v_sub_f32 v198, v198, v249
    v_sub_f32 v199, v199, v249
    v_accvgpr_read_b32 v245, a8
    v_accvgpr_read_b32 v246, a9
    v_accvgpr_read_b32 v247, a10
    v_accvgpr_read_b32 v248, a11
    v_mul_f32 v245, v245, v250
    v_mul_f32 v246, v246, v250
    v_mul_f32 v247, v247, v250
    v_mul_f32 v248, v248, v250
    v_accvgpr_write_b32 a8, v245
    v_accvgpr_write_b32 a9, v246
    v_accvgpr_write_b32 a10, v247
    v_accvgpr_write_b32 a11, v248
    v_accvgpr_read_b32 v245, a12
    v_accvgpr_read_b32 v246, a13
    v_accvgpr_read_b32 v247, a14
    v_accvgpr_read_b32 v248, a15
    v_mul_f32 v245, v245, v250
    v_mul_f32 v246, v246, v250
    v_mul_f32 v247, v247, v250
    v_mul_f32 v248, v248, v250
    v_accvgpr_write_b32 a12, v245
    v_accvgpr_write_b32 a13, v246
    v_accvgpr_write_b32 a14, v247
    v_accvgpr_write_b32 a15, v248
    v_accvgpr_read_b32 v245, a40
    v_accvgpr_read_b32 v246, a41
    v_accvgpr_read_b32 v247, a42
    v_accvgpr_read_b32 v248, a43
    v_mul_f32 v245, v245, v250
    v_mul_f32 v246, v246, v250
    v_mul_f32 v247, v247, v250
    v_mul_f32 v248, v248, v250
    v_accvgpr_write_b32 a40, v245
    v_accvgpr_write_b32 a41, v246
    v_accvgpr_write_b32 a42, v247
    v_accvgpr_write_b32 a43, v248
    v_accvgpr_read_b32 v245, a44
    v_accvgpr_read_b32 v246, a45
    v_accvgpr_read_b32 v247, a46
    v_accvgpr_read_b32 v248, a47
    v_mul_f32 v245, v245, v250
    v_mul_f32 v246, v246, v250
    v_mul_f32 v247, v247, v250
    v_mul_f32 v248, v248, v250
    v_accvgpr_write_b32 a44, v245
    v_accvgpr_write_b32 a45, v246
    v_accvgpr_write_b32 a46, v247
    v_accvgpr_write_b32 a47, v248
    v_accvgpr_read_b32 v245, a72
    v_accvgpr_read_b32 v246, a73
    v_accvgpr_read_b32 v247, a74
    v_accvgpr_read_b32 v248, a75
    v_mul_f32 v245, v245, v250
    v_mul_f32 v246, v246, v250
    v_mul_f32 v247, v247, v250
    v_mul_f32 v248, v248, v250
    v_accvgpr_write_b32 a72, v245
    v_accvgpr_write_b32 a73, v246
    v_accvgpr_write_b32 a74, v247
    v_accvgpr_write_b32 a75, v248
    v_accvgpr_read_b32 v245, a76
    v_accvgpr_read_b32 v246, a77
    v_accvgpr_read_b32 v247, a78
    v_accvgpr_read_b32 v248, a79
    v_mul_f32 v245, v245, v250
    v_mul_f32 v246, v246, v250
    v_mul_f32 v247, v247, v250
    v_mul_f32 v248, v248, v250
    v_accvgpr_write_b32 a76, v245
    v_accvgpr_write_b32 a77, v246
    v_accvgpr_write_b32 a78, v247
    v_accvgpr_write_b32 a79, v248
    v_accvgpr_read_b32 v245, a104
    v_accvgpr_read_b32 v246, a105
    v_accvgpr_read_b32 v247, a106
    v_accvgpr_read_b32 v248, a107
    v_mul_f32 v245, v245, v250
    v_mul_f32 v246, v246, v250
    v_mul_f32 v247, v247, v250
    v_mul_f32 v248, v248, v250
    v_accvgpr_write_b32 a104, v245
    v_accvgpr_write_b32 a105, v246
    v_accvgpr_write_b32 a106, v247
    v_accvgpr_write_b32 a107, v248
    v_accvgpr_read_b32 v245, a108
    v_accvgpr_read_b32 v246, a109
    v_accvgpr_read_b32 v247, a110
    v_accvgpr_read_b32 v248, a111
    v_mul_f32 v245, v245, v250
    v_mul_f32 v246, v246, v250
    v_mul_f32 v247, v247, v250
    v_mul_f32 v248, v248, v250
    v_accvgpr_write_b32 a108, v245
    v_accvgpr_write_b32 a109, v246
    v_accvgpr_write_b32 a110, v247
    v_accvgpr_write_b32 a111, v248
    v_accvgpr_read_b32 v245, a136
    v_accvgpr_read_b32 v246, a137
    v_accvgpr_read_b32 v247, a138
    v_accvgpr_read_b32 v248, a139
    v_mul_f32 v245, v245, v250
    v_mul_f32 v246, v246, v250
    v_mul_f32 v247, v247, v250
    v_mul_f32 v248, v248, v250
    v_accvgpr_write_b32 a136, v245
    v_accvgpr_write_b32 a137, v246
    v_accvgpr_write_b32 a138, v247
    v_accvgpr_write_b32 a139, v248
    v_accvgpr_read_b32 v245, a140
    v_accvgpr_read_b32 v246, a141
    v_accvgpr_read_b32 v247, a142
    v_accvgpr_read_b32 v248, a143
    v_mul_f32 v245, v245, v250
    v_mul_f32 v246, v246, v250
    v_mul_f32 v247, v247, v250
    v_mul_f32 v248, v248, v250
    v_accvgpr_write_b32 a140, v245
    v_accvgpr_write_b32 a141, v246
    v_accvgpr_write_b32 a142, v247
    v_accvgpr_write_b32 a143, v248
    v_accvgpr_read_b32 v245, a168
    v_accvgpr_read_b32 v246, a169
    v_accvgpr_read_b32 v247, a170
    v_accvgpr_read_b32 v248, a171
    v_mul_f32 v245, v245, v250
    v_mul_f32 v246, v246, v250
    v_mul_f32 v247, v247, v250
    v_mul_f32 v248, v248, v250
    v_accvgpr_write_b32 a168, v245
    v_accvgpr_write_b32 a169, v246
    v_accvgpr_write_b32 a170, v247
    v_accvgpr_write_b32 a171, v248
    v_accvgpr_read_b32 v245, a172
    v_accvgpr_read_b32 v246, a173
    v_accvgpr_read_b32 v247, a174
    v_accvgpr_read_b32 v248, a175
    v_mul_f32 v245, v245, v250
    v_mul_f32 v246, v246, v250
    v_mul_f32 v247, v247, v250
    v_mul_f32 v248, v248, v250
    v_accvgpr_write_b32 a172, v245
    v_accvgpr_write_b32 a173, v246
    v_accvgpr_write_b32 a174, v247
    v_accvgpr_write_b32 a175, v248
    v_accvgpr_read_b32 v245, a196
    v_accvgpr_read_b32 v246, a197
    v_accvgpr_read_b32 v247, a198
    v_accvgpr_read_b32 v248, a199
    v_mul_f32 v245, v245, v250
    v_mul_f32 v246, v246, v250
    v_mul_f32 v247, v247, v250
    v_mul_f32 v248, v248, v250
    v_accvgpr_write_b32 a196, v245
    v_accvgpr_write_b32 a197, v246
    v_accvgpr_write_b32 a198, v247
    v_accvgpr_write_b32 a199, v248
    v_exp_f32 v245, v136
    v_exp_f32 v246, v137
    v_exp_f32 v247, v138
    v_cvt_pk_bf16_f32 v180, v245, v246
    v_exp_f32 v248, v139
    v_exp_f32 v245, v140
    v_exp_f32 v246, v141
    v_cvt_pk_bf16_f32 v181, v247, v248
    v_exp_f32 v247, v142
    v_cvt_pk_bf16_f32 v182, v245, v246
    v_exp_f32 v248, v143
    s_nop 0
    v_cvt_pk_bf16_f32 v183, v247, v248
    v_max3_f32 v249, v144, v145, v146
    v_max3_f32 v249, v249, v147, v148
    v_max3_f32 v249, v249, v149, v150
    v_max_f32 v249, v249, v151
    v_mov_b32 v245, v249
    s_nop 1
    v_permlane32_swap_b32 v249, v245
    v_max_f32 v249, v249, v245
    v_mov_b32 v245, v249
    s_nop 1
    v_permlane16_swap_b32 v249, v245
    v_max_f32 v249, v249, v245
    v_add_f32 v249, 0x40e00000, v249
    v_max_f32 v249, 0, v249
    v_sub_f32 v250, 0, v249
    v_exp_f32 v250, v250
    v_sub_f32 v144, v144, v249
    v_sub_f32 v145, v145, v249
    v_sub_f32 v146, v146, v249
    v_sub_f32 v147, v147, v249
    v_sub_f32 v148, v148, v249
    v_sub_f32 v149, v149, v249
    v_sub_f32 v150, v150, v249
    v_sub_f32 v151, v151, v249
    v_sub_f32 v112, v112, v249
    v_sub_f32 v113, v113, v249
    v_sub_f32 v114, v114, v249
    v_sub_f32 v115, v115, v249
    v_sub_f32 v116, v116, v249
    v_sub_f32 v117, v117, v249
    v_sub_f32 v118, v118, v249
    v_sub_f32 v119, v119, v249
    v_sub_f32 v200, v200, v249
    v_sub_f32 v201, v201, v249
    v_sub_f32 v202, v202, v249
    v_sub_f32 v203, v203, v249
    v_accvgpr_read_b32 v245, a16
    v_accvgpr_read_b32 v246, a17
    v_accvgpr_read_b32 v247, a18
    v_accvgpr_read_b32 v248, a19
    v_mul_f32 v245, v245, v250
    v_mul_f32 v246, v246, v250
    v_mul_f32 v247, v247, v250
    v_mul_f32 v248, v248, v250
    v_accvgpr_write_b32 a16, v245
    v_accvgpr_write_b32 a17, v246
    v_accvgpr_write_b32 a18, v247
    v_accvgpr_write_b32 a19, v248
    v_accvgpr_read_b32 v245, a20
    v_accvgpr_read_b32 v246, a21
    v_accvgpr_read_b32 v247, a22
    v_accvgpr_read_b32 v248, a23
    v_mul_f32 v245, v245, v250
    v_mul_f32 v246, v246, v250
    v_mul_f32 v247, v247, v250
    v_mul_f32 v248, v248, v250
    v_accvgpr_write_b32 a20, v245
    v_accvgpr_write_b32 a21, v246
    v_accvgpr_write_b32 a22, v247
    v_accvgpr_write_b32 a23, v248
    v_accvgpr_read_b32 v245, a48
    v_accvgpr_read_b32 v246, a49
    v_accvgpr_read_b32 v247, a50
    v_accvgpr_read_b32 v248, a51
    v_mul_f32 v245, v245, v250
    v_mul_f32 v246, v246, v250
    v_mul_f32 v247, v247, v250
    v_mul_f32 v248, v248, v250
    v_accvgpr_write_b32 a48, v245
    v_accvgpr_write_b32 a49, v246
    v_accvgpr_write_b32 a50, v247
    v_accvgpr_write_b32 a51, v248
    v_accvgpr_read_b32 v245, a52
    v_accvgpr_read_b32 v246, a53
    v_accvgpr_read_b32 v247, a54
    v_accvgpr_read_b32 v248, a55
    v_mul_f32 v245, v245, v250
    v_mul_f32 v246, v246, v250
    v_mul_f32 v247, v247, v250
    v_mul_f32 v248, v248, v250
    v_accvgpr_write_b32 a52, v245
    v_accvgpr_write_b32 a53, v246
    v_accvgpr_write_b32 a54, v247
    v_accvgpr_write_b32 a55, v248
    v_accvgpr_read_b32 v245, a80
    v_accvgpr_read_b32 v246, a81
    v_accvgpr_read_b32 v247, a82
    v_accvgpr_read_b32 v248, a83
    v_mul_f32 v245, v245, v250
    v_mul_f32 v246, v246, v250
    v_mul_f32 v247, v247, v250
    v_mul_f32 v248, v248, v250
    v_accvgpr_write_b32 a80, v245
    v_accvgpr_write_b32 a81, v246
    v_accvgpr_write_b32 a82, v247
    v_accvgpr_write_b32 a83, v248
    v_accvgpr_read_b32 v245, a84
    v_accvgpr_read_b32 v246, a85
    v_accvgpr_read_b32 v247, a86
    v_accvgpr_read_b32 v248, a87
    v_mul_f32 v245, v245, v250
    v_mul_f32 v246, v246, v250
    v_mul_f32 v247, v247, v250
    v_mul_f32 v248, v248, v250
    v_accvgpr_write_b32 a84, v245
    v_accvgpr_write_b32 a85, v246
    v_accvgpr_write_b32 a86, v247
    v_accvgpr_write_b32 a87, v248
    v_accvgpr_read_b32 v245, a112
    v_accvgpr_read_b32 v246, a113
    v_accvgpr_read_b32 v247, a114
    v_accvgpr_read_b32 v248, a115
    v_mul_f32 v245, v245, v250
    v_mul_f32 v246, v246, v250
    v_mul_f32 v247, v247, v250
    v_mul_f32 v248, v248, v250
    v_accvgpr_write_b32 a112, v245
    v_accvgpr_write_b32 a113, v246
    v_accvgpr_write_b32 a114, v247
    v_accvgpr_write_b32 a115, v248
    v_accvgpr_read_b32 v245, a116
    v_accvgpr_read_b32 v246, a117
    v_accvgpr_read_b32 v247, a118
    v_accvgpr_read_b32 v248, a119
    v_mul_f32 v245, v245, v250
    v_mul_f32 v246, v246, v250
    v_mul_f32 v247, v247, v250
    v_mul_f32 v248, v248, v250
    v_accvgpr_write_b32 a116, v245
    v_accvgpr_write_b32 a117, v246
    v_accvgpr_write_b32 a118, v247
    v_accvgpr_write_b32 a119, v248
    v_accvgpr_read_b32 v245, a144
    v_accvgpr_read_b32 v246, a145
    v_accvgpr_read_b32 v247, a146
    v_accvgpr_read_b32 v248, a147
    v_mul_f32 v245, v245, v250
    v_mul_f32 v246, v246, v250
    v_mul_f32 v247, v247, v250
    v_mul_f32 v248, v248, v250
    v_accvgpr_write_b32 a144, v245
    v_accvgpr_write_b32 a145, v246
    v_accvgpr_write_b32 a146, v247
    v_accvgpr_write_b32 a147, v248
    v_accvgpr_read_b32 v245, a148
    v_accvgpr_read_b32 v246, a149
    v_accvgpr_read_b32 v247, a150
    v_accvgpr_read_b32 v248, a151
    v_mul_f32 v245, v245, v250
    v_mul_f32 v246, v246, v250
    v_mul_f32 v247, v247, v250
    v_mul_f32 v248, v248, v250
    v_accvgpr_write_b32 a148, v245
    v_accvgpr_write_b32 a149, v246
    v_accvgpr_write_b32 a150, v247
    v_accvgpr_write_b32 a151, v248
    v_accvgpr_read_b32 v245, a176
    v_accvgpr_read_b32 v246, a177
    v_accvgpr_read_b32 v247, a178
    v_accvgpr_read_b32 v248, a179
    v_mul_f32 v245, v245, v250
    v_mul_f32 v246, v246, v250
    v_mul_f32 v247, v247, v250
    v_mul_f32 v248, v248, v250
    v_accvgpr_write_b32 a176, v245
    v_accvgpr_write_b32 a177, v246
    v_accvgpr_write_b32 a178, v247
    v_accvgpr_write_b32 a179, v248
    v_accvgpr_read_b32 v245, a180
    v_accvgpr_read_b32 v246, a181
    v_accvgpr_read_b32 v247, a182
    v_accvgpr_read_b32 v248, a183
    v_mul_f32 v245, v245, v250
    v_mul_f32 v246, v246, v250
    v_mul_f32 v247, v247, v250
    v_mul_f32 v248, v248, v250
    v_accvgpr_write_b32 a180, v245
    v_accvgpr_write_b32 a181, v246
    v_accvgpr_write_b32 a182, v247
    v_accvgpr_write_b32 a183, v248
    v_accvgpr_read_b32 v245, a200
    v_accvgpr_read_b32 v246, a201
    v_accvgpr_read_b32 v247, a202
    v_accvgpr_read_b32 v248, a203
    v_mul_f32 v245, v245, v250
    v_mul_f32 v246, v246, v250
    v_mul_f32 v247, v247, v250
    v_mul_f32 v248, v248, v250
    v_accvgpr_write_b32 a200, v245
    v_accvgpr_write_b32 a201, v246
    v_accvgpr_write_b32 a202, v247
    v_accvgpr_write_b32 a203, v248
    v_exp_f32 v245, v144
    v_exp_f32 v246, v145
    v_exp_f32 v247, v146
    v_cvt_pk_bf16_f32 v184, v245, v246
    v_exp_f32 v248, v147
    v_exp_f32 v245, v148
    v_exp_f32 v246, v149
    v_cvt_pk_bf16_f32 v185, v247, v248
    v_exp_f32 v247, v150
    v_cvt_pk_bf16_f32 v186, v245, v246
    v_exp_f32 v248, v151
    s_nop 0
    v_cvt_pk_bf16_f32 v187, v247, v248
    v_max3_f32 v249, v152, v153, v154
    v_max3_f32 v249, v249, v155, v156
    v_max3_f32 v249, v249, v157, v158
    v_max_f32 v249, v249, v159
    v_mov_b32 v245, v249
    s_nop 1
    v_permlane32_swap_b32 v249, v245
    v_max_f32 v249, v249, v245
    v_mov_b32 v245, v249
    s_nop 1
    v_permlane16_swap_b32 v249, v245
    v_max_f32 v249, v249, v245
    v_add_f32 v249, 0x40e00000, v249
    v_max_f32 v249, 0, v249
    v_sub_f32 v250, 0, v249
    v_exp_f32 v250, v250
    v_sub_f32 v152, v152, v249
    v_sub_f32 v153, v153, v249
    v_sub_f32 v154, v154, v249
    v_sub_f32 v155, v155, v249
    v_sub_f32 v156, v156, v249
    v_sub_f32 v157, v157, v249
    v_sub_f32 v158, v158, v249
    v_sub_f32 v159, v159, v249
    v_sub_f32 v120, v120, v249
    v_sub_f32 v121, v121, v249
    v_sub_f32 v122, v122, v249
    v_sub_f32 v123, v123, v249
    v_sub_f32 v124, v124, v249
    v_sub_f32 v125, v125, v249
    v_sub_f32 v126, v126, v249
    v_sub_f32 v127, v127, v249
    v_sub_f32 v204, v204, v249
    v_sub_f32 v205, v205, v249
    v_sub_f32 v206, v206, v249
    v_sub_f32 v207, v207, v249
    v_accvgpr_read_b32 v245, a24
    v_accvgpr_read_b32 v246, a25
    v_accvgpr_read_b32 v247, a26
    v_accvgpr_read_b32 v248, a27
    v_mul_f32 v245, v245, v250
    v_mul_f32 v246, v246, v250
    v_mul_f32 v247, v247, v250
    v_mul_f32 v248, v248, v250
    v_accvgpr_write_b32 a24, v245
    v_accvgpr_write_b32 a25, v246
    v_accvgpr_write_b32 a26, v247
    v_accvgpr_write_b32 a27, v248
    v_accvgpr_read_b32 v245, a28
    v_accvgpr_read_b32 v246, a29
    v_accvgpr_read_b32 v247, a30
    v_accvgpr_read_b32 v248, a31
    v_mul_f32 v245, v245, v250
    v_mul_f32 v246, v246, v250
    v_mul_f32 v247, v247, v250
    v_mul_f32 v248, v248, v250
    v_accvgpr_write_b32 a28, v245
    v_accvgpr_write_b32 a29, v246
    v_accvgpr_write_b32 a30, v247
    v_accvgpr_write_b32 a31, v248
    v_accvgpr_read_b32 v245, a56
    v_accvgpr_read_b32 v246, a57
    v_accvgpr_read_b32 v247, a58
    v_accvgpr_read_b32 v248, a59
    v_mul_f32 v245, v245, v250
    v_mul_f32 v246, v246, v250
    v_mul_f32 v247, v247, v250
    v_mul_f32 v248, v248, v250
    v_accvgpr_write_b32 a56, v245
    v_accvgpr_write_b32 a57, v246
    v_accvgpr_write_b32 a58, v247
    v_accvgpr_write_b32 a59, v248
    v_accvgpr_read_b32 v245, a60
    v_accvgpr_read_b32 v246, a61
    v_accvgpr_read_b32 v247, a62
    v_accvgpr_read_b32 v248, a63
    v_mul_f32 v245, v245, v250
    v_mul_f32 v246, v246, v250
    v_mul_f32 v247, v247, v250
    v_mul_f32 v248, v248, v250
    v_accvgpr_write_b32 a60, v245
    v_accvgpr_write_b32 a61, v246
    v_accvgpr_write_b32 a62, v247
    v_accvgpr_write_b32 a63, v248
    v_accvgpr_read_b32 v245, a88
    v_accvgpr_read_b32 v246, a89
    v_accvgpr_read_b32 v247, a90
    v_accvgpr_read_b32 v248, a91
    v_mul_f32 v245, v245, v250
    v_mul_f32 v246, v246, v250
    v_mul_f32 v247, v247, v250
    v_mul_f32 v248, v248, v250
    v_accvgpr_write_b32 a88, v245
    v_accvgpr_write_b32 a89, v246
    v_accvgpr_write_b32 a90, v247
    v_accvgpr_write_b32 a91, v248
    v_accvgpr_read_b32 v245, a92
    v_accvgpr_read_b32 v246, a93
    v_accvgpr_read_b32 v247, a94
    v_accvgpr_read_b32 v248, a95
    v_mul_f32 v245, v245, v250
    v_mul_f32 v246, v246, v250
    v_mul_f32 v247, v247, v250
    v_mul_f32 v248, v248, v250
    v_accvgpr_write_b32 a92, v245
    v_accvgpr_write_b32 a93, v246
    v_accvgpr_write_b32 a94, v247
    v_accvgpr_write_b32 a95, v248
    v_accvgpr_read_b32 v245, a120
    v_accvgpr_read_b32 v246, a121
    v_accvgpr_read_b32 v247, a122
    v_accvgpr_read_b32 v248, a123
    v_mul_f32 v245, v245, v250
    v_mul_f32 v246, v246, v250
    v_mul_f32 v247, v247, v250
    v_mul_f32 v248, v248, v250
    v_accvgpr_write_b32 a120, v245
    v_accvgpr_write_b32 a121, v246
    v_accvgpr_write_b32 a122, v247
    v_accvgpr_write_b32 a123, v248
    v_accvgpr_read_b32 v245, a124
    v_accvgpr_read_b32 v246, a125
    v_accvgpr_read_b32 v247, a126
    v_accvgpr_read_b32 v248, a127
    v_mul_f32 v245, v245, v250
    v_mul_f32 v246, v246, v250
    v_mul_f32 v247, v247, v250
    v_mul_f32 v248, v248, v250
    v_accvgpr_write_b32 a124, v245
    v_accvgpr_write_b32 a125, v246
    v_accvgpr_write_b32 a126, v247
    v_accvgpr_write_b32 a127, v248
    v_accvgpr_read_b32 v245, a152
    v_accvgpr_read_b32 v246, a153
    v_accvgpr_read_b32 v247, a154
    v_accvgpr_read_b32 v248, a155
    v_mul_f32 v245, v245, v250
    v_mul_f32 v246, v246, v250
    v_mul_f32 v247, v247, v250
    v_mul_f32 v248, v248, v250
    v_accvgpr_write_b32 a152, v245
    v_accvgpr_write_b32 a153, v246
    v_accvgpr_write_b32 a154, v247
    v_accvgpr_write_b32 a155, v248
    v_accvgpr_read_b32 v245, a156
    v_accvgpr_read_b32 v246, a157
    v_accvgpr_read_b32 v247, a158
    v_accvgpr_read_b32 v248, a159
    v_mul_f32 v245, v245, v250
    v_mul_f32 v246, v246, v250
    v_mul_f32 v247, v247, v250
    v_mul_f32 v248, v248, v250
    v_accvgpr_write_b32 a156, v245
    v_accvgpr_write_b32 a157, v246
    v_accvgpr_write_b32 a158, v247
    v_accvgpr_write_b32 a159, v248
    v_accvgpr_read_b32 v245, a184
    v_accvgpr_read_b32 v246, a185
    v_accvgpr_read_b32 v247, a186
    v_accvgpr_read_b32 v248, a187
    v_mul_f32 v245, v245, v250
    v_mul_f32 v246, v246, v250
    v_mul_f32 v247, v247, v250
    v_mul_f32 v248, v248, v250
    v_accvgpr_write_b32 a184, v245
    v_accvgpr_write_b32 a185, v246
    v_accvgpr_write_b32 a186, v247
    v_accvgpr_write_b32 a187, v248
    v_accvgpr_read_b32 v245, a188
    v_accvgpr_read_b32 v246, a189
    v_accvgpr_read_b32 v247, a190
    v_accvgpr_read_b32 v248, a191
    v_mul_f32 v245, v245, v250
    v_mul_f32 v246, v246, v250
    v_mul_f32 v247, v247, v250
    v_mul_f32 v248, v248, v250
    v_accvgpr_write_b32 a188, v245
    v_accvgpr_write_b32 a189, v246
    v_accvgpr_write_b32 a190, v247
    v_accvgpr_write_b32 a191, v248
    v_accvgpr_read_b32 v245, a204
    v_accvgpr_read_b32 v246, a205
    v_accvgpr_read_b32 v247, a206
    v_accvgpr_read_b32 v248, a207
    v_mul_f32 v245, v245, v250
    v_mul_f32 v246, v246, v250
    v_mul_f32 v247, v247, v250
    v_mul_f32 v248, v248, v250
    v_accvgpr_write_b32 a204, v245
    v_accvgpr_write_b32 a205, v246
    v_accvgpr_write_b32 a206, v247
    v_accvgpr_write_b32 a207, v248
    v_exp_f32 v245, v152
    v_exp_f32 v246, v153
    v_exp_f32 v247, v154
    v_cvt_pk_bf16_f32 v188, v245, v246
    v_exp_f32 v248, v155
    v_exp_f32 v245, v156
    v_exp_f32 v246, v157
    v_cvt_pk_bf16_f32 v189, v247, v248
    v_exp_f32 v247, v158
    v_cvt_pk_bf16_f32 v190, v245, v246
    v_exp_f32 v248, v159
    s_nop 0
    v_cvt_pk_bf16_f32 v191, v247, v248
    s_cmp_eq_u32 s39, 0
    s_cbranch_scc1 Lrare_0_back
    s_cmp_eq_u32 s39, 1
    s_cbranch_scc1 Lrare_L1_back
    s_cmp_eq_u32 s39, 2
    s_cbranch_scc1 Lrare_L3_back
    s_cmp_eq_u32 s39, 3
    s_cbranch_scc1 Lrare_L5_back
    s_cmp_eq_u32 s39, 4
    s_cbranch_scc1 Lrare_26_back
    s_branch Lrare_28_back
Lrare_L0:
    s_mov_b32 s39, 0
    s_branch Lrareblk_0_1
Lrare_L2:
    s_mov_b32 s39, 1
    s_branch Lrareblk_0_1
Lrare_L4:
    s_mov_b32 s39, 2
    s_branch Lrareblk_0_1
Lrare_25:
    s_mov_b32 s39, 3
    s_branch Lrareblk_0_1
Lrare_27:
    s_mov_b32 s39, 4
    s_branch Lrareblk_0_1
Lrare_29:
    s_mov_b32 s39, 5
    s_branch Lrareblk_0_1
Lrareblk_0_1:
    s_nop 7
    v_max3_f32 v249, v96, v97, v98
    v_max3_f32 v249, v249, v99, v100
    v_max3_f32 v249, v249, v101, v102
    v_max_f32 v249, v249, v103
    v_mov_b32 v245, v249
    s_nop 1
    v_permlane32_swap_b32 v249, v245
    v_max_f32 v249, v249, v245
    v_mov_b32 v245, v249
    s_nop 1
    v_permlane16_swap_b32 v249, v245
    v_max_f32 v249, v249, v245
    v_add_f32 v249, 0x40e00000, v249
    v_max_f32 v249, 0, v249
    v_sub_f32 v250, 0, v249
    v_exp_f32 v250, v250
    v_sub_f32 v96, v96, v249
    v_sub_f32 v97, v97, v249
    v_sub_f32 v98, v98, v249
    v_sub_f32 v99, v99, v249
    v_sub_f32 v100, v100, v249
    v_sub_f32 v101, v101, v249
    v_sub_f32 v102, v102, v249
    v_sub_f32 v103, v103, v249
    v_sub_f32 v128, v128, v249
    v_sub_f32 v129, v129, v249
    v_sub_f32 v130, v130, v249
    v_sub_f32 v131, v131, v249
    v_sub_f32 v132, v132, v249
    v_sub_f32 v133, v133, v249
    v_sub_f32 v134, v134, v249
    v_sub_f32 v135, v135, v249
    v_sub_f32 v192, v192, v249
    v_sub_f32 v193, v193, v249
    v_sub_f32 v194, v194, v249
    v_sub_f32 v195, v195, v249
    v_accvgpr_read_b32 v245, a0
    v_accvgpr_read_b32 v246, a1
    v_accvgpr_read_b32 v247, a2
    v_accvgpr_read_b32 v248, a3
    v_mul_f32 v245, v245, v250
    v_mul_f32 v246, v246, v250
    v_mul_f32 v247, v247, v250
    v_mul_f32 v248, v248, v250
    v_accvgpr_write_b32 a0, v245
    v_accvgpr_write_b32 a1, v246
    v_accvgpr_write_b32 a2, v247
    v_accvgpr_write_b32 a3, v248
    v_accvgpr_read_b32 v245, a4
    v_accvgpr_read_b32 v246, a5
    v_accvgpr_read_b32 v247, a6
    v_accvgpr_read_b32 v248, a7
    v_mul_f32 v245, v245, v250
    v_mul_f32 v246, v246, v250
    v_mul_f32 v247, v247, v250
    v_mul_f32 v248, v248, v250
    v_accvgpr_write_b32 a4, v245
    v_accvgpr_write_b32 a5, v246
    v_accvgpr_write_b32 a6, v247
    v_accvgpr_write_b32 a7, v248
    v_accvgpr_read_b32 v245, a32
    v_accvgpr_read_b32 v246, a33
    v_accvgpr_read_b32 v247, a34
    v_accvgpr_read_b32 v248, a35
    v_mul_f32 v245, v245, v250
    v_mul_f32 v246, v246, v250
    v_mul_f32 v247, v247, v250
    v_mul_f32 v248, v248, v250
    v_accvgpr_write_b32 a32, v245
    v_accvgpr_write_b32 a33, v246
    v_accvgpr_write_b32 a34, v247
    v_accvgpr_write_b32 a35, v248
    v_accvgpr_read_b32 v245, a36
    v_accvgpr_read_b32 v246, a37
    v_accvgpr_read_b32 v247, a38
    v_accvgpr_read_b32 v248, a39
    v_mul_f32 v245, v245, v250
    v_mul_f32 v246, v246, v250
    v_mul_f32 v247, v247, v250
    v_mul_f32 v248, v248, v250
    v_accvgpr_write_b32 a36, v245
    v_accvgpr_write_b32 a37, v246
    v_accvgpr_write_b32 a38, v247
    v_accvgpr_write_b32 a39, v248
    v_accvgpr_read_b32 v245, a64
    v_accvgpr_read_b32 v246, a65
    v_accvgpr_read_b32 v247, a66
    v_accvgpr_read_b32 v248, a67
    v_mul_f32 v245, v245, v250
    v_mul_f32 v246, v246, v250
    v_mul_f32 v247, v247, v250
    v_mul_f32 v248, v248, v250
    v_accvgpr_write_b32 a64, v245
    v_accvgpr_write_b32 a65, v246
    v_accvgpr_write_b32 a66, v247
    v_accvgpr_write_b32 a67, v248
    v_accvgpr_read_b32 v245, a68
    v_accvgpr_read_b32 v246, a69
    v_accvgpr_read_b32 v247, a70
    v_accvgpr_read_b32 v248, a71
    v_mul_f32 v245, v245, v250
    v_mul_f32 v246, v246, v250
    v_mul_f32 v247, v247, v250
    v_mul_f32 v248, v248, v250
    v_accvgpr_write_b32 a68, v245
    v_accvgpr_write_b32 a69, v246
    v_accvgpr_write_b32 a70, v247
    v_accvgpr_write_b32 a71, v248
    v_accvgpr_read_b32 v245, a96
    v_accvgpr_read_b32 v246, a97
    v_accvgpr_read_b32 v247, a98
    v_accvgpr_read_b32 v248, a99
    v_mul_f32 v245, v245, v250
    v_mul_f32 v246, v246, v250
    v_mul_f32 v247, v247, v250
    v_mul_f32 v248, v248, v250
    v_accvgpr_write_b32 a96, v245
    v_accvgpr_write_b32 a97, v246
    v_accvgpr_write_b32 a98, v247
    v_accvgpr_write_b32 a99, v248
    v_accvgpr_read_b32 v245, a100
    v_accvgpr_read_b32 v246, a101
    v_accvgpr_read_b32 v247, a102
    v_accvgpr_read_b32 v248, a103
    v_mul_f32 v245, v245, v250
    v_mul_f32 v246, v246, v250
    v_mul_f32 v247, v247, v250
    v_mul_f32 v248, v248, v250
    v_accvgpr_write_b32 a100, v245
    v_accvgpr_write_b32 a101, v246
    v_accvgpr_write_b32 a102, v247
    v_accvgpr_write_b32 a103, v248
    v_accvgpr_read_b32 v245, a128
    v_accvgpr_read_b32 v246, a129
    v_accvgpr_read_b32 v247, a130
    v_accvgpr_read_b32 v248, a131
    v_mul_f32 v245, v245, v250
    v_mul_f32 v246, v246, v250
    v_mul_f32 v247, v247, v250
    v_mul_f32 v248, v248, v250
    v_accvgpr_write_b32 a128, v245
    v_accvgpr_write_b32 a129, v246
    v_accvgpr_write_b32 a130, v247
    v_accvgpr_write_b32 a131, v248
    v_accvgpr_read_b32 v245, a132
    v_accvgpr_read_b32 v246, a133
    v_accvgpr_read_b32 v247, a134
    v_accvgpr_read_b32 v248, a135
    v_mul_f32 v245, v245, v250
    v_mul_f32 v246, v246, v250
    v_mul_f32 v247, v247, v250
    v_mul_f32 v248, v248, v250
    v_accvgpr_write_b32 a132, v245
    v_accvgpr_write_b32 a133, v246
    v_accvgpr_write_b32 a134, v247
    v_accvgpr_write_b32 a135, v248
    v_accvgpr_read_b32 v245, a160
    v_accvgpr_read_b32 v246, a161
    v_accvgpr_read_b32 v247, a162
    v_accvgpr_read_b32 v248, a163
    v_mul_f32 v245, v245, v250
    v_mul_f32 v246, v246, v250
    v_mul_f32 v247, v247, v250
    v_mul_f32 v248, v248, v250
    v_accvgpr_write_b32 a160, v245
    v_accvgpr_write_b32 a161, v246
    v_accvgpr_write_b32 a162, v247
    v_accvgpr_write_b32 a163, v248
    v_accvgpr_read_b32 v245, a164
    v_accvgpr_read_b32 v246, a165
    v_accvgpr_read_b32 v247, a166
    v_accvgpr_read_b32 v248, a167
    v_mul_f32 v245, v245, v250
    v_mul_f32 v246, v246, v250
    v_mul_f32 v247, v247, v250
    v_mul_f32 v248, v248, v250
    v_accvgpr_write_b32 a164, v245
    v_accvgpr_write_b32 a165, v246
    v_accvgpr_write_b32 a166, v247
    v_accvgpr_write_b32 a167, v248
    v_accvgpr_read_b32 v245, a192
    v_accvgpr_read_b32 v246, a193
    v_accvgpr_read_b32 v247, a194
    v_accvgpr_read_b32 v248, a195
    v_mul_f32 v245, v245, v250
    v_mul_f32 v246, v246, v250
    v_mul_f32 v247, v247, v250
    v_mul_f32 v248, v248, v250
    v_accvgpr_write_b32 a192, v245
    v_accvgpr_write_b32 a193, v246
    v_accvgpr_write_b32 a194, v247
    v_accvgpr_write_b32 a195, v248
    v_exp_f32 v245, v96
    v_exp_f32 v246, v97
    v_exp_f32 v247, v98
    v_cvt_pk_bf16_f32 v160, v245, v246
    v_exp_f32 v248, v99
    v_exp_f32 v245, v100
    v_exp_f32 v246, v101
    v_cvt_pk_bf16_f32 v161, v247, v248
    v_exp_f32 v247, v102
    v_cvt_pk_bf16_f32 v162, v245, v246
    v_exp_f32 v248, v103
    s_nop 0
    v_cvt_pk_bf16_f32 v163, v247, v248
    v_max3_f32 v249, v104, v105, v106
    v_max3_f32 v249, v249, v107, v108
    v_max3_f32 v249, v249, v109, v110
    v_max_f32 v249, v249, v111
    v_mov_b32 v245, v249
    s_nop 1
    v_permlane32_swap_b32 v249, v245
    v_max_f32 v249, v249, v245
    v_mov_b32 v245, v249
    s_nop 1
    v_permlane16_swap_b32 v249, v245
    v_max_f32 v249, v249, v245
    v_add_f32 v249, 0x40e00000, v249
    v_max_f32 v249, 0, v249
    v_sub_f32 v250, 0, v249
    v_exp_f32 v250, v250
    v_sub_f32 v104, v104, v249
    v_sub_f32 v105, v105, v249
    v_sub_f32 v106, v106, v249
    v_sub_f32 v107, v107, v249
    v_sub_f32 v108, v108, v249
    v_sub_f32 v109, v109, v249
    v_sub_f32 v110, v110, v249
    v_sub_f32 v111, v111, v249
    v_sub_f32 v136, v136, v249
    v_sub_f32 v137, v137, v249
    v_sub_f32 v138, v138, v249
    v_sub_f32 v139, v139, v249
    v_sub_f32 v140, v140, v249
    v_sub_f32 v141, v141, v249
    v_sub_f32 v142, v142, v249
    v_sub_f32 v143, v143, v249
    v_sub_f32 v196, v196, v249
    v_sub_f32 v197, v197, v249
    v_sub_f32 v198, v198, v249
    v_sub_f32 v199, v199, v249
    v_accvgpr_read_b32 v245, a8
    v_accvgpr_read_b32 v246, a9
    v_accvgpr_read_b32 v247, a10
    v_accvgpr_read_b32 v248, a11
    v_mul_f32 v245, v245, v250
    v_mul_f32 v246, v246, v250
    v_mul_f32 v247, v247, v250
    v_mul_f32 v248, v248, v250
    v_accvgpr_write_b32 a8, v245
    v_accvgpr_write_b32 a9, v246
    v_accvgpr_write_b32 a10, v247
    v_accvgpr_write_b32 a11, v248
    v_accvgpr_read_b32 v245, a12
    v_accvgpr_read_b32 v246, a13
    v_accvgpr_read_b32 v247, a14
    v_accvgpr_read_b32 v248, a15
    v_mul_f32 v245, v245, v250
    v_mul_f32 v246, v246, v250
    v_mul_f32 v247, v247, v250
    v_mul_f32 v248, v248, v250
    v_accvgpr_write_b32 a12, v245
    v_accvgpr_write_b32 a13, v246
    v_accvgpr_write_b32 a14, v247
    v_accvgpr_write_b32 a15, v248
    v_accvgpr_read_b32 v245, a40
    v_accvgpr_read_b32 v246, a41
    v_accvgpr_read_b32 v247, a42
    v_accvgpr_read_b32 v248, a43
    v_mul_f32 v245, v245, v250
    v_mul_f32 v246, v246, v250
    v_mul_f32 v247, v247, v250
    v_mul_f32 v248, v248, v250
    v_accvgpr_write_b32 a40, v245
    v_accvgpr_write_b32 a41, v246
    v_accvgpr_write_b32 a42, v247
    v_accvgpr_write_b32 a43, v248
    v_accvgpr_read_b32 v245, a44
    v_accvgpr_read_b32 v246, a45
    v_accvgpr_read_b32 v247, a46
    v_accvgpr_read_b32 v248, a47
    v_mul_f32 v245, v245, v250
    v_mul_f32 v246, v246, v250
    v_mul_f32 v247, v247, v250
    v_mul_f32 v248, v248, v250
    v_accvgpr_write_b32 a44, v245
    v_accvgpr_write_b32 a45, v246
    v_accvgpr_write_b32 a46, v247
    v_accvgpr_write_b32 a47, v248
    v_accvgpr_read_b32 v245, a72
    v_accvgpr_read_b32 v246, a73
    v_accvgpr_read_b32 v247, a74
    v_accvgpr_read_b32 v248, a75
    v_mul_f32 v245, v245, v250
    v_mul_f32 v246, v246, v250
    v_mul_f32 v247, v247, v250
    v_mul_f32 v248, v248, v250
    v_accvgpr_write_b32 a72, v245
    v_accvgpr_write_b32 a73, v246
    v_accvgpr_write_b32 a74, v247
    v_accvgpr_write_b32 a75, v248
    v_accvgpr_read_b32 v245, a76
    v_accvgpr_read_b32 v246, a77
    v_accvgpr_read_b32 v247, a78
    v_accvgpr_read_b32 v248, a79
    v_mul_f32 v245, v245, v250
    v_mul_f32 v246, v246, v250
    v_mul_f32 v247, v247, v250
    v_mul_f32 v248, v248, v250
    v_accvgpr_write_b32 a76, v245
    v_accvgpr_write_b32 a77, v246
    v_accvgpr_write_b32 a78, v247
    v_accvgpr_write_b32 a79, v248
    v_accvgpr_read_b32 v245, a104
    v_accvgpr_read_b32 v246, a105
    v_accvgpr_read_b32 v247, a106
    v_accvgpr_read_b32 v248, a107
    v_mul_f32 v245, v245, v250
    v_mul_f32 v246, v246, v250
    v_mul_f32 v247, v247, v250
    v_mul_f32 v248, v248, v250
    v_accvgpr_write_b32 a104, v245
    v_accvgpr_write_b32 a105, v246
    v_accvgpr_write_b32 a106, v247
    v_accvgpr_write_b32 a107, v248
    v_accvgpr_read_b32 v245, a108
    v_accvgpr_read_b32 v246, a109
    v_accvgpr_read_b32 v247, a110
    v_accvgpr_read_b32 v248, a111
    v_mul_f32 v245, v245, v250
    v_mul_f32 v246, v246, v250
    v_mul_f32 v247, v247, v250
    v_mul_f32 v248, v248, v250
    v_accvgpr_write_b32 a108, v245
    v_accvgpr_write_b32 a109, v246
    v_accvgpr_write_b32 a110, v247
    v_accvgpr_write_b32 a111, v248
    v_accvgpr_read_b32 v245, a136
    v_accvgpr_read_b32 v246, a137
    v_accvgpr_read_b32 v247, a138
    v_accvgpr_read_b32 v248, a139
    v_mul_f32 v245, v245, v250
    v_mul_f32 v246, v246, v250
    v_mul_f32 v247, v247, v250
    v_mul_f32 v248, v248, v250
    v_accvgpr_write_b32 a136, v245
    v_accvgpr_write_b32 a137, v246
    v_accvgpr_write_b32 a138, v247
    v_accvgpr_write_b32 a139, v248
    v_accvgpr_read_b32 v245, a140
    v_accvgpr_read_b32 v246, a141
    v_accvgpr_read_b32 v247, a142
    v_accvgpr_read_b32 v248, a143
    v_mul_f32 v245, v245, v250
    v_mul_f32 v246, v246, v250
    v_mul_f32 v247, v247, v250
    v_mul_f32 v248, v248, v250
    v_accvgpr_write_b32 a140, v245
    v_accvgpr_write_b32 a141, v246
    v_accvgpr_write_b32 a142, v247
    v_accvgpr_write_b32 a143, v248
    v_accvgpr_read_b32 v245, a168
    v_accvgpr_read_b32 v246, a169
    v_accvgpr_read_b32 v247, a170
    v_accvgpr_read_b32 v248, a171
    v_mul_f32 v245, v245, v250
    v_mul_f32 v246, v246, v250
    v_mul_f32 v247, v247, v250
    v_mul_f32 v248, v248, v250
    v_accvgpr_write_b32 a168, v245
    v_accvgpr_write_b32 a169, v246
    v_accvgpr_write_b32 a170, v247
    v_accvgpr_write_b32 a171, v248
    v_accvgpr_read_b32 v245, a172
    v_accvgpr_read_b32 v246, a173
    v_accvgpr_read_b32 v247, a174
    v_accvgpr_read_b32 v248, a175
    v_mul_f32 v245, v245, v250
    v_mul_f32 v246, v246, v250
    v_mul_f32 v247, v247, v250
    v_mul_f32 v248, v248, v250
    v_accvgpr_write_b32 a172, v245
    v_accvgpr_write_b32 a173, v246
    v_accvgpr_write_b32 a174, v247
    v_accvgpr_write_b32 a175, v248
    v_accvgpr_read_b32 v245, a196
    v_accvgpr_read_b32 v246, a197
    v_accvgpr_read_b32 v247, a198
    v_accvgpr_read_b32 v248, a199
    v_mul_f32 v245, v245, v250
    v_mul_f32 v246, v246, v250
    v_mul_f32 v247, v247, v250
    v_mul_f32 v248, v248, v250
    v_accvgpr_write_b32 a196, v245
    v_accvgpr_write_b32 a197, v246
    v_accvgpr_write_b32 a198, v247
    v_accvgpr_write_b32 a199, v248
    v_exp_f32 v245, v104
    v_exp_f32 v246, v105
    v_exp_f32 v247, v106
    v_cvt_pk_bf16_f32 v164, v245, v246
    v_exp_f32 v248, v107
    v_exp_f32 v245, v108
    v_exp_f32 v246, v109
    v_cvt_pk_bf16_f32 v165, v247, v248
    v_exp_f32 v247, v110
    v_cvt_pk_bf16_f32 v166, v245, v246
    v_exp_f32 v248, v111
    s_nop 0
    v_cvt_pk_bf16_f32 v167, v247, v248
    v_max3_f32 v249, v112, v113, v114
    v_max3_f32 v249, v249, v115, v116
    v_max3_f32 v249, v249, v117, v118
    v_max_f32 v249, v249, v119
    v_mov_b32 v245, v249
    s_nop 1
    v_permlane32_swap_b32 v249, v245
    v_max_f32 v249, v249, v245
    v_mov_b32 v245, v249
    s_nop 1
    v_permlane16_swap_b32 v249, v245
    v_max_f32 v249, v249, v245
    v_add_f32 v249, 0x40e00000, v249
    v_max_f32 v249, 0, v249
    v_sub_f32 v250, 0, v249
    v_exp_f32 v250, v250
    v_sub_f32 v112, v112, v249
    v_sub_f32 v113, v113, v249
    v_sub_f32 v114, v114, v249
    v_sub_f32 v115, v115, v249
    v_sub_f32 v116, v116, v249
    v_sub_f32 v117, v117, v249
    v_sub_f32 v118, v118, v249
    v_sub_f32 v119, v119, v249
    v_sub_f32 v144, v144, v249
    v_sub_f32 v145, v145, v249
    v_sub_f32 v146, v146, v249
    v_sub_f32 v147, v147, v249
    v_sub_f32 v148, v148, v249
    v_sub_f32 v149, v149, v249
    v_sub_f32 v150, v150, v249
    v_sub_f32 v151, v151, v249
    v_sub_f32 v200, v200, v249
    v_sub_f32 v201, v201, v249
    v_sub_f32 v202, v202, v249
    v_sub_f32 v203, v203, v249
    v_accvgpr_read_b32 v245, a16
    v_accvgpr_read_b32 v246, a17
    v_accvgpr_read_b32 v247, a18
    v_accvgpr_read_b32 v248, a19
    v_mul_f32 v245, v245, v250
    v_mul_f32 v246, v246, v250
    v_mul_f32 v247, v247, v250
    v_mul_f32 v248, v248, v250
    v_accvgpr_write_b32 a16, v245
    v_accvgpr_write_b32 a17, v246
    v_accvgpr_write_b32 a18, v247
    v_accvgpr_write_b32 a19, v248
    v_accvgpr_read_b32 v245, a20
    v_accvgpr_read_b32 v246, a21
    v_accvgpr_read_b32 v247, a22
    v_accvgpr_read_b32 v248, a23
    v_mul_f32 v245, v245, v250
    v_mul_f32 v246, v246, v250
    v_mul_f32 v247, v247, v250
    v_mul_f32 v248, v248, v250
    v_accvgpr_write_b32 a20, v245
    v_accvgpr_write_b32 a21, v246
    v_accvgpr_write_b32 a22, v247
    v_accvgpr_write_b32 a23, v248
    v_accvgpr_read_b32 v245, a48
    v_accvgpr_read_b32 v246, a49
    v_accvgpr_read_b32 v247, a50
    v_accvgpr_read_b32 v248, a51
    v_mul_f32 v245, v245, v250
    v_mul_f32 v246, v246, v250
    v_mul_f32 v247, v247, v250
    v_mul_f32 v248, v248, v250
    v_accvgpr_write_b32 a48, v245
    v_accvgpr_write_b32 a49, v246
    v_accvgpr_write_b32 a50, v247
    v_accvgpr_write_b32 a51, v248
    v_accvgpr_read_b32 v245, a52
    v_accvgpr_read_b32 v246, a53
    v_accvgpr_read_b32 v247, a54
    v_accvgpr_read_b32 v248, a55
    v_mul_f32 v245, v245, v250
    v_mul_f32 v246, v246, v250
    v_mul_f32 v247, v247, v250
    v_mul_f32 v248, v248, v250
    v_accvgpr_write_b32 a52, v245
    v_accvgpr_write_b32 a53, v246
    v_accvgpr_write_b32 a54, v247
    v_accvgpr_write_b32 a55, v248
    v_accvgpr_read_b32 v245, a80
    v_accvgpr_read_b32 v246, a81
    v_accvgpr_read_b32 v247, a82
    v_accvgpr_read_b32 v248, a83
    v_mul_f32 v245, v245, v250
    v_mul_f32 v246, v246, v250
    v_mul_f32 v247, v247, v250
    v_mul_f32 v248, v248, v250
    v_accvgpr_write_b32 a80, v245
    v_accvgpr_write_b32 a81, v246
    v_accvgpr_write_b32 a82, v247
    v_accvgpr_write_b32 a83, v248
    v_accvgpr_read_b32 v245, a84
    v_accvgpr_read_b32 v246, a85
    v_accvgpr_read_b32 v247, a86
    v_accvgpr_read_b32 v248, a87
    v_mul_f32 v245, v245, v250
    v_mul_f32 v246, v246, v250
    v_mul_f32 v247, v247, v250
    v_mul_f32 v248, v248, v250
    v_accvgpr_write_b32 a84, v245
    v_accvgpr_write_b32 a85, v246
    v_accvgpr_write_b32 a86, v247
    v_accvgpr_write_b32 a87, v248
    v_accvgpr_read_b32 v245, a112
    v_accvgpr_read_b32 v246, a113
    v_accvgpr_read_b32 v247, a114
    v_accvgpr_read_b32 v248, a115
    v_mul_f32 v245, v245, v250
    v_mul_f32 v246, v246, v250
    v_mul_f32 v247, v247, v250
    v_mul_f32 v248, v248, v250
    v_accvgpr_write_b32 a112, v245
    v_accvgpr_write_b32 a113, v246
    v_accvgpr_write_b32 a114, v247
    v_accvgpr_write_b32 a115, v248
    v_accvgpr_read_b32 v245, a116
    v_accvgpr_read_b32 v246, a117
    v_accvgpr_read_b32 v247, a118
    v_accvgpr_read_b32 v248, a119
    v_mul_f32 v245, v245, v250
    v_mul_f32 v246, v246, v250
    v_mul_f32 v247, v247, v250
    v_mul_f32 v248, v248, v250
    v_accvgpr_write_b32 a116, v245
    v_accvgpr_write_b32 a117, v246
    v_accvgpr_write_b32 a118, v247
    v_accvgpr_write_b32 a119, v248
    v_accvgpr_read_b32 v245, a144
    v_accvgpr_read_b32 v246, a145
    v_accvgpr_read_b32 v247, a146
    v_accvgpr_read_b32 v248, a147
    v_mul_f32 v245, v245, v250
    v_mul_f32 v246, v246, v250
    v_mul_f32 v247, v247, v250
    v_mul_f32 v248, v248, v250
    v_accvgpr_write_b32 a144, v245
    v_accvgpr_write_b32 a145, v246
    v_accvgpr_write_b32 a146, v247
    v_accvgpr_write_b32 a147, v248
    v_accvgpr_read_b32 v245, a148
    v_accvgpr_read_b32 v246, a149
    v_accvgpr_read_b32 v247, a150
    v_accvgpr_read_b32 v248, a151
    v_mul_f32 v245, v245, v250
    v_mul_f32 v246, v246, v250
    v_mul_f32 v247, v247, v250
    v_mul_f32 v248, v248, v250
    v_accvgpr_write_b32 a148, v245
    v_accvgpr_write_b32 a149, v246
    v_accvgpr_write_b32 a150, v247
    v_accvgpr_write_b32 a151, v248
    v_accvgpr_read_b32 v245, a176
    v_accvgpr_read_b32 v246, a177
    v_accvgpr_read_b32 v247, a178
    v_accvgpr_read_b32 v248, a179
    v_mul_f32 v245, v245, v250
    v_mul_f32 v246, v246, v250
    v_mul_f32 v247, v247, v250
    v_mul_f32 v248, v248, v250
    v_accvgpr_write_b32 a176, v245
    v_accvgpr_write_b32 a177, v246
    v_accvgpr_write_b32 a178, v247
    v_accvgpr_write_b32 a179, v248
    v_accvgpr_read_b32 v245, a180
    v_accvgpr_read_b32 v246, a181
    v_accvgpr_read_b32 v247, a182
    v_accvgpr_read_b32 v248, a183
    v_mul_f32 v245, v245, v250
    v_mul_f32 v246, v246, v250
    v_mul_f32 v247, v247, v250
    v_mul_f32 v248, v248, v250
    v_accvgpr_write_b32 a180, v245
    v_accvgpr_write_b32 a181, v246
    v_accvgpr_write_b32 a182, v247
    v_accvgpr_write_b32 a183, v248
    v_accvgpr_read_b32 v245, a200
    v_accvgpr_read_b32 v246, a201
    v_accvgpr_read_b32 v247, a202
    v_accvgpr_read_b32 v248, a203
    v_mul_f32 v245, v245, v250
    v_mul_f32 v246, v246, v250
    v_mul_f32 v247, v247, v250
    v_mul_f32 v248, v248, v250
    v_accvgpr_write_b32 a200, v245
    v_accvgpr_write_b32 a201, v246
    v_accvgpr_write_b32 a202, v247
    v_accvgpr_write_b32 a203, v248
    v_exp_f32 v245, v112
    v_exp_f32 v246, v113
    v_exp_f32 v247, v114
    v_cvt_pk_bf16_f32 v168, v245, v246
    v_exp_f32 v248, v115
    v_exp_f32 v245, v116
    v_exp_f32 v246, v117
    v_cvt_pk_bf16_f32 v169, v247, v248
    v_exp_f32 v247, v118
    v_cvt_pk_bf16_f32 v170, v245, v246
    v_exp_f32 v248, v119
    s_nop 0
    v_cvt_pk_bf16_f32 v171, v247, v248
    v_max3_f32 v249, v120, v121, v122
    v_max3_f32 v249, v249, v123, v124
    v_max3_f32 v249, v249, v125, v126
    v_max_f32 v249, v249, v127
    v_mov_b32 v245, v249
    s_nop 1
    v_permlane32_swap_b32 v249, v245
    v_max_f32 v249, v249, v245
    v_mov_b32 v245, v249
    s_nop 1
    v_permlane16_swap_b32 v249, v245
    v_max_f32 v249, v249, v245
    v_add_f32 v249, 0x40e00000, v249
    v_max_f32 v249, 0, v249
    v_sub_f32 v250, 0, v249
    v_exp_f32 v250, v250
    v_sub_f32 v120, v120, v249
    v_sub_f32 v121, v121, v249
    v_sub_f32 v122, v122, v249
    v_sub_f32 v123, v123, v249
    v_sub_f32 v124, v124, v249
    v_sub_f32 v125, v125, v249
    v_sub_f32 v126, v126, v249
    v_sub_f32 v127, v127, v249
    v_sub_f32 v152, v152, v249
    v_sub_f32 v153, v153, v249
    v_sub_f32 v154, v154, v249
    v_sub_f32 v155, v155, v249
    v_sub_f32 v156, v156, v249
    v_sub_f32 v157, v157, v249
    v_sub_f32 v158, v158, v249
    v_sub_f32 v159, v159, v249
    v_sub_f32 v204, v204, v249
    v_sub_f32 v205, v205, v249
    v_sub_f32 v206, v206, v249
    v_sub_f32 v207, v207, v249
    v_accvgpr_read_b32 v245, a24
    v_accvgpr_read_b32 v246, a25
    v_accvgpr_read_b32 v247, a26
    v_accvgpr_read_b32 v248, a27
    v_mul_f32 v245, v245, v250
    v_mul_f32 v246, v246, v250
    v_mul_f32 v247, v247, v250
    v_mul_f32 v248, v248, v250
    v_accvgpr_write_b32 a24, v245
    v_accvgpr_write_b32 a25, v246
    v_accvgpr_write_b32 a26, v247
    v_accvgpr_write_b32 a27, v248
    v_accvgpr_read_b32 v245, a28
    v_accvgpr_read_b32 v246, a29
    v_accvgpr_read_b32 v247, a30
    v_accvgpr_read_b32 v248, a31
    v_mul_f32 v245, v245, v250
    v_mul_f32 v246, v246, v250
    v_mul_f32 v247, v247, v250
    v_mul_f32 v248, v248, v250
    v_accvgpr_write_b32 a28, v245
    v_accvgpr_write_b32 a29, v246
    v_accvgpr_write_b32 a30, v247
    v_accvgpr_write_b32 a31, v248
    v_accvgpr_read_b32 v245, a56
    v_accvgpr_read_b32 v246, a57
    v_accvgpr_read_b32 v247, a58
    v_accvgpr_read_b32 v248, a59
    v_mul_f32 v245, v245, v250
    v_mul_f32 v246, v246, v250
    v_mul_f32 v247, v247, v250
    v_mul_f32 v248, v248, v250
    v_accvgpr_write_b32 a56, v245
    v_accvgpr_write_b32 a57, v246
    v_accvgpr_write_b32 a58, v247
    v_accvgpr_write_b32 a59, v248
    v_accvgpr_read_b32 v245, a60
    v_accvgpr_read_b32 v246, a61
    v_accvgpr_read_b32 v247, a62
    v_accvgpr_read_b32 v248, a63
    v_mul_f32 v245, v245, v250
    v_mul_f32 v246, v246, v250
    v_mul_f32 v247, v247, v250
    v_mul_f32 v248, v248, v250
    v_accvgpr_write_b32 a60, v245
    v_accvgpr_write_b32 a61, v246
    v_accvgpr_write_b32 a62, v247
    v_accvgpr_write_b32 a63, v248
    v_accvgpr_read_b32 v245, a88
    v_accvgpr_read_b32 v246, a89
    v_accvgpr_read_b32 v247, a90
    v_accvgpr_read_b32 v248, a91
    v_mul_f32 v245, v245, v250
    v_mul_f32 v246, v246, v250
    v_mul_f32 v247, v247, v250
    v_mul_f32 v248, v248, v250
    v_accvgpr_write_b32 a88, v245
    v_accvgpr_write_b32 a89, v246
    v_accvgpr_write_b32 a90, v247
    v_accvgpr_write_b32 a91, v248
    v_accvgpr_read_b32 v245, a92
    v_accvgpr_read_b32 v246, a93
    v_accvgpr_read_b32 v247, a94
    v_accvgpr_read_b32 v248, a95
    v_mul_f32 v245, v245, v250
    v_mul_f32 v246, v246, v250
    v_mul_f32 v247, v247, v250
    v_mul_f32 v248, v248, v250
    v_accvgpr_write_b32 a92, v245
    v_accvgpr_write_b32 a93, v246
    v_accvgpr_write_b32 a94, v247
    v_accvgpr_write_b32 a95, v248
    v_accvgpr_read_b32 v245, a120
    v_accvgpr_read_b32 v246, a121
    v_accvgpr_read_b32 v247, a122
    v_accvgpr_read_b32 v248, a123
    v_mul_f32 v245, v245, v250
    v_mul_f32 v246, v246, v250
    v_mul_f32 v247, v247, v250
    v_mul_f32 v248, v248, v250
    v_accvgpr_write_b32 a120, v245
    v_accvgpr_write_b32 a121, v246
    v_accvgpr_write_b32 a122, v247
    v_accvgpr_write_b32 a123, v248
    v_accvgpr_read_b32 v245, a124
    v_accvgpr_read_b32 v246, a125
    v_accvgpr_read_b32 v247, a126
    v_accvgpr_read_b32 v248, a127
    v_mul_f32 v245, v245, v250
    v_mul_f32 v246, v246, v250
    v_mul_f32 v247, v247, v250
    v_mul_f32 v248, v248, v250
    v_accvgpr_write_b32 a124, v245
    v_accvgpr_write_b32 a125, v246
    v_accvgpr_write_b32 a126, v247
    v_accvgpr_write_b32 a127, v248
    v_accvgpr_read_b32 v245, a152
    v_accvgpr_read_b32 v246, a153
    v_accvgpr_read_b32 v247, a154
    v_accvgpr_read_b32 v248, a155
    v_mul_f32 v245, v245, v250
    v_mul_f32 v246, v246, v250
    v_mul_f32 v247, v247, v250
    v_mul_f32 v248, v248, v250
    v_accvgpr_write_b32 a152, v245
    v_accvgpr_write_b32 a153, v246
    v_accvgpr_write_b32 a154, v247
    v_accvgpr_write_b32 a155, v248
    v_accvgpr_read_b32 v245, a156
    v_accvgpr_read_b32 v246, a157
    v_accvgpr_read_b32 v247, a158
    v_accvgpr_read_b32 v248, a159
    v_mul_f32 v245, v245, v250
    v_mul_f32 v246, v246, v250
    v_mul_f32 v247, v247, v250
    v_mul_f32 v248, v248, v250
    v_accvgpr_write_b32 a156, v245
    v_accvgpr_write_b32 a157, v246
    v_accvgpr_write_b32 a158, v247
    v_accvgpr_write_b32 a159, v248
    v_accvgpr_read_b32 v245, a184
    v_accvgpr_read_b32 v246, a185
    v_accvgpr_read_b32 v247, a186
    v_accvgpr_read_b32 v248, a187
    v_mul_f32 v245, v245, v250
    v_mul_f32 v246, v246, v250
    v_mul_f32 v247, v247, v250
    v_mul_f32 v248, v248, v250
    v_accvgpr_write_b32 a184, v245
    v_accvgpr_write_b32 a185, v246
    v_accvgpr_write_b32 a186, v247
    v_accvgpr_write_b32 a187, v248
    v_accvgpr_read_b32 v245, a188
    v_accvgpr_read_b32 v246, a189
    v_accvgpr_read_b32 v247, a190
    v_accvgpr_read_b32 v248, a191
    v_mul_f32 v245, v245, v250
    v_mul_f32 v246, v246, v250
    v_mul_f32 v247, v247, v250
    v_mul_f32 v248, v248, v250
    v_accvgpr_write_b32 a188, v245
    v_accvgpr_write_b32 a189, v246
    v_accvgpr_write_b32 a190, v247
    v_accvgpr_write_b32 a191, v248
    v_accvgpr_read_b32 v245, a204
    v_accvgpr_read_b32 v246, a205
    v_accvgpr_read_b32 v247, a206
    v_accvgpr_read_b32 v248, a207
    v_mul_f32 v245, v245, v250
    v_mul_f32 v246, v246, v250
    v_mul_f32 v247, v247, v250
    v_mul_f32 v248, v248, v250
    v_accvgpr_write_b32 a204, v245
    v_accvgpr_write_b32 a205, v246
    v_accvgpr_write_b32 a206, v247
    v_accvgpr_write_b32 a207, v248
    v_exp_f32 v245, v120
    v_exp_f32 v246, v121
    v_exp_f32 v247, v122
    v_cvt_pk_bf16_f32 v172, v245, v246
    v_exp_f32 v248, v123
    v_exp_f32 v245, v124
    v_exp_f32 v246, v125
    v_cvt_pk_bf16_f32 v173, v247, v248
    v_exp_f32 v247, v126
    v_cvt_pk_bf16_f32 v174, v245, v246
    v_exp_f32 v248, v127
    s_nop 0
    v_cvt_pk_bf16_f32 v175, v247, v248
    s_cmp_eq_u32 s39, 0
    s_cbranch_scc1 Lrare_L0_back
    s_cmp_eq_u32 s39, 1
    s_cbranch_scc1 Lrare_L2_back
    s_cmp_eq_u32 s39, 2
    s_cbranch_scc1 Lrare_L4_back
    s_cmp_eq_u32 s39, 3
    s_cbranch_scc1 Lrare_25_back
    s_cmp_eq_u32 s39, 4
    s_cbranch_scc1 Lrare_27_back
    s_branch Lrare_29_back
Lrare_f:
    s_mov_b32 s39, 0
    s_branch Lrareblk_1_0
Lrareblk_1_0:
    s_nop 7
    v_max3_f32 v249, v128, v129, v130
    v_max3_f32 v249, v249, v131, v132
    v_max3_f32 v249, v249, v133, v134
    v_max_f32 v249, v249, v135
    v_mov_b32 v245, v249
    s_nop 1
    v_permlane32_swap_b32 v249, v245
    v_max_f32 v249, v249, v245
    v_mov_b32 v245, v249
    s_nop 1
    v_permlane16_swap_b32 v249, v245
    v_max_f32 v249, v249, v245
    v_add_f32 v249, 0x40e00000, v249
    v_max_f32 v249, 0, v249
    v_sub_f32 v250, 0, v249
    v_exp_f32 v250, v250
    v_sub_f32 v128, v128, v249
    v_sub_f32 v129, v129, v249
    v_sub_f32 v130, v130, v249
    v_sub_f32 v131, v131, v249
    v_sub_f32 v132, v132, v249
    v_sub_f32 v133, v133, v249
    v_sub_f32 v134, v134, v249
    v_sub_f32 v135, v135, v249
    v_sub_f32 v192, v192, v249
    v_sub_f32 v193, v193, v249
    v_sub_f32 v194, v194, v249
    v_sub_f32 v195, v195, v249
    v_accvgpr_read_b32 v245, a0
    v_accvgpr_read_b32 v246, a1
    v_accvgpr_read_b32 v247, a2
    v_accvgpr_read_b32 v248, a3
    v_mul_f32 v245, v245, v250
    v_mul_f32 v246, v246, v250
    v_mul_f32 v247, v247, v250
    v_mul_f32 v248, v248, v250
    v_accvgpr_write_b32 a0, v245
    v_accvgpr_write_b32 a1, v246
    v_accvgpr_write_b32 a2, v247
    v_accvgpr_write_b32 a3, v248
    v_accvgpr_read_b32 v245, a4
    v_accvgpr_read_b32 v246, a5
    v_accvgpr_read_b32 v247, a6
    v_accvgpr_read_b32 v248, a7
    v_mul_f32 v245, v245, v250
    v_mul_f32 v246, v246, v250
    v_mul_f32 v247, v247, v250
    v_mul_f32 v248, v248, v250
    v_accvgpr_write_b32 a4, v245
    v_accvgpr_write_b32 a5, v246
    v_accvgpr_write_b32 a6, v247
    v_accvgpr_write_b32 a7, v248
    v_accvgpr_read_b32 v245, a32
    v_accvgpr_read_b32 v246, a33
    v_accvgpr_read_b32 v247, a34
    v_accvgpr_read_b32 v248, a35
    v_mul_f32 v245, v245, v250
    v_mul_f32 v246, v246, v250
    v_mul_f32 v247, v247, v250
    v_mul_f32 v248, v248, v250
    v_accvgpr_write_b32 a32, v245
    v_accvgpr_write_b32 a33, v246
    v_accvgpr_write_b32 a34, v247
    v_accvgpr_write_b32 a35, v248
    v_accvgpr_read_b32 v245, a36
    v_accvgpr_read_b32 v246, a37
    v_accvgpr_read_b32 v247, a38
    v_accvgpr_read_b32 v248, a39
    v_mul_f32 v245, v245, v250
    v_mul_f32 v246, v246, v250
    v_mul_f32 v247, v247, v250
    v_mul_f32 v248, v248, v250
    v_accvgpr_write_b32 a36, v245
    v_accvgpr_write_b32 a37, v246
    v_accvgpr_write_b32 a38, v247
    v_accvgpr_write_b32 a39, v248
    v_accvgpr_read_b32 v245, a64
    v_accvgpr_read_b32 v246, a65
    v_accvgpr_read_b32 v247, a66
    v_accvgpr_read_b32 v248, a67
    v_mul_f32 v245, v245, v250
    v_mul_f32 v246, v246, v250
    v_mul_f32 v247, v247, v250
    v_mul_f32 v248, v248, v250
    v_accvgpr_write_b32 a64, v245
    v_accvgpr_write_b32 a65, v246
    v_accvgpr_write_b32 a66, v247
    v_accvgpr_write_b32 a67, v248
    v_accvgpr_read_b32 v245, a68
    v_accvgpr_read_b32 v246, a69
    v_accvgpr_read_b32 v247, a70
    v_accvgpr_read_b32 v248, a71
    v_mul_f32 v245, v245, v250
    v_mul_f32 v246, v246, v250
    v_mul_f32 v247, v247, v250
    v_mul_f32 v248, v248, v250
    v_accvgpr_write_b32 a68, v245
    v_accvgpr_write_b32 a69, v246
    v_accvgpr_write_b32 a70, v247
    v_accvgpr_write_b32 a71, v248
    v_accvgpr_read_b32 v245, a96
    v_accvgpr_read_b32 v246, a97
    v_accvgpr_read_b32 v247, a98
    v_accvgpr_read_b32 v248, a99
    v_mul_f32 v245, v245, v250
    v_mul_f32 v246, v246, v250
    v_mul_f32 v247, v247, v250
    v_mul_f32 v248, v248, v250
    v_accvgpr_write_b32 a96, v245
    v_accvgpr_write_b32 a97, v246
    v_accvgpr_write_b32 a98, v247
    v_accvgpr_write_b32 a99, v248
    v_accvgpr_read_b32 v245, a100
    v_accvgpr_read_b32 v246, a101
    v_accvgpr_read_b32 v247, a102
    v_accvgpr_read_b32 v248, a103
    v_mul_f32 v245, v245, v250
    v_mul_f32 v246, v246, v250
    v_mul_f32 v247, v247, v250
    v_mul_f32 v248, v248, v250
    v_accvgpr_write_b32 a100, v245
    v_accvgpr_write_b32 a101, v246
    v_accvgpr_write_b32 a102, v247
    v_accvgpr_write_b32 a103, v248
    v_accvgpr_read_b32 v245, a128
    v_accvgpr_read_b32 v246, a129
    v_accvgpr_read_b32 v247, a130
    v_accvgpr_read_b32 v248, a131
    v_mul_f32 v245, v245, v250
    v_mul_f32 v246, v246, v250
    v_mul_f32 v247, v247, v250
    v_mul_f32 v248, v248, v250
    v_accvgpr_write_b32 a128, v245
    v_accvgpr_write_b32 a129, v246
    v_accvgpr_write_b32 a130, v247
    v_accvgpr_write_b32 a131, v248
    v_accvgpr_read_b32 v245, a132
    v_accvgpr_read_b32 v246, a133
    v_accvgpr_read_b32 v247, a134
    v_accvgpr_read_b32 v248, a135
    v_mul_f32 v245, v245, v250
    v_mul_f32 v246, v246, v250
    v_mul_f32 v247, v247, v250
    v_mul_f32 v248, v248, v250
    v_accvgpr_write_b32 a132, v245
    v_accvgpr_write_b32 a133, v246
    v_accvgpr_write_b32 a134, v247
    v_accvgpr_write_b32 a135, v248
    v_accvgpr_read_b32 v245, a160
    v_accvgpr_read_b32 v246, a161
    v_accvgpr_read_b32 v247, a162
    v_accvgpr_read_b32 v248, a163
    v_mul_f32 v245, v245, v250
    v_mul_f32 v246, v246, v250
    v_mul_f32 v247, v247, v250
    v_mul_f32 v248, v248, v250
    v_accvgpr_write_b32 a160, v245
    v_accvgpr_write_b32 a161, v246
    v_accvgpr_write_b32 a162, v247
    v_accvgpr_write_b32 a163, v248
    v_accvgpr_read_b32 v245, a164
    v_accvgpr_read_b32 v246, a165
    v_accvgpr_read_b32 v247, a166
    v_accvgpr_read_b32 v248, a167
    v_mul_f32 v245, v245, v250
    v_mul_f32 v246, v246, v250
    v_mul_f32 v247, v247, v250
    v_mul_f32 v248, v248, v250
    v_accvgpr_write_b32 a164, v245
    v_accvgpr_write_b32 a165, v246
    v_accvgpr_write_b32 a166, v247
    v_accvgpr_write_b32 a167, v248
    v_accvgpr_read_b32 v245, a192
    v_accvgpr_read_b32 v246, a193
    v_accvgpr_read_b32 v247, a194
    v_accvgpr_read_b32 v248, a195
    v_mul_f32 v245, v245, v250
    v_mul_f32 v246, v246, v250
    v_mul_f32 v247, v247, v250
    v_mul_f32 v248, v248, v250
    v_accvgpr_write_b32 a192, v245
    v_accvgpr_write_b32 a193, v246
    v_accvgpr_write_b32 a194, v247
    v_accvgpr_write_b32 a195, v248
    v_exp_f32 v245, v128
    v_exp_f32 v246, v129
    v_exp_f32 v247, v130
    v_cvt_pk_bf16_f32 v176, v245, v246
    v_exp_f32 v248, v131
    v_exp_f32 v245, v132
    v_exp_f32 v246, v133
    v_cvt_pk_bf16_f32 v177, v247, v248
    v_exp_f32 v247, v134
    v_cvt_pk_bf16_f32 v178, v245, v246
    v_exp_f32 v248, v135
    s_nop 0
    v_cvt_pk_bf16_f32 v179, v247, v248
    v_max3_f32 v249, v136, v137, v138
    v_max3_f32 v249, v249, v139, v140
    v_max3_f32 v249, v249, v141, v142
    v_max_f32 v249, v249, v143
    v_mov_b32 v245, v249
    s_nop 1
    v_permlane32_swap_b32 v249, v245
    v_max_f32 v249, v249, v245
    v_mov_b32 v245, v249
    s_nop 1
    v_permlane16_swap_b32 v249, v245
    v_max_f32 v249, v249, v245
    v_add_f32 v249, 0x40e00000, v249
    v_max_f32 v249, 0, v249
    v_sub_f32 v250, 0, v249
    v_exp_f32 v250, v250
    v_sub_f32 v136, v136, v249
    v_sub_f32 v137, v137, v249
    v_sub_f32 v138, v138, v249
    v_sub_f32 v139, v139, v249
    v_sub_f32 v140, v140, v249
    v_sub_f32 v141, v141, v249
    v_sub_f32 v142, v142, v249
    v_sub_f32 v143, v143, v249
    v_sub_f32 v196, v196, v249
    v_sub_f32 v197, v197, v249
    v_sub_f32 v198, v198, v249
    v_sub_f32 v199, v199, v249
    v_accvgpr_read_b32 v245, a8
    v_accvgpr_read_b32 v246, a9
    v_accvgpr_read_b32 v247, a10
    v_accvgpr_read_b32 v248, a11
    v_mul_f32 v245, v245, v250
    v_mul_f32 v246, v246, v250
    v_mul_f32 v247, v247, v250
    v_mul_f32 v248, v248, v250
    v_accvgpr_write_b32 a8, v245
    v_accvgpr_write_b32 a9, v246
    v_accvgpr_write_b32 a10, v247
    v_accvgpr_write_b32 a11, v248
    v_accvgpr_read_b32 v245, a12
    v_accvgpr_read_b32 v246, a13
    v_accvgpr_read_b32 v247, a14
    v_accvgpr_read_b32 v248, a15
    v_mul_f32 v245, v245, v250
    v_mul_f32 v246, v246, v250
    v_mul_f32 v247, v247, v250
    v_mul_f32 v248, v248, v250
    v_accvgpr_write_b32 a12, v245
    v_accvgpr_write_b32 a13, v246
    v_accvgpr_write_b32 a14, v247
    v_accvgpr_write_b32 a15, v248
    v_accvgpr_read_b32 v245, a40
    v_accvgpr_read_b32 v246, a41
    v_accvgpr_read_b32 v247, a42
    v_accvgpr_read_b32 v248, a43
    v_mul_f32 v245, v245, v250
    v_mul_f32 v246, v246, v250
    v_mul_f32 v247, v247, v250
    v_mul_f32 v248, v248, v250
    v_accvgpr_write_b32 a40, v245
    v_accvgpr_write_b32 a41, v246
    v_accvgpr_write_b32 a42, v247
    v_accvgpr_write_b32 a43, v248
    v_accvgpr_read_b32 v245, a44
    v_accvgpr_read_b32 v246, a45
    v_accvgpr_read_b32 v247, a46
    v_accvgpr_read_b32 v248, a47
    v_mul_f32 v245, v245, v250
    v_mul_f32 v246, v246, v250
    v_mul_f32 v247, v247, v250
    v_mul_f32 v248, v248, v250
    v_accvgpr_write_b32 a44, v245
    v_accvgpr_write_b32 a45, v246
    v_accvgpr_write_b32 a46, v247
    v_accvgpr_write_b32 a47, v248
    v_accvgpr_read_b32 v245, a72
    v_accvgpr_read_b32 v246, a73
    v_accvgpr_read_b32 v247, a74
    v_accvgpr_read_b32 v248, a75
    v_mul_f32 v245, v245, v250
    v_mul_f32 v246, v246, v250
    v_mul_f32 v247, v247, v250
    v_mul_f32 v248, v248, v250
    v_accvgpr_write_b32 a72, v245
    v_accvgpr_write_b32 a73, v246
    v_accvgpr_write_b32 a74, v247
    v_accvgpr_write_b32 a75, v248
    v_accvgpr_read_b32 v245, a76
    v_accvgpr_read_b32 v246, a77
    v_accvgpr_read_b32 v247, a78
    v_accvgpr_read_b32 v248, a79
    v_mul_f32 v245, v245, v250
    v_mul_f32 v246, v246, v250
    v_mul_f32 v247, v247, v250
    v_mul_f32 v248, v248, v250
    v_accvgpr_write_b32 a76, v245
    v_accvgpr_write_b32 a77, v246
    v_accvgpr_write_b32 a78, v247
    v_accvgpr_write_b32 a79, v248
    v_accvgpr_read_b32 v245, a104
    v_accvgpr_read_b32 v246, a105
    v_accvgpr_read_b32 v247, a106
    v_accvgpr_read_b32 v248, a107
    v_mul_f32 v245, v245, v250
    v_mul_f32 v246, v246, v250
    v_mul_f32 v247, v247, v250
    v_mul_f32 v248, v248, v250
    v_accvgpr_write_b32 a104, v245
    v_accvgpr_write_b32 a105, v246
    v_accvgpr_write_b32 a106, v247
    v_accvgpr_write_b32 a107, v248
    v_accvgpr_read_b32 v245, a108
    v_accvgpr_read_b32 v246, a109
    v_accvgpr_read_b32 v247, a110
    v_accvgpr_read_b32 v248, a111
    v_mul_f32 v245, v245, v250
    v_mul_f32 v246, v246, v250
    v_mul_f32 v247, v247, v250
    v_mul_f32 v248, v248, v250
    v_accvgpr_write_b32 a108, v245
    v_accvgpr_write_b32 a109, v246
    v_accvgpr_write_b32 a110, v247
    v_accvgpr_write_b32 a111, v248
    v_accvgpr_read_b32 v245, a136
    v_accvgpr_read_b32 v246, a137
    v_accvgpr_read_b32 v247, a138
    v_accvgpr_read_b32 v248, a139
    v_mul_f32 v245, v245, v250
    v_mul_f32 v246, v246, v250
    v_mul_f32 v247, v247, v250
    v_mul_f32 v248, v248, v250
    v_accvgpr_write_b32 a136, v245
    v_accvgpr_write_b32 a137, v246
    v_accvgpr_write_b32 a138, v247
    v_accvgpr_write_b32 a139, v248
    v_accvgpr_read_b32 v245, a140
    v_accvgpr_read_b32 v246, a141
    v_accvgpr_read_b32 v247, a142
    v_accvgpr_read_b32 v248, a143
    v_mul_f32 v245, v245, v250
    v_mul_f32 v246, v246, v250
    v_mul_f32 v247, v247, v250
    v_mul_f32 v248, v248, v250
    v_accvgpr_write_b32 a140, v245
    v_accvgpr_write_b32 a141, v246
    v_accvgpr_write_b32 a142, v247
    v_accvgpr_write_b32 a143, v248
    v_accvgpr_read_b32 v245, a168
    v_accvgpr_read_b32 v246, a169
    v_accvgpr_read_b32 v247, a170
    v_accvgpr_read_b32 v248, a171
    v_mul_f32 v245, v245, v250
    v_mul_f32 v246, v246, v250
    v_mul_f32 v247, v247, v250
    v_mul_f32 v248, v248, v250
    v_accvgpr_write_b32 a168, v245
    v_accvgpr_write_b32 a169, v246
    v_accvgpr_write_b32 a170, v247
    v_accvgpr_write_b32 a171, v248
    v_accvgpr_read_b32 v245, a172
    v_accvgpr_read_b32 v246, a173
    v_accvgpr_read_b32 v247, a174
    v_accvgpr_read_b32 v248, a175
    v_mul_f32 v245, v245, v250
    v_mul_f32 v246, v246, v250
    v_mul_f32 v247, v247, v250
    v_mul_f32 v248, v248, v250
    v_accvgpr_write_b32 a172, v245
    v_accvgpr_write_b32 a173, v246
    v_accvgpr_write_b32 a174, v247
    v_accvgpr_write_b32 a175, v248
    v_accvgpr_read_b32 v245, a196
    v_accvgpr_read_b32 v246, a197
    v_accvgpr_read_b32 v247, a198
    v_accvgpr_read_b32 v248, a199
    v_mul_f32 v245, v245, v250
    v_mul_f32 v246, v246, v250
    v_mul_f32 v247, v247, v250
    v_mul_f32 v248, v248, v250
    v_accvgpr_write_b32 a196, v245
    v_accvgpr_write_b32 a197, v246
    v_accvgpr_write_b32 a198, v247
    v_accvgpr_write_b32 a199, v248
    v_exp_f32 v245, v136
    v_exp_f32 v246, v137
    v_exp_f32 v247, v138
    v_cvt_pk_bf16_f32 v180, v245, v246
    v_exp_f32 v248, v139
    v_exp_f32 v245, v140
    v_exp_f32 v246, v141
    v_cvt_pk_bf16_f32 v181, v247, v248
    v_exp_f32 v247, v142
    v_cvt_pk_bf16_f32 v182, v245, v246
    v_exp_f32 v248, v143
    s_nop 0
    v_cvt_pk_bf16_f32 v183, v247, v248
    v_max3_f32 v249, v144, v145, v146
    v_max3_f32 v249, v249, v147, v148
    v_max3_f32 v249, v249, v149, v150
    v_max_f32 v249, v249, v151
    v_mov_b32 v245, v249
    s_nop 1
    v_permlane32_swap_b32 v249, v245
    v_max_f32 v249, v249, v245
    v_mov_b32 v245, v249
    s_nop 1
    v_permlane16_swap_b32 v249, v245
    v_max_f32 v249, v249, v245
    v_add_f32 v249, 0x40e00000, v249
    v_max_f32 v249, 0, v249
    v_sub_f32 v250, 0, v249
    v_exp_f32 v250, v250
    v_sub_f32 v144, v144, v249
    v_sub_f32 v145, v145, v249
    v_sub_f32 v146, v146, v249
    v_sub_f32 v147, v147, v249
    v_sub_f32 v148, v148, v249
    v_sub_f32 v149, v149, v249
    v_sub_f32 v150, v150, v249
    v_sub_f32 v151, v151, v249
    v_sub_f32 v200, v200, v249
    v_sub_f32 v201, v201, v249
    v_sub_f32 v202, v202, v249
    v_sub_f32 v203, v203, v249
    v_accvgpr_read_b32 v245, a16
    v_accvgpr_read_b32 v246, a17
    v_accvgpr_read_b32 v247, a18
    v_accvgpr_read_b32 v248, a19
    v_mul_f32 v245, v245, v250
    v_mul_f32 v246, v246, v250
    v_mul_f32 v247, v247, v250
    v_mul_f32 v248, v248, v250
    v_accvgpr_write_b32 a16, v245
    v_accvgpr_write_b32 a17, v246
    v_accvgpr_write_b32 a18, v247
    v_accvgpr_write_b32 a19, v248
    v_accvgpr_read_b32 v245, a20
    v_accvgpr_read_b32 v246, a21
    v_accvgpr_read_b32 v247, a22
    v_accvgpr_read_b32 v248, a23
    v_mul_f32 v245, v245, v250
    v_mul_f32 v246, v246, v250
    v_mul_f32 v247, v247, v250
    v_mul_f32 v248, v248, v250
    v_accvgpr_write_b32 a20, v245
    v_accvgpr_write_b32 a21, v246
    v_accvgpr_write_b32 a22, v247
    v_accvgpr_write_b32 a23, v248
    v_accvgpr_read_b32 v245, a48
    v_accvgpr_read_b32 v246, a49
    v_accvgpr_read_b32 v247, a50
    v_accvgpr_read_b32 v248, a51
    v_mul_f32 v245, v245, v250
    v_mul_f32 v246, v246, v250
    v_mul_f32 v247, v247, v250
    v_mul_f32 v248, v248, v250
    v_accvgpr_write_b32 a48, v245
    v_accvgpr_write_b32 a49, v246
    v_accvgpr_write_b32 a50, v247
    v_accvgpr_write_b32 a51, v248
    v_accvgpr_read_b32 v245, a52
    v_accvgpr_read_b32 v246, a53
    v_accvgpr_read_b32 v247, a54
    v_accvgpr_read_b32 v248, a55
    v_mul_f32 v245, v245, v250
    v_mul_f32 v246, v246, v250
    v_mul_f32 v247, v247, v250
    v_mul_f32 v248, v248, v250
    v_accvgpr_write_b32 a52, v245
    v_accvgpr_write_b32 a53, v246
    v_accvgpr_write_b32 a54, v247
    v_accvgpr_write_b32 a55, v248
    v_accvgpr_read_b32 v245, a80
    v_accvgpr_read_b32 v246, a81
    v_accvgpr_read_b32 v247, a82
    v_accvgpr_read_b32 v248, a83
    v_mul_f32 v245, v245, v250
    v_mul_f32 v246, v246, v250
    v_mul_f32 v247, v247, v250
    v_mul_f32 v248, v248, v250
    v_accvgpr_write_b32 a80, v245
    v_accvgpr_write_b32 a81, v246
    v_accvgpr_write_b32 a82, v247
    v_accvgpr_write_b32 a83, v248
    v_accvgpr_read_b32 v245, a84
    v_accvgpr_read_b32 v246, a85
    v_accvgpr_read_b32 v247, a86
    v_accvgpr_read_b32 v248, a87
    v_mul_f32 v245, v245, v250
    v_mul_f32 v246, v246, v250
    v_mul_f32 v247, v247, v250
    v_mul_f32 v248, v248, v250
    v_accvgpr_write_b32 a84, v245
    v_accvgpr_write_b32 a85, v246
    v_accvgpr_write_b32 a86, v247
    v_accvgpr_write_b32 a87, v248
    v_accvgpr_read_b32 v245, a112
    v_accvgpr_read_b32 v246, a113
    v_accvgpr_read_b32 v247, a114
    v_accvgpr_read_b32 v248, a115
    v_mul_f32 v245, v245, v250
    v_mul_f32 v246, v246, v250
    v_mul_f32 v247, v247, v250
    v_mul_f32 v248, v248, v250
    v_accvgpr_write_b32 a112, v245
    v_accvgpr_write_b32 a113, v246
    v_accvgpr_write_b32 a114, v247
    v_accvgpr_write_b32 a115, v248
    v_accvgpr_read_b32 v245, a116
    v_accvgpr_read_b32 v246, a117
    v_accvgpr_read_b32 v247, a118
    v_accvgpr_read_b32 v248, a119
    v_mul_f32 v245, v245, v250
    v_mul_f32 v246, v246, v250
    v_mul_f32 v247, v247, v250
    v_mul_f32 v248, v248, v250
    v_accvgpr_write_b32 a116, v245
    v_accvgpr_write_b32 a117, v246
    v_accvgpr_write_b32 a118, v247
    v_accvgpr_write_b32 a119, v248
    v_accvgpr_read_b32 v245, a144
    v_accvgpr_read_b32 v246, a145
    v_accvgpr_read_b32 v247, a146
    v_accvgpr_read_b32 v248, a147
    v_mul_f32 v245, v245, v250
    v_mul_f32 v246, v246, v250
    v_mul_f32 v247, v247, v250
    v_mul_f32 v248, v248, v250
    v_accvgpr_write_b32 a144, v245
    v_accvgpr_write_b32 a145, v246
    v_accvgpr_write_b32 a146, v247
    v_accvgpr_write_b32 a147, v248
    v_accvgpr_read_b32 v245, a148
    v_accvgpr_read_b32 v246, a149
    v_accvgpr_read_b32 v247, a150
    v_accvgpr_read_b32 v248, a151
    v_mul_f32 v245, v245, v250
    v_mul_f32 v246, v246, v250
    v_mul_f32 v247, v247, v250
    v_mul_f32 v248, v248, v250
    v_accvgpr_write_b32 a148, v245
    v_accvgpr_write_b32 a149, v246
    v_accvgpr_write_b32 a150, v247
    v_accvgpr_write_b32 a151, v248
    v_accvgpr_read_b32 v245, a176
    v_accvgpr_read_b32 v246, a177
    v_accvgpr_read_b32 v247, a178
    v_accvgpr_read_b32 v248, a179
    v_mul_f32 v245, v245, v250
    v_mul_f32 v246, v246, v250
    v_mul_f32 v247, v247, v250
    v_mul_f32 v248, v248, v250
    v_accvgpr_write_b32 a176, v245
    v_accvgpr_write_b32 a177, v246
    v_accvgpr_write_b32 a178, v247
    v_accvgpr_write_b32 a179, v248
    v_accvgpr_read_b32 v245, a180
    v_accvgpr_read_b32 v246, a181
    v_accvgpr_read_b32 v247, a182
    v_accvgpr_read_b32 v248, a183
    v_mul_f32 v245, v245, v250
    v_mul_f32 v246, v246, v250
    v_mul_f32 v247, v247, v250
    v_mul_f32 v248, v248, v250
    v_accvgpr_write_b32 a180, v245
    v_accvgpr_write_b32 a181, v246
    v_accvgpr_write_b32 a182, v247
    v_accvgpr_write_b32 a183, v248
    v_accvgpr_read_b32 v245, a200
    v_accvgpr_read_b32 v246, a201
    v_accvgpr_read_b32 v247, a202
    v_accvgpr_read_b32 v248, a203
    v_mul_f32 v245, v245, v250
    v_mul_f32 v246, v246, v250
    v_mul_f32 v247, v247, v250
    v_mul_f32 v248, v248, v250
    v_accvgpr_write_b32 a200, v245
    v_accvgpr_write_b32 a201, v246
    v_accvgpr_write_b32 a202, v247
    v_accvgpr_write_b32 a203, v248
    v_exp_f32 v245, v144
    v_exp_f32 v246, v145
    v_exp_f32 v247, v146
    v_cvt_pk_bf16_f32 v184, v245, v246
    v_exp_f32 v248, v147
    v_exp_f32 v245, v148
    v_exp_f32 v246, v149
    v_cvt_pk_bf16_f32 v185, v247, v248
    v_exp_f32 v247, v150
    v_cvt_pk_bf16_f32 v186, v245, v246
    v_exp_f32 v248, v151
    s_nop 0
    v_cvt_pk_bf16_f32 v187, v247, v248
    v_max3_f32 v249, v152, v153, v154
    v_max3_f32 v249, v249, v155, v156
    v_max3_f32 v249, v249, v157, v158
    v_max_f32 v249, v249, v159
    v_mov_b32 v245, v249
    s_nop 1
    v_permlane32_swap_b32 v249, v245
    v_max_f32 v249, v249, v245
    v_mov_b32 v245, v249
    s_nop 1
    v_permlane16_swap_b32 v249, v245
    v_max_f32 v249, v249, v245
    v_add_f32 v249, 0x40e00000, v249
    v_max_f32 v249, 0, v249
    v_sub_f32 v250, 0, v249
    v_exp_f32 v250, v250
    v_sub_f32 v152, v152, v249
    v_sub_f32 v153, v153, v249
    v_sub_f32 v154, v154, v249
    v_sub_f32 v155, v155, v249
    v_sub_f32 v156, v156, v249
    v_sub_f32 v157, v157, v249
    v_sub_f32 v158, v158, v249
    v_sub_f32 v159, v159, v249
    v_sub_f32 v204, v204, v249
    v_sub_f32 v205, v205, v249
    v_sub_f32 v206, v206, v249
    v_sub_f32 v207, v207, v249
    v_accvgpr_read_b32 v245, a24
    v_accvgpr_read_b32 v246, a25
    v_accvgpr_read_b32 v247, a26
    v_accvgpr_read_b32 v248, a27
    v_mul_f32 v245, v245, v250
    v_mul_f32 v246, v246, v250
    v_mul_f32 v247, v247, v250
    v_mul_f32 v248, v248, v250
    v_accvgpr_write_b32 a24, v245
    v_accvgpr_write_b32 a25, v246
    v_accvgpr_write_b32 a26, v247
    v_accvgpr_write_b32 a27, v248
    v_accvgpr_read_b32 v245, a28
    v_accvgpr_read_b32 v246, a29
    v_accvgpr_read_b32 v247, a30
    v_accvgpr_read_b32 v248, a31
    v_mul_f32 v245, v245, v250
    v_mul_f32 v246, v246, v250
    v_mul_f32 v247, v247, v250
    v_mul_f32 v248, v248, v250
    v_accvgpr_write_b32 a28, v245
    v_accvgpr_write_b32 a29, v246
    v_accvgpr_write_b32 a30, v247
    v_accvgpr_write_b32 a31, v248
    v_accvgpr_read_b32 v245, a56
    v_accvgpr_read_b32 v246, a57
    v_accvgpr_read_b32 v247, a58
    v_accvgpr_read_b32 v248, a59
    v_mul_f32 v245, v245, v250
    v_mul_f32 v246, v246, v250
    v_mul_f32 v247, v247, v250
    v_mul_f32 v248, v248, v250
    v_accvgpr_write_b32 a56, v245
    v_accvgpr_write_b32 a57, v246
    v_accvgpr_write_b32 a58, v247
    v_accvgpr_write_b32 a59, v248
    v_accvgpr_read_b32 v245, a60
    v_accvgpr_read_b32 v246, a61
    v_accvgpr_read_b32 v247, a62
    v_accvgpr_read_b32 v248, a63
    v_mul_f32 v245, v245, v250
    v_mul_f32 v246, v246, v250
    v_mul_f32 v247, v247, v250
    v_mul_f32 v248, v248, v250
    v_accvgpr_write_b32 a60, v245
    v_accvgpr_write_b32 a61, v246
    v_accvgpr_write_b32 a62, v247
    v_accvgpr_write_b32 a63, v248
    v_accvgpr_read_b32 v245, a88
    v_accvgpr_read_b32 v246, a89
    v_accvgpr_read_b32 v247, a90
    v_accvgpr_read_b32 v248, a91
    v_mul_f32 v245, v245, v250
    v_mul_f32 v246, v246, v250
    v_mul_f32 v247, v247, v250
    v_mul_f32 v248, v248, v250
    v_accvgpr_write_b32 a88, v245
    v_accvgpr_write_b32 a89, v246
    v_accvgpr_write_b32 a90, v247
    v_accvgpr_write_b32 a91, v248
    v_accvgpr_read_b32 v245, a92
    v_accvgpr_read_b32 v246, a93
    v_accvgpr_read_b32 v247, a94
    v_accvgpr_read_b32 v248, a95
    v_mul_f32 v245, v245, v250
    v_mul_f32 v246, v246, v250
    v_mul_f32 v247, v247, v250
    v_mul_f32 v248, v248, v250
    v_accvgpr_write_b32 a92, v245
    v_accvgpr_write_b32 a93, v246
    v_accvgpr_write_b32 a94, v247
    v_accvgpr_write_b32 a95, v248
    v_accvgpr_read_b32 v245, a120
    v_accvgpr_read_b32 v246, a121
    v_accvgpr_read_b32 v247, a122
    v_accvgpr_read_b32 v248, a123
    v_mul_f32 v245, v245, v250
    v_mul_f32 v246, v246, v250
    v_mul_f32 v247, v247, v250
    v_mul_f32 v248, v248, v250
    v_accvgpr_write_b32 a120, v245
    v_accvgpr_write_b32 a121, v246
    v_accvgpr_write_b32 a122, v247
    v_accvgpr_write_b32 a123, v248
    v_accvgpr_read_b32 v245, a124
    v_accvgpr_read_b32 v246, a125
    v_accvgpr_read_b32 v247, a126
    v_accvgpr_read_b32 v248, a127
    v_mul_f32 v245, v245, v250
    v_mul_f32 v246, v246, v250
    v_mul_f32 v247, v247, v250
    v_mul_f32 v248, v248, v250
    v_accvgpr_write_b32 a124, v245
    v_accvgpr_write_b32 a125, v246
    v_accvgpr_write_b32 a126, v247
    v_accvgpr_write_b32 a127, v248
    v_accvgpr_read_b32 v245, a152
    v_accvgpr_read_b32 v246, a153
    v_accvgpr_read_b32 v247, a154
    v_accvgpr_read_b32 v248, a155
    v_mul_f32 v245, v245, v250
    v_mul_f32 v246, v246, v250
    v_mul_f32 v247, v247, v250
    v_mul_f32 v248, v248, v250
    v_accvgpr_write_b32 a152, v245
    v_accvgpr_write_b32 a153, v246
    v_accvgpr_write_b32 a154, v247
    v_accvgpr_write_b32 a155, v248
    v_accvgpr_read_b32 v245, a156
    v_accvgpr_read_b32 v246, a157
    v_accvgpr_read_b32 v247, a158
    v_accvgpr_read_b32 v248, a159
    v_mul_f32 v245, v245, v250
    v_mul_f32 v246, v246, v250
    v_mul_f32 v247, v247, v250
    v_mul_f32 v248, v248, v250
    v_accvgpr_write_b32 a156, v245
    v_accvgpr_write_b32 a157, v246
    v_accvgpr_write_b32 a158, v247
    v_accvgpr_write_b32 a159, v248
    v_accvgpr_read_b32 v245, a184
    v_accvgpr_read_b32 v246, a185
    v_accvgpr_read_b32 v247, a186
    v_accvgpr_read_b32 v248, a187
    v_mul_f32 v245, v245, v250
    v_mul_f32 v246, v246, v250
    v_mul_f32 v247, v247, v250
    v_mul_f32 v248, v248, v250
    v_accvgpr_write_b32 a184, v245
    v_accvgpr_write_b32 a185, v246
    v_accvgpr_write_b32 a186, v247
    v_accvgpr_write_b32 a187, v248
    v_accvgpr_read_b32 v245, a188
    v_accvgpr_read_b32 v246, a189
    v_accvgpr_read_b32 v247, a190
    v_accvgpr_read_b32 v248, a191
    v_mul_f32 v245, v245, v250
    v_mul_f32 v246, v246, v250
    v_mul_f32 v247, v247, v250
    v_mul_f32 v248, v248, v250
    v_accvgpr_write_b32 a188, v245
    v_accvgpr_write_b32 a189, v246
    v_accvgpr_write_b32 a190, v247
    v_accvgpr_write_b32 a191, v248
    v_accvgpr_read_b32 v245, a204
    v_accvgpr_read_b32 v246, a205
    v_accvgpr_read_b32 v247, a206
    v_accvgpr_read_b32 v248, a207
    v_mul_f32 v245, v245, v250
    v_mul_f32 v246, v246, v250
    v_mul_f32 v247, v247, v250
    v_mul_f32 v248, v248, v250
    v_accvgpr_write_b32 a204, v245
    v_accvgpr_write_b32 a205, v246
    v_accvgpr_write_b32 a206, v247
    v_accvgpr_write_b32 a207, v248
    v_exp_f32 v245, v152
    v_exp_f32 v246, v153
    v_exp_f32 v247, v154
    v_cvt_pk_bf16_f32 v188, v245, v246
    v_exp_f32 v248, v155
    v_exp_f32 v245, v156
    v_exp_f32 v246, v157
    v_cvt_pk_bf16_f32 v189, v247, v248
    v_exp_f32 v247, v158
    v_cvt_pk_bf16_f32 v190, v245, v246
    v_exp_f32 v248, v159
    s_nop 0
    v_cvt_pk_bf16_f32 v191, v247, v248
    s_branch Lrare_f_back
.section .rodata,"a"
.p2align 6
.amdhsa_kernel concat_heads__gqa_block_cached__gqa_block_cached__near_ridge_kernel
  .amdhsa_next_free_vgpr 512
  .amdhsa_next_free_sgpr 102
  .amdhsa_accum_offset 256
  .amdhsa_group_segment_fixed_size 0
  .amdhsa_kernarg_size 104
  .amdhsa_user_sgpr_count 2
  .amdhsa_user_sgpr_kernarg_segment_ptr 1
  .amdhsa_system_sgpr_workgroup_id_x 1
.end_amdhsa_kernel
```
